```python
import torch

def _softmax(x, axis=-1):
    return torch.softmax(x, dim=axis)
def _gelu(x):
    return torch.nn.functional.gelu(x, approximate="tanh")
def _silu(x):
    return torch.nn.functional.silu(x)
def _sigmoid(x):
    return torch.sigmoid(x)
def _layernorm(x, axis=-1, eps=1e-5):
    m = x.mean(dim=axis, keepdim=True)
    v = x.var(dim=axis, keepdim=True, unbiased=False)
    return (x - m) / torch.sqrt(v + eps)
def _scatter_add(tgt, idx, src, axis=0):
    return tgt.clone().index_add_(axis, idx, src)
def _segment_sum(src, seg, n):
    out = torch.zeros((n,) + src.shape[1:], dtype=src.dtype)
    return out.index_add_(0, seg, src)
def _pad(x, pw):
    flat = tuple(v for pair in reversed(pw) for v in pair)
    return torch.nn.functional.pad(x, flat)

kernel_name = 'interleave_layers__spectral_gfnet__mixer_channel_mlp__prompt'

def setup_inputs():

    _w = (lambda a: (lambda t: t.to(torch.bfloat16) if t.is_floating_point() else t)(torch.as_tensor(a)))
    def _A_setup():
        B, S, D = 1, 2048, 448
        Df = D // 2 + 1
        return {
            "x": _w((lambda *s: torch.randn(*s, dtype=torch.bfloat16) * 0.05)(B, S, D)),
            "w_r": _w((lambda *s: torch.randn(*s, dtype=torch.bfloat16) * 0.8)(S, Df) * 0.02),
            "w_i": _w((lambda *s: torch.randn(*s, dtype=torch.bfloat16) * 0.8)(S, Df) * 0.02),
        }
    _A_in = _A_setup()

    def _B_setup():
        B, S, D, F = 1, 2048, 448, 1792
        return {
            "x": _w((lambda *s: torch.randn(*s, dtype=torch.bfloat16) * 0.05)(B, S, D)),
            "w1": _w((lambda *s: torch.randn(*s, dtype=torch.bfloat16) * 0.8)(D, F) * (D ** -0.5)),
            "b1": _w((lambda *s: torch.randn(*s, dtype=torch.bfloat16) * 0.4)(F)),
            "w2": _w((lambda *s: torch.randn(*s, dtype=torch.bfloat16) * 0.05)(F, D) * (F ** -0.5)),
            "b2": _w((lambda *s: torch.randn(*s, dtype=torch.bfloat16) * 0.05)(D)),
        }
    _B_in = _B_setup()

    return {
        "A_x": _A_in["x"],
        "A_w_r": _A_in["w_r"],
        "A_w_i": _A_in["w_i"],
        "B_x": _B_in["x"],
        "B_w1": _B_in["w1"],
        "B_b1": _B_in["b1"],
        "B_w2": _B_in["w2"],
        "B_b2": _B_in["b2"],
    }

def reference(A_x, A_w_r, A_w_i, B_x, B_w1, B_b1, B_w2, B_b2):
    def _A_ref(x, w_r, w_i):
        B, S, D = x.shape
        X = (lambda x, axes=(-2,-1): torch.fft.rfft2(x.float(), dim=axes))(x, axes=(-2, -1))
        W = w_r + 1j * w_i
        X = X * W
        y = (lambda x, s, axes=(-2,-1): torch.fft.irfft2(x, s=s, dim=axes).to(torch.bfloat16))(X, (S, D), axes=(-2, -1))
        return y

    def _B_ref(x, w1, b1, w2, b2):
        y = _layernorm(x, axis=-1)
        h = _gelu(torch.einsum("bsd,df->bsf", y, w1) + b1)
        return torch.einsum("bsf,fd->bsd", h, w2) + b2

    x = A_x
    x = x + _A_ref(_layernorm(x, axis=-1), A_w_r, A_w_i)
    x = x + _B_ref(_layernorm(x, axis=-1), B_w1, B_b1, B_w2, B_b2)
    x = x + _A_ref(_layernorm(x, axis=-1), A_w_r, A_w_i)
    x = x + _B_ref(_layernorm(x, axis=-1), B_w1, B_b1, B_w2, B_b2)
    return x
```

```asm
; @launch kernel=k_kernel grid=(256,1,1) block=(256,1,1) lds=163840
.amdgcn_target "amdgcn-amd-amdhsa--gfx950"
.text
.globl k_kernel
.p2align 8
.type k_kernel,@function
k_kernel:
    s_load_dwordx2 s[8:9], s[0:1], 0
    s_load_dwordx2 s[4:5], s[0:1], 80
    s_load_dwordx2 s[12:13], s[0:1], 32
    s_load_dwordx2 s[84:85], s[0:1], 72
    s_load_dwordx2 s[88:89], s[0:1], 8
    s_load_dwordx2 s[92:93], s[0:1], 16
    s_sub_u32 s3, s2, 32
    s_cmp_lt_u32 s3, 224
    s_cbranch_scc1 J_main
    s_add_u32 s3, s2, 208
    s_sub_u32 s30, s2, 16
    s_cmp_lt_u32 s30, 16
    s_cbranch_scc1 J_main
    s_sub_u32 s3, s2, 0
    s_cmp_lt_u32 s3, 32
    s_cbranch_scc1 J_help
    s_endpgm
J_help:
    v_lshrrev_b32 v2, 6, v0
    v_and_b32 v1, 63, v0
    v_readfirstlane_b32 s16, v2
    s_mov_b32 s6, 34603008
    s_mov_b32 s7, 0x00020000
    v_lshlrev_b32 v15, 4, v1
    s_lshl2_add_u32 s22, s3, s16
    s_lshl_b32 s23, s22, 9
    s_mul_i32 s18, s22, 28672
    s_lshl_b32 s22, s22, 11
    s_add_u32 s22, s22, 1835008
    s_add_u32 s23, s23, 1966080
    v_accvgpr_write_b32 a252, -1
    v_accvgpr_write_b32 a253, -1
    v_accvgpr_write_b32 a254, -1
    v_accvgpr_write_b32 a255, -1
    v_mov_b32 v6, 0
    v_mov_b32 v7, 0
    v_lshlrev_b32 v5, 3, v1
    s_waitcnt lgkmcnt(0)
    buffer_store_dwordx4 a[252:255], v15, s[4:7], s22 offen offset:0 sc1
    buffer_store_dwordx4 a[252:255], v15, s[4:7], s22 offen offset:1024 sc1
    buffer_store_dwordx2 v[6:7], v5, s[4:7], s23 offen sc1
    s_mov_b32 s86, 256
    s_mov_b32 s87, 0x00020000
    s_lshl_b32 s36, s16, 26
    s_lshl4_add_u32 s22, s3, s36
    s_mov_b32 s32, 0x4000000
    s_mov_b32 s21, 0
    s_waitcnt vmcnt(0)
    s_barrier
    s_mov_b64 exec, 1
    buffer_store_dword a252, v1, s[84:87], s22 offen sc1
    s_mov_b64 exec, -1
    s_branch J_help2

.p2align 6
J_main:
    v_lshrrev_b32 v2, 6, v0
    v_and_b32 v1, 63, v0
    v_readfirstlane_b32 s16, v2
    s_lshr_b32 s35, s3, 3
    s_lshl2_add_u32 s23, s35, s16
    s_getpc_b64 s[30:31]
L_pc83200_1:
    s_sub_u32 s30, s30, L_pc83200_1-k_kernel
    s_subb_u32 s31, s31, 0
    s_lshl_b32 s29, s23, 10
    v_lshl_add_u32 v5, v1, 4, s29
    v_min_u32 v5, L_exit-k_kernel, v5
    global_load_dword a255, v5, s[30:31]
    s_and_b32 s27, s3, 7
    s_lshl_b32 s34, s16, 11
    v_lshlrev_b32 v15, 4, v1
    v_lshrrev_b32 v38, 5, v1
    s_mov_b32 s11, 0x00020000
    s_mov_b32 m0, s34
    s_cmp_gt_u32 s35, 15
    s_cbranch_scc1 L_tU
    s_lshr_b32 s26, s35, 2
    s_lshl2_add_u32 s26, s27, s26
    s_and_b32 s29, s35, 3
    s_lshl_b32 s96, s29, 1
    s_and_b32 s23, s26, 1
    s_mul_i32 s23, s23, -3
    s_lshl2_add_u32 s23, s26, s23
    s_lshl2_add_u32 s23, s23, s16
    s_mul_i32 s23, s23, 28
    s_add_u32 s23, s23, s96
    v_lshrrev_b32 v7, 4, v1
    v_xor_b32 v7, v7, v1
    v_and_b32 v7, 7, v7
    v_bfe_u32 v8, v1, 3, 2
    v_lshl_add_u32 v8, v8, 5, v38
    v_mul_u32_u24 v8, 56, v8
    v_add_lshl_u32 v32, v8, v7, 4
    v_xor_b32 v33, 64, v32
    v_add_u32 v33, 768, v33
    s_mov_b32 s10, 1835008
    s_movk_i32 s82, 128
    s_waitcnt lgkmcnt(0)
    s_branch L_tJ
L_tU:
    s_mul_i32 s21, s27, 14
    s_add_u32 s21, s21, s35
    s_sub_u32 s21, s21, 16
    s_lshr_b32 s26, s21, 2
    s_and_b32 s29, s21, 3
    s_lshl_b32 s96, s29, 1
    s_lshl2_add_u32 s23, s96, s16
    s_mul_i32 s23, s23, 448
    s_add_u32 s23, s23, s26
    v_lshrrev_b32 v11, 3, v1
    v_and_b32 v12, 0x70, v15
    v_and_b32 v13, 16, v1
    v_lshlrev_b32 v13, 2, v13
    v_xor_b32 v12, v12, v13
    v_mul_u32_u24 v11, 3584, v11
    v_add_u32 v32, v12, v11
    v_add_u32 v33, 27648, v32
    s_mov_b32 s10, 1605632
    s_mov_b32 s82, 229376
    s_waitcnt lgkmcnt(0)
    s_mov_b64 s[8:9], s[12:13]
L_tJ:
    s_lshl_b32 s23, s23, 7
    buffer_load_dwordx4 v32, s[8:11], s23 offen offset:0 lds
    buffer_load_dwordx4 v33, s[8:11], s23 offen offset:1024 lds
    s_add_u32 m0, s34, 8192
    s_mul_i32 s83, s82, -6
    s_cmp_eq_u32 s96, 6
    s_cselect_b32 s30, s83, s82
    s_add_u32 s23, s23, s30
    buffer_load_dwordx4 v32, s[8:11], s23 offen offset:0 lds
    buffer_load_dwordx4 v33, s[8:11], s23 offen offset:1024 lds
    s_add_u32 m0, s34, 16384
    s_cmp_eq_u32 s96, 5
    s_cselect_b32 s30, s83, s82
    s_add_u32 s23, s23, s30
    buffer_load_dwordx4 v32, s[8:11], s23 offen offset:0 lds
    buffer_load_dwordx4 v33, s[8:11], s23 offen offset:1024 lds
    s_lshl2_add_u32 s32, s29, s16
    s_bitcmp1_b32 0x8800, s32
    s_cselect_b32 s36, 0x4000000, 0
    s_cmp_eq_u32 s29, 3
    s_subb_u32 s32, s32, 0
    s_mul_i32 s20, s35, 37
    s_lshr_b32 s20, s20, 8
    s_mul_i32 s30, s20, 7
    s_sub_u32 s18, s35, s30
    s_lshl2_add_u32 s17, s27, s20
    s_lshr_b32 s97, s17, 1
    s_and_b32 s33, s16, 1
    s_mov_b32 s90, 921600
    s_mov_b32 s91, 0x00020000
    s_mov_b32 s94, 921600
    s_mov_b32 s95, 0x00020000
    s_bfe_u32 s31, s17, 0x20001
    s_lshl2_add_u32 s31, s31, s16
    s_lshr_b32 s30, s17, 3
    s_lshl2_add_u32 s31, s31, s30
    s_and_b32 s28, s17, 1
    s_lshl1_add_u32 s28, s31, s28
    s_mul_i32 s28, s28, 3600
    s_lshl_b32 s30, s18, 6
    s_add_u32 s28, s28, s30
    v_and_b32 v11, 1, v1
    v_mul_u32_u24 v11, 3600, v11
    v_lshrrev_b32 v126, 1, v1
    v_min_u32 v126, 4, v126
    v_add_lshl_u32 v126, v126, v11, 7
    s_mul_i32 s30, s18, 448
    s_add_u32 s30, s30, s28
    buffer_load_dword a253, v126, s[88:91], s30 offen
    s_mul_i32 s30, s18, 448
    s_add_u32 s30, s30, s28
    buffer_load_dword a254, v126, s[92:95], s30 offen
    s_load_dwordx2 s[12:13], s[0:1], 48
    s_load_dwordx2 s[76:77], s[0:1], 56
    s_lshl_b32 s30, s32, 5
    v_and_or_b32 v113, v1, 31, s30
    v_lshrrev_b32 v116, 1, v113
    v_cvt_f32_u32 v114, v116
    v_mul_f32 v114, 0x3b124925, v114
    v_and_b32 v116, 1, v113
    v_cvt_f32_u32 v115, v116
    v_mul_f32 v115, 0x3e800000, v115
    v_cmp_eq_u32 vcc, 0, v113
    v_mov_b32 v116, 0x3e000000
    s_nop 0
    v_cndmask_b32 v114, v114, 0.5, vcc
    v_cndmask_b32 v115, v115, v116, vcc
    v_cmp_eq_u32 vcc, 1, v113
    s_nop 1
    v_cndmask_b32 v115, v115, v116, vcc
    s_lshl_b32 s30, s96, 6
    v_lshl_add_u32 v116, v38, 3, s30
    v_cvt_f32_u32 v116, v116
    v_fmac_f32 v115, v116, v114
    v_mul_f32 v112, 16.0, v114
    v_cos_f32 v112, v112
    v_fract_f32 v115, v115
    s_mov_b32 s24, 0x3d88d677
    v_add_f32 v112, v112, v112
    s_mov_b32 s25, s24
    v_fmamk_f32 v208, v114, 0x00000000, v115
    v_fmamk_f32 v209, v114, 0x3f800000, v115
    v_cos_f32 v208, v208
    v_cos_f32 v209, v209
    v_fmamk_f32 v210, v114, 0x40000000, v115
    v_fmamk_f32 v211, v114, 0x40400000, v115
    v_cos_f32 v210, v210
    v_cos_f32 v211, v211
    v_fmamk_f32 v212, v114, 0x40800000, v115
    v_fmamk_f32 v213, v114, 0x40a00000, v115
    v_cos_f32 v212, v212
    v_cos_f32 v213, v213
    v_fmamk_f32 v214, v114, 0x40c00000, v115
    v_fmamk_f32 v215, v114, 0x40e00000, v115
    v_cos_f32 v214, v214
    v_cos_f32 v215, v215
    v_pk_mul_f32 v[208:209], v[208:209], s[24:25]
    v_pk_mul_f32 v[210:211], v[210:211], s[24:25]
    v_pk_mul_f32 v[212:213], v[212:213], s[24:25]
    v_pk_mul_f32 v[214:215], v[214:215], s[24:25]
    v_cvt_pk_bf16_f32 v48, v208, v209
    v_cvt_pk_bf16_f32 v49, v210, v211
    v_cvt_pk_bf16_f32 v50, v212, v213
    v_cvt_pk_bf16_f32 v51, v214, v215
    v_fmamk_f32 v216, v114, 0x41800000, v115
    v_fmamk_f32 v217, v114, 0x41880000, v115
    v_cos_f32 v216, v216
    v_cos_f32 v217, v217
    v_fmamk_f32 v218, v114, 0x41900000, v115
    v_fmamk_f32 v219, v114, 0x41980000, v115
    v_cos_f32 v218, v218
    v_cos_f32 v219, v219
    v_fmamk_f32 v220, v114, 0x41a00000, v115
    v_fmamk_f32 v221, v114, 0x41a80000, v115
    v_cos_f32 v220, v220
    v_cos_f32 v221, v221
    v_fmamk_f32 v222, v114, 0x41b00000, v115
    v_fmamk_f32 v223, v114, 0x41b80000, v115
    v_cos_f32 v222, v222
    v_cos_f32 v223, v223
    v_pk_mul_f32 v[216:217], v[216:217], s[24:25]
    v_pk_mul_f32 v[218:219], v[218:219], s[24:25]
    v_pk_mul_f32 v[220:221], v[220:221], s[24:25]
    v_pk_mul_f32 v[222:223], v[222:223], s[24:25]
    v_cvt_pk_bf16_f32 v52, v216, v217
    v_cvt_pk_bf16_f32 v53, v218, v219
    v_cvt_pk_bf16_f32 v54, v220, v221
    v_cvt_pk_bf16_f32 v55, v222, v223
    v_pk_fma_f32 v[208:209], v[112:113], v[216:217], v[208:209] op_sel_hi:[0,1,1] neg_lo:[0,0,1] neg_hi:[0,0,1]
    v_pk_fma_f32 v[210:211], v[112:113], v[218:219], v[210:211] op_sel_hi:[0,1,1] neg_lo:[0,0,1] neg_hi:[0,0,1]
    v_pk_fma_f32 v[212:213], v[112:113], v[220:221], v[212:213] op_sel_hi:[0,1,1] neg_lo:[0,0,1] neg_hi:[0,0,1]
    v_pk_fma_f32 v[214:215], v[112:113], v[222:223], v[214:215] op_sel_hi:[0,1,1] neg_lo:[0,0,1] neg_hi:[0,0,1]
    v_cvt_pk_bf16_f32 v56, v208, v209
    v_cvt_pk_bf16_f32 v57, v210, v211
    v_cvt_pk_bf16_f32 v58, v212, v213
    v_cvt_pk_bf16_f32 v59, v214, v215
    v_pk_fma_f32 v[216:217], v[112:113], v[208:209], v[216:217] op_sel_hi:[0,1,1] neg_lo:[0,0,1] neg_hi:[0,0,1]
    v_pk_fma_f32 v[218:219], v[112:113], v[210:211], v[218:219] op_sel_hi:[0,1,1] neg_lo:[0,0,1] neg_hi:[0,0,1]
    v_pk_fma_f32 v[220:221], v[112:113], v[212:213], v[220:221] op_sel_hi:[0,1,1] neg_lo:[0,0,1] neg_hi:[0,0,1]
    v_pk_fma_f32 v[222:223], v[112:113], v[214:215], v[222:223] op_sel_hi:[0,1,1] neg_lo:[0,0,1] neg_hi:[0,0,1]
    v_cvt_pk_bf16_f32 v60, v216, v217
    v_cvt_pk_bf16_f32 v61, v218, v219
    v_cvt_pk_bf16_f32 v62, v220, v221
    v_cvt_pk_bf16_f32 v63, v222, v223
    v_pk_fma_f32 v[208:209], v[112:113], v[216:217], v[208:209] op_sel_hi:[0,1,1] neg_lo:[0,0,1] neg_hi:[0,0,1]
    v_pk_fma_f32 v[210:211], v[112:113], v[218:219], v[210:211] op_sel_hi:[0,1,1] neg_lo:[0,0,1] neg_hi:[0,0,1]
    v_pk_fma_f32 v[212:213], v[112:113], v[220:221], v[212:213] op_sel_hi:[0,1,1] neg_lo:[0,0,1] neg_hi:[0,0,1]
    v_pk_fma_f32 v[214:215], v[112:113], v[222:223], v[214:215] op_sel_hi:[0,1,1] neg_lo:[0,0,1] neg_hi:[0,0,1]
    v_cvt_pk_bf16_f32 v64, v208, v209
    v_cvt_pk_bf16_f32 v65, v210, v211
    v_cvt_pk_bf16_f32 v66, v212, v213
    v_cvt_pk_bf16_f32 v67, v214, v215
    v_pk_fma_f32 v[216:217], v[112:113], v[208:209], v[216:217] op_sel_hi:[0,1,1] neg_lo:[0,0,1] neg_hi:[0,0,1]
    v_pk_fma_f32 v[218:219], v[112:113], v[210:211], v[218:219] op_sel_hi:[0,1,1] neg_lo:[0,0,1] neg_hi:[0,0,1]
    s_add_u32 m0, s34, 24576
    s_cmp_eq_u32 s96, 4
    s_cselect_b32 s30, s83, s82
    s_add_u32 s23, s23, s30
    buffer_load_dwordx4 v32, s[8:11], s23 offen offset:0 lds
    buffer_load_dwordx4 v33, s[8:11], s23 offen offset:1024 lds
    v_pk_fma_f32 v[220:221], v[112:113], v[212:213], v[220:221] op_sel_hi:[0,1,1] neg_lo:[0,0,1] neg_hi:[0,0,1]
    v_pk_fma_f32 v[222:223], v[112:113], v[214:215], v[222:223] op_sel_hi:[0,1,1] neg_lo:[0,0,1] neg_hi:[0,0,1]
    v_cvt_pk_bf16_f32 v68, v216, v217
    v_cvt_pk_bf16_f32 v69, v218, v219
    v_cvt_pk_bf16_f32 v70, v220, v221
    v_cvt_pk_bf16_f32 v71, v222, v223
    s_cmp_gt_u32 s35, 15
    s_cbranch_scc1 L_prepU
    v_bfe_u32 v13, v1, 1, 3
    v_xor_b32 v13, v13, v38
    v_and_b32 v14, 31, v1
    v_lshl_add_u32 v13, v14, 3, v13
    v_lshlrev_b32 v40, 4, v13
    v_xor_b32 v41, 32, v40
    v_xor_b32 v42, 64, v40
    v_xor_b32 v43, 96, v40
    v_lshlrev_b32 v37, 2, v14
    v_lshrrev_b32 v13, 4, v1
    v_and_b32 v14, 15, v1
    v_lshl_add_u32 v14, v2, 4, v14
    v_lshlrev_b32 v13, 2, v13
    v_xor_b32 v13, v13, v1
    v_and_b32 v13, 14, v13
    v_lshl_add_u32 v13, v14, 4, v13
    v_lshlrev_b32 v39, 3, v13
    v_xor_b32 v35, 16, v39
    v_lshlrev_b32 v36, 2, v14
    v_mov_b32 v192, 0x3f803f80
    v_mov_b32 v193, 0x3f803f80
    v_mov_b32 v194, 0x3f803f80
    v_mov_b32 v195, 0x3f803f80
    s_mov_b32 s6, 34603008
    s_mov_b32 s7, 0x00020000
    s_mov_b32 s86, 256
    s_mov_b32 s87, 0x00020000
    v_accvgpr_write_b32 a0, -1
    v_accvgpr_write_b32 a1, -1
    v_accvgpr_write_b32 a2, -1
    v_accvgpr_write_b32 a3, -1
    s_lshl_b32 s21, s32, 9
    s_add_u32 s21, s21, s26
    s_lshl_b32 s21, s21, 8
    s_add_u32 s21, s21, s36
    v_lshrrev_b32 v11, 4, v1
    v_and_b32 v12, 0xf0, v15
    v_lshl_add_u32 v127, v11, 13, v12
    v_and_b32 v9, 7, v1
    v_min_u32 v9, 4, v9
    v_and_b32 v11, 56, v1
    v_mul_u32_u24 v11, 56, v11
    v_lshl_add_u32 v9, v9, 4, v11
    s_mov_b32 s78, s26
    s_lshl2_add_u32 s22, s78, s16
    s_mov_b32 s14, 1605632
    s_mov_b32 s15, 0x00020000
    s_mul_i32 s22, s22, 56
    s_add_u32 s22, s22, s96
    s_lshl_b32 s22, s22, 7
    s_lshl_b32 s79, s16, 10
    v_lshrrev_b32 v11, 4, v0
    v_xor_b32 v11, v11, v1
    v_and_b32 v11, 7, v11
    v_lshrrev_b32 v12, 3, v1
    v_mul_u32_u24 v12, 56, v12
    v_add_lshl_u32 v121, v11, v12, 4
    v_pk_fma_f32 v[208:209], v[112:113], v[216:217], v[208:209] op_sel_hi:[0,1,1] neg_lo:[0,0,1] neg_hi:[0,0,1]
    v_pk_fma_f32 v[210:211], v[112:113], v[218:219], v[210:211] op_sel_hi:[0,1,1] neg_lo:[0,0,1] neg_hi:[0,0,1]
    v_pk_fma_f32 v[212:213], v[112:113], v[220:221], v[212:213] op_sel_hi:[0,1,1] neg_lo:[0,0,1] neg_hi:[0,0,1]
    v_pk_fma_f32 v[214:215], v[112:113], v[222:223], v[214:215] op_sel_hi:[0,1,1] neg_lo:[0,0,1] neg_hi:[0,0,1]
    v_cvt_pk_bf16_f32 v72, v208, v209
    v_cvt_pk_bf16_f32 v73, v210, v211
    v_cvt_pk_bf16_f32 v74, v212, v213
    v_cvt_pk_bf16_f32 v75, v214, v215
    v_pk_fma_f32 v[216:217], v[112:113], v[208:209], v[216:217] op_sel_hi:[0,1,1] neg_lo:[0,0,1] neg_hi:[0,0,1]
    v_pk_fma_f32 v[218:219], v[112:113], v[210:211], v[218:219] op_sel_hi:[0,1,1] neg_lo:[0,0,1] neg_hi:[0,0,1]
    v_pk_fma_f32 v[220:221], v[112:113], v[212:213], v[220:221] op_sel_hi:[0,1,1] neg_lo:[0,0,1] neg_hi:[0,0,1]
    v_pk_fma_f32 v[222:223], v[112:113], v[214:215], v[222:223] op_sel_hi:[0,1,1] neg_lo:[0,0,1] neg_hi:[0,0,1]
    v_cvt_pk_bf16_f32 v76, v216, v217
    v_cvt_pk_bf16_f32 v77, v218, v219
    v_cvt_pk_bf16_f32 v78, v220, v221
    v_cvt_pk_bf16_f32 v79, v222, v223
    v_pk_fma_f32 v[208:209], v[112:113], v[216:217], v[208:209] op_sel_hi:[0,1,1] neg_lo:[0,0,1] neg_hi:[0,0,1]
    v_pk_fma_f32 v[210:211], v[112:113], v[218:219], v[210:211] op_sel_hi:[0,1,1] neg_lo:[0,0,1] neg_hi:[0,0,1]
    v_pk_fma_f32 v[212:213], v[112:113], v[220:221], v[212:213] op_sel_hi:[0,1,1] neg_lo:[0,0,1] neg_hi:[0,0,1]
    v_pk_fma_f32 v[214:215], v[112:113], v[222:223], v[214:215] op_sel_hi:[0,1,1] neg_lo:[0,0,1] neg_hi:[0,0,1]
    v_cvt_pk_bf16_f32 v80, v208, v209
    v_cvt_pk_bf16_f32 v81, v210, v211
    v_cvt_pk_bf16_f32 v82, v212, v213
    v_cvt_pk_bf16_f32 v83, v214, v215
    v_pk_fma_f32 v[216:217], v[112:113], v[208:209], v[216:217] op_sel_hi:[0,1,1] neg_lo:[0,0,1] neg_hi:[0,0,1]
    v_pk_fma_f32 v[218:219], v[112:113], v[210:211], v[218:219] op_sel_hi:[0,1,1] neg_lo:[0,0,1] neg_hi:[0,0,1]
    v_pk_fma_f32 v[220:221], v[112:113], v[212:213], v[220:221] op_sel_hi:[0,1,1] neg_lo:[0,0,1] neg_hi:[0,0,1]
    s_waitcnt vmcnt(8)
    s_barrier
    ds_read_b128 a[64:67], v40 offset:0
    ds_read_b128 a[68:71], v40 offset:4096
    ds_read_b128 a[72:75], v41 offset:0
    ds_read_b128 a[76:79], v41 offset:4096
    s_add_u32 m0, s34, 32768
    s_cmp_eq_u32 s96, 3
    s_cselect_b32 s30, s83, s82
    s_add_u32 s23, s23, s30
    buffer_load_dwordx4 v32, s[8:11], s23 offen offset:0 lds
    buffer_load_dwordx4 v33, s[8:11], s23 offen offset:1024 lds
    ds_read_b128 a[80:83], v42 offset:0
    ds_read_b128 a[84:87], v42 offset:4096
    s_waitcnt lgkmcnt(0)
    v_mfma_f32_32x32x16_bf16 v[224:239], v[48:51], a[64:67], 0
    ds_read_b128 a[88:91], v43 offset:0
    v_pk_fma_f32 v[222:223], v[112:113], v[214:215], v[222:223] op_sel_hi:[0,1,1] neg_lo:[0,0,1] neg_hi:[0,0,1]
    v_cvt_pk_bf16_f32 v84, v216, v217
    v_cvt_pk_bf16_f32 v85, v218, v219
    v_cvt_pk_bf16_f32 v86, v220, v221
    v_mfma_f32_32x32x16_bf16 v[240:255], v[48:51], a[68:71], 0
    ds_read_b128 a[92:95], v43 offset:4096
    v_cvt_pk_bf16_f32 v87, v222, v223
    v_pk_fma_f32 v[208:209], v[112:113], v[216:217], v[208:209] op_sel_hi:[0,1,1] neg_lo:[0,0,1] neg_hi:[0,0,1]
    v_pk_fma_f32 v[210:211], v[112:113], v[218:219], v[210:211] op_sel_hi:[0,1,1] neg_lo:[0,0,1] neg_hi:[0,0,1]
    v_pk_fma_f32 v[212:213], v[112:113], v[220:221], v[212:213] op_sel_hi:[0,1,1] neg_lo:[0,0,1] neg_hi:[0,0,1]
    v_pk_fma_f32 v[214:215], v[112:113], v[222:223], v[214:215] op_sel_hi:[0,1,1] neg_lo:[0,0,1] neg_hi:[0,0,1]
    v_mfma_f32_32x32x16_bf16 v[224:239], v[52:55], a[72:75], v[224:239]
    s_waitcnt vmcnt(8)
    s_barrier
    ds_read_b128 a[96:99], v40 offset:8192
    s_add_u32 m0, s34, 40960
    s_cmp_eq_u32 s96, 2
    s_cselect_b32 s30, s83, s82
    s_add_u32 s23, s23, s30
    buffer_load_dwordx4 v32, s[8:11], s23 offen offset:0 lds
    buffer_load_dwordx4 v33, s[8:11], s23 offen offset:1024 lds
    v_mfma_f32_32x32x16_bf16 v[240:255], v[52:55], a[76:79], v[240:255]
    ds_read_b128 a[100:103], v40 offset:12288
    ds_read_b128 v[16:19], v39 offset:0
    ds_read_b128 v[20:23], v35 offset:0
    ds_read_b128 v[24:27], v39 offset:8192
    ds_read_b128 v[28:31], v35 offset:8192
    v_cvt_pk_bf16_f32 v88, v208, v209
    v_mfma_f32_32x32x16_bf16 v[224:239], v[56:59], a[80:83], v[224:239]
    ds_read_b128 a[104:107], v41 offset:8192
    s_add_u32 m0, s34, 49152
    s_cmp_eq_u32 s96, 1
    s_cselect_b32 s30, s83, s82
    s_add_u32 s23, s23, s30
    buffer_load_dwordx4 v32, s[8:11], s23 offen offset:0 lds
    buffer_load_dwordx4 v33, s[8:11], s23 offen offset:1024 lds
    v_mfma_f32_32x32x16_bf16 v[240:255], v[56:59], a[84:87], v[240:255]
    ds_read_b128 a[108:111], v41 offset:12288
    v_cvt_pk_bf16_f32 v89, v210, v211
    v_cvt_pk_bf16_f32 v90, v212, v213
    v_cvt_pk_bf16_f32 v91, v214, v215
    v_pk_fma_f32 v[216:217], v[112:113], v[208:209], v[216:217] op_sel_hi:[0,1,1] neg_lo:[0,0,1] neg_hi:[0,0,1]
    s_waitcnt lgkmcnt(9)
    v_mfma_f32_32x32x16_bf16 v[224:239], v[60:63], a[88:91], v[224:239]
    ds_read_b128 a[112:115], v42 offset:8192
    s_mul_i32 s30, s16, 1056
    s_add_u32 m0, s30, 81920
    s_nop 0
    buffer_load_dwordx4 v9, s[88:91], s28 offen lds
    s_waitcnt lgkmcnt(6)
    v_mfma_f32_16x16x32_bf16 v[196:199], v[16:19], v[16:19], 0
    v_mfma_f32_16x16x32_bf16 v[200:203], v[192:195], v[16:19], 0
    s_waitcnt lgkmcnt(5)
    v_mfma_f32_16x16x32_bf16 v[196:199], v[20:23], v[20:23], v[196:199]
    v_mfma_f32_16x16x32_bf16 v[200:203], v[192:195], v[20:23], v[200:203]
    v_pk_fma_f32 v[218:219], v[112:113], v[210:211], v[218:219] op_sel_hi:[0,1,1] neg_lo:[0,0,1] neg_hi:[0,0,1]
    v_pk_fma_f32 v[220:221], v[112:113], v[212:213], v[220:221] op_sel_hi:[0,1,1] neg_lo:[0,0,1] neg_hi:[0,0,1]
    v_pk_fma_f32 v[222:223], v[112:113], v[214:215], v[222:223] op_sel_hi:[0,1,1] neg_lo:[0,0,1] neg_hi:[0,0,1]
    v_cvt_pk_bf16_f32 v92, v216, v217
    v_cvt_pk_bf16_f32 v93, v218, v219
    v_mfma_f32_32x32x16_bf16 v[240:255], v[60:63], a[92:95], v[240:255]
    ds_read_b128 a[116:119], v42 offset:12288
    s_mul_i32 s30, s16, 1056
    s_add_u32 m0, s30, 86144
    s_add_u32 s30, s28, 460800
    buffer_load_dwordx4 v9, s[88:91], s30 offen lds
    v_cvt_pk_bf16_f32 v94, v220, v221
    v_mfma_f32_32x32x16_bf16 v[224:239], v[64:67], a[96:99], v[224:239]
    ds_read_b128 a[120:123], v43 offset:8192
    s_mul_i32 s30, s16, 1056
    s_add_u32 m0, s30, 90368
    s_nop 0
    buffer_load_dwordx4 v9, s[92:95], s28 offen lds
    v_mfma_f32_32x32x16_bf16 v[240:255], v[64:67], a[100:103], v[240:255]
    ds_read_b128 a[124:127], v43 offset:12288
    s_mul_i32 s30, s16, 1056
    s_add_u32 m0, s30, 94592
    s_add_u32 s30, s28, 460800
    buffer_load_dwordx4 v9, s[92:95], s30 offen lds
    v_cvt_pk_bf16_f32 v95, v222, v223
    s_waitcnt lgkmcnt(5)
    v_mfma_f32_32x32x16_bf16 v[224:239], v[68:71], a[104:107], v[224:239]
    s_waitcnt vmcnt(14)
    s_barrier
    ds_read_b128 a[64:67], v40 offset:16384
    v_pk_fma_f32 v[208:209], v[112:113], v[216:217], v[208:209] op_sel_hi:[0,1,1] neg_lo:[0,0,1] neg_hi:[0,0,1]
    v_pk_fma_f32 v[210:211], v[112:113], v[218:219], v[210:211] op_sel_hi:[0,1,1] neg_lo:[0,0,1] neg_hi:[0,0,1]
    s_waitcnt lgkmcnt(5)
    v_mfma_f32_32x32x16_bf16 v[240:255], v[68:71], a[108:111], v[240:255]
    ds_read_b128 a[68:71], v40 offset:20480
    ds_read_b128 v[16:19], v39 offset:16384
    ds_read_b128 v[20:23], v35 offset:16384
    v_mfma_f32_16x16x32_bf16 v[196:199], v[24:27], v[24:27], v[196:199]
    v_mfma_f32_16x16x32_bf16 v[200:203], v[192:195], v[24:27], v[200:203]
    v_pk_fma_f32 v[212:213], v[112:113], v[220:221], v[212:213] op_sel_hi:[0,1,1] neg_lo:[0,0,1] neg_hi:[0,0,1]
    v_pk_fma_f32 v[214:215], v[112:113], v[222:223], v[214:215] op_sel_hi:[0,1,1] neg_lo:[0,0,1] neg_hi:[0,0,1]
    v_cvt_pk_bf16_f32 v96, v208, v209
    v_cvt_pk_bf16_f32 v97, v210, v211
    s_waitcnt lgkmcnt(7)
    v_mfma_f32_32x32x16_bf16 v[224:239], v[72:75], a[112:115], v[224:239]
    ds_read_b128 a[72:75], v41 offset:16384
    buffer_store_dwordx4 a[0:3], v127, s[4:7], s21 offen sc1
    s_add_u32 s30, s21, 32768
    buffer_store_dwordx4 a[0:3], v127, s[4:7], s30 offen sc1
    v_mfma_f32_16x16x32_bf16 v[196:199], v[28:31], v[28:31], v[196:199]
    v_mfma_f32_16x16x32_bf16 v[200:203], v[192:195], v[28:31], v[200:203]
    v_cvt_pk_bf16_f32 v98, v212, v213
    v_cvt_pk_bf16_f32 v99, v214, v215
    v_pk_fma_f32 v[216:217], v[112:113], v[208:209], v[216:217] op_sel_hi:[0,1,1] neg_lo:[0,0,1] neg_hi:[0,0,1]
    s_waitcnt lgkmcnt(7)
    v_mfma_f32_32x32x16_bf16 v[240:255], v[72:75], a[116:119], v[240:255]
    ds_read_b128 a[76:79], v41 offset:20480
    s_add_u32 s30, s21, 65536
    buffer_store_dwordx4 a[0:3], v127, s[4:7], s30 offen sc1
    s_add_u32 s30, s21, 98304
    buffer_store_dwordx4 a[0:3], v127, s[4:7], s30 offen sc1
    v_pk_fma_f32 v[218:219], v[112:113], v[210:211], v[218:219] op_sel_hi:[0,1,1] neg_lo:[0,0,1] neg_hi:[0,0,1]
    s_waitcnt lgkmcnt(7)
    v_mfma_f32_32x32x16_bf16 v[224:239], v[76:79], a[120:123], v[224:239]
    ds_read_b128 a[80:83], v42 offset:16384
    v_pk_fma_f32 v[220:221], v[112:113], v[212:213], v[220:221] op_sel_hi:[0,1,1] neg_lo:[0,0,1] neg_hi:[0,0,1]
    v_pk_fma_f32 v[222:223], v[112:113], v[214:215], v[222:223] op_sel_hi:[0,1,1] neg_lo:[0,0,1] neg_hi:[0,0,1]
    v_cvt_pk_bf16_f32 v100, v216, v217
    v_cvt_pk_bf16_f32 v101, v218, v219
    s_waitcnt lgkmcnt(7)
    v_mfma_f32_32x32x16_bf16 v[240:255], v[76:79], a[124:127], v[240:255]
    ds_read_b128 a[84:87], v42 offset:20480
    v_cvt_pk_bf16_f32 v102, v220, v221
    v_cvt_pk_bf16_f32 v103, v222, v223
    s_waitcnt lgkmcnt(7)
    v_mfma_f32_32x32x16_bf16 v[224:239], v[80:83], a[64:67], v[224:239]
    ds_read_b128 a[88:91], v43 offset:16384
    s_lshl_b32 s30, s32, 5
    s_add_u32 s30, s30, s26
    s_lshl4_add_u32 s30, s30, s36
    s_add_u32 s39, s30, 1933312
    v_bfe_u32 v10, v1, 2, 3
    s_waitcnt lgkmcnt(7)
    v_mfma_f32_32x32x16_bf16 v[240:255], v[80:83], a[68:71], v[240:255]
    ds_read_b128 a[92:95], v43 offset:20480
    v_mul_u32_u24 v10, 1056, v10
    v_and_b32 v11, 3, v1
    v_lshl_add_u32 v10, v11, 3, v10
    v_mul_u32_u24 v11, 520, v38
    v_lshl_add_u32 v10, v2, 7, v10
    s_waitcnt lgkmcnt(5)
    v_mfma_f32_32x32x16_bf16 v[224:239], v[84:87], a[72:75], v[224:239]
    s_waitcnt vmcnt(14)
    s_waitcnt vmcnt(6)
    s_waitcnt vmcnt(4)
    s_barrier
    ds_read_b128 a[96:99], v40 offset:24576
    v_add_u32 v11, 81920, v11
    v_add_u32 v10, v10, v11
    ds_read_b64_tr_b16 a[224:225], v10 offset:0
    ds_read_b64_tr_b16 a[226:227], v10 offset:8448
    ds_read_b64_tr_b16 a[228:229], v10 offset:32
    ds_read_b64_tr_b16 a[230:231], v10 offset:8480
    ds_read_b64_tr_b16 a[232:233], v10 offset:64
    ds_read_b64_tr_b16 a[234:235], v10 offset:8512
    s_waitcnt lgkmcnt(11)
    v_mfma_f32_32x32x16_bf16 v[240:255], v[84:87], a[76:79], v[240:255]
    ds_read_b128 a[100:103], v40 offset:28672
    ds_read_b128 v[24:27], v39 offset:24576
    ds_read_b128 v[28:31], v35 offset:24576
    v_mfma_f32_16x16x32_bf16 v[196:199], v[16:19], v[16:19], v[196:199]
    v_mfma_f32_16x16x32_bf16 v[200:203], v[192:195], v[16:19], v[200:203]
    v_and_b32 v11, 15, v1
    v_mul_u32_u24 v11, 272, v11
    v_and_b32 v12, 48, v1
    v_mul_u32_u24 v13, 208, v2
    s_waitcnt lgkmcnt(13)
    v_mfma_f32_32x32x16_bf16 v[224:239], v[88:91], a[80:83], v[224:239]
    ds_read_b128 a[104:107], v41 offset:24576
    v_and_b32 v120, 0xf0, v15
    buffer_load_dword v120, v120, s[84:87], 0 offen sc1
    v_mfma_f32_16x16x32_bf16 v[196:199], v[20:23], v[20:23], v[196:199]
    v_mfma_f32_16x16x32_bf16 v[200:203], v[192:195], v[20:23], v[200:203]
    v_sub_u32 v12, v12, v13
    v_add_u32 v12, 49152, v12
    v_add_u32 v123, v12, v11
    s_waitcnt lgkmcnt(13)
    v_mfma_f32_32x32x16_bf16 v[240:255], v[88:91], a[84:87], v[240:255]
    ds_read_b128 a[108:111], v41 offset:28672
    s_waitcnt lgkmcnt(9)
    ds_write_b128 v123, a[224:227] offset:9008
    s_waitcnt lgkmcnt(8)
    ds_write_b128 v123, a[228:231] offset:13360
    s_waitcnt lgkmcnt(7)
    ds_write_b128 v123, a[232:235] offset:17712
    v_mfma_f32_32x32x16_bf16 v[224:239], v[92:95], a[88:91], v[224:239]
    ds_read_b128 a[112:115], v42 offset:24576
    s_add_u32 m0, s79, 135168
    s_nop 0
    buffer_load_dwordx4 v121, s[12:15], s22 offen lds
    v_lshrrev_b32 v13, 4, v1
    v_mfma_f32_32x32x16_bf16 v[240:255], v[92:95], a[92:95], v[240:255]
    ds_read_b128 a[116:119], v42 offset:28672
    s_add_u32 m0, s79, 139264
    s_cmp_eq_u32 s96, 6
    s_cselect_b32 s30, -48, 8
    s_lshl4_add_u32 s22, s30, s22
    buffer_load_dwordx4 v121, s[12:15], s22 offen lds
    v_mfma_f32_32x32x16_bf16 v[224:239], v[96:99], a[96:99], v[224:239]
    ds_read_b128 a[120:123], v43 offset:24576
    s_add_u32 m0, s79, 143360
    s_cmp_eq_u32 s96, 5
    s_cselect_b32 s30, -48, 8
    s_lshl4_add_u32 s22, s30, s22
    buffer_load_dwordx4 v121, s[12:15], s22 offen lds
    v_lshl_add_u32 v13, v2, 3, v13
    s_waitcnt lgkmcnt(10)
    v_mfma_f32_32x32x16_bf16 v[240:255], v[96:99], a[100:103], v[240:255]
    ds_read_b128 a[124:127], v43 offset:28672
    s_add_u32 m0, s79, 147456
    s_cmp_eq_u32 s96, 4
    s_cselect_b32 s30, -48, 8
    s_lshl4_add_u32 s22, s30, s22
    buffer_load_dwordx4 v121, s[12:15], s22 offen lds
    s_waitcnt lgkmcnt(8)
    v_mfma_f32_32x32x16_bf16 v[224:239], v[100:103], a[104:107], v[224:239]
    s_waitcnt lgkmcnt(4)
    s_barrier
    ds_read_b128 a[64:67], v40 offset:32768
    v_and_b32 v12, 0xf0, v15
    v_mul_u32_u24 v11, 272, v13
    v_add_u32 v124, v11, v12
    v_lshl_add_u32 v125, v13, 13, v12
    s_lshl_b32 s38, s18, 10
    s_add_u32 s38, s38, s17
    s_lshl_b32 s38, s38, 8
    s_add_u32 s38, s38, 25305088
    ds_read_b128 a[224:227], v124 offset:58432
    ds_read_b128 a[228:231], v124 offset:59520
    v_mfma_f32_32x32x16_bf16 v[240:255], v[100:103], a[108:111], v[240:255]
    ds_read_b128 a[68:71], v40 offset:36864
    s_add_u32 m0, s79, 151552
    s_cmp_eq_u32 s96, 3
    s_cselect_b32 s30, -48, 8
    s_lshl4_add_u32 s22, s30, s22
    buffer_load_dwordx4 v121, s[12:15], s22 offen lds
    ds_read_b128 v[16:19], v39 offset:32768
    ds_read_b128 v[20:23], v35 offset:32768
    v_pk_mul_f32 v[226:227], v[226:227], -1.0 op_sel_hi:[1,0]
    v_pk_mul_f32 v[230:231], v[230:231], -1.0 op_sel_hi:[1,0]
    v_pk_mul_f32 v[234:235], v[234:235], -1.0 op_sel_hi:[1,0]
    v_pk_mul_f32 v[238:239], v[238:239], -1.0 op_sel_hi:[1,0]
    s_waitcnt lgkmcnt(9)
    s_nop 0
    v_mfma_f32_32x32x16_bf16 v[224:239], v[48:51], a[112:115], v[224:239]
    ds_read_b128 a[72:75], v41 offset:32768
    s_add_u32 m0, s79, 155648
    s_cmp_eq_u32 s96, 2
    s_cselect_b32 s30, -48, 8
    s_lshl4_add_u32 s22, s30, s22
    buffer_load_dwordx4 v121, s[12:15], s22 offen lds
    v_mfma_f32_16x16x32_bf16 v[196:199], v[24:27], v[24:27], v[196:199]
    v_mfma_f32_16x16x32_bf16 v[200:203], v[192:195], v[24:27], v[200:203]
    v_mfma_f32_16x16x32_bf16 v[196:199], v[28:31], v[28:31], v[196:199]
    v_mfma_f32_16x16x32_bf16 v[200:203], v[192:195], v[28:31], v[200:203]
    s_lshr_b32 s30, s3, 4
    s_min_u32 s30, s30, 13
    s_lshl_b32 s30, s30, 9
    s_sub_u32 s31, s3, 1
    s_min_u32 s31, s31, 223
    s_lshr_b32 s31, s31, 3
    s_lshl_b32 s31, s31, 9
    s_sub_u32 s31, s31, s30
    s_add_u32 s31, s31, 8192
    s_add_u32 s30, s30, 1933312
    v_mul_u32_u24 v11, s31, v38
    v_lshl_add_u32 v11, v2, 7, v11
    v_and_b32 v12, 0x70, v15
    v_add3_u32 v46, v11, v12, s30
    v_pk_mul_f32 v[242:243], v[242:243], -1.0 op_sel_hi:[1,0]
    v_pk_mul_f32 v[246:247], v[246:247], -1.0 op_sel_hi:[1,0]
    v_pk_mul_f32 v[250:251], v[250:251], -1.0 op_sel_hi:[1,0]
    v_pk_mul_f32 v[254:255], v[254:255], -1.0 op_sel_hi:[1,0]
    s_waitcnt lgkmcnt(9)
    s_nop 0
    v_mfma_f32_32x32x16_bf16 v[240:255], v[48:51], a[116:119], v[240:255]
    ds_read_b128 a[76:79], v41 offset:36864
    s_add_u32 m0, s79, 159744
    s_cmp_eq_u32 s96, 1
    s_cselect_b32 s30, -48, 8
    s_lshl4_add_u32 s22, s30, s22
    buffer_load_dwordx4 v121, s[12:15], s22 offen lds
    s_waitcnt lgkmcnt(9)
    v_mfma_f32_32x32x16_bf16 v[224:239], v[52:55], a[120:123], v[224:239]
    ds_read_b128 a[80:83], v42 offset:32768
    s_waitcnt lgkmcnt(9)
    v_mfma_f32_32x32x16_bf16 v[240:255], v[52:55], a[124:127], v[240:255]
    ds_read_b128 a[84:87], v42 offset:36864
    s_add_u32 s30, s38, 32768
    s_waitcnt lgkmcnt(8)
    buffer_store_dwordx4 a[224:227], v125, s[4:7], s38 offen sc1
    s_waitcnt lgkmcnt(7)
    buffer_store_dwordx4 a[228:231], v125, s[4:7], s30 offen sc1
    v_mfma_f32_32x32x16_bf16 v[224:239], v[56:59], a[64:67], v[224:239]
    ds_read_b128 a[88:91], v43 offset:32768
    s_waitcnt lgkmcnt(7)
    v_mfma_f32_32x32x16_bf16 v[240:255], v[56:59], a[68:71], v[240:255]
    ds_read_b128 a[92:95], v43 offset:36864
    s_waitcnt lgkmcnt(5)
    v_mfma_f32_32x32x16_bf16 v[224:239], v[60:63], a[72:75], v[224:239]
    s_barrier
    ds_read_b128 a[96:99], v40 offset:40960
    s_lshl_b32 s30, s27, 11
    s_add_u32 s30, s30, 1835008
    v_min_u32 v14, 27, v1
    v_lshl_add_u32 v45, v14, 6, s30
    s_lshl_b32 s31, s35, 6
    s_add_u32 s30, s30, s31
    v_mov_b32 v122, s30
    s_getreg_b32 s30, hwreg(HW_REG_XCC_ID, 0, 4)
    v_mov_b32 v44, s30
    s_waitcnt lgkmcnt(5)
    v_mfma_f32_32x32x16_bf16 v[240:255], v[60:63], a[76:79], v[240:255]
    ds_read_b128 a[100:103], v40 offset:45056
    ds_read_b128 v[24:27], v39 offset:40960
    ds_read_b128 v[28:31], v35 offset:40960
    v_mfma_f32_16x16x32_bf16 v[196:199], v[16:19], v[16:19], v[196:199]
    v_mfma_f32_16x16x32_bf16 v[200:203], v[192:195], v[16:19], v[200:203]
    s_waitcnt lgkmcnt(7)
    v_mfma_f32_32x32x16_bf16 v[224:239], v[64:67], a[80:83], v[224:239]
    ds_read_b128 a[104:107], v41 offset:40960
    v_mfma_f32_16x16x32_bf16 v[196:199], v[20:23], v[20:23], v[196:199]
    v_mfma_f32_16x16x32_bf16 v[200:203], v[192:195], v[20:23], v[200:203]
    s_waitcnt vmcnt(9)
    v_cmp_eq_u32 vcc, 0, v120
    s_nop 0
    s_cmp_eq_u64 vcc, 0
    s_cselect_b32 s30, s39, 0x4000000
    s_mov_b64 exec, 1
    buffer_store_dword v1, v1, s[4:7], s30 offen sc1
    s_mov_b64 exec, -1
    s_waitcnt lgkmcnt(7)
    v_mfma_f32_32x32x16_bf16 v[240:255], v[64:67], a[84:87], v[240:255]
    ds_read_b128 a[108:111], v41 offset:45056
    s_lshl_b32 s30, s26, 8
    s_add_u32 s30, s30, 1957888
    s_cmp_eq_u32 s29, s16
    s_cselect_b32 s37, s30, 0x4000000
    s_waitcnt lgkmcnt(7)
    v_mfma_f32_32x32x16_bf16 v[224:239], v[68:71], a[88:91], v[224:239]
    ds_read_b128 a[112:115], v42 offset:40960
    s_and_b32 s30, s78, 3
    s_mul_i32 s30, s30, 391
    s_add_u32 s26, s30, s78
    s_and_b32 s30, s32, 1
    s_mul_i32 s30, s30, -27
    s_add_u32 s26, s26, s30
    s_mul_i32 s30, s32, 28
    s_add_u32 s26, s26, s30
    s_waitcnt lgkmcnt(7)
    v_mfma_f32_32x32x16_bf16 v[240:255], v[68:71], a[92:95], v[240:255]
    ds_read_b128 a[116:119], v42 offset:45056
    s_waitcnt lgkmcnt(7)
    v_mfma_f32_32x32x16_bf16 v[224:239], v[72:75], a[96:99], v[224:239]
    ds_read_b128 a[120:123], v43 offset:40960
    s_lshl_b32 s26, s26, 10
    s_add_u32 s26, s26, s36
    s_add_u32 s26, s26, 20971520
    s_waitcnt lgkmcnt(7)
    v_mfma_f32_32x32x16_bf16 v[240:255], v[72:75], a[100:103], v[240:255]
    ds_read_b128 a[124:127], v43 offset:45056
    s_waitcnt lgkmcnt(5)
    v_mfma_f32_32x32x16_bf16 v[224:239], v[76:79], a[104:107], v[224:239]
    s_barrier
    ds_read_b128 a[64:67], v40 offset:49152
    s_waitcnt lgkmcnt(5)
    v_mfma_f32_32x32x16_bf16 v[240:255], v[76:79], a[108:111], v[240:255]
    ds_read_b128 a[68:71], v40 offset:53248
    ds_read_b128 v[16:19], v39 offset:49152
    ds_read_b128 v[20:23], v35 offset:49152
    v_mfma_f32_16x16x32_bf16 v[196:199], v[24:27], v[24:27], v[196:199]
    v_mfma_f32_16x16x32_bf16 v[200:203], v[192:195], v[24:27], v[200:203]
    s_waitcnt lgkmcnt(7)
    v_mfma_f32_32x32x16_bf16 v[224:239], v[80:83], a[112:115], v[224:239]
    ds_read_b128 a[72:75], v41 offset:49152
    v_mfma_f32_16x16x32_bf16 v[196:199], v[28:31], v[28:31], v[196:199]
    v_mfma_f32_16x16x32_bf16 v[200:203], v[192:195], v[28:31], v[200:203]
    s_waitcnt lgkmcnt(7)
    v_mfma_f32_32x32x16_bf16 v[240:255], v[80:83], a[116:119], v[240:255]
    ds_read_b128 a[76:79], v41 offset:53248
    s_waitcnt lgkmcnt(7)
    v_mfma_f32_32x32x16_bf16 v[224:239], v[84:87], a[120:123], v[224:239]
    ds_read_b128 a[80:83], v42 offset:49152
    s_waitcnt lgkmcnt(4)
    v_mfma_f32_16x16x32_bf16 v[196:199], v[16:19], v[16:19], v[196:199]
    v_mfma_f32_16x16x32_bf16 v[200:203], v[192:195], v[16:19], v[200:203]
    s_waitcnt lgkmcnt(3)
    v_mfma_f32_16x16x32_bf16 v[196:199], v[20:23], v[20:23], v[196:199]
    v_mfma_f32_16x16x32_bf16 v[200:203], v[192:195], v[20:23], v[200:203]
    v_mfma_f32_32x32x16_bf16 v[240:255], v[84:87], a[124:127], v[240:255]
    ds_read_b128 a[84:87], v42 offset:53248
    s_mov_b32 s30, 0xaaaaaaaa
    s_mov_b32 s31, s30
    v_mov_b32 v16, 0x3727c5ac
    s_nop 1
    v_cndmask_b32 v196, v196, v197, s[30:31]
    v_cndmask_b32 v198, v198, v199, s[30:31]
    s_mov_b32 s30, 0xcccccccc
    s_mov_b32 s31, s30
    v_mul_f32 v200, v200, v200
    v_cndmask_b32 v34, v196, v198, s[30:31]
    v_mfma_f32_32x32x16_bf16 v[224:239], v[88:91], a[64:67], v[224:239]
    ds_read_b128 a[88:91], v43 offset:49152
    v_fmamk_f32 v34, v200, 0xbb124925, v34
    v_max_f32 v34, 0, v34
    v_fmamk_f32 v34, v34, 0x3b124925, v16
    v_rsq_f32 v200, v34
    v_add_u32 v39, 69696, v36
    s_mov_b32 s80, 0x00f0000f
    s_mov_b32 s81, 0xf0000f00
    v_mfma_f32_32x32x16_bf16 v[240:255], v[88:91], a[68:71], v[240:255]
    ds_read_b128 a[92:95], v43 offset:53248
    s_mov_b64 exec, s[80:81]
    ds_write_b32 v39, v200 offset:61440
    s_mov_b64 exec, -1
    v_mul_f32 v34, v34, v200
    v_add_u32 v39, 131136, v37
    v_lshl_add_u32 v37, v38, 14, v37
    s_waitcnt lgkmcnt(6)
    v_mfma_f32_32x32x16_bf16 v[224:239], v[92:95], a[72:75], v[224:239]
    s_waitcnt lgkmcnt(0)
    s_barrier
    ds_read2_b32 v[118:119], v39 offset0:0 offset1:32
    v_mfma_f32_32x32x16_bf16 v[240:255], v[92:95], a[76:79], v[240:255]
    v_add_u32 v40, 135168, v40
    v_add_u32 v41, 135168, v41
    v_add_u32 v42, 135168, v42
    v_add_u32 v43, 135168, v43
    v_mfma_f32_32x32x16_bf16 v[224:239], v[96:99], a[80:83], v[224:239]
    v_mfma_f32_32x32x16_bf16 v[240:255], v[96:99], a[84:87], v[240:255]
    v_mfma_f32_32x32x16_bf16 v[224:239], v[100:103], a[88:91], v[224:239]
    v_mfma_f32_32x32x16_bf16 v[240:255], v[100:103], a[92:95], v[240:255]
    s_waitcnt lgkmcnt(0)
    s_nop 9
    v_pk_mul_f32 v[224:225], v[224:225], v[118:119] op_sel:[0,0] op_sel_hi:[1,0]
    v_pk_mul_f32 v[226:227], v[226:227], v[118:119] op_sel:[0,0] op_sel_hi:[1,0]
    v_cvt_pk_bf16_f32 v224, v224, v225
    s_add_u32 s31, s21, 0
    buffer_store_dword v224, v37, s[4:7], s31 offen offset:0 sc1
    v_pk_mul_f32 v[228:229], v[228:229], v[118:119] op_sel:[0,0] op_sel_hi:[1,0]
    v_cvt_pk_bf16_f32 v225, -v226, -v227
    s_add_u32 s31, s21, 8192
    buffer_store_dword v225, v37, s[4:7], s31 offen offset:0 sc1
    v_pk_mul_f32 v[230:231], v[230:231], v[118:119] op_sel:[0,0] op_sel_hi:[1,0]
    v_cvt_pk_bf16_f32 v226, v228, v229
    s_add_u32 s31, s21, 32768
    buffer_store_dword v226, v37, s[4:7], s31 offen offset:0 sc1
    v_pk_mul_f32 v[232:233], v[232:233], v[118:119] op_sel:[0,0] op_sel_hi:[1,0]
    v_cvt_pk_bf16_f32 v227, -v230, -v231
    s_add_u32 s31, s21, 40960
    buffer_store_dword v227, v37, s[4:7], s31 offen offset:0 sc1
    v_pk_mul_f32 v[234:235], v[234:235], v[118:119] op_sel:[0,0] op_sel_hi:[1,0]
    v_cvt_pk_bf16_f32 v228, v232, v233
    s_add_u32 s31, s21, 65536
    buffer_store_dword v228, v37, s[4:7], s31 offen offset:0 sc1
    v_pk_mul_f32 v[236:237], v[236:237], v[118:119] op_sel:[0,0] op_sel_hi:[1,0]
    v_cvt_pk_bf16_f32 v229, -v234, -v235
    s_add_u32 s31, s21, 73728
    buffer_store_dword v229, v37, s[4:7], s31 offen offset:0 sc1
    v_pk_mul_f32 v[238:239], v[238:239], v[118:119] op_sel:[0,0] op_sel_hi:[1,0]
    v_cvt_pk_bf16_f32 v230, v236, v237
    s_add_u32 s31, s21, 98304
    buffer_store_dword v230, v37, s[4:7], s31 offen offset:0 sc1
    v_cvt_pk_bf16_f32 v231, -v238, -v239
    s_add_u32 s31, s21, 106496
    buffer_store_dword v231, v37, s[4:7], s31 offen offset:0 sc1
    v_pk_mul_f32 v[240:241], v[240:241], v[118:119] op_sel:[0,1] op_sel_hi:[1,1]
    v_pk_mul_f32 v[242:243], v[242:243], v[118:119] op_sel:[0,1] op_sel_hi:[1,1]
    v_cvt_pk_bf16_f32 v240, v240, v241
    s_add_u32 s31, s21, 0
    buffer_store_dword v240, v37, s[4:7], s31 offen offset:128 sc1
    v_pk_mul_f32 v[244:245], v[244:245], v[118:119] op_sel:[0,1] op_sel_hi:[1,1]
    v_cvt_pk_bf16_f32 v241, -v242, -v243
    s_add_u32 s31, s21, 8192
    buffer_store_dword v241, v37, s[4:7], s31 offen offset:128 sc1
    v_pk_mul_f32 v[246:247], v[246:247], v[118:119] op_sel:[0,1] op_sel_hi:[1,1]
    v_cvt_pk_bf16_f32 v242, v244, v245
    s_add_u32 s31, s21, 32768
    buffer_store_dword v242, v37, s[4:7], s31 offen offset:128 sc1
    v_pk_mul_f32 v[248:249], v[248:249], v[118:119] op_sel:[0,1] op_sel_hi:[1,1]
    v_cvt_pk_bf16_f32 v243, -v246, -v247
    s_add_u32 s31, s21, 40960
    buffer_store_dword v243, v37, s[4:7], s31 offen offset:128 sc1
    v_pk_mul_f32 v[250:251], v[250:251], v[118:119] op_sel:[0,1] op_sel_hi:[1,1]
    v_cvt_pk_bf16_f32 v244, v248, v249
    s_add_u32 s31, s21, 65536
    buffer_store_dword v244, v37, s[4:7], s31 offen offset:128 sc1
    v_pk_mul_f32 v[252:253], v[252:253], v[118:119] op_sel:[0,1] op_sel_hi:[1,1]
    v_cvt_pk_bf16_f32 v245, -v250, -v251
    s_add_u32 s31, s21, 73728
    buffer_store_dword v245, v37, s[4:7], s31 offen offset:128 sc1
    v_pk_mul_f32 v[254:255], v[254:255], v[118:119] op_sel:[0,1] op_sel_hi:[1,1]
    v_cvt_pk_bf16_f32 v246, v252, v253
    s_add_u32 s31, s21, 98304
    buffer_store_dword v246, v37, s[4:7], s31 offen offset:128 sc1
    v_cvt_pk_bf16_f32 v247, -v254, -v255
    s_add_u32 s31, s21, 106496
    buffer_store_dword v247, v37, s[4:7], s31 offen offset:128 sc1
    s_mov_b32 s21, 0
    v_cmp_eq_u32 vcc, 0, v120
    s_cbranch_vccnz R_mdX
B_mdX:
    s_lshl_b32 s31, s16, 26
    s_mov_b64 exec, s[80:81]
    buffer_store_dword v34, v36, s[4:7], s37 offen sc1
    s_mov_b64 exec, 1
    buffer_store_dword v44, v122, s[4:7], s31 offen sc1
    s_mov_b64 exec, -1
    s_lshl4_add_u32 s30, s78, s32
    s_lshl2_add_u32 s30, s30, s36
    s_add_u32 s32, s30, 1912832
    s_waitcnt vmcnt(21)
    s_barrier
    ds_read_b128 a[64:67], v40 offset:0
    ds_read_b128 a[68:71], v42 offset:12288
    ds_read_b128 a[72:75], v41 offset:0
    ds_read_b128 a[76:79], v43 offset:12288
    ds_read_b128 a[80:83], v42 offset:0
    ds_read_b128 a[84:87], v40 offset:16384
    v_lshlrev_b32 v117, 30, v1
    v_and_b32 v117, 0x80000000, v117
    v_or_b32 v117, 1.0, v117
    v_lshrrev_b32 v13, 4, v1
    v_lshlrev_b32 v6, 11, v2
    v_lshl_add_u32 v6, v13, 9, v6
    v_and_b32 v13, 15, v1
    v_lshl_add_u32 v5, v13, 4, v6
    v_and_b32 v13, 3, v1
    v_lshl_add_u32 v6, v13, 6, v6
    v_and_b32 v13, 4, v1
    v_lshl_add_u32 v6, v13, 3, v6
    v_and_b32 v13, 8, v1
    v_lshl_add_u32 v6, v13, 5, v6
    s_lshl_b32 s100, s3, 13
    s_cmp_eq_u32 s3, 0
    s_cselect_b32 s101, 1835008, s100
    s_add_u32 s101, s101, 25296896
    v_add_u32 v7, 114688, v5
    s_waitcnt lgkmcnt(5)
    v_mfma_f32_32x32x16_bf16 v[224:239], a[64:67], v[48:51], 0
    ds_read_b128 a[88:91], v43 offset:0
    v_and_b32 v8, 0x7ff, v5
    v_add_u32 v8, 114688, v8
    v_lshrrev_b32 v4, 4, v0
    v_bfe_u32 v3, v1, 3, 1
    v_lshl_add_u32 v4, v4, 2, v3
    s_waitcnt lgkmcnt(5)
    v_mfma_f32_32x32x16_bf16 v[240:255], a[68:71], v[48:51], 0
    ds_read_b128 a[92:95], v41 offset:16384
    v_mul_u32_u24 v4, 28672, v4
    v_and_b32 v3, 0x70, v15
    v_add_u32 v4, v4, v3
    v_and_b32 v11, 7, v1
    v_and_b32 v12, 8, v1
    s_waitcnt lgkmcnt(5)
    v_mfma_f32_32x32x16_bf16 v[224:239], a[72:75], v[52:55], v[224:239]
    ds_read_b128 a[96:99], v40 offset:4096
    s_lshl2_add_u32 s30, s18, s16
    s_lshl_b32 s30, s30, 5
    s_add_u32 s30, s30, s17
    s_lshl_b32 s30, s30, 4
    s_add_u32 s30, s30, 1941504
    s_waitcnt vmcnt(19)
    s_mov_b64 exec, 1
    buffer_store_dword v1, v1, s[4:7], s30 offen sc1
    s_mov_b64 exec, -1
    v_lshlrev_b32 v12, 3, v12
    s_waitcnt lgkmcnt(5)
    v_mfma_f32_32x32x16_bf16 v[240:255], a[76:79], v[52:55], v[240:255]
    ds_read_b128 a[100:103], v42 offset:16384
    v_lshl_add_u32 v11, v11, 11, v12
    v_add_u32 v47, 1836800, v11
    s_and_b32 s30, s20, 1
    s_mul_i32 s30, s30, 7
    s_add_u32 s19, s18, s30
    s_waitcnt lgkmcnt(5)
    v_mfma_f32_32x32x16_bf16 v[224:239], a[80:83], v[56:59], v[224:239]
    ds_read_b128 a[104:107], v41 offset:4096
    s_lshl2_add_u32 s30, s97, s16
    s_mul_i32 s35, s30, 28672
    s_waitcnt lgkmcnt(5)
    v_mfma_f32_32x32x16_bf16 v[240:255], a[84:87], v[56:59], v[240:255]
    ds_read_b128 a[108:111], v43 offset:16384
    s_lshl2_add_u32 s30, s19, s16
    s_mul_i32 s30, s30, 28672
    s_sub_u32 s37, s30, s35
    s_add_u32 s37, s37, 18874368
    s_waitcnt lgkmcnt(5)
    v_mfma_f32_32x32x16_bf16 v[224:239], a[88:91], v[60:63], v[224:239]
    ds_read_b128 a[64:67], v42 offset:4096
    s_lshl1_add_u32 s20, s20, s18
    s_cmp_ge_u32 s20, 7
    s_cselect_b32 s30, 7, 0
    s_sub_u32 s20, s20, s30
    s_waitcnt lgkmcnt(5)
    v_mfma_f32_32x32x16_bf16 v[240:255], a[92:95], v[60:63], v[240:255]
    ds_read_b128 a[68:71], v40 offset:20480
    s_cmp_ge_u32 s20, 7
    s_cselect_b32 s30, -7, 0
    s_add_u32 s30, s30, s20
    s_lshl_b32 s30, s30, 12
    s_add_u32 s76, s30, s35
    s_waitcnt lgkmcnt(5)
    v_mfma_f32_32x32x16_bf16 v[224:239], a[96:99], v[64:67], v[224:239]
    ds_read_b128 a[72:75], v43 offset:4096
    s_cmp_ge_u32 s20, 6
    s_cselect_b32 s30, -6, 1
    s_add_u32 s30, s30, s20
    s_lshl_b32 s30, s30, 12
    s_add_u32 s77, s30, s35
    s_waitcnt lgkmcnt(5)
    v_mfma_f32_32x32x16_bf16 v[240:255], a[100:103], v[64:67], v[240:255]
    ds_read_b128 a[76:79], v41 offset:20480
    s_cmp_ge_u32 s20, 5
    s_cselect_b32 s30, -5, 2
    s_add_u32 s30, s30, s20
    s_lshl_b32 s30, s30, 12
    s_add_u32 s78, s30, s35
    s_waitcnt lgkmcnt(5)
    v_mfma_f32_32x32x16_bf16 v[224:239], a[104:107], v[68:71], v[224:239]
    ds_read_b128 a[80:83], v40 offset:8192
    s_waitcnt lgkmcnt(5)
    v_mfma_f32_32x32x16_bf16 v[240:255], a[108:111], v[68:71], v[240:255]
    ds_read_b128 a[84:87], v42 offset:20480
    s_cmp_ge_u32 s20, 4
    s_cselect_b32 s30, -4, 3
    s_add_u32 s30, s30, s20
    s_lshl_b32 s30, s30, 12
    s_add_u32 s79, s30, s35
    s_waitcnt lgkmcnt(5)
    v_mfma_f32_32x32x16_bf16 v[224:239], a[64:67], v[72:75], v[224:239]
    ds_read_b128 a[88:91], v41 offset:8192
    s_cmp_ge_u32 s20, 3
    s_cselect_b32 s30, -3, 4
    s_add_u32 s30, s30, s20
    s_lshl_b32 s30, s30, 12
    s_add_u32 s80, s30, s35
    s_waitcnt lgkmcnt(5)
    v_mfma_f32_32x32x16_bf16 v[240:255], a[68:71], v[72:75], v[240:255]
    ds_read_b128 a[92:95], v43 offset:20480
    s_cmp_ge_u32 s20, 2
    s_cselect_b32 s30, -2, 5
    s_add_u32 s30, s30, s20
    s_lshl_b32 s30, s30, 12
    s_add_u32 s81, s30, s35
    s_waitcnt lgkmcnt(5)
    v_mfma_f32_32x32x16_bf16 v[224:239], a[72:75], v[76:79], v[224:239]
    ds_read_b128 a[96:99], v42 offset:8192
    s_waitcnt lgkmcnt(5)
    v_mfma_f32_32x32x16_bf16 v[240:255], a[76:79], v[76:79], v[240:255]
    ds_read_b128 a[100:103], v40 offset:24576
    s_cmp_ge_u32 s20, 1
    s_cselect_b32 s30, -1, 6
    s_add_u32 s30, s30, s20
    s_lshl_b32 s30, s30, 12
    s_add_u32 s82, s30, s35
    s_waitcnt lgkmcnt(5)
    v_mfma_f32_32x32x16_bf16 v[224:239], a[80:83], v[80:83], v[224:239]
    ds_read_b128 a[104:107], v43 offset:8192
    s_lshl_b32 s36, s16, 13
    s_add_u32 s36, s36, 131072
    s_lshr_b32 s30, s16, 1
    s_lshl1_add_u32 s99, s97, s30
    s_mul_i32 s99, s99, 229376
    s_waitcnt lgkmcnt(5)
    v_mfma_f32_32x32x16_bf16 v[240:255], a[84:87], v[80:83], v[240:255]
    ds_read_b128 a[108:111], v41 offset:24576
    s_lshl2_add_u32 s30, s19, s33
    s_lshl_b32 s30, s30, 10
    s_add_u32 s99, s99, s30
    v_and_b32 v109, 15, v1
    s_waitcnt lgkmcnt(5)
    v_mfma_f32_32x32x16_bf16 v[224:239], a[88:91], v[84:87], v[224:239]
    ds_read_b128 a[64:67], v40 offset:12288
    v_lshrrev_b32 v110, 4, v1
    v_lshl_add_u32 v104, v2, 4, v109
    v_cvt_f32_u32 v104, v104
    v_lshlrev_b32 v105, 2, v110
    v_cvt_f32_u32 v105, v105
    s_waitcnt lgkmcnt(5)
    v_mfma_f32_32x32x16_bf16 v[240:255], a[92:95], v[84:87], v[240:255]
    ds_read_b128 a[68:71], v42 offset:24576
    v_cvt_f32_u32 v106, v109
    v_mul_f32 v107, 0x3c800000, v104
    v_mul_f32 v108, v107, v105
    v_bfe_i32 v111, v1, 0, 1
    s_waitcnt lgkmcnt(5)
    v_mfma_f32_32x32x16_bf16 v[224:239], a[96:99], v[88:91], v[224:239]
    ds_read_b128 a[72:75], v41 offset:12288
    v_and_b32 v111, 0x80008000, v111
    v_fmamk_f32 v109, v107, 0x00000000, v108
    v_fmamk_f32 v110, v107, 0x3f800000, v108
    v_cos_f32 v132, v109
    s_waitcnt lgkmcnt(5)
    v_mfma_f32_32x32x16_bf16 v[240:255], a[100:103], v[88:91], v[240:255]
    ds_read_b128 a[76:79], v43 offset:24576
    v_sin_f32 v109, v109
    v_cos_f32 v133, v110
    s_waitcnt lgkmcnt(5)
    v_mfma_f32_32x32x16_bf16 v[224:239], a[104:107], v[92:95], v[224:239]
    v_sin_f32 v110, v110
    v_cvt_pk_bf16_f32 v128, v132, v109
    v_cvt_pk_bf16_f32 v132, -v109, v132
    v_cvt_pk_bf16_f32 v129, v133, v110
    v_cvt_pk_bf16_f32 v133, -v110, v133
    s_waitcnt lgkmcnt(4)
    v_mfma_f32_32x32x16_bf16 v[240:255], a[108:111], v[92:95], v[240:255]
    v_fmamk_f32 v109, v107, 0x40000000, v108
    v_fmamk_f32 v110, v107, 0x40400000, v108
    v_cos_f32 v134, v109
    s_waitcnt lgkmcnt(3)
    v_mfma_f32_32x32x16_bf16 v[224:239], a[64:67], v[96:99], v[224:239]
    buffer_load_dword v126, v46, s[4:7], 0 offen sc1
    v_sin_f32 v109, v109
    s_waitcnt lgkmcnt(2)
    v_mfma_f32_32x32x16_bf16 v[240:255], a[68:71], v[96:99], v[240:255]
    v_cos_f32 v135, v110
    v_sin_f32 v110, v110
    v_cvt_pk_bf16_f32 v130, v134, v109
    v_cvt_pk_bf16_f32 v134, -v109, v134
    s_waitcnt lgkmcnt(1)
    v_mfma_f32_32x32x16_bf16 v[224:239], a[72:75], v[100:103], v[224:239]
    v_cvt_pk_bf16_f32 v131, v135, v110
    v_cvt_pk_bf16_f32 v135, -v110, v135
    v_fmamk_f32 v109, v107, 0x41800000, v108
    v_fmamk_f32 v110, v107, 0x41880000, v108
    v_cos_f32 v140, v109
    s_waitcnt lgkmcnt(0)
    v_mfma_f32_32x32x16_bf16 v[240:255], a[76:79], v[100:103], v[240:255]
    v_sin_f32 v109, v109
    v_cos_f32 v141, v110
    v_sin_f32 v110, v110
    v_cvt_pk_bf16_f32 v136, v140, v109
    v_cvt_pk_bf16_f32 v140, -v109, v140
    v_cvt_pk_bf16_f32 v137, v141, v110
    v_cvt_pk_bf16_f32 v141, -v110, v141
    v_fmamk_f32 v109, v107, 0x41900000, v108
    v_fmamk_f32 v110, v107, 0x41980000, v108
    v_cos_f32 v142, v109
    v_sin_f32 v109, v109
    v_cos_f32 v143, v110
    v_sin_f32 v110, v110
    v_pk_fma_f32 v[224:225], v[240:241], v[116:117], v[224:225] op_sel:[0,1,0] op_sel_hi:[1,1,1]
    v_pk_fma_f32 v[226:227], v[242:243], v[116:117], v[226:227] op_sel:[0,1,0] op_sel_hi:[1,1,1]
    v_pk_fma_f32 v[228:229], v[244:245], v[116:117], v[228:229] op_sel:[0,1,0] op_sel_hi:[1,1,1]
    v_pk_fma_f32 v[230:231], v[246:247], v[116:117], v[230:231] op_sel:[0,1,0] op_sel_hi:[1,1,1]
    v_pk_fma_f32 v[232:233], v[248:249], v[116:117], v[232:233] op_sel:[0,1,0] op_sel_hi:[1,1,1]
    v_pk_fma_f32 v[234:235], v[250:251], v[116:117], v[234:235] op_sel:[0,1,0] op_sel_hi:[1,1,1]
    v_pk_fma_f32 v[236:237], v[252:253], v[116:117], v[236:237] op_sel:[0,1,0] op_sel_hi:[1,1,1]
    v_pk_fma_f32 v[238:239], v[254:255], v[116:117], v[238:239] op_sel:[0,1,0] op_sel_hi:[1,1,1]
    v_cvt_pk_bf16_f32 v224, v224, v225
    v_cvt_pk_bf16_f32 v225, v226, v227
    v_cvt_pk_bf16_f32 v226, v228, v229
    v_cvt_pk_bf16_f32 v227, v230, v231
    v_cvt_pk_bf16_f32 v228, v232, v233
    v_cvt_pk_bf16_f32 v229, v234, v235
    v_cvt_pk_bf16_f32 v230, v236, v237
    v_cvt_pk_bf16_f32 v231, v238, v239
    buffer_store_dwordx4 v[224:227], v15, s[4:7], s26 offen offset:0 sc1
    buffer_store_dwordx4 v[228:231], v15, s[4:7], s26 offen offset:2048 sc1
    v_cvt_pk_bf16_f32 v138, v142, v109
    v_cvt_pk_bf16_f32 v142, -v109, v142
    v_cvt_pk_bf16_f32 v139, v143, v110
    v_cvt_pk_bf16_f32 v143, -v110, v143
    v_xor_b32 v144, v111, v128
    v_xor_b32 v145, v111, v129
    v_xor_b32 v146, v111, v130
    v_xor_b32 v147, v111, v131
    v_xor_b32 v148, v111, v132
    v_xor_b32 v149, v111, v133
    v_xor_b32 v150, v111, v134
    v_xor_b32 v151, v111, v135
    v_xor_b32 v152, v111, v136
    v_xor_b32 v153, v111, v137
    v_xor_b32 v154, v111, v138
    v_xor_b32 v155, v111, v139
    v_xor_b32 v156, v111, v140
    v_xor_b32 v157, v111, v141
    v_xor_b32 v158, v111, v142
    v_xor_b32 v159, v111, v143
    v_mul_f32 v107, 0x3a000000, v104
    v_mul_f32 v108, v107, v105
    v_fmamk_f32 v109, v107, 0x00000000, v108
    v_cos_f32 v192, v109
    v_sin_f32 v200, v109
    v_fmamk_f32 v110, v107, 0x3f800000, v108
    v_cos_f32 v193, v110
    v_sin_f32 v201, v110
    v_fmamk_f32 v109, v107, 0x40000000, v108
    v_cos_f32 v194, v109
    v_sin_f32 v202, v109
    v_fmamk_f32 v110, v107, 0x40400000, v108
    v_cos_f32 v195, v110
    v_sin_f32 v203, v110
    v_fmamk_f32 v109, v107, 0x41800000, v108
    v_cos_f32 v196, v109
    v_sin_f32 v204, v109
    v_fmamk_f32 v110, v107, 0x41880000, v108
    v_cos_f32 v197, v110
    v_sin_f32 v205, v110
    v_fmamk_f32 v109, v107, 0x41900000, v108
    v_cos_f32 v198, v109
    v_sin_f32 v206, v109
    v_fmamk_f32 v110, v107, 0x41980000, v108
    v_cos_f32 v199, v110
    v_sin_f32 v207, v110
    v_mul_f32 v107, 0x3d000000, v106
    v_mul_f32 v108, v107, v105
    v_fmamk_f32 v109, v107, 0x00000000, v108
    v_fmamk_f32 v110, v107, 0x3f800000, v108
    v_cos_f32 v164, v109
    v_sin_f32 v109, v109
    v_cos_f32 v165, v110
    v_sin_f32 v110, v110
    v_cvt_pk_bf16_f32 v160, v164, v109
    v_cvt_pk_bf16_f32 v164, -v109, v164
    v_cvt_pk_bf16_f32 v161, v165, v110
    v_cvt_pk_bf16_f32 v165, -v110, v165
    v_fmamk_f32 v109, v107, 0x40000000, v108
    v_fmamk_f32 v110, v107, 0x40400000, v108
    v_cos_f32 v166, v109
    v_sin_f32 v109, v109
    v_cos_f32 v167, v110
    v_sin_f32 v110, v110
    v_cvt_pk_bf16_f32 v162, v166, v109
    v_cvt_pk_bf16_f32 v166, -v109, v166
    v_cvt_pk_bf16_f32 v163, v167, v110
    v_cvt_pk_bf16_f32 v167, -v110, v167
    v_xor_b32 v168, v111, v160
    v_xor_b32 v169, v111, v161
    v_xor_b32 v170, v111, v162
    v_xor_b32 v171, v111, v163
    v_xor_b32 v172, v111, v164
    v_xor_b32 v173, v111, v165
    v_xor_b32 v174, v111, v166
    v_xor_b32 v175, v111, v167
    v_mov_b32 v176, v160
    v_xor_b32 v177, 0x80008000, v161
    v_mov_b32 v178, v162
    v_xor_b32 v179, 0x80008000, v163
    v_mov_b32 v180, v164
    v_xor_b32 v181, 0x80008000, v165
    v_mov_b32 v182, v166
    v_xor_b32 v183, 0x80008000, v167
    v_mov_b32 v184, v168
    v_xor_b32 v185, 0x80008000, v169
    v_mov_b32 v186, v170
    v_xor_b32 v187, 0x80008000, v171
    v_mov_b32 v188, v172
    v_xor_b32 v189, 0x80008000, v173
    v_mov_b32 v190, v174
    v_xor_b32 v191, 0x80008000, v175
    v_lshlrev_b32 v109, 4, v2
    v_cvt_f32_u32 v109, v109
    v_add_f32 v105, v105, v109
    v_add_f32 v107, 0x00000000, v106
    v_mul_f32 v107, 0x3a000000, v107
    v_mul_f32 v108, v107, v105
    v_fmamk_f32 v109, v107, 0x00000000, v108
    v_cos_f32 v208, v109
    v_sin_f32 v216, v109
    v_fmamk_f32 v110, v107, 0x3f800000, v108
    v_cos_f32 v209, v110
    v_sin_f32 v217, v110
    v_fmamk_f32 v109, v107, 0x40000000, v108
    v_cos_f32 v210, v109
    v_sin_f32 v218, v109
    v_fmamk_f32 v110, v107, 0x40400000, v108
    v_cos_f32 v211, v110
    v_sin_f32 v219, v110
    v_add_f32 v107, 0x41800000, v106
    v_mul_f32 v107, 0x3a000000, v107
    v_mul_f32 v108, v107, v105
    v_fmamk_f32 v109, v107, 0x00000000, v108
    v_cos_f32 v212, v109
    v_sin_f32 v220, v109
    v_fmamk_f32 v110, v107, 0x3f800000, v108
    v_cos_f32 v213, v110
    v_sin_f32 v221, v110
    v_fmamk_f32 v109, v107, 0x40000000, v108
    v_cos_f32 v214, v109
    v_sin_f32 v222, v109
    v_fmamk_f32 v110, v107, 0x40400000, v108
    v_cos_f32 v215, v110
    v_sin_f32 v223, v110
    s_mul_i32 s30, s16, 14336
    s_lshr_b32 s31, s35, 1
    s_sub_u32 s96, s30, s31
    s_mul_i32 s30, s17, 229376
    s_add_u32 s89, s30, s96
    s_mul_i32 s30, s18, 57344
    s_add_u32 s96, s30, s96
    s_lshr_b32 s30, s16, 1
    s_lshl_b32 s30, s30, 10
    s_add_u32 s96, s30, s96
    s_lshr_b32 s30, s76, 1
    s_add_u32 s83, s30, s89
    s_add_u32 s90, s30, s96
    s_lshr_b32 s30, s77, 1
    s_add_u32 s84, s30, s89
    s_add_u32 s91, s30, s96
    s_lshr_b32 s30, s78, 1
    s_add_u32 s85, s30, s89
    s_add_u32 s92, s30, s96
    s_lshr_b32 s30, s79, 1
    s_add_u32 s86, s30, s89
    s_add_u32 s93, s30, s96
    s_lshr_b32 s30, s80, 1
    s_add_u32 s87, s30, s89
    s_add_u32 s94, s30, s96
    s_lshr_b32 s30, s81, 1
    s_add_u32 s88, s30, s89
    s_add_u32 s95, s30, s96
    s_lshr_b32 s30, s82, 1
    s_add_u32 s89, s30, s89
    s_add_u32 s96, s30, s96
    s_waitcnt vmcnt(2)
    v_cmp_eq_u32 vcc, -1, v126
    s_nop 0
    s_lshl_b64 vcc, vcc, 32
    s_cbranch_vccnz R_mxfX
B_mxfX:
    buffer_load_dwordx4 v[16:19], v5, s[4:7], s100 offen offset:0 sc1
    buffer_load_dwordx4 v[20:23], v5, s[4:7], s100 offen offset:256 sc1
    buffer_load_dword v34, v46, s[4:7], 0 offen sc1
    buffer_load_dword v36, v45, s[4:7], 0 offen sc1
    s_branch L_prepJ
L_prepU:
    v_and_b32 v11, 3, v1
    v_lshlrev_b32 v11, 3, v11
    v_and_b32 v12, 16, v1
    v_lshl_or_b32 v11, v12, 1, v11
    v_and_b32 v12, 12, v1
    v_lshl_or_b32 v11, v12, 5, v11
    v_and_b32 v12, 8, v1
    v_lshl_or_b32 v11, v12, 3, v11
    v_lshl_or_b32 v40, v38, 10, v11
    v_xor_b32 v41, 64, v40
    s_mov_b32 s6, 34603008
    s_mov_b32 s7, 0x00020000
    s_mov_b32 s86, 256
    s_mov_b32 s87, 0x00020000
    v_accvgpr_write_b32 a0, -1
    v_accvgpr_write_b32 a1, -1
    v_accvgpr_write_b32 a2, -1
    v_accvgpr_write_b32 a3, -1
    v_and_b32 v9, 7, v1
    v_min_u32 v9, 4, v9
    v_and_b32 v11, 56, v1
    v_mul_u32_u24 v11, 56, v11
    v_lshl_add_u32 v9, v9, 4, v11
    s_mul_i32 s78, s27, 3
    s_lshr_b32 s30, s35, 2
    s_add_u32 s78, s78, s30
    s_add_u32 s78, s78, 28
    s_cmp_gt_u32 s35, 27
    s_cselect_b32 s78, 56, s78
    s_lshl2_add_u32 s22, s78, s16
    s_mov_b32 s14, 1605632
    s_mov_b32 s15, 0x00020000
    s_cmp_gt_u32 s35, 27
    s_waitcnt lgkmcnt(0)
    s_cselect_b64 s[12:13], s[76:77], s[12:13]
    s_cselect_b32 s14, 896, s14
    s_cselect_b32 s22, s16, s22
    s_mul_i32 s22, s22, 56
    s_add_u32 s22, s22, s96
    s_lshl_b32 s22, s22, 7
    s_lshl_b32 s79, s16, 10
    v_lshrrev_b32 v11, 4, v0
    v_xor_b32 v11, v11, v1
    v_and_b32 v11, 7, v11
    v_lshrrev_b32 v12, 3, v1
    v_mul_u32_u24 v12, 56, v12
    v_add_lshl_u32 v121, v11, v12, 4
    v_pk_fma_f32 v[208:209], v[112:113], v[216:217], v[208:209] op_sel_hi:[0,1,1] neg_lo:[0,0,1] neg_hi:[0,0,1]
    v_pk_fma_f32 v[210:211], v[112:113], v[218:219], v[210:211] op_sel_hi:[0,1,1] neg_lo:[0,0,1] neg_hi:[0,0,1]
    v_pk_fma_f32 v[212:213], v[112:113], v[220:221], v[212:213] op_sel_hi:[0,1,1] neg_lo:[0,0,1] neg_hi:[0,0,1]
    v_pk_fma_f32 v[214:215], v[112:113], v[222:223], v[214:215] op_sel_hi:[0,1,1] neg_lo:[0,0,1] neg_hi:[0,0,1]
    v_cvt_pk_bf16_f32 v72, v208, v209
    v_cvt_pk_bf16_f32 v73, v210, v211
    v_cvt_pk_bf16_f32 v74, v212, v213
    v_cvt_pk_bf16_f32 v75, v214, v215
    v_pk_fma_f32 v[216:217], v[112:113], v[208:209], v[216:217] op_sel_hi:[0,1,1] neg_lo:[0,0,1] neg_hi:[0,0,1]
    v_pk_fma_f32 v[218:219], v[112:113], v[210:211], v[218:219] op_sel_hi:[0,1,1] neg_lo:[0,0,1] neg_hi:[0,0,1]
    v_pk_fma_f32 v[220:221], v[112:113], v[212:213], v[220:221] op_sel_hi:[0,1,1] neg_lo:[0,0,1] neg_hi:[0,0,1]
    v_pk_fma_f32 v[222:223], v[112:113], v[214:215], v[222:223] op_sel_hi:[0,1,1] neg_lo:[0,0,1] neg_hi:[0,0,1]
    v_cvt_pk_bf16_f32 v76, v216, v217
    v_cvt_pk_bf16_f32 v77, v218, v219
    v_cvt_pk_bf16_f32 v78, v220, v221
    v_cvt_pk_bf16_f32 v79, v222, v223
    v_pk_fma_f32 v[208:209], v[112:113], v[216:217], v[208:209] op_sel_hi:[0,1,1] neg_lo:[0,0,1] neg_hi:[0,0,1]
    v_pk_fma_f32 v[210:211], v[112:113], v[218:219], v[210:211] op_sel_hi:[0,1,1] neg_lo:[0,0,1] neg_hi:[0,0,1]
    v_pk_fma_f32 v[212:213], v[112:113], v[220:221], v[212:213] op_sel_hi:[0,1,1] neg_lo:[0,0,1] neg_hi:[0,0,1]
    v_pk_fma_f32 v[214:215], v[112:113], v[222:223], v[214:215] op_sel_hi:[0,1,1] neg_lo:[0,0,1] neg_hi:[0,0,1]
    v_cvt_pk_bf16_f32 v80, v208, v209
    v_cvt_pk_bf16_f32 v81, v210, v211
    v_cvt_pk_bf16_f32 v82, v212, v213
    v_cvt_pk_bf16_f32 v83, v214, v215
    v_pk_fma_f32 v[216:217], v[112:113], v[208:209], v[216:217] op_sel_hi:[0,1,1] neg_lo:[0,0,1] neg_hi:[0,0,1]
    v_pk_fma_f32 v[218:219], v[112:113], v[210:211], v[218:219] op_sel_hi:[0,1,1] neg_lo:[0,0,1] neg_hi:[0,0,1]
    v_pk_fma_f32 v[220:221], v[112:113], v[212:213], v[220:221] op_sel_hi:[0,1,1] neg_lo:[0,0,1] neg_hi:[0,0,1]
    v_pk_fma_f32 v[222:223], v[112:113], v[214:215], v[222:223] op_sel_hi:[0,1,1] neg_lo:[0,0,1] neg_hi:[0,0,1]
    v_cvt_pk_bf16_f32 v84, v216, v217
    v_cvt_pk_bf16_f32 v85, v218, v219
    v_cvt_pk_bf16_f32 v86, v220, v221
    v_cvt_pk_bf16_f32 v87, v222, v223
    v_pk_fma_f32 v[208:209], v[112:113], v[216:217], v[208:209] op_sel_hi:[0,1,1] neg_lo:[0,0,1] neg_hi:[0,0,1]
    v_pk_fma_f32 v[210:211], v[112:113], v[218:219], v[210:211] op_sel_hi:[0,1,1] neg_lo:[0,0,1] neg_hi:[0,0,1]
    v_pk_fma_f32 v[212:213], v[112:113], v[220:221], v[212:213] op_sel_hi:[0,1,1] neg_lo:[0,0,1] neg_hi:[0,0,1]
    v_pk_fma_f32 v[214:215], v[112:113], v[222:223], v[214:215] op_sel_hi:[0,1,1] neg_lo:[0,0,1] neg_hi:[0,0,1]
    v_cvt_pk_bf16_f32 v88, v208, v209
    v_cvt_pk_bf16_f32 v89, v210, v211
    v_cvt_pk_bf16_f32 v90, v212, v213
    s_waitcnt vmcnt(8)
    s_barrier
    ds_read_b64_tr_b16 a[64:65], v40 offset:0
    ds_read_b64_tr_b16 a[66:67], v40 offset:512
    ds_read_b64_tr_b16 a[68:69], v41 offset:0
    ds_read_b64_tr_b16 a[70:71], v41 offset:512
    ds_read_b64_tr_b16 a[72:73], v40 offset:2048
    ds_read_b64_tr_b16 a[74:75], v40 offset:2560
    ds_read_b64_tr_b16 a[76:77], v41 offset:2048
    ds_read_b64_tr_b16 a[78:79], v41 offset:2560
    s_add_u32 m0, s34, 32768
    s_cmp_eq_u32 s96, 3
    s_cselect_b32 s30, s83, s82
    s_add_u32 s23, s23, s30
    buffer_load_dwordx4 v32, s[8:11], s23 offen offset:0 lds
    buffer_load_dwordx4 v33, s[8:11], s23 offen offset:1024 lds
    ds_read_b64_tr_b16 a[80:81], v40 offset:4096
    ds_read_b64_tr_b16 a[82:83], v40 offset:4608
    ds_read_b64_tr_b16 a[84:85], v41 offset:4096
    ds_read_b64_tr_b16 a[86:87], v41 offset:4608
    s_waitcnt lgkmcnt(10)
    v_mfma_f32_32x32x16_bf16 v[224:239], v[48:51], a[64:67], 0
    ds_read_b64_tr_b16 a[88:89], v40 offset:6144
    ds_read_b64_tr_b16 a[90:91], v40 offset:6656
    v_cvt_pk_bf16_f32 v91, v214, v215
    v_pk_fma_f32 v[216:217], v[112:113], v[208:209], v[216:217] op_sel_hi:[0,1,1] neg_lo:[0,0,1] neg_hi:[0,0,1]
    v_pk_fma_f32 v[218:219], v[112:113], v[210:211], v[218:219] op_sel_hi:[0,1,1] neg_lo:[0,0,1] neg_hi:[0,0,1]
    s_waitcnt lgkmcnt(10)
    v_mfma_f32_32x32x16_bf16 v[240:255], v[48:51], a[68:71], 0
    ds_read_b64_tr_b16 a[92:93], v41 offset:6144
    ds_read_b64_tr_b16 a[94:95], v41 offset:6656
    v_pk_fma_f32 v[220:221], v[112:113], v[212:213], v[220:221] op_sel_hi:[0,1,1] neg_lo:[0,0,1] neg_hi:[0,0,1]
    v_pk_fma_f32 v[222:223], v[112:113], v[214:215], v[222:223] op_sel_hi:[0,1,1] neg_lo:[0,0,1] neg_hi:[0,0,1]
    v_cvt_pk_bf16_f32 v92, v216, v217
    v_cvt_pk_bf16_f32 v93, v218, v219
    s_waitcnt lgkmcnt(10)
    v_mfma_f32_32x32x16_bf16 v[224:239], v[52:55], a[72:75], v[224:239]
    s_waitcnt vmcnt(8)
    s_barrier
    ds_read_b64_tr_b16 a[96:97], v40 offset:8192
    ds_read_b64_tr_b16 a[98:99], v40 offset:8704
    s_add_u32 m0, s34, 40960
    s_cmp_eq_u32 s96, 2
    s_cselect_b32 s30, s83, s82
    s_add_u32 s23, s23, s30
    buffer_load_dwordx4 v32, s[8:11], s23 offen offset:0 lds
    buffer_load_dwordx4 v33, s[8:11], s23 offen offset:1024 lds
    s_waitcnt lgkmcnt(10)
    v_mfma_f32_32x32x16_bf16 v[240:255], v[52:55], a[76:79], v[240:255]
    ds_read_b64_tr_b16 a[100:101], v41 offset:8192
    ds_read_b64_tr_b16 a[102:103], v41 offset:8704
    v_cvt_pk_bf16_f32 v94, v220, v221
    v_cvt_pk_bf16_f32 v95, v222, v223
    v_pk_fma_f32 v[208:209], v[112:113], v[216:217], v[208:209] op_sel_hi:[0,1,1] neg_lo:[0,0,1] neg_hi:[0,0,1]
    s_waitcnt lgkmcnt(10)
    v_mfma_f32_32x32x16_bf16 v[224:239], v[56:59], a[80:83], v[224:239]
    ds_read_b64_tr_b16 a[104:105], v40 offset:10240
    ds_read_b64_tr_b16 a[106:107], v40 offset:10752
    s_add_u32 m0, s34, 49152
    s_cmp_eq_u32 s96, 1
    s_cselect_b32 s30, s83, s82
    s_add_u32 s23, s23, s30
    buffer_load_dwordx4 v32, s[8:11], s23 offen offset:0 lds
    buffer_load_dwordx4 v33, s[8:11], s23 offen offset:1024 lds
    s_waitcnt lgkmcnt(10)
    v_mfma_f32_32x32x16_bf16 v[240:255], v[56:59], a[84:87], v[240:255]
    ds_read_b64_tr_b16 a[108:109], v41 offset:10240
    ds_read_b64_tr_b16 a[110:111], v41 offset:10752
    v_pk_fma_f32 v[210:211], v[112:113], v[218:219], v[210:211] op_sel_hi:[0,1,1] neg_lo:[0,0,1] neg_hi:[0,0,1]
    v_pk_fma_f32 v[212:213], v[112:113], v[220:221], v[212:213] op_sel_hi:[0,1,1] neg_lo:[0,0,1] neg_hi:[0,0,1]
    v_pk_fma_f32 v[214:215], v[112:113], v[222:223], v[214:215] op_sel_hi:[0,1,1] neg_lo:[0,0,1] neg_hi:[0,0,1]
    v_cvt_pk_bf16_f32 v96, v208, v209
    s_waitcnt lgkmcnt(10)
    v_mfma_f32_32x32x16_bf16 v[224:239], v[60:63], a[88:91], v[224:239]
    ds_read_b64_tr_b16 a[112:113], v40 offset:12288
    ds_read_b64_tr_b16 a[114:115], v40 offset:12800
    s_mul_i32 s30, s16, 1056
    s_add_u32 m0, s30, 81920
    s_nop 0
    buffer_load_dwordx4 v9, s[88:91], s28 offen lds
    s_waitcnt lgkmcnt(10)
    v_mfma_f32_32x32x16_bf16 v[240:255], v[60:63], a[92:95], v[240:255]
    ds_read_b64_tr_b16 a[116:117], v41 offset:12288
    ds_read_b64_tr_b16 a[118:119], v41 offset:12800
    s_mul_i32 s30, s16, 1056
    s_add_u32 m0, s30, 86144
    s_add_u32 s30, s28, 460800
    buffer_load_dwordx4 v9, s[88:91], s30 offen lds
    s_waitcnt lgkmcnt(10)
    v_mfma_f32_32x32x16_bf16 v[224:239], v[64:67], a[96:99], v[224:239]
    ds_read_b64_tr_b16 a[120:121], v40 offset:14336
    ds_read_b64_tr_b16 a[122:123], v40 offset:14848
    s_mul_i32 s30, s16, 1056
    s_add_u32 m0, s30, 90368
    s_nop 0
    buffer_load_dwordx4 v9, s[92:95], s28 offen lds
    s_waitcnt lgkmcnt(10)
    v_mfma_f32_32x32x16_bf16 v[240:255], v[64:67], a[100:103], v[240:255]
    ds_read_b64_tr_b16 a[124:125], v41 offset:14336
    ds_read_b64_tr_b16 a[126:127], v41 offset:14848
    s_mul_i32 s30, s16, 1056
    s_add_u32 m0, s30, 94592
    s_add_u32 s30, s28, 460800
    buffer_load_dwordx4 v9, s[92:95], s30 offen lds
    s_waitcnt lgkmcnt(10)
    v_mfma_f32_32x32x16_bf16 v[224:239], v[68:71], a[104:107], v[224:239]
    s_waitcnt vmcnt(14)
    s_barrier
    ds_read_b64_tr_b16 a[64:65], v40 offset:16384
    ds_read_b64_tr_b16 a[66:67], v40 offset:16896
    v_cvt_pk_bf16_f32 v97, v210, v211
    s_waitcnt lgkmcnt(10)
    v_mfma_f32_32x32x16_bf16 v[240:255], v[68:71], a[108:111], v[240:255]
    ds_read_b64_tr_b16 a[68:69], v41 offset:16384
    ds_read_b64_tr_b16 a[70:71], v41 offset:16896
    v_cvt_pk_bf16_f32 v98, v212, v213
    v_cvt_pk_bf16_f32 v99, v214, v215
    v_pk_fma_f32 v[216:217], v[112:113], v[208:209], v[216:217] op_sel_hi:[0,1,1] neg_lo:[0,0,1] neg_hi:[0,0,1]
    v_pk_fma_f32 v[218:219], v[112:113], v[210:211], v[218:219] op_sel_hi:[0,1,1] neg_lo:[0,0,1] neg_hi:[0,0,1]
    s_waitcnt lgkmcnt(10)
    v_mfma_f32_32x32x16_bf16 v[224:239], v[72:75], a[112:115], v[224:239]
    ds_read_b64_tr_b16 a[72:73], v40 offset:18432
    ds_read_b64_tr_b16 a[74:75], v40 offset:18944
    v_pk_fma_f32 v[220:221], v[112:113], v[212:213], v[220:221] op_sel_hi:[0,1,1] neg_lo:[0,0,1] neg_hi:[0,0,1]
    v_pk_fma_f32 v[222:223], v[112:113], v[214:215], v[222:223] op_sel_hi:[0,1,1] neg_lo:[0,0,1] neg_hi:[0,0,1]
    v_cvt_pk_bf16_f32 v100, v216, v217
    s_waitcnt lgkmcnt(10)
    v_mfma_f32_32x32x16_bf16 v[240:255], v[72:75], a[116:119], v[240:255]
    ds_read_b64_tr_b16 a[76:77], v41 offset:18432
    ds_read_b64_tr_b16 a[78:79], v41 offset:18944
    v_cvt_pk_bf16_f32 v101, v218, v219
    v_cvt_pk_bf16_f32 v102, v220, v221
    v_cvt_pk_bf16_f32 v103, v222, v223
    v_bfe_u32 v10, v1, 2, 3
    s_waitcnt lgkmcnt(10)
    v_mfma_f32_32x32x16_bf16 v[224:239], v[76:79], a[120:123], v[224:239]
    ds_read_b64_tr_b16 a[80:81], v40 offset:20480
    ds_read_b64_tr_b16 a[82:83], v40 offset:20992
    v_mul_u32_u24 v10, 1056, v10
    v_and_b32 v11, 3, v1
    v_lshl_add_u32 v10, v11, 3, v10
    s_waitcnt lgkmcnt(10)
    v_mfma_f32_32x32x16_bf16 v[240:255], v[76:79], a[124:127], v[240:255]
    ds_read_b64_tr_b16 a[84:85], v41 offset:20480
    ds_read_b64_tr_b16 a[86:87], v41 offset:20992
    v_mul_u32_u24 v11, 520, v38
    v_lshl_add_u32 v10, v2, 7, v10
    v_add_u32 v11, 81920, v11
    v_add_u32 v10, v10, v11
    s_waitcnt lgkmcnt(10)
    v_mfma_f32_32x32x16_bf16 v[224:239], v[80:83], a[64:67], v[224:239]
    ds_read_b64_tr_b16 a[88:89], v40 offset:22528
    ds_read_b64_tr_b16 a[90:91], v40 offset:23040
    v_and_b32 v11, 15, v1
    v_mul_u32_u24 v11, 272, v11
    v_and_b32 v12, 48, v1
    s_waitcnt lgkmcnt(10)
    v_mfma_f32_32x32x16_bf16 v[240:255], v[80:83], a[68:71], v[240:255]
    ds_read_b64_tr_b16 a[92:93], v41 offset:22528
    ds_read_b64_tr_b16 a[94:95], v41 offset:23040
    v_mul_u32_u24 v13, 208, v2
    v_sub_u32 v12, v12, v13
    v_add_u32 v12, 49152, v12
    v_add_u32 v123, v12, v11
    s_waitcnt lgkmcnt(10)
    v_mfma_f32_32x32x16_bf16 v[224:239], v[84:87], a[72:75], v[224:239]
    s_waitcnt vmcnt(10)
    s_waitcnt vmcnt(2)
    s_waitcnt vmcnt(0)
    s_barrier
    ds_read_b64_tr_b16 a[96:97], v40 offset:24576
    ds_read_b64_tr_b16 a[98:99], v40 offset:25088
    v_lshrrev_b32 v13, 4, v1
    s_waitcnt lgkmcnt(10)
    v_mfma_f32_32x32x16_bf16 v[240:255], v[84:87], a[76:79], v[240:255]
    ds_read_b64_tr_b16 a[100:101], v41 offset:24576
    ds_read_b64_tr_b16 a[102:103], v41 offset:25088
    ds_read_b64_tr_b16 a[224:225], v10 offset:0
    ds_read_b64_tr_b16 a[226:227], v10 offset:8448
    ds_read_b64_tr_b16 a[228:229], v10 offset:32
    ds_read_b64_tr_b16 a[230:231], v10 offset:8480
    ds_read_b64_tr_b16 a[232:233], v10 offset:64
    ds_read_b64_tr_b16 a[234:235], v10 offset:8512
    s_waitcnt lgkmcnt(15)
    v_mfma_f32_32x32x16_bf16 v[224:239], v[88:91], a[80:83], v[224:239]
    ds_read_b64_tr_b16 a[104:105], v40 offset:26624
    ds_read_b64_tr_b16 a[106:107], v40 offset:27136
    v_and_b32 v120, 0xf0, v15
    buffer_load_dword v120, v120, s[84:87], 0 offen sc1
    s_waitcnt lgkmcnt(15)
    v_mfma_f32_32x32x16_bf16 v[240:255], v[88:91], a[84:87], v[240:255]
    ds_read_b64_tr_b16 a[108:109], v41 offset:26624
    ds_read_b64_tr_b16 a[110:111], v41 offset:27136
    v_lshl_add_u32 v13, v2, 3, v13
    v_and_b32 v12, 0xf0, v15
    v_mul_u32_u24 v11, 272, v13
    v_add_u32 v124, v11, v12
    s_waitcnt lgkmcnt(15)
    v_mfma_f32_32x32x16_bf16 v[224:239], v[92:95], a[88:91], v[224:239]
    ds_read_b64_tr_b16 a[112:113], v40 offset:28672
    ds_read_b64_tr_b16 a[114:115], v40 offset:29184
    s_add_u32 m0, s79, 135168
    s_nop 0
    buffer_load_dwordx4 v121, s[12:15], s22 offen lds
    s_waitcnt lgkmcnt(15)
    v_mfma_f32_32x32x16_bf16 v[240:255], v[92:95], a[92:95], v[240:255]
    ds_read_b64_tr_b16 a[116:117], v41 offset:28672
    ds_read_b64_tr_b16 a[118:119], v41 offset:29184
    s_add_u32 m0, s79, 139264
    s_cmp_eq_u32 s96, 6
    s_cselect_b32 s30, -48, 8
    s_lshl4_add_u32 s22, s30, s22
    buffer_load_dwordx4 v121, s[12:15], s22 offen lds
    s_waitcnt lgkmcnt(15)
    v_mfma_f32_32x32x16_bf16 v[224:239], v[96:99], a[96:99], v[224:239]
    ds_read_b64_tr_b16 a[120:121], v40 offset:30720
    ds_read_b64_tr_b16 a[122:123], v40 offset:31232
    s_add_u32 m0, s79, 143360
    s_cmp_eq_u32 s96, 5
    s_cselect_b32 s30, -48, 8
    s_lshl4_add_u32 s22, s30, s22
    buffer_load_dwordx4 v121, s[12:15], s22 offen lds
    s_waitcnt lgkmcnt(15)
    v_mfma_f32_32x32x16_bf16 v[240:255], v[96:99], a[100:103], v[240:255]
    ds_read_b64_tr_b16 a[124:125], v41 offset:30720
    ds_read_b64_tr_b16 a[126:127], v41 offset:31232
    s_add_u32 m0, s79, 147456
    s_cmp_eq_u32 s96, 4
    s_cselect_b32 s30, -48, 8
    s_lshl4_add_u32 s22, s30, s22
    buffer_load_dwordx4 v121, s[12:15], s22 offen lds
    s_waitcnt lgkmcnt(10)
    v_mfma_f32_32x32x16_bf16 v[224:239], v[100:103], a[104:107], v[224:239]
    s_barrier
    ds_read_b64_tr_b16 a[64:65], v40 offset:32768
    ds_read_b64_tr_b16 a[66:67], v40 offset:33280
    v_lshl_add_u32 v125, v13, 13, v12
    s_waitcnt lgkmcnt(10)
    v_mfma_f32_32x32x16_bf16 v[240:255], v[100:103], a[108:111], v[240:255]
    ds_read_b64_tr_b16 a[68:69], v41 offset:32768
    ds_read_b64_tr_b16 a[70:71], v41 offset:33280
    s_add_u32 m0, s79, 151552
    s_cmp_eq_u32 s96, 3
    s_cselect_b32 s30, -48, 8
    s_lshl4_add_u32 s22, s30, s22
    buffer_load_dwordx4 v121, s[12:15], s22 offen lds
    v_pk_mul_f32 v[226:227], v[226:227], -1.0 op_sel_hi:[1,0]
    v_pk_mul_f32 v[230:231], v[230:231], -1.0 op_sel_hi:[1,0]
    v_pk_mul_f32 v[234:235], v[234:235], -1.0 op_sel_hi:[1,0]
    v_pk_mul_f32 v[238:239], v[238:239], -1.0 op_sel_hi:[1,0]
    s_waitcnt lgkmcnt(10)
    s_nop 0
    v_mfma_f32_32x32x16_bf16 v[224:239], v[48:51], a[112:115], v[224:239]
    ds_read_b64_tr_b16 a[72:73], v40 offset:34816
    ds_read_b64_tr_b16 a[74:75], v40 offset:35328
    s_add_u32 m0, s79, 155648
    s_cmp_eq_u32 s96, 2
    s_cselect_b32 s30, -48, 8
    s_lshl4_add_u32 s22, s30, s22
    buffer_load_dwordx4 v121, s[12:15], s22 offen lds
    v_pk_mul_f32 v[242:243], v[242:243], -1.0 op_sel_hi:[1,0]
    v_pk_mul_f32 v[246:247], v[246:247], -1.0 op_sel_hi:[1,0]
    v_pk_mul_f32 v[250:251], v[250:251], -1.0 op_sel_hi:[1,0]
    v_pk_mul_f32 v[254:255], v[254:255], -1.0 op_sel_hi:[1,0]
    s_waitcnt lgkmcnt(10)
    s_nop 0
    v_mfma_f32_32x32x16_bf16 v[240:255], v[48:51], a[116:119], v[240:255]
    ds_read_b64_tr_b16 a[76:77], v41 offset:34816
    ds_read_b64_tr_b16 a[78:79], v41 offset:35328
    s_add_u32 m0, s79, 159744
    s_cmp_eq_u32 s96, 1
    s_cselect_b32 s30, -48, 8
    s_lshl4_add_u32 s22, s30, s22
    buffer_load_dwordx4 v121, s[12:15], s22 offen lds
    s_waitcnt lgkmcnt(10)
    v_mfma_f32_32x32x16_bf16 v[224:239], v[52:55], a[120:123], v[224:239]
    ds_read_b64_tr_b16 a[80:81], v40 offset:36864
    ds_read_b64_tr_b16 a[82:83], v40 offset:37376
    s_waitcnt lgkmcnt(10)
    v_mfma_f32_32x32x16_bf16 v[240:255], v[52:55], a[124:127], v[240:255]
    ds_read_b64_tr_b16 a[84:85], v41 offset:36864
    ds_read_b64_tr_b16 a[86:87], v41 offset:37376
    ds_write_b128 v123, a[224:227] offset:9008
    ds_write_b128 v123, a[228:231] offset:13360
    ds_write_b128 v123, a[232:235] offset:17712
    s_waitcnt lgkmcnt(13)
    v_mfma_f32_32x32x16_bf16 v[224:239], v[56:59], a[64:67], v[224:239]
    ds_read_b64_tr_b16 a[88:89], v40 offset:38912
    ds_read_b64_tr_b16 a[90:91], v40 offset:39424
    s_lshl_b32 s38, s18, 10
    s_add_u32 s38, s38, s17
    s_lshl_b32 s38, s38, 8
    s_add_u32 s38, s38, 25305088
    s_waitcnt lgkmcnt(13)
    v_mfma_f32_32x32x16_bf16 v[240:255], v[56:59], a[68:71], v[240:255]
    ds_read_b64_tr_b16 a[92:93], v41 offset:38912
    ds_read_b64_tr_b16 a[94:95], v41 offset:39424
    s_cmp_gt_u32 s35, 27
    s_cselect_b32 s38, 0x4000000, s38
    s_waitcnt lgkmcnt(13)
    v_mfma_f32_32x32x16_bf16 v[224:239], v[60:63], a[72:75], v[224:239]
    s_waitcnt lgkmcnt(4)
    s_barrier
    ds_read_b64_tr_b16 a[96:97], v40 offset:40960
    ds_read_b64_tr_b16 a[98:99], v40 offset:41472
    s_lshr_b32 s30, s3, 4
    s_min_u32 s30, s30, 13
    s_lshl_b32 s30, s30, 9
    s_sub_u32 s31, s3, 1
    s_min_u32 s31, s31, 223
    s_lshr_b32 s31, s31, 3
    s_lshl_b32 s31, s31, 9
    s_sub_u32 s31, s31, s30
    s_add_u32 s31, s31, 8192
    s_add_u32 s30, s30, 1933312
    v_mul_u32_u24 v11, s31, v38
    v_lshl_add_u32 v11, v2, 7, v11
    v_and_b32 v12, 0x70, v15
    v_add3_u32 v46, v11, v12, s30
    v_mfma_f32_32x32x16_bf16 v[240:255], v[60:63], a[76:79], v[240:255]
    ds_read_b64_tr_b16 a[100:101], v41 offset:40960
    ds_read_b64_tr_b16 a[102:103], v41 offset:41472
    ds_read_b128 a[224:227], v124 offset:58432
    ds_read_b128 a[228:231], v124 offset:59520
    v_mfma_f32_32x32x16_bf16 v[224:239], v[64:67], a[80:83], v[224:239]
    ds_read_b64_tr_b16 a[104:105], v40 offset:43008
    ds_read_b64_tr_b16 a[106:107], v40 offset:43520
    v_mfma_f32_32x32x16_bf16 v[240:255], v[64:67], a[84:87], v[240:255]
    ds_read_b64_tr_b16 a[108:109], v41 offset:43008
    ds_read_b64_tr_b16 a[110:111], v41 offset:43520
    s_waitcnt lgkmcnt(12)
    v_mfma_f32_32x32x16_bf16 v[224:239], v[68:71], a[88:91], v[224:239]
    ds_read_b64_tr_b16 a[112:113], v40 offset:45056
    ds_read_b64_tr_b16 a[114:115], v40 offset:45568
    s_add_u32 s30, s38, 32768
    s_waitcnt lgkmcnt(7)
    buffer_store_dwordx4 a[224:227], v125, s[4:7], s38 offen sc1
    s_waitcnt lgkmcnt(6)
    buffer_store_dwordx4 a[228:231], v125, s[4:7], s30 offen sc1
    v_mfma_f32_32x32x16_bf16 v[240:255], v[68:71], a[92:95], v[240:255]
    ds_read_b64_tr_b16 a[116:117], v41 offset:45056
    ds_read_b64_tr_b16 a[118:119], v41 offset:45568
    v_mfma_f32_32x32x16_bf16 v[224:239], v[72:75], a[96:99], v[224:239]
    ds_read_b64_tr_b16 a[120:121], v40 offset:47104
    ds_read_b64_tr_b16 a[122:123], v40 offset:47616
    v_mfma_f32_32x32x16_bf16 v[240:255], v[72:75], a[100:103], v[240:255]
    ds_read_b64_tr_b16 a[124:125], v41 offset:47104
    ds_read_b64_tr_b16 a[126:127], v41 offset:47616
    s_lshl_b32 s30, s27, 11
    s_add_u32 s30, s30, 1835008
    v_min_u32 v14, 27, v1
    v_lshl_add_u32 v45, v14, 6, s30
    s_lshl_b32 s31, s35, 6
    s_add_u32 s30, s30, s31
    v_mov_b32 v122, s30
    s_getreg_b32 s30, hwreg(HW_REG_XCC_ID, 0, 4)
    v_mov_b32 v44, s30
    s_waitcnt lgkmcnt(10)
    v_mfma_f32_32x32x16_bf16 v[224:239], v[76:79], a[104:107], v[224:239]
    s_barrier
    ds_read_b64_tr_b16 a[64:65], v40 offset:49152
    ds_read_b64_tr_b16 a[66:67], v40 offset:49664
    s_waitcnt lgkmcnt(10)
    v_mfma_f32_32x32x16_bf16 v[240:255], v[76:79], a[108:111], v[240:255]
    ds_read_b64_tr_b16 a[68:69], v41 offset:49152
    ds_read_b64_tr_b16 a[70:71], v41 offset:49664
    s_waitcnt lgkmcnt(10)
    v_mfma_f32_32x32x16_bf16 v[224:239], v[80:83], a[112:115], v[224:239]
    ds_read_b64_tr_b16 a[72:73], v40 offset:51200
    ds_read_b64_tr_b16 a[74:75], v40 offset:51712
    s_lshl_b32 s29, s32, 7
    s_add_u32 s29, s29, s36
    s_add_u32 s29, s29, 1998848
    s_and_b32 s30, s3, 0xf6
    s_cmp_eq_u32 s30, 0xe0
    s_cselect_b32 s29, s29, 0x4000000
    s_waitcnt lgkmcnt(10)
    v_mfma_f32_32x32x16_bf16 v[240:255], v[80:83], a[116:119], v[240:255]
    ds_read_b64_tr_b16 a[76:77], v41 offset:51200
    ds_read_b64_tr_b16 a[78:79], v41 offset:51712
    s_waitcnt lgkmcnt(10)
    v_mfma_f32_32x32x16_bf16 v[224:239], v[84:87], a[120:123], v[224:239]
    ds_read_b64_tr_b16 a[80:81], v40 offset:53248
    ds_read_b64_tr_b16 a[82:83], v40 offset:53760
    s_mul_i32 s27, s26, 28
    s_add_u32 s27, s27, s32
    s_lshl_b32 s27, s27, 11
    s_add_u32 s27, s27, 18874368
    s_add_u32 s27, s27, s36
    s_waitcnt lgkmcnt(10)
    v_mfma_f32_32x32x16_bf16 v[240:255], v[84:87], a[124:127], v[240:255]
    ds_read_b64_tr_b16 a[84:85], v41 offset:53248
    ds_read_b64_tr_b16 a[86:87], v41 offset:53760
    s_waitcnt lgkmcnt(10)
    v_mfma_f32_32x32x16_bf16 v[224:239], v[88:91], a[64:67], v[224:239]
    ds_read_b64_tr_b16 a[88:89], v40 offset:55296
    ds_read_b64_tr_b16 a[90:91], v40 offset:55808
    s_lshl4_add_u32 s30, s26, s32
    s_lshl_b32 s30, s30, 6
    s_add_u32 s30, s30, s36
    s_add_u32 s39, s30, 1884160
    s_waitcnt lgkmcnt(10)
    v_mfma_f32_32x32x16_bf16 v[240:255], v[88:91], a[68:71], v[240:255]
    ds_read_b64_tr_b16 a[92:93], v41 offset:55296
    ds_read_b64_tr_b16 a[94:95], v41 offset:55808
    s_and_b32 s30, s78, 3
    s_mul_i32 s30, s30, 391
    s_add_u32 s26, s30, s78
    s_and_b32 s30, s32, 1
    s_mul_i32 s30, s30, -27
    s_add_u32 s26, s26, s30
    s_mul_i32 s30, s32, 28
    s_add_u32 s26, s26, s30
    s_waitcnt lgkmcnt(10)
    v_mfma_f32_32x32x16_bf16 v[224:239], v[92:95], a[72:75], v[224:239]
    v_bfe_u32 v16, v1, 1, 3
    v_xor_b32 v16, v16, v38
    v_and_b32 v17, 31, v1
    v_lshl_add_u32 v16, v17, 3, v16
    v_mov_b32 v17, 135168
    v_lshl_add_u32 v40, v16, 4, v17
    v_xor_b32 v41, 32, v40
    v_xor_b32 v42, 64, v40
    v_xor_b32 v43, 96, v40
    s_waitcnt lgkmcnt(8)
    v_mfma_f32_32x32x16_bf16 v[240:255], v[92:95], a[76:79], v[240:255]
    s_waitcnt lgkmcnt(6)
    v_mfma_f32_32x32x16_bf16 v[224:239], v[96:99], a[80:83], v[224:239]
    s_lshl_b32 s26, s26, 10
    s_add_u32 s26, s26, s36
    s_add_u32 s26, s26, 20971520
    s_waitcnt lgkmcnt(4)
    v_mfma_f32_32x32x16_bf16 v[240:255], v[96:99], a[84:87], v[240:255]
    s_cmp_gt_u32 s35, 27
    s_cselect_b32 s26, 0x4000000, s26
    s_cselect_b32 s30, s29, 0
    s_and_b32 s30, s30, 0x4000000
    s_or_b32 s36, s36, s30
    s_waitcnt lgkmcnt(2)
    v_mfma_f32_32x32x16_bf16 v[224:239], v[100:103], a[88:91], v[224:239]
    s_waitcnt lgkmcnt(0)
    v_mfma_f32_32x32x16_bf16 v[240:255], v[100:103], a[92:95], v[240:255]
    s_cmp_eq_u32 s32, 0
    s_cselect_b32 s30, -1, 0
    s_mov_b32 s31, 0
    s_nop 6
    v_cndmask_b32 v225, v225, 0, s[30:31]
    v_cvt_pk_bf16_f32 v224, v224, v225
    v_cvt_pk_bf16_f32 v225, -v226, -v227
    v_cvt_pk_bf16_f32 v226, v228, v229
    v_cvt_pk_bf16_f32 v227, -v230, -v231
    buffer_store_dwordx4 v[224:227], v15, s[4:7], s27 offen offset:0 sc1
    v_cvt_pk_bf16_f32 v232, v232, v233
    v_cvt_pk_bf16_f32 v233, -v234, -v235
    v_cvt_pk_bf16_f32 v234, v236, v237
    v_cvt_pk_bf16_f32 v235, -v238, -v239
    buffer_store_dwordx4 v[232:235], v15, s[4:7], s27 offen offset:1024 sc1
    s_cmp_eq_u32 s32, 0
    s_cselect_b32 s30, -1, 0
    s_mov_b32 s31, 0
    v_cndmask_b32 v241, v241, 0, s[30:31]
    s_add_u32 s27, s27, 28672
    v_cvt_pk_bf16_f32 v240, v240, v241
    v_cvt_pk_bf16_f32 v241, -v242, -v243
    v_cvt_pk_bf16_f32 v242, v244, v245
    v_cvt_pk_bf16_f32 v243, -v246, -v247
    buffer_store_dwordx4 v[240:243], v15, s[4:7], s27 offen offset:0 sc1
    v_cvt_pk_bf16_f32 v248, v248, v249
    v_cvt_pk_bf16_f32 v249, -v250, -v251
    v_cvt_pk_bf16_f32 v250, v252, v253
    v_cvt_pk_bf16_f32 v251, -v254, -v255
    buffer_store_dwordx4 v[248:251], v15, s[4:7], s27 offen offset:1024 sc1
    s_mov_b32 s21, 0
    s_waitcnt vmcnt(13)
    v_cmp_eq_u32 vcc, 0, v120
    s_cbranch_vccnz R_mdU
B_mdU:
    s_lshl_b32 s31, s16, 26
    s_cmp_gt_u32 s35, 27
    s_cselect_b32 s31, 0x4000000, s31
    s_mov_b64 exec, 1
    buffer_store_dword v44, v122, s[4:7], s31 offen sc1
    s_mov_b64 exec, -1
    s_lshl4_add_u32 s30, s78, s32
    s_lshl2_add_u32 s30, s30, s36
    s_add_u32 s32, s30, 1912832
    s_waitcnt vmcnt(7)
    s_barrier
    ds_read_b128 a[64:67], v40 offset:0
    ds_read_b128 a[68:71], v42 offset:12288
    ds_read_b128 a[72:75], v41 offset:0
    ds_read_b128 a[76:79], v43 offset:12288
    ds_read_b128 a[80:83], v42 offset:0
    ds_read_b128 a[84:87], v40 offset:16384
    v_lshlrev_b32 v117, 30, v1
    v_and_b32 v117, 0x80000000, v117
    v_or_b32 v117, 1.0, v117
    v_lshrrev_b32 v13, 4, v1
    v_lshlrev_b32 v6, 11, v2
    v_lshl_add_u32 v6, v13, 9, v6
    v_and_b32 v13, 15, v1
    v_lshl_add_u32 v5, v13, 4, v6
    v_and_b32 v13, 3, v1
    v_lshl_add_u32 v6, v13, 6, v6
    v_and_b32 v13, 4, v1
    v_lshl_add_u32 v6, v13, 3, v6
    v_and_b32 v13, 8, v1
    v_lshl_add_u32 v6, v13, 5, v6
    s_lshl_b32 s100, s3, 13
    s_cmp_eq_u32 s3, 0
    s_cselect_b32 s101, 1835008, s100
    s_add_u32 s101, s101, 25296896
    v_add_u32 v7, 114688, v5
    s_waitcnt lgkmcnt(5)
    v_mfma_f32_32x32x16_bf16 v[224:239], a[64:67], v[48:51], 0
    ds_read_b128 a[88:91], v43 offset:0
    v_and_b32 v8, 0x7ff, v5
    v_add_u32 v8, 114688, v8
    v_lshrrev_b32 v4, 4, v0
    v_bfe_u32 v3, v1, 3, 1
    v_lshl_add_u32 v4, v4, 2, v3
    s_waitcnt lgkmcnt(5)
    v_mfma_f32_32x32x16_bf16 v[240:255], a[68:71], v[48:51], 0
    ds_read_b128 a[92:95], v41 offset:16384
    v_mul_u32_u24 v4, 28672, v4
    v_and_b32 v3, 0x70, v15
    v_add_u32 v4, v4, v3
    v_and_b32 v11, 7, v1
    v_and_b32 v12, 8, v1
    s_waitcnt lgkmcnt(5)
    v_mfma_f32_32x32x16_bf16 v[224:239], a[72:75], v[52:55], v[224:239]
    ds_read_b128 a[96:99], v40 offset:4096
    s_lshl2_add_u32 s30, s18, s16
    s_lshl_b32 s30, s30, 5
    s_add_u32 s30, s30, s17
    s_lshl_b32 s30, s30, 4
    s_add_u32 s30, s30, 1941504
    s_cmp_gt_u32 s3, 223
    s_cselect_b32 s30, 0x4000000, s30
    s_waitcnt vmcnt(5)
    s_mov_b64 exec, 1
    buffer_store_dword v1, v1, s[4:7], s30 offen sc1
    s_mov_b64 exec, -1
    v_lshlrev_b32 v12, 3, v12
    s_waitcnt lgkmcnt(5)
    v_mfma_f32_32x32x16_bf16 v[240:255], a[76:79], v[52:55], v[240:255]
    ds_read_b128 a[100:103], v42 offset:16384
    v_lshl_add_u32 v11, v11, 11, v12
    v_add_u32 v47, 1836800, v11
    s_and_b32 s30, s20, 1
    s_mul_i32 s30, s30, 7
    s_add_u32 s19, s18, s30
    s_waitcnt lgkmcnt(5)
    v_mfma_f32_32x32x16_bf16 v[224:239], a[80:83], v[56:59], v[224:239]
    ds_read_b128 a[104:107], v41 offset:4096
    s_lshl2_add_u32 s30, s97, s16
    s_mul_i32 s35, s30, 28672
    s_waitcnt lgkmcnt(5)
    v_mfma_f32_32x32x16_bf16 v[240:255], a[84:87], v[56:59], v[240:255]
    ds_read_b128 a[108:111], v43 offset:16384
    s_lshl2_add_u32 s30, s19, s16
    s_mul_i32 s30, s30, 28672
    s_sub_u32 s37, s30, s35
    s_add_u32 s37, s37, 18874368
    s_waitcnt lgkmcnt(5)
    v_mfma_f32_32x32x16_bf16 v[224:239], a[88:91], v[60:63], v[224:239]
    ds_read_b128 a[64:67], v42 offset:4096
    s_lshl1_add_u32 s20, s20, s18
    s_cmp_ge_u32 s20, 7
    s_cselect_b32 s30, 7, 0
    s_sub_u32 s20, s20, s30
    s_waitcnt lgkmcnt(5)
    v_mfma_f32_32x32x16_bf16 v[240:255], a[92:95], v[60:63], v[240:255]
    ds_read_b128 a[68:71], v40 offset:20480
    s_cmp_ge_u32 s20, 7
    s_cselect_b32 s30, -7, 0
    s_add_u32 s30, s30, s20
    s_lshl_b32 s30, s30, 12
    s_add_u32 s76, s30, s35
    s_waitcnt lgkmcnt(5)
    v_mfma_f32_32x32x16_bf16 v[224:239], a[96:99], v[64:67], v[224:239]
    ds_read_b128 a[72:75], v43 offset:4096
    s_cmp_ge_u32 s20, 6
    s_cselect_b32 s30, -6, 1
    s_add_u32 s30, s30, s20
    s_lshl_b32 s30, s30, 12
    s_add_u32 s77, s30, s35
    s_waitcnt lgkmcnt(5)
    v_mfma_f32_32x32x16_bf16 v[240:255], a[100:103], v[64:67], v[240:255]
    ds_read_b128 a[76:79], v41 offset:20480
    s_cmp_ge_u32 s20, 5
    s_cselect_b32 s30, -5, 2
    s_add_u32 s30, s30, s20
    s_lshl_b32 s30, s30, 12
    s_add_u32 s78, s30, s35
    s_waitcnt lgkmcnt(5)
    v_mfma_f32_32x32x16_bf16 v[224:239], a[104:107], v[68:71], v[224:239]
    ds_read_b128 a[80:83], v40 offset:8192
    s_waitcnt lgkmcnt(5)
    v_mfma_f32_32x32x16_bf16 v[240:255], a[108:111], v[68:71], v[240:255]
    ds_read_b128 a[84:87], v42 offset:20480
    s_cmp_ge_u32 s20, 4
    s_cselect_b32 s30, -4, 3
    s_add_u32 s30, s30, s20
    s_lshl_b32 s30, s30, 12
    s_add_u32 s79, s30, s35
    s_waitcnt lgkmcnt(5)
    v_mfma_f32_32x32x16_bf16 v[224:239], a[64:67], v[72:75], v[224:239]
    ds_read_b128 a[88:91], v41 offset:8192
    s_cmp_ge_u32 s20, 3
    s_cselect_b32 s30, -3, 4
    s_add_u32 s30, s30, s20
    s_lshl_b32 s30, s30, 12
    s_add_u32 s80, s30, s35
    s_waitcnt lgkmcnt(5)
    v_mfma_f32_32x32x16_bf16 v[240:255], a[68:71], v[72:75], v[240:255]
    ds_read_b128 a[92:95], v43 offset:20480
    s_cmp_ge_u32 s20, 2
    s_cselect_b32 s30, -2, 5
    s_add_u32 s30, s30, s20
    s_lshl_b32 s30, s30, 12
    s_add_u32 s81, s30, s35
    s_waitcnt lgkmcnt(5)
    v_mfma_f32_32x32x16_bf16 v[224:239], a[72:75], v[76:79], v[224:239]
    ds_read_b128 a[96:99], v42 offset:8192
    s_waitcnt lgkmcnt(5)
    v_mfma_f32_32x32x16_bf16 v[240:255], a[76:79], v[76:79], v[240:255]
    ds_read_b128 a[100:103], v40 offset:24576
    s_cmp_ge_u32 s20, 1
    s_cselect_b32 s30, -1, 6
    s_add_u32 s30, s30, s20
    s_lshl_b32 s30, s30, 12
    s_add_u32 s82, s30, s35
    s_waitcnt lgkmcnt(5)
    v_mfma_f32_32x32x16_bf16 v[224:239], a[80:83], v[80:83], v[224:239]
    ds_read_b128 a[104:107], v43 offset:8192
    s_lshl_b32 s36, s16, 13
    s_add_u32 s36, s36, 131072
    s_lshr_b32 s30, s16, 1
    s_lshl1_add_u32 s99, s97, s30
    s_mul_i32 s99, s99, 229376
    s_waitcnt lgkmcnt(5)
    v_mfma_f32_32x32x16_bf16 v[240:255], a[84:87], v[80:83], v[240:255]
    ds_read_b128 a[108:111], v41 offset:24576
    s_lshl2_add_u32 s30, s19, s33
    s_lshl_b32 s30, s30, 10
    s_add_u32 s99, s99, s30
    v_and_b32 v109, 15, v1
    s_waitcnt lgkmcnt(5)
    v_mfma_f32_32x32x16_bf16 v[224:239], a[88:91], v[84:87], v[224:239]
    ds_read_b128 a[64:67], v40 offset:12288
    v_lshrrev_b32 v110, 4, v1
    v_lshl_add_u32 v104, v2, 4, v109
    v_cvt_f32_u32 v104, v104
    v_lshlrev_b32 v105, 2, v110
    v_cvt_f32_u32 v105, v105
    s_waitcnt lgkmcnt(5)
    v_mfma_f32_32x32x16_bf16 v[240:255], a[92:95], v[84:87], v[240:255]
    ds_read_b128 a[68:71], v42 offset:24576
    v_cvt_f32_u32 v106, v109
    v_mul_f32 v107, 0x3c800000, v104
    v_mul_f32 v108, v107, v105
    v_bfe_i32 v111, v1, 0, 1
    s_waitcnt lgkmcnt(5)
    v_mfma_f32_32x32x16_bf16 v[224:239], a[96:99], v[88:91], v[224:239]
    ds_read_b128 a[72:75], v41 offset:12288
    v_and_b32 v111, 0x80008000, v111
    v_fmamk_f32 v109, v107, 0x00000000, v108
    v_fmamk_f32 v110, v107, 0x3f800000, v108
    v_cos_f32 v132, v109
    s_waitcnt lgkmcnt(5)
    v_mfma_f32_32x32x16_bf16 v[240:255], a[100:103], v[88:91], v[240:255]
    ds_read_b128 a[76:79], v43 offset:24576
    v_sin_f32 v109, v109
    v_cos_f32 v133, v110
    s_waitcnt lgkmcnt(5)
    v_mfma_f32_32x32x16_bf16 v[224:239], a[104:107], v[92:95], v[224:239]
    s_waitcnt vmcnt(2)
    s_mov_b64 exec, 1
    buffer_store_dword v1, v1, s[4:7], s39 offen sc1
    s_mov_b64 exec, -1
    v_sin_f32 v110, v110
    v_cvt_pk_bf16_f32 v128, v132, v109
    s_waitcnt lgkmcnt(4)
    v_mfma_f32_32x32x16_bf16 v[240:255], a[108:111], v[92:95], v[240:255]
    v_cvt_pk_bf16_f32 v132, -v109, v132
    v_cvt_pk_bf16_f32 v129, v133, v110
    v_cvt_pk_bf16_f32 v133, -v110, v133
    v_fmamk_f32 v109, v107, 0x40000000, v108
    v_fmamk_f32 v110, v107, 0x40400000, v108
    s_waitcnt lgkmcnt(3)
    v_mfma_f32_32x32x16_bf16 v[224:239], a[64:67], v[96:99], v[224:239]
    buffer_load_dword v126, v46, s[4:7], 0 offen sc1
    v_cos_f32 v134, v109
    s_waitcnt lgkmcnt(2)
    v_mfma_f32_32x32x16_bf16 v[240:255], a[68:71], v[96:99], v[240:255]
    v_sin_f32 v109, v109
    v_cos_f32 v135, v110
    v_sin_f32 v110, v110
    s_waitcnt lgkmcnt(1)
    v_mfma_f32_32x32x16_bf16 v[224:239], a[72:75], v[100:103], v[224:239]
    v_cvt_pk_bf16_f32 v130, v134, v109
    v_cvt_pk_bf16_f32 v134, -v109, v134
    v_cvt_pk_bf16_f32 v131, v135, v110
    v_cvt_pk_bf16_f32 v135, -v110, v135
    v_fmamk_f32 v109, v107, 0x41800000, v108
    v_fmamk_f32 v110, v107, 0x41880000, v108
    s_waitcnt lgkmcnt(0)
    v_mfma_f32_32x32x16_bf16 v[240:255], a[76:79], v[100:103], v[240:255]
    v_cos_f32 v140, v109
    v_sin_f32 v109, v109
    v_cos_f32 v141, v110
    v_sin_f32 v110, v110
    v_cvt_pk_bf16_f32 v136, v140, v109
    v_cvt_pk_bf16_f32 v140, -v109, v140
    v_cvt_pk_bf16_f32 v137, v141, v110
    v_cvt_pk_bf16_f32 v141, -v110, v141
    v_fmamk_f32 v109, v107, 0x41900000, v108
    v_fmamk_f32 v110, v107, 0x41980000, v108
    v_cos_f32 v142, v109
    v_sin_f32 v109, v109
    v_cos_f32 v143, v110
    v_pk_fma_f32 v[224:225], v[240:241], v[116:117], v[224:225] op_sel:[0,1,0] op_sel_hi:[1,1,1]
    v_pk_fma_f32 v[226:227], v[242:243], v[116:117], v[226:227] op_sel:[0,1,0] op_sel_hi:[1,1,1]
    v_pk_fma_f32 v[228:229], v[244:245], v[116:117], v[228:229] op_sel:[0,1,0] op_sel_hi:[1,1,1]
    v_pk_fma_f32 v[230:231], v[246:247], v[116:117], v[230:231] op_sel:[0,1,0] op_sel_hi:[1,1,1]
    v_pk_fma_f32 v[232:233], v[248:249], v[116:117], v[232:233] op_sel:[0,1,0] op_sel_hi:[1,1,1]
    v_pk_fma_f32 v[234:235], v[250:251], v[116:117], v[234:235] op_sel:[0,1,0] op_sel_hi:[1,1,1]
    v_pk_fma_f32 v[236:237], v[252:253], v[116:117], v[236:237] op_sel:[0,1,0] op_sel_hi:[1,1,1]
    v_pk_fma_f32 v[238:239], v[254:255], v[116:117], v[238:239] op_sel:[0,1,0] op_sel_hi:[1,1,1]
    v_mul_f32 v240, 0xbeeff558, v224
    v_lshlrev_b32 v241, 2, v1
    v_cvt_pk_bf16_f32 v224, v224, v225
    v_cvt_pk_bf16_f32 v225, v226, v227
    v_cvt_pk_bf16_f32 v226, v228, v229
    v_cvt_pk_bf16_f32 v227, v230, v231
    v_cvt_pk_bf16_f32 v228, v232, v233
    v_cvt_pk_bf16_f32 v229, v234, v235
    v_cvt_pk_bf16_f32 v230, v236, v237
    v_cvt_pk_bf16_f32 v231, v238, v239
    buffer_store_dwordx4 v[224:227], v15, s[4:7], s26 offen offset:0 sc1
    buffer_store_dwordx4 v[228:231], v15, s[4:7], s26 offen offset:2048 sc1
    s_mov_b64 exec, 0xffffffff
    buffer_store_dword v240, v241, s[4:7], s29 offen sc1
    s_mov_b64 exec, -1
    v_sin_f32 v110, v110
    v_cvt_pk_bf16_f32 v138, v142, v109
    v_cvt_pk_bf16_f32 v142, -v109, v142
    v_cvt_pk_bf16_f32 v139, v143, v110
    v_cvt_pk_bf16_f32 v143, -v110, v143
    v_xor_b32 v144, v111, v128
    v_xor_b32 v145, v111, v129
    v_xor_b32 v146, v111, v130
    v_xor_b32 v147, v111, v131
    v_xor_b32 v148, v111, v132
    v_xor_b32 v149, v111, v133
    v_xor_b32 v150, v111, v134
    v_xor_b32 v151, v111, v135
    v_xor_b32 v152, v111, v136
    v_xor_b32 v153, v111, v137
    v_xor_b32 v154, v111, v138
    v_xor_b32 v155, v111, v139
    v_xor_b32 v156, v111, v140
    v_xor_b32 v157, v111, v141
    v_xor_b32 v158, v111, v142
    v_xor_b32 v159, v111, v143
    v_mul_f32 v107, 0x3a000000, v104
    v_mul_f32 v108, v107, v105
    v_fmamk_f32 v109, v107, 0x00000000, v108
    v_cos_f32 v192, v109
    v_sin_f32 v200, v109
    v_fmamk_f32 v110, v107, 0x3f800000, v108
    v_cos_f32 v193, v110
    v_sin_f32 v201, v110
    v_fmamk_f32 v109, v107, 0x40000000, v108
    v_cos_f32 v194, v109
    v_sin_f32 v202, v109
    v_fmamk_f32 v110, v107, 0x40400000, v108
    v_cos_f32 v195, v110
    v_sin_f32 v203, v110
    v_fmamk_f32 v109, v107, 0x41800000, v108
    v_cos_f32 v196, v109
    v_sin_f32 v204, v109
    v_fmamk_f32 v110, v107, 0x41880000, v108
    v_cos_f32 v197, v110
    v_sin_f32 v205, v110
    v_fmamk_f32 v109, v107, 0x41900000, v108
    v_cos_f32 v198, v109
    v_sin_f32 v206, v109
    v_fmamk_f32 v110, v107, 0x41980000, v108
    v_cos_f32 v199, v110
    v_sin_f32 v207, v110
    v_mul_f32 v107, 0x3d000000, v106
    v_mul_f32 v108, v107, v105
    v_fmamk_f32 v109, v107, 0x00000000, v108
    v_fmamk_f32 v110, v107, 0x3f800000, v108
    v_cos_f32 v164, v109
    v_sin_f32 v109, v109
    v_cos_f32 v165, v110
    v_sin_f32 v110, v110
    v_cvt_pk_bf16_f32 v160, v164, v109
    v_cvt_pk_bf16_f32 v164, -v109, v164
    v_cvt_pk_bf16_f32 v161, v165, v110
    v_cvt_pk_bf16_f32 v165, -v110, v165
    v_fmamk_f32 v109, v107, 0x40000000, v108
    v_fmamk_f32 v110, v107, 0x40400000, v108
    v_cos_f32 v166, v109
    v_sin_f32 v109, v109
    v_cos_f32 v167, v110
    v_sin_f32 v110, v110
    v_cvt_pk_bf16_f32 v162, v166, v109
    v_cvt_pk_bf16_f32 v166, -v109, v166
    v_cvt_pk_bf16_f32 v163, v167, v110
    v_cvt_pk_bf16_f32 v167, -v110, v167
    v_xor_b32 v168, v111, v160
    v_xor_b32 v169, v111, v161
    v_xor_b32 v170, v111, v162
    v_xor_b32 v171, v111, v163
    v_xor_b32 v172, v111, v164
    v_xor_b32 v173, v111, v165
    v_xor_b32 v174, v111, v166
    v_xor_b32 v175, v111, v167
    v_mov_b32 v176, v160
    v_xor_b32 v177, 0x80008000, v161
    v_mov_b32 v178, v162
    v_xor_b32 v179, 0x80008000, v163
    v_mov_b32 v180, v164
    v_xor_b32 v181, 0x80008000, v165
    v_mov_b32 v182, v166
    v_xor_b32 v183, 0x80008000, v167
    v_mov_b32 v184, v168
    v_xor_b32 v185, 0x80008000, v169
    v_mov_b32 v186, v170
    v_xor_b32 v187, 0x80008000, v171
    v_mov_b32 v188, v172
    v_xor_b32 v189, 0x80008000, v173
    v_mov_b32 v190, v174
    v_xor_b32 v191, 0x80008000, v175
    v_lshlrev_b32 v109, 4, v2
    v_cvt_f32_u32 v109, v109
    v_add_f32 v105, v105, v109
    v_add_f32 v107, 0x00000000, v106
    v_mul_f32 v107, 0x3a000000, v107
    v_mul_f32 v108, v107, v105
    v_fmamk_f32 v109, v107, 0x00000000, v108
    v_cos_f32 v208, v109
    v_sin_f32 v216, v109
    v_fmamk_f32 v110, v107, 0x3f800000, v108
    v_cos_f32 v209, v110
    v_sin_f32 v217, v110
    v_fmamk_f32 v109, v107, 0x40000000, v108
    v_cos_f32 v210, v109
    v_sin_f32 v218, v109
    v_fmamk_f32 v110, v107, 0x40400000, v108
    v_cos_f32 v211, v110
    v_sin_f32 v219, v110
    v_add_f32 v107, 0x41800000, v106
    v_mul_f32 v107, 0x3a000000, v107
    v_mul_f32 v108, v107, v105
    v_fmamk_f32 v109, v107, 0x00000000, v108
    v_cos_f32 v212, v109
    v_sin_f32 v220, v109
    v_fmamk_f32 v110, v107, 0x3f800000, v108
    v_cos_f32 v213, v110
    v_sin_f32 v221, v110
    v_fmamk_f32 v109, v107, 0x40000000, v108
    v_cos_f32 v214, v109
    v_sin_f32 v222, v109
    v_fmamk_f32 v110, v107, 0x40400000, v108
    v_cos_f32 v215, v110
    v_sin_f32 v223, v110
    s_mul_i32 s30, s16, 14336
    s_lshr_b32 s31, s35, 1
    s_sub_u32 s96, s30, s31
    s_mul_i32 s30, s17, 229376
    s_add_u32 s89, s30, s96
    s_mul_i32 s30, s18, 57344
    s_add_u32 s96, s30, s96
    s_lshr_b32 s30, s16, 1
    s_lshl_b32 s30, s30, 10
    s_add_u32 s96, s30, s96
    s_lshr_b32 s30, s76, 1
    s_add_u32 s83, s30, s89
    s_add_u32 s90, s30, s96
    s_lshr_b32 s30, s77, 1
    s_add_u32 s84, s30, s89
    s_add_u32 s91, s30, s96
    s_lshr_b32 s30, s78, 1
    s_add_u32 s85, s30, s89
    s_add_u32 s92, s30, s96
    s_lshr_b32 s30, s79, 1
    s_add_u32 s86, s30, s89
    s_add_u32 s93, s30, s96
    s_lshr_b32 s30, s80, 1
    s_add_u32 s87, s30, s89
    s_add_u32 s94, s30, s96
    s_lshr_b32 s30, s81, 1
    s_add_u32 s88, s30, s89
    s_add_u32 s95, s30, s96
    s_lshr_b32 s30, s82, 1
    s_add_u32 s89, s30, s89
    s_add_u32 s96, s30, s96
    s_waitcnt vmcnt(3)
    v_cmp_eq_u32 vcc, -1, v126
    s_nop 0
    s_lshl_b64 vcc, vcc, 32
    s_cbranch_vccnz R_mxfU
B_mxfU:
    buffer_load_dwordx4 v[16:19], v5, s[4:7], s100 offen offset:0 sc1
    buffer_load_dwordx4 v[20:23], v5, s[4:7], s100 offen offset:256 sc1
    buffer_load_dword v34, v46, s[4:7], 0 offen sc1
    buffer_load_dword v36, v45, s[4:7], 0 offen sc1
    s_cmp_gt_u32 s3, 223
    s_cbranch_scc1 J_help3
L_prepJ:
    s_lshl2_add_u32 s22, s19, s16
    s_lshr_b32 s22, s22, 1
    s_lshl_b32 s22, s22, 10
    s_add_u32 s22, s22, 1884160
    v_min_u32 v3, 13, v1
    v_lshlrev_b32 v3, 6, v3
    buffer_load_dword v3, v3, s[4:7], s22 offen sc1
    buffer_load_dword v35, v47, s[4:7], 0 offen offset:4 sc1
    s_waitcnt vmcnt(2)
    v_cmp_eq_u32 vcc, -1, v36
    s_cbranch_vccnz R_mvU
B_mvU:
    v_cmp_ne_u32 vcc, v44, v36
    s_nop 0
    s_cmp_eq_u64 vcc, 0
    s_cselect_b32 s98, 1, 0
    s_cmp_eq_u32 s98, 0
    s_cbranch_scc1 A_0
    s_add_u32 s23, s99, 10485760
    buffer_store_dwordx4 a[0:3], v15, s[4:7], s23 offen offset:0
    buffer_store_dwordx4 a[0:3], v15, s[4:7], s23 offen offset:2048
    s_add_u32 s23, s99, 10543104
    buffer_store_dwordx4 a[0:3], v15, s[4:7], s23 offen offset:0
    buffer_store_dwordx4 a[0:3], v15, s[4:7], s23 offen offset:2048
    s_add_u32 s23, s99, 10600448
    buffer_store_dwordx4 a[0:3], v15, s[4:7], s23 offen offset:0
    buffer_store_dwordx4 a[0:3], v15, s[4:7], s23 offen offset:2048
    s_add_u32 s23, s99, 10657792
    buffer_store_dwordx4 a[0:3], v15, s[4:7], s23 offen offset:0
    buffer_store_dwordx4 a[0:3], v15, s[4:7], s23 offen offset:2048
AB_0:
    s_waitcnt vmcnt(9)
    v_cmp_eq_u32 vcc, -1, v3
    s_cbranch_vccnz R_mf1
B_mf1:
    s_mul_i32 s34, s16, 28672
    s_add_u32 m0, s34, 0
    s_add_u32 s34, s76, s37
    buffer_load_dwordx4 v15, s[4:7], s34 offen offset:0 lds
    buffer_load_dwordx4 v15, s[4:7], s34 offen offset:1024 lds
    s_mul_i32 s34, s16, 28672
    s_add_u32 m0, s34, 0
    s_add_u32 s34, s76, s37
    buffer_load_dwordx4 v15, s[4:7], s34 offen offset:2048 lds
    buffer_load_dwordx4 v15, s[4:7], s34 offen offset:3072 lds
    s_mul_i32 s34, s16, 28672
    s_add_u32 m0, s34, 4096
    s_add_u32 s34, s77, s37
    buffer_load_dwordx4 v15, s[4:7], s34 offen offset:0 lds
    buffer_load_dwordx4 v15, s[4:7], s34 offen offset:1024 lds
    s_load_dwordx2 s[8:9], s[0:1], 64
    s_mov_b32 s10, 1835008
    s_mov_b32 s11, 0x00020000
    s_load_dwordx2 s[12:13], s[0:1], 40
    s_mov_b32 s14, 3584
    s_mov_b32 s15, 0x00020000
    s_cmp_eq_u32 s3, 0
    s_cselect_b32 s28, 0, 1.0
    s_cselect_b32 s29, 0, -1.0
    s_cselect_b32 s27, 0xffff, -1
    v_max3_u32 v13, v16, v17, v18
    v_max3_u32 v13, v13, v19, v20
    v_max3_u32 v13, v13, v21, v22
    v_max_u32 v13, v13, v23
    v_cmp_eq_u32 vcc, -1, v13
    s_cbranch_vccnz R_mc0
B_mc0:
    v_cmp_eq_u32 vcc, -1, v34
    s_nop 0
    s_lshr_b64 vcc, vcc, 32
    s_cbranch_vccnz R_mwf
B_mwf:
    buffer_load_dwordx4 v[48:51], v6, s[4:7], s101 offen offset:0 sc1
    buffer_load_dwordx4 v[52:55], v6, s[4:7], s101 offen offset:16 sc1
    s_mov_b32 s31, 1957888
    buffer_load_dwordx4 v[24:27], v5, s[4:7], s31 offen offset:0 sc1
    buffer_load_dwordx4 v[28:31], v5, s[4:7], s31 offen offset:256 sc1
    v_and_b32 v120, s27, v16
    v_and_b32 v121, s27, v17
    v_and_b32 v122, s27, v18
    v_and_b32 v123, s27, v19
    v_and_b32 v124, s27, v20
    v_and_b32 v125, s27, v21
    v_and_b32 v126, s27, v22
    v_and_b32 v127, s27, v23
    ds_write_b128 v7, v[120:123] offset:0
    ds_write_b128 v7, v[124:127] offset:256
    v_lshlrev_b32 v56, 16, v16
    v_and_b32 v64, 0xffff0000, v16
    v_lshlrev_b32 v57, 16, v17
    v_and_b32 v65, 0xffff0000, v17
    v_lshlrev_b32 v58, 16, v18
    v_and_b32 v66, 0xffff0000, v18
    v_lshlrev_b32 v59, 16, v19
    v_and_b32 v67, 0xffff0000, v19
    v_lshlrev_b32 v60, 16, v20
    v_and_b32 v68, 0xffff0000, v20
    v_lshlrev_b32 v61, 16, v21
    v_and_b32 v69, 0xffff0000, v21
    v_lshlrev_b32 v62, 16, v22
    v_and_b32 v70, 0xffff0000, v22
    v_lshlrev_b32 v63, 16, v23
    v_and_b32 v71, 0xffff0000, v23
    s_waitcnt lgkmcnt(0)
    s_barrier
    ds_read_b128 v[224:227], v8 offset:0
    ds_read_b128 v[228:231], v8 offset:2048
    ds_read_b128 v[232:235], v8 offset:4096
    ds_read_b128 v[236:239], v8 offset:6144
    ds_read_b128 v[240:243], v8 offset:256
    ds_read_b128 v[244:247], v8 offset:2304
    ds_read_b128 v[248:251], v8 offset:4352
    ds_read_b128 v[252:255], v8 offset:6400
    s_waitcnt lgkmcnt(7)
    v_mfma_f32_16x16x32_bf16 v[88:91], v[224:227], v[128:131], 0
    v_mfma_f32_16x16x32_bf16 v[92:95], v[224:227], v[132:135], 0
    s_waitcnt lgkmcnt(6)
    v_mfma_f32_16x16x32_bf16 v[88:91], v[228:231], v[136:139], v[88:91]
    v_mfma_f32_16x16x32_bf16 v[92:95], v[228:231], v[140:143], v[92:95]
    s_waitcnt lgkmcnt(5)
    v_mfma_f32_16x16x32_bf16 v[88:91], v[232:235], v[144:147], v[88:91]
    v_mfma_f32_16x16x32_bf16 v[92:95], v[232:235], v[148:151], v[92:95]
    s_waitcnt lgkmcnt(4)
    v_mfma_f32_16x16x32_bf16 v[88:91], v[236:239], v[152:155], v[88:91]
    v_mfma_f32_16x16x32_bf16 v[92:95], v[236:239], v[156:159], v[92:95]
    s_waitcnt lgkmcnt(3)
    v_mfma_f32_16x16x32_bf16 v[96:99], v[240:243], v[128:131], 0
    v_mfma_f32_16x16x32_bf16 v[100:103], v[240:243], v[132:135], 0
    s_waitcnt lgkmcnt(2)
    v_mfma_f32_16x16x32_bf16 v[96:99], v[244:247], v[136:139], v[96:99]
    v_mfma_f32_16x16x32_bf16 v[100:103], v[244:247], v[140:143], v[100:103]
    s_waitcnt lgkmcnt(1)
    v_mfma_f32_16x16x32_bf16 v[96:99], v[248:251], v[144:147], v[96:99]
    v_mfma_f32_16x16x32_bf16 v[100:103], v[248:251], v[148:151], v[100:103]
    s_waitcnt lgkmcnt(0)
    v_mfma_f32_16x16x32_bf16 v[96:99], v[252:255], v[152:155], v[96:99]
    v_mfma_f32_16x16x32_bf16 v[100:103], v[252:255], v[156:159], v[100:103]
    v_pk_mul_f32 v[104:105], v[88:89], v[192:193]
    v_pk_mul_f32 v[112:113], v[92:93], v[192:193]
    v_pk_fma_f32 v[104:105], v[92:93], v[200:201], v[104:105]
    v_pk_fma_f32 v[112:113], v[88:89], v[200:201], v[112:113] neg_lo:[1,0,0] neg_hi:[1,0,0]
    v_pk_mul_f32 v[106:107], v[90:91], v[194:195]
    v_pk_mul_f32 v[114:115], v[94:95], v[194:195]
    v_pk_fma_f32 v[106:107], v[94:95], v[202:203], v[106:107]
    v_pk_fma_f32 v[114:115], v[90:91], v[202:203], v[114:115] neg_lo:[1,0,0] neg_hi:[1,0,0]
    v_cvt_pk_bf16_f32 v120, v104, v112
    v_cvt_pk_bf16_f32 v121, v105, v113
    v_cvt_pk_bf16_f32 v122, v106, v114
    v_cvt_pk_bf16_f32 v123, v107, v115
    v_pk_mul_f32 v[108:109], v[96:97], v[196:197]
    v_pk_mul_f32 v[116:117], v[100:101], v[196:197]
    v_pk_fma_f32 v[108:109], v[100:101], v[204:205], v[108:109]
    v_pk_fma_f32 v[116:117], v[96:97], v[204:205], v[116:117] neg_lo:[1,0,0] neg_hi:[1,0,0]
    v_pk_mul_f32 v[110:111], v[98:99], v[198:199]
    v_pk_mul_f32 v[118:119], v[102:103], v[198:199]
    v_pk_fma_f32 v[110:111], v[102:103], v[206:207], v[110:111]
    v_pk_fma_f32 v[118:119], v[98:99], v[206:207], v[118:119] neg_lo:[1,0,0] neg_hi:[1,0,0]
    v_cvt_pk_bf16_f32 v124, v108, v116
    v_cvt_pk_bf16_f32 v125, v109, v117
    v_cvt_pk_bf16_f32 v126, v110, v118
    v_cvt_pk_bf16_f32 v127, v111, v119
    v_mfma_f32_16x16x32_bf16 v[88:91], v[160:163], v[120:123], 0
    v_mfma_f32_16x16x32_bf16 v[92:95], v[164:167], v[120:123], 0
    v_mfma_f32_16x16x32_bf16 v[88:91], v[168:171], v[124:127], v[88:91]
    v_mfma_f32_16x16x32_bf16 v[92:95], v[172:175], v[124:127], v[92:95]
    v_mfma_f32_16x16x32_bf16 v[96:99], v[176:179], v[120:123], 0
    v_mfma_f32_16x16x32_bf16 v[100:103], v[180:183], v[120:123], 0
    v_mfma_f32_16x16x32_bf16 v[96:99], v[184:187], v[124:127], v[96:99]
    v_mfma_f32_16x16x32_bf16 v[100:103], v[188:191], v[124:127], v[100:103]
    s_mov_b64 exec, 1
    buffer_store_dword v1, v1, s[4:7], s32 offen sc1
    s_mov_b64 exec, -1
    s_mov_b32 s30, 0x3a000000
    s_mov_b32 s31, 0x3a000000
    s_waitcnt vmcnt(4)
    v_lshlrev_b32 v72, 16, v48
    v_and_b32 v73, 0xffff0000, v48
    v_lshlrev_b32 v80, 16, v50
    v_and_b32 v81, 0xffff0000, v50
    v_lshlrev_b32 v74, 16, v49
    v_and_b32 v75, 0xffff0000, v49
    v_lshlrev_b32 v82, 16, v51
    v_and_b32 v83, 0xffff0000, v51
    s_waitcnt vmcnt(3)
    v_lshlrev_b32 v76, 16, v52
    v_and_b32 v77, 0xffff0000, v52
    v_lshlrev_b32 v84, 16, v54
    v_and_b32 v85, 0xffff0000, v54
    v_lshlrev_b32 v78, 16, v53
    v_and_b32 v79, 0xffff0000, v53
    v_lshlrev_b32 v86, 16, v55
    v_and_b32 v87, 0xffff0000, v55
    v_pk_mul_f32 v[72:73], v[72:73], s[30:31]
    v_pk_mul_f32 v[80:81], v[80:81], s[30:31]
    v_pk_mul_f32 v[74:75], v[74:75], s[30:31]
    v_pk_mul_f32 v[82:83], v[82:83], s[30:31]
    v_pk_mul_f32 v[76:77], v[76:77], s[30:31]
    v_pk_mul_f32 v[84:85], v[84:85], s[30:31]
    v_pk_mul_f32 v[78:79], v[78:79], s[30:31]
    v_pk_mul_f32 v[86:87], v[86:87], s[30:31]
    v_pk_mul_f32 v[104:105], v[88:89], v[72:73]
    v_pk_mul_f32 v[112:113], v[88:89], v[80:81]
    v_pk_fma_f32 v[104:105], v[92:93], v[80:81], v[104:105] neg_lo:[1,0,0] neg_hi:[1,0,0]
    v_pk_fma_f32 v[112:113], v[92:93], v[72:73], v[112:113]
    v_pk_mul_f32 v[106:107], v[90:91], v[74:75]
    v_pk_mul_f32 v[114:115], v[90:91], v[82:83]
    v_pk_fma_f32 v[106:107], v[94:95], v[82:83], v[106:107] neg_lo:[1,0,0] neg_hi:[1,0,0]
    v_pk_fma_f32 v[114:115], v[94:95], v[74:75], v[114:115]
    v_cvt_pk_bf16_f32 v120, v104, -v112
    v_cvt_pk_bf16_f32 v121, v105, -v113
    v_cvt_pk_bf16_f32 v122, v106, -v114
    v_cvt_pk_bf16_f32 v123, v107, -v115
    v_pk_mul_f32 v[108:109], v[96:97], v[76:77]
    v_pk_mul_f32 v[116:117], v[96:97], v[84:85]
    v_pk_fma_f32 v[108:109], v[100:101], v[84:85], v[108:109] neg_lo:[1,0,0] neg_hi:[1,0,0]
    v_pk_fma_f32 v[116:117], v[100:101], v[76:77], v[116:117]
    v_pk_mul_f32 v[110:111], v[98:99], v[78:79]
    v_pk_mul_f32 v[118:119], v[98:99], v[86:87]
    v_pk_fma_f32 v[110:111], v[102:103], v[86:87], v[110:111] neg_lo:[1,0,0] neg_hi:[1,0,0]
    v_pk_fma_f32 v[118:119], v[102:103], v[78:79], v[118:119]
    v_cvt_pk_bf16_f32 v124, v108, -v116
    v_cvt_pk_bf16_f32 v125, v109, -v117
    v_cvt_pk_bf16_f32 v126, v110, -v118
    v_cvt_pk_bf16_f32 v127, v111, -v119
    s_mul_i32 s34, s16, 28672
    s_add_u32 m0, s34, 4096
    s_add_u32 s34, s77, s37
    buffer_load_dwordx4 v15, s[4:7], s34 offen offset:2048 lds
    buffer_load_dwordx4 v15, s[4:7], s34 offen offset:3072 lds
    s_mul_i32 s34, s16, 28672
    s_add_u32 m0, s34, 8192
    s_add_u32 s34, s78, s37
    buffer_load_dwordx4 v15, s[4:7], s34 offen offset:0 lds
    buffer_load_dwordx4 v15, s[4:7], s34 offen offset:1024 lds
    v_mfma_f32_16x16x32_bf16 v[88:91], v[120:123], v[160:163], 0
    v_mfma_f32_16x16x32_bf16 v[92:95], v[120:123], v[164:167], 0
    v_mfma_f32_16x16x32_bf16 v[88:91], v[124:127], v[168:171], v[88:91]
    v_mfma_f32_16x16x32_bf16 v[92:95], v[124:127], v[172:175], v[92:95]
    v_mfma_f32_16x16x32_bf16 v[96:99], v[120:123], v[176:179], 0
    v_mfma_f32_16x16x32_bf16 v[100:103], v[120:123], v[180:183], 0
    v_mfma_f32_16x16x32_bf16 v[96:99], v[124:127], v[184:187], v[96:99]
    v_mfma_f32_16x16x32_bf16 v[100:103], v[124:127], v[188:191], v[100:103]
    s_mul_i32 s34, s16, 28672
    s_add_u32 m0, s34, 8192
    s_add_u32 s34, s78, s37
    buffer_load_dwordx4 v15, s[4:7], s34 offen offset:2048 lds
    buffer_load_dwordx4 v15, s[4:7], s34 offen offset:3072 lds
    s_mul_i32 s34, s16, 28672
    s_add_u32 m0, s34, 12288
    s_add_u32 s34, s79, s37
    buffer_load_dwordx4 v15, s[4:7], s34 offen offset:0 lds
    buffer_load_dwordx4 v15, s[4:7], s34 offen offset:1024 lds
    v_pk_mul_f32 v[104:105], v[88:89], v[208:209]
    v_pk_mul_f32 v[112:113], v[92:93], v[208:209]
    v_pk_fma_f32 v[104:105], v[92:93], v[216:217], v[104:105]
    v_pk_fma_f32 v[112:113], v[88:89], v[216:217], v[112:113] neg_lo:[1,0,0] neg_hi:[1,0,0]
    v_pk_mul_f32 v[106:107], v[90:91], v[210:211]
    v_pk_mul_f32 v[114:115], v[94:95], v[210:211]
    v_pk_fma_f32 v[106:107], v[94:95], v[218:219], v[106:107]
    v_pk_fma_f32 v[114:115], v[90:91], v[218:219], v[114:115] neg_lo:[1,0,0] neg_hi:[1,0,0]
    v_cvt_pk_bf16_f32 v120, v104, v112
    v_cvt_pk_bf16_f32 v121, v105, v113
    v_cvt_pk_bf16_f32 v122, v106, v114
    v_cvt_pk_bf16_f32 v123, v107, v115
    v_pk_mul_f32 v[108:109], v[96:97], v[212:213]
    v_pk_mul_f32 v[116:117], v[100:101], v[212:213]
    v_pk_fma_f32 v[108:109], v[100:101], v[220:221], v[108:109]
    v_pk_fma_f32 v[116:117], v[96:97], v[220:221], v[116:117] neg_lo:[1,0,0] neg_hi:[1,0,0]
    v_pk_mul_f32 v[110:111], v[98:99], v[214:215]
    v_pk_mul_f32 v[118:119], v[102:103], v[214:215]
    v_pk_fma_f32 v[110:111], v[102:103], v[222:223], v[110:111]
    v_pk_fma_f32 v[118:119], v[98:99], v[222:223], v[118:119] neg_lo:[1,0,0] neg_hi:[1,0,0]
    v_cvt_pk_bf16_f32 v124, v108, v116
    v_cvt_pk_bf16_f32 v125, v109, v117
    v_cvt_pk_bf16_f32 v126, v110, v118
    v_cvt_pk_bf16_f32 v127, v111, v119
    s_waitcnt vmcnt(10)
    v_max3_u32 v13, v24, v25, v26
    s_waitcnt vmcnt(9)
    v_max3_u32 v13, v13, v27, v28
    v_max3_u32 v13, v13, v29, v30
    v_max_u32 v13, v13, v31
    v_cmp_eq_u32 vcc, -1, v13
    s_cbranch_vccnz R_mq0
B_mq0:
    v_pk_mul_f32 v[56:57], v[56:57], v[24:25]
    v_pk_mul_f32 v[64:65], v[64:65], v[24:25]
    v_pk_mul_f32 v[58:59], v[58:59], v[26:27]
    v_pk_mul_f32 v[66:67], v[66:67], v[26:27]
    v_pk_mul_f32 v[60:61], v[60:61], v[28:29]
    v_pk_mul_f32 v[68:69], v[68:69], v[28:29]
    v_pk_mul_f32 v[62:63], v[62:63], v[30:31]
    v_pk_mul_f32 v[70:71], v[70:71], v[30:31]
    ds_write_b128 v7, v[120:123] offset:8192
    ds_write_b128 v7, v[124:127] offset:8448
    s_lshl_b32 s23, s3, 7
    s_add_u32 s24, s23, 2097152
    s_add_u32 s25, s23, 2154496
    s_waitcnt lgkmcnt(0)
    s_barrier
    v_cmp_eq_u32 vcc, -1, v35
    s_cbranch_vccnz R_mc30
B_mc30:
    ds_read_b128 v[224:227], v8 offset:8192
    ds_read_b128 v[228:231], v8 offset:10240
    ds_read_b128 v[232:235], v8 offset:12288
    ds_read_b128 v[236:239], v8 offset:14336
    ds_read_b128 v[240:243], v8 offset:8448
    ds_read_b128 v[244:247], v8 offset:10496
    ds_read_b128 v[248:251], v8 offset:12544
    ds_read_b128 v[252:255], v8 offset:14592
    s_lshl_b32 s22, s16, 5
    s_add_u32 s22, s22, s3
    s_cmp_gt_u32 s22, 31
    s_cbranch_scc1 L_nogo0
    s_add_u32 s23, s23, 1916928
    s_mov_b64 exec, 1
    buffer_store_dword v1, v1, s[4:7], s23 offen sc1
    s_mov_b64 exec, -1
L_nogo0:
    s_waitcnt lgkmcnt(7)
    v_mfma_f32_16x16x32_bf16 v[88:91], v[128:131], v[224:227], 0
    v_mfma_f32_16x16x32_bf16 v[92:95], v[132:135], v[224:227], 0
    s_waitcnt lgkmcnt(6)
    v_mfma_f32_16x16x32_bf16 v[88:91], v[136:139], v[228:231], v[88:91]
    v_mfma_f32_16x16x32_bf16 v[92:95], v[140:143], v[228:231], v[92:95]
    s_waitcnt lgkmcnt(5)
    v_mfma_f32_16x16x32_bf16 v[88:91], v[144:147], v[232:235], v[88:91]
    v_mfma_f32_16x16x32_bf16 v[92:95], v[148:151], v[232:235], v[92:95]
    s_waitcnt lgkmcnt(4)
    v_mfma_f32_16x16x32_bf16 v[88:91], v[152:155], v[236:239], v[88:91]
    v_mfma_f32_16x16x32_bf16 v[92:95], v[156:159], v[236:239], v[92:95]
    s_waitcnt lgkmcnt(3)
    v_mfma_f32_16x16x32_bf16 v[96:99], v[128:131], v[240:243], 0
    v_mfma_f32_16x16x32_bf16 v[100:103], v[132:135], v[240:243], 0
    s_waitcnt lgkmcnt(2)
    v_mfma_f32_16x16x32_bf16 v[96:99], v[136:139], v[244:247], v[96:99]
    v_mfma_f32_16x16x32_bf16 v[100:103], v[140:143], v[244:247], v[100:103]
    s_waitcnt lgkmcnt(1)
    v_mfma_f32_16x16x32_bf16 v[96:99], v[144:147], v[248:251], v[96:99]
    v_mfma_f32_16x16x32_bf16 v[100:103], v[148:151], v[248:251], v[100:103]
    s_waitcnt lgkmcnt(0)
    v_mfma_f32_16x16x32_bf16 v[96:99], v[152:155], v[252:255], v[96:99]
    v_mfma_f32_16x16x32_bf16 v[100:103], v[156:159], v[252:255], v[100:103]
    v_pk_add_f32 v[104:105], v[56:57], v[88:89]
    v_pk_fma_f32 v[112:113], v[92:93], s[28:29], v[64:65] op_sel:[0,1,0] op_sel_hi:[1,1,1]
    v_pk_add_f32 v[106:107], v[58:59], v[90:91]
    v_pk_fma_f32 v[114:115], v[94:95], s[28:29], v[66:67] op_sel:[0,1,0] op_sel_hi:[1,1,1]
    v_cvt_pk_bf16_f32 v120, v104, v105
    v_cvt_pk_bf16_f32 v121, v106, v107
    v_cvt_pk_bf16_f32 v122, v112, v113
    v_cvt_pk_bf16_f32 v123, v114, v115
    buffer_store_dwordx4 v[120:123], v4, s[4:7], s24 offen sc1
    v_pk_add_f32 v[108:109], v[60:61], v[96:97]
    v_pk_fma_f32 v[116:117], v[100:101], s[28:29], v[68:69] op_sel:[0,1,0] op_sel_hi:[1,1,1]
    v_pk_add_f32 v[110:111], v[62:63], v[98:99]
    v_pk_fma_f32 v[118:119], v[102:103], s[28:29], v[70:71] op_sel:[0,1,0] op_sel_hi:[1,1,1]
    v_cvt_pk_bf16_f32 v124, v108, v109
    v_cvt_pk_bf16_f32 v125, v110, v111
    v_cvt_pk_bf16_f32 v126, v116, v117
    v_cvt_pk_bf16_f32 v127, v118, v119
    buffer_store_dwordx4 v[124:127], v4, s[4:7], s25 offen sc1
    v_and_b32 v8, 0x31, v1
    v_lshlrev_b32 v8, 2, v8
    v_and_or_b32 v8, v1, 8, v8
    v_and_b32 v9, 6, v1
    v_lshl_or_b32 v8, v9, 3, v8
    s_lshl_b32 s23, s19, 8
    buffer_load_dword v8, v8, s[12:15], s23 offen
    s_mul_i32 s34, s16, 28672
    s_add_u32 m0, s34, 12288
    s_add_u32 s34, s79, s37
    buffer_load_dwordx4 v15, s[4:7], s34 offen offset:2048 lds
    buffer_load_dwordx4 v15, s[4:7], s34 offen offset:3072 lds
    s_mul_i32 s34, s16, 28672
    s_add_u32 m0, s34, 16384
    s_add_u32 s34, s80, s37
    buffer_load_dwordx4 v15, s[4:7], s34 offen offset:0 lds
    buffer_load_dwordx4 v15, s[4:7], s34 offen offset:1024 lds
    s_mul_i32 s34, s16, 28672
    s_add_u32 m0, s34, 16384
    s_add_u32 s34, s80, s37
    buffer_load_dwordx4 v15, s[4:7], s34 offen offset:2048 lds
    buffer_load_dwordx4 v15, s[4:7], s34 offen offset:3072 lds
    s_mul_i32 s34, s16, 28672
    s_add_u32 m0, s34, 20480
    s_add_u32 s34, s81, s37
    buffer_load_dwordx4 v15, s[4:7], s34 offen offset:0 lds
    buffer_load_dwordx4 v15, s[4:7], s34 offen offset:1024 lds
    s_mul_i32 s34, s16, 28672
    s_add_u32 m0, s34, 20480
    s_add_u32 s34, s81, s37
    buffer_load_dwordx4 v15, s[4:7], s34 offen offset:2048 lds
    buffer_load_dwordx4 v15, s[4:7], s34 offen offset:3072 lds
    s_mul_i32 s34, s16, 28672
    s_add_u32 m0, s34, 24576
    s_add_u32 s34, s82, s37
    buffer_load_dwordx4 v15, s[4:7], s34 offen offset:0 lds
    buffer_load_dwordx4 v15, s[4:7], s34 offen offset:1024 lds
    s_mul_i32 s34, s16, 28672
    s_add_u32 m0, s34, 24576
    s_add_u32 s34, s82, s37
    buffer_load_dwordx4 v15, s[4:7], s34 offen offset:2048 lds
    buffer_load_dwordx4 v15, s[4:7], s34 offen offset:3072 lds
    v_lshrrev_b32 v3, 5, v1
    v_and_b32 v4, 31, v1
    v_and_b32 v6, 3, v1
    v_lshlrev_b32 v6, 4, v6
    v_and_b32 v5, 4, v1
    v_lshl_or_b32 v6, v5, 1, v6
    v_and_b32 v5, 8, v1
    v_lshl_or_b32 v6, v5, 4, v6
    v_and_b32 v5, 16, v1
    v_lshl_or_b32 v6, v5, 2, v6
    v_and_b32 v5, 32, v1
    v_lshl_or_b32 v6, v5, 3, v6
    v_add_u32 v6, s36, v6
    v_lshlrev_b32 v7, 2, v4
    v_add_u32 v5, 0x10000, v15
    s_lshl_b32 s22, s16, 10
    s_add_u32 s22, s22, 114688
    s_lshl2_add_u32 s27, s97, s16
    s_lshl_b32 s27, s27, 7
    s_add_u32 s27, s27, 1851392
    s_lshr_b32 s31, s16, 1
    s_lshl1_add_u32 s30, s18, s31
    s_and_b32 s33, s16, 1
    s_lshl1_add_u32 s32, s17, s33
    s_mul_i32 s29, s32, 28672
    s_lshl_b32 s23, s30, 11
    s_add_u32 s20, s23, s29
    s_add_u32 s20, s20, 2097152
    s_lshl_b32 s24, s30, 7
    s_add_u32 s24, s24, 1998848
    s_lshl_b32 s25, s30, 17
    s_lshl_b32 s23, s32, 7
    s_add_u32 s25, s25, s23
    s_add_u32 s25, s25, 3932160
    s_lshl_b32 s28, s32, 8
    s_add_u32 s28, s28, 1966080
    s_waitcnt vmcnt(14)
    v_lshlrev_b32 v12, 16, v8
    v_and_b32 v13, 0xffff0000, v8
    v_mul_f32 v12, 0xbeeff558, v12
    v_mul_f32 v13, 0xbeeff558, v13
    v_lshl_add_u32 v9, v1, 3, s22
    ds_write_b64 v9, v[12:13]
    v_lshl_add_u32 v9, v3, 6, s22
    v_add_u32 v8, 8192, v7
    s_lshl_b32 s23, s16, 10
    s_and_b32 s23, s23, 1024
    v_add_u32 v12, s23, v15
    v_xor_b32 v13, 1024, v12
    s_waitcnt vmcnt(0)
    s_barrier
    ds_read_b128 v[192:195], v15 offset:0
    ds_read_b128 v[196:199], v15 offset:28672
    ds_read_b128 v[200:203], v15 offset:57344
    ds_read_b128 v[204:207], v5 offset:20480
    ds_read_b128 v[208:211], v15 offset:1024
    ds_read_b128 v[212:215], v15 offset:29696
    ds_read_b128 v[216:219], v15 offset:58368
    ds_read_b128 v[220:223], v5 offset:21504
    s_add_u32 m0, s36, 0
    s_add_u32 s26, s76, 2097152
    buffer_load_dwordx4 v15, s[4:7], s26 offen offset:0 sc1 lds
    s_add_u32 m0, s36, 0
    s_add_u32 s26, s76, 2097152
    buffer_load_dwordx4 v15, s[4:7], s26 offen offset:1024 sc1 lds
    buffer_load_dwordx4 v15, s[4:7], s26 offen offset:2048 sc1 lds
    buffer_load_dwordx4 v15, s[4:7], s26 offen offset:3072 sc1 lds
    s_add_u32 m0, s36, 4096
    s_add_u32 s26, s77, 2097152
    buffer_load_dwordx4 v15, s[4:7], s26 offen offset:0 sc1 lds
    buffer_load_dwordx4 v15, s[4:7], s26 offen offset:1024 sc1 lds
    buffer_load_dwordx4 v15, s[4:7], s26 offen offset:2048 sc1 lds
    s_waitcnt vmcnt(6)
    ds_read_b64_tr_b16 v[16:17], v6 offset:0
    ds_read_b64_tr_b16 v[18:19], v6 offset:512
    s_waitcnt vmcnt(5)
    ds_read_b64_tr_b16 v[20:21], v6 offset:1024
    ds_read_b64_tr_b16 v[22:23], v6 offset:1536
    s_waitcnt lgkmcnt(2)
    v_max3_u32 v14, v16, v17, v18
    v_max_u32 v14, v14, v19
    v_cmp_eq_u32 vcc, -1, v14
    s_cbranch_vccnz R_mx0_0
B_mx0_0:
    v_mfma_f32_32x32x16_bf16 v[128:143], v[192:195], v[16:19], 0
    s_waitcnt vmcnt(4)
    ds_read_b64_tr_b16 v[24:25], v6 offset:2048
    ds_read_b128 v[224:227], v15 offset:2048
    v_mfma_f32_32x32x16_bf16 v[144:159], v[196:199], v[16:19], 0
    s_mul_i32 s30, s16, 14
    v_and_b32 v10, 48, v1
    s_and_b32 s30, s30, 60
    v_lshlrev_b32 v10, 2, v10
    s_lshl3_add_u32 s31, s18, 1912832
    v_add3_u32 v10, v10, v1, s30
    v_min_u32 v10, 56, v10
    v_lshlrev_b32 v10, 6, v10
    buffer_load_dwordx2 v[10:11], v10, s[4:7], s31 offen sc1
    ds_read_b64_tr_b16 v[26:27], v6 offset:2560
    ds_read_b128 v[228:231], v15 offset:30720
    v_mfma_f32_32x32x16_bf16 v[160:175], v[200:203], v[16:19], 0
    ds_read_b128 v[232:235], v15 offset:59392
    s_waitcnt lgkmcnt(5)
    v_max3_u32 v14, v20, v21, v22
    v_max_u32 v14, v14, v23
    v_mfma_f32_32x32x16_bf16 v[176:191], v[204:207], v[16:19], 0
    ds_read_b128 v[236:239], v5 offset:22528
    v_cmp_eq_u32 vcc, -1, v14
    buffer_load_dwordx4 v15, s[4:7], s26 offen offset:3072 sc1 lds
    s_cbranch_vccnz R_mx0_1
B_mx0_1:
    v_mfma_f32_32x32x16_bf16 v[128:143], v[208:211], v[20:23], v[128:143]
    s_waitcnt vmcnt(5)
    ds_read_b64_tr_b16 v[28:29], v6 offset:3072
    ds_read_b128 v[240:243], v15 offset:3072
    v_mfma_f32_32x32x16_bf16 v[144:159], v[212:215], v[20:23], v[144:159]
    ds_read_b64_tr_b16 v[30:31], v6 offset:3584
    ds_read_b128 v[244:247], v15 offset:31744
    v_mfma_f32_32x32x16_bf16 v[160:175], v[216:219], v[20:23], v[160:175]
    ds_read_b128 v[248:251], v15 offset:60416
    s_waitcnt lgkmcnt(8)
    v_max3_u32 v14, v24, v25, v26
    v_max_u32 v14, v14, v27
    v_mfma_f32_32x32x16_bf16 v[176:191], v[220:223], v[20:23], v[176:191]
    ds_read_b128 v[252:255], v5 offset:23552
    v_cmp_eq_u32 vcc, -1, v14
    s_add_u32 m0, s36, 0
    s_add_u32 s26, s78, 2097152
    buffer_load_dwordx4 v15, s[4:7], s26 offen offset:0 sc1 lds
    s_cbranch_vccnz R_mx0_2
B_mx0_2:
    s_waitcnt lgkmcnt(6)
    v_mfma_f32_32x32x16_bf16 v[128:143], v[224:227], v[24:27], v[128:143]
    s_waitcnt vmcnt(5)
    ds_read_b64_tr_b16 v[32:33], v6 offset:4096
    ds_read_b128 v[192:195], v15 offset:4096
    v_mfma_f32_32x32x16_bf16 v[144:159], v[228:231], v[24:27], v[144:159]
    ds_read_b64_tr_b16 v[34:35], v6 offset:4608
    ds_read_b128 v[196:199], v15 offset:32768
    v_mfma_f32_32x32x16_bf16 v[160:175], v[232:235], v[24:27], v[160:175]
    ds_read_b128 v[200:203], v15 offset:61440
    s_waitcnt lgkmcnt(8)
    v_max3_u32 v14, v28, v29, v30
    v_max_u32 v14, v14, v31
    v_mfma_f32_32x32x16_bf16 v[176:191], v[236:239], v[24:27], v[176:191]
    ds_read_b128 v[204:207], v5 offset:24576
    v_cmp_eq_u32 vcc, -1, v14
    buffer_load_dwordx4 v15, s[4:7], s26 offen offset:1024 sc1 lds
    s_cbranch_vccnz R_mx0_3
B_mx0_3:
    s_waitcnt lgkmcnt(6)
    v_mfma_f32_32x32x16_bf16 v[128:143], v[240:243], v[28:31], v[128:143]
    s_waitcnt vmcnt(3)
    v_max_u32 v10, v10, v11
    v_cmp_eq_u32 vcc, -1, v10
    s_cbranch_vccnz R_mf2
B_mf2:
    ds_read_b64_tr_b16 v[36:37], v6 offset:5120
    ds_read_b128 v[208:211], v15 offset:5120
    v_mfma_f32_32x32x16_bf16 v[144:159], v[244:247], v[28:31], v[144:159]
    ds_read_b64_tr_b16 v[38:39], v6 offset:5632
    ds_read_b128 v[212:215], v15 offset:33792
    s_add_u32 s38, s90, 20971520
    buffer_load_dwordx4 a[32:35], v15, s[4:7], s38 offen
    v_mfma_f32_32x32x16_bf16 v[160:175], v[248:251], v[28:31], v[160:175]
    ds_read_b128 v[216:219], v15 offset:62464
    s_waitcnt lgkmcnt(8)
    v_max3_u32 v14, v32, v33, v34
    v_max_u32 v14, v14, v35
    v_mfma_f32_32x32x16_bf16 v[176:191], v[252:255], v[28:31], v[176:191]
    ds_read_b128 v[220:223], v5 offset:25600
    v_cmp_eq_u32 vcc, -1, v14
    buffer_load_dwordx4 v15, s[4:7], s26 offen offset:2048 sc1 lds
    s_cbranch_vccnz R_mx0_4
B_mx0_4:
    s_waitcnt lgkmcnt(6)
    v_mfma_f32_32x32x16_bf16 v[128:143], v[192:195], v[32:35], v[128:143]
    ds_read_b64_tr_b16 v[40:41], v6 offset:6144
    ds_read_b128 v[224:227], v15 offset:6144
    v_mfma_f32_32x32x16_bf16 v[144:159], v[196:199], v[32:35], v[144:159]
    ds_read_b64_tr_b16 v[42:43], v6 offset:6656
    ds_read_b128 v[228:231], v15 offset:34816
    s_xor_b32 s38, s38, 1024
    buffer_load_dwordx4 a[36:39], v15, s[4:7], s38 offen
    v_mfma_f32_32x32x16_bf16 v[160:175], v[200:203], v[32:35], v[160:175]
    ds_read_b128 v[232:235], v15 offset:63488
    s_waitcnt lgkmcnt(8)
    v_max3_u32 v14, v36, v37, v38
    v_max_u32 v14, v14, v39
    v_mfma_f32_32x32x16_bf16 v[176:191], v[204:207], v[32:35], v[176:191]
    ds_read_b128 v[236:239], v5 offset:26624
    v_cmp_eq_u32 vcc, -1, v14
    buffer_load_dwordx4 v15, s[4:7], s26 offen offset:3072 sc1 lds
    s_cbranch_vccnz R_mx0_5
B_mx0_5:
    s_waitcnt lgkmcnt(6)
    v_mfma_f32_32x32x16_bf16 v[128:143], v[208:211], v[36:39], v[128:143]
    s_waitcnt vmcnt(6)
    ds_read_b64_tr_b16 v[44:45], v6 offset:7168
    ds_read_b128 v[240:243], v15 offset:7168
    v_mfma_f32_32x32x16_bf16 v[144:159], v[212:215], v[36:39], v[144:159]
    ds_read_b64_tr_b16 v[46:47], v6 offset:7680
    ds_read_b128 v[244:247], v15 offset:35840
    s_add_u32 s38, s91, 20971520
    buffer_load_dwordx4 a[40:43], v15, s[4:7], s38 offen
    v_mfma_f32_32x32x16_bf16 v[160:175], v[216:219], v[36:39], v[160:175]
    ds_read_b128 v[248:251], v15 offset:64512
    s_waitcnt lgkmcnt(8)
    v_max3_u32 v14, v40, v41, v42
    v_max_u32 v14, v14, v43
    v_mfma_f32_32x32x16_bf16 v[176:191], v[220:223], v[36:39], v[176:191]
    ds_read_b128 v[252:255], v5 offset:27648
    v_cmp_eq_u32 vcc, -1, v14
    s_add_u32 m0, s36, 4096
    s_add_u32 s26, s79, 2097152
    buffer_load_dwordx4 v15, s[4:7], s26 offen offset:0 sc1 lds
    s_cbranch_vccnz R_mx0_6
B_mx0_6:
    s_waitcnt lgkmcnt(6)
    v_mfma_f32_32x32x16_bf16 v[128:143], v[224:227], v[40:43], v[128:143]
    s_waitcnt vmcnt(7)
    ds_read_b64_tr_b16 v[48:49], v6 offset:0
    ds_read_b128 v[192:195], v15 offset:8192
    v_mfma_f32_32x32x16_bf16 v[144:159], v[228:231], v[40:43], v[144:159]
    ds_read_b64_tr_b16 v[50:51], v6 offset:512
    ds_read_b128 v[196:199], v15 offset:36864
    s_xor_b32 s38, s38, 1024
    buffer_load_dwordx4 a[44:47], v15, s[4:7], s38 offen
    v_mfma_f32_32x32x16_bf16 v[160:175], v[232:235], v[40:43], v[160:175]
    ds_read_b128 v[200:203], v5 offset:0
    s_waitcnt lgkmcnt(8)
    v_max3_u32 v14, v44, v45, v46
    v_max_u32 v14, v14, v47
    v_mfma_f32_32x32x16_bf16 v[176:191], v[236:239], v[40:43], v[176:191]
    ds_read_b128 v[204:207], v5 offset:28672
    v_cmp_eq_u32 vcc, -1, v14
    buffer_load_dwordx4 v15, s[4:7], s26 offen offset:1024 sc1 lds
    s_cbranch_vccnz R_mx0_7
B_mx0_7:
    s_waitcnt lgkmcnt(6)
    v_mfma_f32_32x32x16_bf16 v[128:143], v[240:243], v[44:47], v[128:143]
    s_waitcnt vmcnt(8)
    ds_read_b64_tr_b16 v[52:53], v6 offset:1024
    ds_read_b128 v[208:211], v15 offset:9216
    v_mfma_f32_32x32x16_bf16 v[144:159], v[244:247], v[44:47], v[144:159]
    ds_read_b64_tr_b16 v[54:55], v6 offset:1536
    ds_read_b128 v[212:215], v15 offset:37888
    s_add_u32 s38, s92, 20971520
    buffer_load_dwordx4 a[48:51], v15, s[4:7], s38 offen
    v_mfma_f32_32x32x16_bf16 v[160:175], v[248:251], v[44:47], v[160:175]
    ds_read_b128 v[216:219], v5 offset:1024
    s_waitcnt lgkmcnt(8)
    v_max3_u32 v14, v48, v49, v50
    v_max_u32 v14, v14, v51
    v_mfma_f32_32x32x16_bf16 v[176:191], v[252:255], v[44:47], v[176:191]
    ds_read_b128 v[220:223], v5 offset:29696
    v_cmp_eq_u32 vcc, -1, v14
    buffer_load_dwordx4 v15, s[4:7], s26 offen offset:2048 sc1 lds
    s_cbranch_vccnz R_mx0_8
B_mx0_8:
    s_waitcnt lgkmcnt(6)
    v_mfma_f32_32x32x16_bf16 v[128:143], v[192:195], v[48:51], v[128:143]
    s_waitcnt vmcnt(8)
    ds_read_b64_tr_b16 v[56:57], v6 offset:2048
    ds_read_b128 v[224:227], v15 offset:10240
    v_mfma_f32_32x32x16_bf16 v[144:159], v[196:199], v[48:51], v[144:159]
    ds_read_b64_tr_b16 v[58:59], v6 offset:2560
    ds_read_b128 v[228:231], v15 offset:38912
    s_xor_b32 s38, s38, 1024
    buffer_load_dwordx4 a[52:55], v15, s[4:7], s38 offen
    v_mfma_f32_32x32x16_bf16 v[160:175], v[200:203], v[48:51], v[160:175]
    ds_read_b128 v[232:235], v5 offset:2048
    s_waitcnt lgkmcnt(8)
    v_max3_u32 v14, v52, v53, v54
    v_max_u32 v14, v14, v55
    v_mfma_f32_32x32x16_bf16 v[176:191], v[204:207], v[48:51], v[176:191]
    ds_read_b128 v[236:239], v5 offset:30720
    v_cmp_eq_u32 vcc, -1, v14
    buffer_load_dwordx4 v15, s[4:7], s26 offen offset:3072 sc1 lds
    s_cbranch_vccnz R_mx0_9
B_mx0_9:
    s_waitcnt lgkmcnt(6)
    v_mfma_f32_32x32x16_bf16 v[128:143], v[208:211], v[52:55], v[128:143]
    s_waitcnt vmcnt(8)
    ds_read_b64_tr_b16 v[60:61], v6 offset:3072
    ds_read_b128 v[240:243], v15 offset:11264
    v_mfma_f32_32x32x16_bf16 v[144:159], v[212:215], v[52:55], v[144:159]
    ds_read_b64_tr_b16 v[62:63], v6 offset:3584
    ds_read_b128 v[244:247], v15 offset:39936
    s_add_u32 s38, s93, 20971520
    buffer_load_dwordx4 a[56:59], v15, s[4:7], s38 offen
    v_mfma_f32_32x32x16_bf16 v[160:175], v[216:219], v[52:55], v[160:175]
    ds_read_b128 v[248:251], v5 offset:3072
    s_waitcnt lgkmcnt(8)
    v_max3_u32 v14, v56, v57, v58
    v_max_u32 v14, v14, v59
    v_mfma_f32_32x32x16_bf16 v[176:191], v[220:223], v[52:55], v[176:191]
    ds_read_b128 v[252:255], v5 offset:31744
    v_cmp_eq_u32 vcc, -1, v14
    s_add_u32 m0, s36, 0
    s_add_u32 s26, s80, 2097152
    buffer_load_dwordx4 v15, s[4:7], s26 offen offset:0 sc1 lds
    s_cbranch_vccnz R_mx0_10
B_mx0_10:
    s_waitcnt lgkmcnt(6)
    v_mfma_f32_32x32x16_bf16 v[128:143], v[224:227], v[56:59], v[128:143]
    s_waitcnt vmcnt(8)
    ds_read_b64_tr_b16 v[64:65], v6 offset:4096
    ds_read_b128 v[192:195], v15 offset:12288
    v_mfma_f32_32x32x16_bf16 v[144:159], v[228:231], v[56:59], v[144:159]
    ds_read_b64_tr_b16 v[66:67], v6 offset:4608
    ds_read_b128 v[196:199], v15 offset:40960
    s_xor_b32 s38, s38, 1024
    buffer_load_dwordx4 a[60:63], v15, s[4:7], s38 offen
    v_mfma_f32_32x32x16_bf16 v[160:175], v[232:235], v[56:59], v[160:175]
    ds_read_b128 v[200:203], v5 offset:4096
    s_waitcnt lgkmcnt(8)
    v_max3_u32 v14, v60, v61, v62
    v_max_u32 v14, v14, v63
    v_mfma_f32_32x32x16_bf16 v[176:191], v[236:239], v[56:59], v[176:191]
    ds_read_b128 v[204:207], v5 offset:32768
    v_cmp_eq_u32 vcc, -1, v14
    buffer_load_dwordx4 v15, s[4:7], s26 offen offset:1024 sc1 lds
    s_cbranch_vccnz R_mx0_11
B_mx0_11:
    s_waitcnt lgkmcnt(6)
    v_mfma_f32_32x32x16_bf16 v[128:143], v[240:243], v[60:63], v[128:143]
    s_waitcnt vmcnt(8)
    ds_read_b64_tr_b16 v[68:69], v6 offset:5120
    ds_read_b128 v[208:211], v15 offset:13312
    v_mfma_f32_32x32x16_bf16 v[144:159], v[244:247], v[60:63], v[144:159]
    ds_read_b64_tr_b16 v[70:71], v6 offset:5632
    ds_read_b128 v[212:215], v15 offset:41984
    s_add_u32 s38, s94, 20971520
    buffer_load_dwordx4 a[64:67], v15, s[4:7], s38 offen
    v_mfma_f32_32x32x16_bf16 v[160:175], v[248:251], v[60:63], v[160:175]
    ds_read_b128 v[216:219], v5 offset:5120
    s_waitcnt lgkmcnt(8)
    v_max3_u32 v14, v64, v65, v66
    v_max_u32 v14, v14, v67
    v_mfma_f32_32x32x16_bf16 v[176:191], v[252:255], v[60:63], v[176:191]
    ds_read_b128 v[220:223], v5 offset:33792
    v_cmp_eq_u32 vcc, -1, v14
    buffer_load_dwordx4 v15, s[4:7], s26 offen offset:2048 sc1 lds
    s_cbranch_vccnz R_mx0_12
B_mx0_12:
    s_waitcnt lgkmcnt(6)
    v_mfma_f32_32x32x16_bf16 v[128:143], v[192:195], v[64:67], v[128:143]
    s_waitcnt vmcnt(8)
    ds_read_b64_tr_b16 v[72:73], v6 offset:6144
    ds_read_b128 v[224:227], v15 offset:14336
    v_mfma_f32_32x32x16_bf16 v[144:159], v[196:199], v[64:67], v[144:159]
    ds_read_b64_tr_b16 v[74:75], v6 offset:6656
    ds_read_b128 v[228:231], v15 offset:43008
    s_xor_b32 s38, s38, 1024
    buffer_load_dwordx4 a[68:71], v15, s[4:7], s38 offen
    v_mfma_f32_32x32x16_bf16 v[160:175], v[200:203], v[64:67], v[160:175]
    ds_read_b128 v[232:235], v5 offset:6144
    s_waitcnt lgkmcnt(8)
    v_max3_u32 v14, v68, v69, v70
    v_max_u32 v14, v14, v71
    v_mfma_f32_32x32x16_bf16 v[176:191], v[204:207], v[64:67], v[176:191]
    ds_read_b128 v[236:239], v5 offset:34816
    v_cmp_eq_u32 vcc, -1, v14
    buffer_load_dwordx4 v15, s[4:7], s26 offen offset:3072 sc1 lds
    s_cbranch_vccnz R_mx0_13
B_mx0_13:
    s_waitcnt lgkmcnt(6)
    v_mfma_f32_32x32x16_bf16 v[128:143], v[208:211], v[68:71], v[128:143]
    s_waitcnt vmcnt(8)
    ds_read_b64_tr_b16 v[76:77], v6 offset:7168
    ds_read_b128 v[240:243], v15 offset:15360
    v_mfma_f32_32x32x16_bf16 v[144:159], v[212:215], v[68:71], v[144:159]
    ds_read_b64_tr_b16 v[78:79], v6 offset:7680
    ds_read_b128 v[244:247], v15 offset:44032
    s_add_u32 s38, s95, 20971520
    buffer_load_dwordx4 a[72:75], v15, s[4:7], s38 offen
    v_mfma_f32_32x32x16_bf16 v[160:175], v[216:219], v[68:71], v[160:175]
    ds_read_b128 v[248:251], v5 offset:7168
    s_waitcnt lgkmcnt(8)
    v_max3_u32 v14, v72, v73, v74
    v_max_u32 v14, v14, v75
    v_mfma_f32_32x32x16_bf16 v[176:191], v[220:223], v[68:71], v[176:191]
    ds_read_b128 v[252:255], v5 offset:35840
    v_cmp_eq_u32 vcc, -1, v14
    s_add_u32 m0, s36, 4096
    s_add_u32 s26, s81, 2097152
    buffer_load_dwordx4 v15, s[4:7], s26 offen offset:0 sc1 lds
    s_cbranch_vccnz R_mx0_14
B_mx0_14:
    s_waitcnt lgkmcnt(6)
    v_mfma_f32_32x32x16_bf16 v[128:143], v[224:227], v[72:75], v[128:143]
    s_waitcnt vmcnt(8)
    ds_read_b64_tr_b16 v[80:81], v6 offset:0
    ds_read_b128 v[192:195], v15 offset:16384
    v_mfma_f32_32x32x16_bf16 v[144:159], v[228:231], v[72:75], v[144:159]
    ds_read_b64_tr_b16 v[82:83], v6 offset:512
    ds_read_b128 v[196:199], v15 offset:45056
    s_xor_b32 s38, s38, 1024
    buffer_load_dwordx4 a[76:79], v15, s[4:7], s38 offen
    v_mfma_f32_32x32x16_bf16 v[160:175], v[232:235], v[72:75], v[160:175]
    ds_read_b128 v[200:203], v5 offset:8192
    s_waitcnt lgkmcnt(8)
    v_max3_u32 v14, v76, v77, v78
    v_max_u32 v14, v14, v79
    v_mfma_f32_32x32x16_bf16 v[176:191], v[236:239], v[72:75], v[176:191]
    ds_read_b128 v[204:207], v5 offset:36864
    v_cmp_eq_u32 vcc, -1, v14
    buffer_load_dwordx4 v15, s[4:7], s26 offen offset:1024 sc1 lds
    s_cbranch_vccnz R_mx0_15
B_mx0_15:
    s_waitcnt lgkmcnt(6)
    v_mfma_f32_32x32x16_bf16 v[128:143], v[240:243], v[76:79], v[128:143]
    s_waitcnt vmcnt(8)
    ds_read_b64_tr_b16 v[84:85], v6 offset:1024
    ds_read_b128 v[208:211], v15 offset:17408
    v_mfma_f32_32x32x16_bf16 v[144:159], v[244:247], v[76:79], v[144:159]
    ds_read_b64_tr_b16 v[86:87], v6 offset:1536
    ds_read_b128 v[212:215], v15 offset:46080
    s_add_u32 s38, s96, 20971520
    buffer_load_dwordx4 a[80:83], v15, s[4:7], s38 offen
    v_mfma_f32_32x32x16_bf16 v[160:175], v[248:251], v[76:79], v[160:175]
    ds_read_b128 v[216:219], v5 offset:9216
    s_waitcnt lgkmcnt(8)
    v_max3_u32 v14, v80, v81, v82
    v_max_u32 v14, v14, v83
    v_mfma_f32_32x32x16_bf16 v[176:191], v[252:255], v[76:79], v[176:191]
    ds_read_b128 v[220:223], v5 offset:37888
    v_cmp_eq_u32 vcc, -1, v14
    buffer_load_dwordx4 v15, s[4:7], s26 offen offset:2048 sc1 lds
    s_cbranch_vccnz R_mx0_16
B_mx0_16:
    s_waitcnt lgkmcnt(6)
    v_mfma_f32_32x32x16_bf16 v[128:143], v[192:195], v[80:83], v[128:143]
    s_waitcnt vmcnt(8)
    ds_read_b64_tr_b16 v[88:89], v6 offset:2048
    ds_read_b128 v[224:227], v15 offset:18432
    v_mfma_f32_32x32x16_bf16 v[144:159], v[196:199], v[80:83], v[144:159]
    ds_read_b64_tr_b16 v[90:91], v6 offset:2560
    ds_read_b128 v[228:231], v15 offset:47104
    s_xor_b32 s38, s38, 1024
    buffer_load_dwordx4 a[84:87], v15, s[4:7], s38 offen
    v_mfma_f32_32x32x16_bf16 v[160:175], v[200:203], v[80:83], v[160:175]
    ds_read_b128 v[232:235], v5 offset:10240
    s_waitcnt lgkmcnt(8)
    v_max3_u32 v14, v84, v85, v86
    v_max_u32 v14, v14, v87
    v_mfma_f32_32x32x16_bf16 v[176:191], v[204:207], v[80:83], v[176:191]
    ds_read_b128 v[236:239], v5 offset:38912
    v_cmp_eq_u32 vcc, -1, v14
    buffer_load_dwordx4 v15, s[4:7], s26 offen offset:3072 sc1 lds
    s_cbranch_vccnz R_mx0_17
B_mx0_17:
    s_waitcnt lgkmcnt(6)
    v_mfma_f32_32x32x16_bf16 v[128:143], v[208:211], v[84:87], v[128:143]
    s_waitcnt vmcnt(8)
    ds_read_b64_tr_b16 v[92:93], v6 offset:3072
    ds_read_b128 v[240:243], v15 offset:19456
    v_mfma_f32_32x32x16_bf16 v[144:159], v[212:215], v[84:87], v[144:159]
    ds_read_b64_tr_b16 v[94:95], v6 offset:3584
    ds_read_b128 v[244:247], v15 offset:48128
    s_add_u32 s38, s90, 21372928
    buffer_load_dwordx4 a[88:91], v15, s[4:7], s38 offen
    v_mfma_f32_32x32x16_bf16 v[160:175], v[216:219], v[84:87], v[160:175]
    ds_read_b128 v[248:251], v5 offset:11264
    s_waitcnt lgkmcnt(8)
    v_max3_u32 v14, v88, v89, v90
    v_max_u32 v14, v14, v91
    v_mfma_f32_32x32x16_bf16 v[176:191], v[220:223], v[84:87], v[176:191]
    ds_read_b128 v[252:255], v5 offset:39936
    v_cmp_eq_u32 vcc, -1, v14
    s_add_u32 m0, s36, 0
    s_add_u32 s26, s82, 2097152
    buffer_load_dwordx4 v15, s[4:7], s26 offen offset:0 sc1 lds
    s_cbranch_vccnz R_mx0_18
B_mx0_18:
    s_waitcnt lgkmcnt(6)
    v_mfma_f32_32x32x16_bf16 v[128:143], v[224:227], v[88:91], v[128:143]
    s_waitcnt vmcnt(8)
    ds_read_b64_tr_b16 v[96:97], v6 offset:4096
    ds_read_b128 v[192:195], v15 offset:20480
    v_mfma_f32_32x32x16_bf16 v[144:159], v[228:231], v[88:91], v[144:159]
    ds_read_b64_tr_b16 v[98:99], v6 offset:4608
    ds_read_b128 v[196:199], v15 offset:49152
    s_xor_b32 s38, s38, 1024
    buffer_load_dwordx4 a[92:95], v15, s[4:7], s38 offen
    v_mfma_f32_32x32x16_bf16 v[160:175], v[232:235], v[88:91], v[160:175]
    s_add_u32 s38, s91, 21372928
    buffer_load_dwordx4 a[96:99], v15, s[4:7], s38 offen
    ds_read_b128 v[200:203], v5 offset:12288
    s_waitcnt lgkmcnt(8)
    v_max3_u32 v14, v92, v93, v94
    v_max_u32 v14, v14, v95
    v_mfma_f32_32x32x16_bf16 v[176:191], v[236:239], v[88:91], v[176:191]
    ds_read_b128 v[204:207], v5 offset:40960
    v_cmp_eq_u32 vcc, -1, v14
    buffer_load_dwordx4 v15, s[4:7], s26 offen offset:1024 sc1 lds
    s_cbranch_vccnz R_mx0_19
B_mx0_19:
    s_waitcnt lgkmcnt(6)
    v_mfma_f32_32x32x16_bf16 v[128:143], v[240:243], v[92:95], v[128:143]
    s_waitcnt vmcnt(9)
    ds_read_b64_tr_b16 v[100:101], v6 offset:5120
    ds_read_b128 v[208:211], v15 offset:21504
    v_mfma_f32_32x32x16_bf16 v[144:159], v[244:247], v[92:95], v[144:159]
    ds_read_b64_tr_b16 v[102:103], v6 offset:5632
    ds_read_b128 v[212:215], v15 offset:50176
    s_xor_b32 s38, s38, 1024
    buffer_load_dwordx4 a[100:103], v15, s[4:7], s38 offen
    v_mfma_f32_32x32x16_bf16 v[160:175], v[248:251], v[92:95], v[160:175]
    s_add_u32 s38, s92, 21372928
    buffer_load_dwordx4 a[104:107], v15, s[4:7], s38 offen
    ds_read_b128 v[216:219], v5 offset:13312
    s_waitcnt lgkmcnt(8)
    v_max3_u32 v14, v96, v97, v98
    v_max_u32 v14, v14, v99
    v_mfma_f32_32x32x16_bf16 v[176:191], v[252:255], v[92:95], v[176:191]
    ds_read_b128 v[220:223], v5 offset:41984
    v_cmp_eq_u32 vcc, -1, v14
    buffer_load_dwordx4 v15, s[4:7], s26 offen offset:2048 sc1 lds
    s_cbranch_vccnz R_mx0_20
B_mx0_20:
    s_waitcnt lgkmcnt(6)
    v_mfma_f32_32x32x16_bf16 v[128:143], v[192:195], v[96:99], v[128:143]
    s_waitcnt vmcnt(10)
    ds_read_b64_tr_b16 v[104:105], v6 offset:6144
    ds_read_b128 v[224:227], v15 offset:22528
    v_mfma_f32_32x32x16_bf16 v[144:159], v[196:199], v[96:99], v[144:159]
    ds_read_b64_tr_b16 v[106:107], v6 offset:6656
    ds_read_b128 v[228:231], v15 offset:51200
    s_xor_b32 s38, s38, 1024
    buffer_load_dwordx4 a[108:111], v15, s[4:7], s38 offen
    v_mfma_f32_32x32x16_bf16 v[160:175], v[200:203], v[96:99], v[160:175]
    s_add_u32 s38, s93, 21372928
    buffer_load_dwordx4 a[112:115], v15, s[4:7], s38 offen
    ds_read_b128 v[232:235], v5 offset:14336
    s_waitcnt lgkmcnt(8)
    v_max3_u32 v14, v100, v101, v102
    v_max_u32 v14, v14, v103
    v_mfma_f32_32x32x16_bf16 v[176:191], v[204:207], v[96:99], v[176:191]
    ds_read_b128 v[236:239], v5 offset:43008
    v_cmp_eq_u32 vcc, -1, v14
    buffer_load_dwordx4 v15, s[4:7], s26 offen offset:3072 sc1 lds
    s_cbranch_vccnz R_mx0_21
B_mx0_21:
    s_waitcnt lgkmcnt(6)
    v_mfma_f32_32x32x16_bf16 v[128:143], v[208:211], v[100:103], v[128:143]
    s_waitcnt vmcnt(11)
    ds_read_b64_tr_b16 v[108:109], v6 offset:7168
    ds_read_b128 v[240:243], v15 offset:23552
    v_mfma_f32_32x32x16_bf16 v[144:159], v[212:215], v[100:103], v[144:159]
    ds_read_b64_tr_b16 v[110:111], v6 offset:7680
    ds_read_b128 v[244:247], v15 offset:52224
    s_xor_b32 s38, s38, 1024
    buffer_load_dwordx4 a[116:119], v15, s[4:7], s38 offen
    v_mfma_f32_32x32x16_bf16 v[160:175], v[216:219], v[100:103], v[160:175]
    s_add_u32 s38, s94, 21372928
    buffer_load_dwordx4 a[120:123], v15, s[4:7], s38 offen
    ds_read_b128 v[248:251], v5 offset:15360
    s_waitcnt lgkmcnt(8)
    v_max3_u32 v14, v104, v105, v106
    v_max_u32 v14, v14, v107
    v_mfma_f32_32x32x16_bf16 v[176:191], v[220:223], v[100:103], v[176:191]
    ds_read_b128 v[252:255], v5 offset:44032
    v_cmp_eq_u32 vcc, -1, v14
    buffer_load_dword v10, v7, s[4:7], s27 offen sc1
    buffer_load_dword v11, v8, s[4:7], s27 offen sc1
    s_cbranch_vccnz R_mx0_22
B_mx0_22:
    s_waitcnt lgkmcnt(6)
    v_mfma_f32_32x32x16_bf16 v[128:143], v[224:227], v[104:107], v[128:143]
    s_waitcnt vmcnt(13)
    ds_read_b64_tr_b16 v[112:113], v6 offset:0
    ds_read_b128 v[192:195], v15 offset:24576
    v_mfma_f32_32x32x16_bf16 v[144:159], v[228:231], v[104:107], v[144:159]
    ds_read_b64_tr_b16 v[114:115], v6 offset:512
    ds_read_b128 v[196:199], v15 offset:53248
    s_xor_b32 s38, s38, 1024
    buffer_load_dwordx4 a[124:127], v15, s[4:7], s38 offen
    v_mfma_f32_32x32x16_bf16 v[160:175], v[232:235], v[104:107], v[160:175]
    s_add_u32 s38, s95, 21372928
    buffer_load_dwordx4 a[128:131], v15, s[4:7], s38 offen
    ds_read_b128 v[200:203], v5 offset:16384
    s_waitcnt lgkmcnt(8)
    v_max3_u32 v14, v108, v109, v110
    v_max_u32 v14, v14, v111
    v_mfma_f32_32x32x16_bf16 v[176:191], v[236:239], v[104:107], v[176:191]
    ds_read_b128 v[204:207], v5 offset:45056
    v_cmp_eq_u32 vcc, -1, v14
    v_lshlrev_b32 v14, 4, v3
    buffer_load_dwordx4 v[16:19], v14, s[4:7], s24 offen offset:0
    s_cbranch_vccnz R_mx0_23
B_mx0_23:
    s_waitcnt lgkmcnt(6)
    v_mfma_f32_32x32x16_bf16 v[128:143], v[240:243], v[108:111], v[128:143]
    s_waitcnt vmcnt(13)
    ds_read_b64_tr_b16 v[116:117], v6 offset:1024
    ds_read_b128 v[208:211], v15 offset:25600
    v_mfma_f32_32x32x16_bf16 v[144:159], v[244:247], v[108:111], v[144:159]
    ds_read_b64_tr_b16 v[118:119], v6 offset:1536
    ds_read_b128 v[212:215], v15 offset:54272
    s_xor_b32 s38, s38, 1024
    buffer_load_dwordx4 a[132:135], v15, s[4:7], s38 offen
    v_mfma_f32_32x32x16_bf16 v[160:175], v[248:251], v[108:111], v[160:175]
    s_add_u32 s38, s96, 21372928
    buffer_load_dwordx4 a[136:139], v15, s[4:7], s38 offen
    ds_read_b128 v[216:219], v5 offset:17408
    s_waitcnt lgkmcnt(8)
    v_max3_u32 v14, v112, v113, v114
    v_max_u32 v14, v14, v115
    v_mfma_f32_32x32x16_bf16 v[176:191], v[252:255], v[108:111], v[176:191]
    ds_read_b128 v[220:223], v5 offset:46080
    v_cmp_eq_u32 vcc, -1, v14
    v_lshlrev_b32 v14, 4, v3
    buffer_load_dwordx4 v[20:23], v14, s[4:7], s24 offen offset:32
    s_cbranch_vccnz R_mx0_24
B_mx0_24:
    s_waitcnt lgkmcnt(6)
    v_mfma_f32_32x32x16_bf16 v[128:143], v[192:195], v[112:115], v[128:143]
    s_waitcnt vmcnt(13)
    ds_read_b64_tr_b16 v[120:121], v6 offset:2048
    ds_read_b128 v[224:227], v15 offset:26624
    v_mfma_f32_32x32x16_bf16 v[144:159], v[196:199], v[112:115], v[144:159]
    ds_read_b64_tr_b16 v[122:123], v6 offset:2560
    ds_read_b128 v[228:231], v15 offset:55296
    s_xor_b32 s38, s38, 1024
    buffer_load_dwordx4 a[140:143], v15, s[4:7], s38 offen
    v_mfma_f32_32x32x16_bf16 v[160:175], v[200:203], v[112:115], v[160:175]
    s_add_u32 s38, s90, 21774336
    buffer_load_dwordx4 a[144:147], v15, s[4:7], s38 offen
    ds_read_b128 v[232:235], v5 offset:18432
    s_waitcnt lgkmcnt(8)
    v_max3_u32 v14, v116, v117, v118
    v_max_u32 v14, v14, v119
    v_mfma_f32_32x32x16_bf16 v[176:191], v[204:207], v[112:115], v[176:191]
    ds_read_b128 v[236:239], v5 offset:47104
    v_cmp_eq_u32 vcc, -1, v14
    v_lshlrev_b32 v14, 4, v3
    buffer_load_dwordx4 v[24:27], v14, s[4:7], s24 offen offset:64
    s_cbranch_vccnz R_mx0_25
B_mx0_25:
    s_waitcnt lgkmcnt(6)
    v_mfma_f32_32x32x16_bf16 v[128:143], v[208:211], v[116:119], v[128:143]
    s_waitcnt vmcnt(13)
    ds_read_b64_tr_b16 v[124:125], v6 offset:3072
    ds_read_b128 v[240:243], v15 offset:27648
    v_mfma_f32_32x32x16_bf16 v[144:159], v[212:215], v[116:119], v[144:159]
    ds_read_b64_tr_b16 v[126:127], v6 offset:3584
    ds_read_b128 v[244:247], v15 offset:56320
    s_xor_b32 s38, s38, 1024
    buffer_load_dwordx4 a[148:151], v15, s[4:7], s38 offen
    v_mfma_f32_32x32x16_bf16 v[160:175], v[216:219], v[116:119], v[160:175]
    s_add_u32 s38, s91, 21774336
    buffer_load_dwordx4 a[152:155], v15, s[4:7], s38 offen
    ds_read_b128 v[248:251], v5 offset:19456
    s_waitcnt lgkmcnt(8)
    v_max3_u32 v14, v120, v121, v122
    v_max_u32 v14, v14, v123
    v_mfma_f32_32x32x16_bf16 v[176:191], v[220:223], v[116:119], v[176:191]
    ds_read_b128 v[252:255], v5 offset:48128
    v_cmp_eq_u32 vcc, -1, v14
    v_lshlrev_b32 v14, 4, v3
    buffer_load_dwordx4 v[28:31], v14, s[4:7], s24 offen offset:96
    s_cbranch_vccnz R_mx0_26
B_mx0_26:
    s_waitcnt lgkmcnt(6)
    v_mfma_f32_32x32x16_bf16 v[128:143], v[224:227], v[120:123], v[128:143]
    v_mfma_f32_32x32x16_bf16 v[144:159], v[228:231], v[120:123], v[144:159]
    s_xor_b32 s38, s38, 1024
    buffer_load_dwordx4 a[156:159], v15, s[4:7], s38 offen
    v_mfma_f32_32x32x16_bf16 v[160:175], v[232:235], v[120:123], v[160:175]
    s_add_u32 s38, s92, 21774336
    buffer_load_dwordx4 a[160:163], v15, s[4:7], s38 offen
    s_waitcnt lgkmcnt(3)
    v_max3_u32 v14, v124, v125, v126
    v_max_u32 v14, v14, v127
    v_mfma_f32_32x32x16_bf16 v[176:191], v[236:239], v[120:123], v[176:191]
    v_cmp_eq_u32 vcc, -1, v14
    s_xor_b32 s38, s38, 1024
    buffer_load_dwordx4 a[164:167], v15, s[4:7], s38 offen
    s_cbranch_vccnz R_mx0_27
B_mx0_27:
    v_mfma_f32_32x32x16_bf16 v[128:143], v[240:243], v[124:127], v[128:143]
    s_waitcnt lgkmcnt(2)
    v_mfma_f32_32x32x16_bf16 v[144:159], v[244:247], v[124:127], v[144:159]
    s_add_u32 s38, s93, 21774336
    buffer_load_dwordx4 a[168:171], v15, s[4:7], s38 offen
    s_waitcnt lgkmcnt(1)
    v_mfma_f32_32x32x16_bf16 v[160:175], v[248:251], v[124:127], v[160:175]
    s_xor_b32 s38, s38, 1024
    buffer_load_dwordx4 a[172:175], v15, s[4:7], s38 offen
    s_waitcnt lgkmcnt(0)
    v_mfma_f32_32x32x16_bf16 v[176:191], v[252:255], v[124:127], v[176:191]
    s_add_u32 s38, s94, 21774336
    buffer_load_dwordx4 a[176:179], v15, s[4:7], s38 offen
    s_mov_b32 m0, s36
    s_nop 0
    buffer_load_dwordx4 v15, s[4:7], s20 offen offset:0 sc1 lds
    buffer_load_dwordx4 v15, s[4:7], s20 offen offset:1024 sc1 lds
    s_waitcnt vmcnt(20)
    v_add_f32 v10, v10, v11
    v_cmp_u_f32 vcc, v10, v10
    s_cbranch_vccnz R_mrs0
B_mrs0:
    v_mov_b32 v11, 0x2ffa496c
    v_fmamk_f32 v10, v10, 0x3c268004, v11
    v_rsq_f32 v10, v10
    s_nop 0
    v_sub_f32 v10, 0, v10
    s_mov_b32 s32, 0x409d30fc
    s_mov_b32 s33, 0x409d30fc
    ds_read_b128 v[224:227], v9 offset:0
    ds_read_b128 v[228:231], v9 offset:16
    s_waitcnt lgkmcnt(1)
    v_pk_fma_f32 v[224:225], v[128:129], v[10:11], v[224:225] op_sel_hi:[1,0,1]
    v_pk_fma_f32 v[226:227], v[130:131], v[10:11], v[226:227] op_sel_hi:[1,0,1]
    s_waitcnt lgkmcnt(0)
    v_pk_fma_f32 v[228:229], v[132:133], v[10:11], v[228:229] op_sel_hi:[1,0,1]
    v_pk_fma_f32 v[230:231], v[134:135], v[10:11], v[230:231] op_sel_hi:[1,0,1]
    ds_read_b128 v[232:235], v9 offset:32
    ds_read_b128 v[236:239], v9 offset:48
    s_xor_b32 s38, s38, 1024
    buffer_load_dwordx4 a[180:183], v15, s[4:7], s38 offen
    v_pk_fma_f32 v[240:241], v[224:225], v[224:225], s[32:33]
    v_pk_fma_f32 v[242:243], v[226:227], v[226:227], s[32:33]
    v_pk_fma_f32 v[244:245], v[228:229], v[228:229], s[32:33]
    v_pk_fma_f32 v[246:247], v[230:231], v[230:231], s[32:33]
    v_pk_mul_f32 v[240:241], v[240:241], v[224:225]
    v_pk_mul_f32 v[242:243], v[242:243], v[226:227]
    v_pk_mul_f32 v[244:245], v[244:245], v[228:229]
    v_pk_mul_f32 v[246:247], v[246:247], v[230:231]
    v_exp_f32 v240, v240
    s_add_u32 s38, s95, 21774336
    buffer_load_dwordx4 a[184:187], v15, s[4:7], s38 offen
    v_exp_f32 v241, v241
    v_exp_f32 v242, v242
    v_exp_f32 v243, v243
    v_exp_f32 v244, v244
    v_exp_f32 v245, v245
    v_exp_f32 v246, v246
    v_exp_f32 v247, v247
    v_pk_add_f32 v[240:241], v[240:241], 1.0 op_sel_hi:[1,0]
    v_pk_add_f32 v[242:243], v[242:243], 1.0 op_sel_hi:[1,0]
    s_xor_b32 s38, s38, 1024
    buffer_load_dwordx4 a[188:191], v15, s[4:7], s38 offen
    v_pk_add_f32 v[244:245], v[244:245], 1.0 op_sel_hi:[1,0]
    v_pk_add_f32 v[246:247], v[246:247], 1.0 op_sel_hi:[1,0]
    v_rcp_f32 v240, v240
    v_rcp_f32 v241, v241
    v_rcp_f32 v242, v242
    v_rcp_f32 v243, v243
    v_rcp_f32 v244, v244
    v_rcp_f32 v245, v245
    v_rcp_f32 v246, v246
    s_add_u32 s38, s96, 21774336
    buffer_load_dwordx4 a[192:195], v15, s[4:7], s38 offen
    v_rcp_f32 v247, v247
    v_pk_mul_f32 v[240:241], v[240:241], v[224:225]
    v_pk_mul_f32 v[242:243], v[242:243], v[226:227]
    v_pk_mul_f32 v[244:245], v[244:245], v[228:229]
    v_pk_mul_f32 v[246:247], v[246:247], v[230:231]
    v_cvt_pk_bf16_f32 v128, v240, v241
    v_cvt_pk_bf16_f32 v129, v242, v243
    v_cvt_pk_bf16_f32 v130, v244, v245
    v_cvt_pk_bf16_f32 v131, v246, v247
    s_xor_b32 s38, s38, 1024
    buffer_load_dwordx4 a[196:199], v15, s[4:7], s38 offen
    s_add_u32 s23, s99, 10485760
    s_cmp_eq_u32 s98, 0
    s_cbranch_scc1 A_1
    buffer_store_dwordx4 v[128:131], v15, s[4:7], s23 offen offset:0
AB_1:
    s_waitcnt lgkmcnt(1)
    v_pk_fma_f32 v[232:233], v[136:137], v[10:11], v[232:233] op_sel_hi:[1,0,1]
    v_pk_fma_f32 v[234:235], v[138:139], v[10:11], v[234:235] op_sel_hi:[1,0,1]
    s_waitcnt lgkmcnt(0)
    v_pk_fma_f32 v[236:237], v[140:141], v[10:11], v[236:237] op_sel_hi:[1,0,1]
    v_pk_fma_f32 v[238:239], v[142:143], v[10:11], v[238:239] op_sel_hi:[1,0,1]
    ds_read_b128 v[224:227], v9 offset:128
    ds_read_b128 v[228:231], v9 offset:144
    v_pk_fma_f32 v[248:249], v[232:233], v[232:233], s[32:33]
    v_pk_fma_f32 v[250:251], v[234:235], v[234:235], s[32:33]
    s_add_u32 s38, s90, 22175744
    buffer_load_dwordx4 a[200:203], v15, s[4:7], s38 offen
    v_pk_fma_f32 v[252:253], v[236:237], v[236:237], s[32:33]
    v_pk_fma_f32 v[254:255], v[238:239], v[238:239], s[32:33]
    v_pk_mul_f32 v[248:249], v[248:249], v[232:233]
    v_pk_mul_f32 v[250:251], v[250:251], v[234:235]
    v_pk_mul_f32 v[252:253], v[252:253], v[236:237]
    v_pk_mul_f32 v[254:255], v[254:255], v[238:239]
    v_exp_f32 v248, v248
    v_exp_f32 v249, v249
    v_exp_f32 v250, v250
    s_xor_b32 s38, s38, 1024
    buffer_load_dwordx4 a[204:207], v15, s[4:7], s38 offen
    v_exp_f32 v251, v251
    v_exp_f32 v252, v252
    v_exp_f32 v253, v253
    v_exp_f32 v254, v254
    v_exp_f32 v255, v255
    v_pk_add_f32 v[248:249], v[248:249], 1.0 op_sel_hi:[1,0]
    v_pk_add_f32 v[250:251], v[250:251], 1.0 op_sel_hi:[1,0]
    v_pk_add_f32 v[252:253], v[252:253], 1.0 op_sel_hi:[1,0]
    v_pk_add_f32 v[254:255], v[254:255], 1.0 op_sel_hi:[1,0]
    s_add_u32 s38, s91, 22175744
    buffer_load_dwordx4 a[208:211], v15, s[4:7], s38 offen
    v_rcp_f32 v248, v248
    v_rcp_f32 v249, v249
    v_rcp_f32 v250, v250
    v_rcp_f32 v251, v251
    v_rcp_f32 v252, v252
    v_rcp_f32 v253, v253
    v_rcp_f32 v254, v254
    v_rcp_f32 v255, v255
    v_pk_mul_f32 v[248:249], v[248:249], v[232:233]
    s_xor_b32 s38, s38, 1024
    buffer_load_dwordx4 a[212:215], v15, s[4:7], s38 offen
    v_pk_mul_f32 v[250:251], v[250:251], v[234:235]
    v_pk_mul_f32 v[252:253], v[252:253], v[236:237]
    v_pk_mul_f32 v[254:255], v[254:255], v[238:239]
    v_cvt_pk_bf16_f32 v136, v248, v249
    v_cvt_pk_bf16_f32 v137, v250, v251
    v_cvt_pk_bf16_f32 v138, v252, v253
    v_cvt_pk_bf16_f32 v139, v254, v255
    s_add_u32 s23, s99, 10485760
    s_cmp_eq_u32 s98, 0
    s_cbranch_scc1 A_2
    buffer_store_dwordx4 v[136:139], v15, s[4:7], s23 offen offset:2048
AB_2:
    s_waitcnt lgkmcnt(1)
    v_pk_fma_f32 v[224:225], v[144:145], v[10:11], v[224:225] op_sel_hi:[1,0,1]
    s_add_u32 s38, s92, 22175744
    buffer_load_dwordx4 a[216:219], v15, s[4:7], s38 offen
    v_pk_fma_f32 v[226:227], v[146:147], v[10:11], v[226:227] op_sel_hi:[1,0,1]
    s_waitcnt lgkmcnt(0)
    v_pk_fma_f32 v[228:229], v[148:149], v[10:11], v[228:229] op_sel_hi:[1,0,1]
    v_pk_fma_f32 v[230:231], v[150:151], v[10:11], v[230:231] op_sel_hi:[1,0,1]
    ds_read_b128 v[232:235], v9 offset:160
    ds_read_b128 v[236:239], v9 offset:176
    v_pk_fma_f32 v[240:241], v[224:225], v[224:225], s[32:33]
    v_pk_fma_f32 v[242:243], v[226:227], v[226:227], s[32:33]
    v_pk_fma_f32 v[244:245], v[228:229], v[228:229], s[32:33]
    v_pk_fma_f32 v[246:247], v[230:231], v[230:231], s[32:33]
    s_xor_b32 s38, s38, 1024
    buffer_load_dwordx4 a[220:223], v15, s[4:7], s38 offen
    v_pk_mul_f32 v[240:241], v[240:241], v[224:225]
    v_pk_mul_f32 v[242:243], v[242:243], v[226:227]
    v_pk_mul_f32 v[244:245], v[244:245], v[228:229]
    v_pk_mul_f32 v[246:247], v[246:247], v[230:231]
    v_exp_f32 v240, v240
    v_exp_f32 v241, v241
    v_exp_f32 v242, v242
    v_exp_f32 v243, v243
    v_exp_f32 v244, v244
    s_add_u32 s38, s93, 22175744
    buffer_load_dwordx4 a[224:227], v15, s[4:7], s38 offen
    v_exp_f32 v245, v245
    v_exp_f32 v246, v246
    v_exp_f32 v247, v247
    v_pk_add_f32 v[240:241], v[240:241], 1.0 op_sel_hi:[1,0]
    v_pk_add_f32 v[242:243], v[242:243], 1.0 op_sel_hi:[1,0]
    v_pk_add_f32 v[244:245], v[244:245], 1.0 op_sel_hi:[1,0]
    v_pk_add_f32 v[246:247], v[246:247], 1.0 op_sel_hi:[1,0]
    v_rcp_f32 v240, v240
    v_rcp_f32 v241, v241
    s_xor_b32 s38, s38, 1024
    buffer_load_dwordx4 a[228:231], v15, s[4:7], s38 offen
    v_rcp_f32 v242, v242
    v_rcp_f32 v243, v243
    v_rcp_f32 v244, v244
    v_rcp_f32 v245, v245
    v_rcp_f32 v246, v246
    v_rcp_f32 v247, v247
    v_pk_mul_f32 v[240:241], v[240:241], v[224:225]
    v_pk_mul_f32 v[242:243], v[242:243], v[226:227]
    v_pk_mul_f32 v[244:245], v[244:245], v[228:229]
    s_add_u32 s38, s94, 22175744
    buffer_load_dwordx4 a[232:235], v15, s[4:7], s38 offen
    v_pk_mul_f32 v[246:247], v[246:247], v[230:231]
    v_cvt_pk_bf16_f32 v144, v240, v241
    v_cvt_pk_bf16_f32 v145, v242, v243
    v_cvt_pk_bf16_f32 v146, v244, v245
    v_cvt_pk_bf16_f32 v147, v246, v247
    s_add_u32 s23, s99, 10543104
    s_cmp_eq_u32 s98, 0
    s_cbranch_scc1 A_3
    buffer_store_dwordx4 v[144:147], v15, s[4:7], s23 offen offset:0
AB_3:
    s_waitcnt lgkmcnt(1)
    v_pk_fma_f32 v[232:233], v[152:153], v[10:11], v[232:233] op_sel_hi:[1,0,1]
    v_pk_fma_f32 v[234:235], v[154:155], v[10:11], v[234:235] op_sel_hi:[1,0,1]
    s_waitcnt lgkmcnt(0)
    v_pk_fma_f32 v[236:237], v[156:157], v[10:11], v[236:237] op_sel_hi:[1,0,1]
    s_xor_b32 s38, s38, 1024
    buffer_load_dwordx4 a[236:239], v15, s[4:7], s38 offen
    v_pk_fma_f32 v[238:239], v[158:159], v[10:11], v[238:239] op_sel_hi:[1,0,1]
    ds_read_b128 v[224:227], v9 offset:256
    ds_read_b128 v[228:231], v9 offset:272
    v_pk_fma_f32 v[248:249], v[232:233], v[232:233], s[32:33]
    v_pk_fma_f32 v[250:251], v[234:235], v[234:235], s[32:33]
    v_pk_fma_f32 v[252:253], v[236:237], v[236:237], s[32:33]
    v_pk_fma_f32 v[254:255], v[238:239], v[238:239], s[32:33]
    v_pk_mul_f32 v[248:249], v[248:249], v[232:233]
    v_pk_mul_f32 v[250:251], v[250:251], v[234:235]
    s_add_u32 s38, s95, 22175744
    buffer_load_dwordx4 a[240:243], v15, s[4:7], s38 offen
    v_pk_mul_f32 v[252:253], v[252:253], v[236:237]
    v_pk_mul_f32 v[254:255], v[254:255], v[238:239]
    v_exp_f32 v248, v248
    v_exp_f32 v249, v249
    v_exp_f32 v250, v250
    v_exp_f32 v251, v251
    v_exp_f32 v252, v252
    v_exp_f32 v253, v253
    v_exp_f32 v254, v254
    s_xor_b32 s38, s38, 1024
    buffer_load_dwordx4 a[244:247], v15, s[4:7], s38 offen
    v_exp_f32 v255, v255
    v_pk_add_f32 v[248:249], v[248:249], 1.0 op_sel_hi:[1,0]
    v_pk_add_f32 v[250:251], v[250:251], 1.0 op_sel_hi:[1,0]
    v_pk_add_f32 v[252:253], v[252:253], 1.0 op_sel_hi:[1,0]
    v_pk_add_f32 v[254:255], v[254:255], 1.0 op_sel_hi:[1,0]
    v_rcp_f32 v248, v248
    v_rcp_f32 v249, v249
    v_rcp_f32 v250, v250
    v_rcp_f32 v251, v251
    s_add_u32 s38, s96, 22175744
    buffer_load_dwordx4 a[248:251], v15, s[4:7], s38 offen
    v_rcp_f32 v252, v252
    v_rcp_f32 v253, v253
    v_rcp_f32 v254, v254
    v_rcp_f32 v255, v255
    v_pk_mul_f32 v[248:249], v[248:249], v[232:233]
    v_pk_mul_f32 v[250:251], v[250:251], v[234:235]
    v_pk_mul_f32 v[252:253], v[252:253], v[236:237]
    v_pk_mul_f32 v[254:255], v[254:255], v[238:239]
    v_cvt_pk_bf16_f32 v152, v248, v249
    s_xor_b32 s38, s38, 1024
    buffer_load_dwordx4 a[252:255], v15, s[4:7], s38 offen
    v_cvt_pk_bf16_f32 v153, v250, v251
    v_cvt_pk_bf16_f32 v154, v252, v253
    v_cvt_pk_bf16_f32 v155, v254, v255
    s_add_u32 s23, s99, 10543104
    s_cmp_eq_u32 s98, 0
    s_cbranch_scc1 A_4
    buffer_store_dwordx4 v[152:155], v15, s[4:7], s23 offen offset:2048
AB_4:
    s_waitcnt lgkmcnt(1)
    v_pk_fma_f32 v[224:225], v[160:161], v[10:11], v[224:225] op_sel_hi:[1,0,1]
    v_pk_fma_f32 v[226:227], v[162:163], v[10:11], v[226:227] op_sel_hi:[1,0,1]
    s_waitcnt lgkmcnt(0)
    v_pk_fma_f32 v[228:229], v[164:165], v[10:11], v[228:229] op_sel_hi:[1,0,1]
    v_pk_fma_f32 v[230:231], v[166:167], v[10:11], v[230:231] op_sel_hi:[1,0,1]
    ds_read_b128 v[232:235], v9 offset:288
    ds_read_b128 v[236:239], v9 offset:304
    v_pk_fma_f32 v[240:241], v[224:225], v[224:225], s[32:33]
    v_pk_fma_f32 v[242:243], v[226:227], v[226:227], s[32:33]
    v_pk_fma_f32 v[244:245], v[228:229], v[228:229], s[32:33]
    v_pk_fma_f32 v[246:247], v[230:231], v[230:231], s[32:33]
    v_pk_mul_f32 v[240:241], v[240:241], v[224:225]
    v_pk_mul_f32 v[242:243], v[242:243], v[226:227]
    v_pk_mul_f32 v[244:245], v[244:245], v[228:229]
    v_pk_mul_f32 v[246:247], v[246:247], v[230:231]
    v_exp_f32 v240, v240
    v_exp_f32 v241, v241
    v_exp_f32 v242, v242
    v_exp_f32 v243, v243
    v_exp_f32 v244, v244
    v_exp_f32 v245, v245
    v_exp_f32 v246, v246
    v_exp_f32 v247, v247
    v_pk_add_f32 v[240:241], v[240:241], 1.0 op_sel_hi:[1,0]
    v_pk_add_f32 v[242:243], v[242:243], 1.0 op_sel_hi:[1,0]
    v_pk_add_f32 v[244:245], v[244:245], 1.0 op_sel_hi:[1,0]
    v_pk_add_f32 v[246:247], v[246:247], 1.0 op_sel_hi:[1,0]
    v_rcp_f32 v240, v240
    v_rcp_f32 v241, v241
    v_rcp_f32 v242, v242
    v_rcp_f32 v243, v243
    v_rcp_f32 v244, v244
    v_rcp_f32 v245, v245
    v_rcp_f32 v246, v246
    v_rcp_f32 v247, v247
    v_pk_mul_f32 v[240:241], v[240:241], v[224:225]
    s_add_u32 s26, s83, 10485760
    buffer_load_dwordx4 v[32:35], v12, s[4:7], s26 offen sc1
    buffer_load_dwordx4 v[36:39], v13, s[4:7], s26 offen sc1
    v_pk_mul_f32 v[242:243], v[242:243], v[226:227]
    v_pk_mul_f32 v[244:245], v[244:245], v[228:229]
    v_pk_mul_f32 v[246:247], v[246:247], v[230:231]
    v_cvt_pk_bf16_f32 v160, v240, v241
    v_cvt_pk_bf16_f32 v161, v242, v243
    v_cvt_pk_bf16_f32 v162, v244, v245
    v_cvt_pk_bf16_f32 v163, v246, v247
    s_add_u32 s23, s99, 10600448
    s_cmp_eq_u32 s98, 0
    s_cbranch_scc1 A_5
    buffer_store_dwordx4 v[160:163], v15, s[4:7], s23 offen offset:0
AB_5:
    s_waitcnt lgkmcnt(1)
    v_pk_fma_f32 v[232:233], v[168:169], v[10:11], v[232:233] op_sel_hi:[1,0,1]
    v_pk_fma_f32 v[234:235], v[170:171], v[10:11], v[234:235] op_sel_hi:[1,0,1]
    s_waitcnt lgkmcnt(0)
    v_pk_fma_f32 v[236:237], v[172:173], v[10:11], v[236:237] op_sel_hi:[1,0,1]
    v_pk_fma_f32 v[238:239], v[174:175], v[10:11], v[238:239] op_sel_hi:[1,0,1]
    ds_read_b128 v[224:227], v9 offset:384
    ds_read_b128 v[228:231], v9 offset:400
    v_pk_fma_f32 v[248:249], v[232:233], v[232:233], s[32:33]
    v_pk_fma_f32 v[250:251], v[234:235], v[234:235], s[32:33]
    s_add_u32 s26, s84, 10485760
    buffer_load_dwordx4 v[40:43], v12, s[4:7], s26 offen sc1
    buffer_load_dwordx4 v[44:47], v13, s[4:7], s26 offen sc1
    v_pk_fma_f32 v[252:253], v[236:237], v[236:237], s[32:33]
    v_pk_fma_f32 v[254:255], v[238:239], v[238:239], s[32:33]
    v_pk_mul_f32 v[248:249], v[248:249], v[232:233]
    v_pk_mul_f32 v[250:251], v[250:251], v[234:235]
    v_pk_mul_f32 v[252:253], v[252:253], v[236:237]
    v_pk_mul_f32 v[254:255], v[254:255], v[238:239]
    v_exp_f32 v248, v248
    v_exp_f32 v249, v249
    v_exp_f32 v250, v250
    v_exp_f32 v251, v251
    v_exp_f32 v252, v252
    v_exp_f32 v253, v253
    v_exp_f32 v254, v254
    v_exp_f32 v255, v255
    v_pk_add_f32 v[248:249], v[248:249], 1.0 op_sel_hi:[1,0]
    v_pk_add_f32 v[250:251], v[250:251], 1.0 op_sel_hi:[1,0]
    s_add_u32 s26, s85, 10485760
    buffer_load_dwordx4 v[48:51], v12, s[4:7], s26 offen sc1
    buffer_load_dwordx4 v[52:55], v13, s[4:7], s26 offen sc1
    v_pk_add_f32 v[252:253], v[252:253], 1.0 op_sel_hi:[1,0]
    v_pk_add_f32 v[254:255], v[254:255], 1.0 op_sel_hi:[1,0]
    v_rcp_f32 v248, v248
    v_rcp_f32 v249, v249
    v_rcp_f32 v250, v250
    v_rcp_f32 v251, v251
    v_rcp_f32 v252, v252
    v_rcp_f32 v253, v253
    v_rcp_f32 v254, v254
    v_rcp_f32 v255, v255
    v_pk_mul_f32 v[248:249], v[248:249], v[232:233]
    v_pk_mul_f32 v[250:251], v[250:251], v[234:235]
    v_pk_mul_f32 v[252:253], v[252:253], v[236:237]
    v_pk_mul_f32 v[254:255], v[254:255], v[238:239]
    v_cvt_pk_bf16_f32 v168, v248, v249
    v_cvt_pk_bf16_f32 v169, v250, v251
    s_add_u32 s26, s86, 10485760
    buffer_load_dwordx4 v[56:59], v12, s[4:7], s26 offen sc1
    buffer_load_dwordx4 v[60:63], v13, s[4:7], s26 offen sc1
    v_cvt_pk_bf16_f32 v170, v252, v253
    v_cvt_pk_bf16_f32 v171, v254, v255
    s_add_u32 s23, s99, 10600448
    s_cmp_eq_u32 s98, 0
    s_cbranch_scc1 A_6
    buffer_store_dwordx4 v[168:171], v15, s[4:7], s23 offen offset:2048
AB_6:
    s_waitcnt lgkmcnt(1)
    v_pk_fma_f32 v[224:225], v[176:177], v[10:11], v[224:225] op_sel_hi:[1,0,1]
    v_pk_fma_f32 v[226:227], v[178:179], v[10:11], v[226:227] op_sel_hi:[1,0,1]
    s_waitcnt lgkmcnt(0)
    v_pk_fma_f32 v[228:229], v[180:181], v[10:11], v[228:229] op_sel_hi:[1,0,1]
    v_pk_fma_f32 v[230:231], v[182:183], v[10:11], v[230:231] op_sel_hi:[1,0,1]
    ds_read_b128 v[232:235], v9 offset:416
    ds_read_b128 v[236:239], v9 offset:432
    v_pk_fma_f32 v[240:241], v[224:225], v[224:225], s[32:33]
    v_pk_fma_f32 v[242:243], v[226:227], v[226:227], s[32:33]
    v_pk_fma_f32 v[244:245], v[228:229], v[228:229], s[32:33]
    v_pk_fma_f32 v[246:247], v[230:231], v[230:231], s[32:33]
    v_pk_mul_f32 v[240:241], v[240:241], v[224:225]
    v_pk_mul_f32 v[242:243], v[242:243], v[226:227]
    v_pk_mul_f32 v[244:245], v[244:245], v[228:229]
    s_add_u32 s26, s87, 10485760
    buffer_load_dwordx4 v[64:67], v12, s[4:7], s26 offen sc1
    buffer_load_dwordx4 v[68:71], v13, s[4:7], s26 offen sc1
    v_pk_mul_f32 v[246:247], v[246:247], v[230:231]
    v_exp_f32 v240, v240
    v_exp_f32 v241, v241
    v_exp_f32 v242, v242
    v_exp_f32 v243, v243
    v_exp_f32 v244, v244
    v_exp_f32 v245, v245
    v_exp_f32 v246, v246
    v_exp_f32 v247, v247
    v_pk_add_f32 v[240:241], v[240:241], 1.0 op_sel_hi:[1,0]
    v_pk_add_f32 v[242:243], v[242:243], 1.0 op_sel_hi:[1,0]
    v_pk_add_f32 v[244:245], v[244:245], 1.0 op_sel_hi:[1,0]
    v_pk_add_f32 v[246:247], v[246:247], 1.0 op_sel_hi:[1,0]
    v_rcp_f32 v240, v240
    v_rcp_f32 v241, v241
    v_rcp_f32 v242, v242
    s_add_u32 s26, s88, 10485760
    buffer_load_dwordx4 v[72:75], v12, s[4:7], s26 offen sc1
    buffer_load_dwordx4 v[76:79], v13, s[4:7], s26 offen sc1
    v_rcp_f32 v243, v243
    v_rcp_f32 v244, v244
    v_rcp_f32 v245, v245
    v_rcp_f32 v246, v246
    v_rcp_f32 v247, v247
    v_pk_mul_f32 v[240:241], v[240:241], v[224:225]
    v_pk_mul_f32 v[242:243], v[242:243], v[226:227]
    v_pk_mul_f32 v[244:245], v[244:245], v[228:229]
    v_pk_mul_f32 v[246:247], v[246:247], v[230:231]
    v_cvt_pk_bf16_f32 v176, v240, v241
    v_cvt_pk_bf16_f32 v177, v242, v243
    v_cvt_pk_bf16_f32 v178, v244, v245
    v_cvt_pk_bf16_f32 v179, v246, v247
    s_add_u32 s23, s99, 10657792
    s_cmp_eq_u32 s98, 0
    s_cbranch_scc1 A_7
    buffer_store_dwordx4 v[176:179], v15, s[4:7], s23 offen offset:0
AB_7:
    s_waitcnt lgkmcnt(1)
    v_pk_fma_f32 v[232:233], v[184:185], v[10:11], v[232:233] op_sel_hi:[1,0,1]
    v_pk_fma_f32 v[234:235], v[186:187], v[10:11], v[234:235] op_sel_hi:[1,0,1]
    s_add_u32 s26, s89, 10485760
    buffer_load_dwordx4 v[80:83], v12, s[4:7], s26 offen sc1
    buffer_load_dwordx4 v[84:87], v13, s[4:7], s26 offen sc1
    s_waitcnt lgkmcnt(0)
    v_pk_fma_f32 v[236:237], v[188:189], v[10:11], v[236:237] op_sel_hi:[1,0,1]
    v_pk_fma_f32 v[238:239], v[190:191], v[10:11], v[238:239] op_sel_hi:[1,0,1]
    v_pk_fma_f32 v[248:249], v[232:233], v[232:233], s[32:33]
    v_pk_fma_f32 v[250:251], v[234:235], v[234:235], s[32:33]
    v_pk_fma_f32 v[252:253], v[236:237], v[236:237], s[32:33]
    v_pk_fma_f32 v[254:255], v[238:239], v[238:239], s[32:33]
    v_pk_mul_f32 v[248:249], v[248:249], v[232:233]
    v_pk_mul_f32 v[250:251], v[250:251], v[234:235]
    v_pk_mul_f32 v[252:253], v[252:253], v[236:237]
    v_pk_mul_f32 v[254:255], v[254:255], v[238:239]
    v_exp_f32 v248, v248
    v_exp_f32 v249, v249
    v_exp_f32 v250, v250
    v_exp_f32 v251, v251
    v_exp_f32 v252, v252
    v_exp_f32 v253, v253
    s_add_u32 s26, s83, 10543104
    buffer_load_dwordx4 v[88:91], v12, s[4:7], s26 offen sc1
    buffer_load_dwordx4 v[92:95], v13, s[4:7], s26 offen sc1
    s_waitcnt vmcnt(17)
    v_max_u32 v14, v35, v39
    v_cmp_eq_u32 vcc, -1, v14
    s_cbranch_vccnz R_mh0_0
B_mh0_0:
    v_mfma_f32_32x32x16_bf16 v[16:31], a[32:35], v[32:35], v[16:31]
    v_exp_f32 v254, v254
    v_exp_f32 v255, v255
    v_mfma_f32_32x32x16_bf16 a[16:31], a[36:39], v[32:35], 0
    s_waitcnt vmcnt(14)
    v_max_u32 v14, v43, v47
    v_pk_add_f32 v[248:249], v[248:249], 1.0 op_sel_hi:[1,0]
    v_pk_add_f32 v[250:251], v[250:251], 1.0 op_sel_hi:[1,0]
    v_pk_add_f32 v[252:253], v[252:253], 1.0 op_sel_hi:[1,0]
    v_mfma_f32_32x32x16_bf16 a[0:15], a[32:35], v[36:39], 0
    v_cmp_eq_u32 vcc, -1, v14
    s_cbranch_vccnz R_mh0_1
B_mh0_1:
    v_pk_add_f32 v[254:255], v[254:255], 1.0 op_sel_hi:[1,0]
    v_rcp_f32 v248, v248
    v_mfma_f32_32x32x16_bf16 v[96:111], a[36:39], v[36:39], 0
    s_add_u32 s26, s84, 10543104
    buffer_load_dwordx4 v[32:35], v12, s[4:7], s26 offen sc1
    buffer_load_dwordx4 v[36:39], v13, s[4:7], s26 offen sc1
    v_rcp_f32 v249, v249
    v_mfma_f32_32x32x16_bf16 v[16:31], a[40:43], v[40:43], v[16:31]
    v_rcp_f32 v250, v250
    v_mfma_f32_32x32x16_bf16 a[16:31], a[44:47], v[40:43], a[16:31]
    s_waitcnt vmcnt(14)
    v_max_u32 v14, v51, v55
    v_rcp_f32 v251, v251
    v_mfma_f32_32x32x16_bf16 a[0:15], a[40:43], v[44:47], a[0:15]
    v_cmp_eq_u32 vcc, -1, v14
    s_cbranch_vccnz R_mh0_2
B_mh0_2:
    v_rcp_f32 v252, v252
    v_rcp_f32 v253, v253
    v_mfma_f32_32x32x16_bf16 v[96:111], a[44:47], v[44:47], v[96:111]
    s_add_u32 s26, s85, 10543104
    buffer_load_dwordx4 v[40:43], v12, s[4:7], s26 offen sc1
    buffer_load_dwordx4 v[44:47], v13, s[4:7], s26 offen sc1
    v_rcp_f32 v254, v254
    v_mfma_f32_32x32x16_bf16 v[16:31], a[48:51], v[48:51], v[16:31]
    v_rcp_f32 v255, v255
    v_mfma_f32_32x32x16_bf16 a[16:31], a[52:55], v[48:51], a[16:31]
    s_waitcnt vmcnt(14)
    v_max_u32 v14, v59, v63
    v_pk_mul_f32 v[248:249], v[248:249], v[232:233]
    v_pk_mul_f32 v[250:251], v[250:251], v[234:235]
    v_pk_mul_f32 v[252:253], v[252:253], v[236:237]
    v_mfma_f32_32x32x16_bf16 a[0:15], a[48:51], v[52:55], a[0:15]
    v_cmp_eq_u32 vcc, -1, v14
    s_cbranch_vccnz R_mh0_3
B_mh0_3:
    v_pk_mul_f32 v[254:255], v[254:255], v[238:239]
    v_cvt_pk_bf16_f32 v184, v248, v249
    v_cvt_pk_bf16_f32 v185, v250, v251
    v_mfma_f32_32x32x16_bf16 v[96:111], a[52:55], v[52:55], v[96:111]
    s_add_u32 s26, s86, 10543104
    buffer_load_dwordx4 v[48:51], v12, s[4:7], s26 offen sc1
    buffer_load_dwordx4 v[52:55], v13, s[4:7], s26 offen sc1
    v_cvt_pk_bf16_f32 v186, v252, v253
    v_mfma_f32_32x32x16_bf16 v[16:31], a[56:59], v[56:59], v[16:31]
    v_cvt_pk_bf16_f32 v187, v254, v255
    v_mfma_f32_32x32x16_bf16 a[16:31], a[60:63], v[56:59], a[16:31]
    s_waitcnt vmcnt(13)
    v_max_u32 v14, v67, v71
    s_add_u32 s23, s99, 10657792
    s_cmp_eq_u32 s98, 0
    s_cbranch_scc1 A_8
    buffer_store_dwordx4 v[184:187], v15, s[4:7], s23 offen offset:2048
AB_8:
    v_mfma_f32_32x32x16_bf16 a[0:15], a[56:59], v[60:63], a[0:15]
    v_cmp_eq_u32 vcc, -1, v14
    s_cbranch_vccnz R_mh0_4
B_mh0_4:
    ds_read_b64_tr_b16 v[112:113], v6 offset:0
    ds_read_b64_tr_b16 v[114:115], v6 offset:512
    ds_read_b64_tr_b16 v[116:117], v6 offset:1024
    ds_read_b64_tr_b16 v[118:119], v6 offset:1536
    v_mfma_f32_32x32x16_bf16 v[96:111], a[60:63], v[60:63], v[96:111]
    s_add_u32 s26, s87, 10543104
    buffer_load_dwordx4 v[56:59], v12, s[4:7], s26 offen sc1
    buffer_load_dwordx4 v[60:63], v13, s[4:7], s26 offen sc1
    v_mfma_f32_32x32x16_bf16 v[16:31], a[64:67], v[64:67], v[16:31]
    s_waitcnt lgkmcnt(2)
    v_max3_u32 v5, v112, v113, v114
    s_waitcnt lgkmcnt(1)
    v_max3_u32 v5, v5, v115, v116
    s_waitcnt lgkmcnt(0)
    v_max3_u32 v5, v5, v117, v118
    v_max_u32 v5, v5, v119
    v_cmp_eq_u32 vcc, -1, v5
    s_cbranch_vccnz R_mr0
B_mr0:
    v_mfma_f32_32x32x16_bf16 a[16:31], a[68:71], v[64:67], a[16:31]
    s_waitcnt vmcnt(14)
    v_max_u32 v14, v75, v79
    v_mfma_f32_32x32x16_bf16 a[0:15], a[64:67], v[68:71], a[0:15]
    v_cmp_eq_u32 vcc, -1, v14
    s_cbranch_vccnz R_mh0_5
B_mh0_5:
    s_barrier
    v_mfma_f32_32x32x16_bf16 v[96:111], a[68:71], v[68:71], v[96:111]
    s_add_u32 s26, s88, 10543104
    buffer_load_dwordx4 v[64:67], v12, s[4:7], s26 offen sc1
    buffer_load_dwordx4 v[68:71], v13, s[4:7], s26 offen sc1
    s_xor_b32 s30, s16, 0
    s_mul_i32 s30, s30, 12288
    s_add_u32 s30, s30, 114688
    v_add_u32 v120, s30, v15
    s_xor_b32 s30, s16, 1
    s_mul_i32 s30, s30, 12288
    s_add_u32 s30, s30, 114688
    v_add_u32 v121, s30, v15
    s_xor_b32 s30, s16, 2
    s_mul_i32 s30, s30, 12288
    s_add_u32 s30, s30, 118784
    v_add_u32 v122, s30, v15
    s_xor_b32 s30, s16, 3
    s_mul_i32 s30, s30, 12288
    s_add_u32 s30, s30, 122880
    v_add_u32 v123, s30, v15
    v_mfma_f32_32x32x16_bf16 v[16:31], a[72:75], v[72:75], v[16:31]
    v_mfma_f32_32x32x16_bf16 a[16:31], a[76:79], v[72:75], a[16:31]
    s_waitcnt vmcnt(13)
    v_max_u32 v14, v83, v87
    v_lshl_add_u32 v124, v3, 14, v7
    v_lshlrev_b32 v125, 3, v1
    v_mfma_f32_32x32x16_bf16 a[0:15], a[72:75], v[76:79], a[0:15]
    v_cmp_eq_u32 vcc, -1, v14
    s_cbranch_vccnz R_mh0_6
B_mh0_6:
    s_lshr_b32 s30, s16, 1
    s_or_b32 s30, s30, s18
    v_or_b32 v126, s30, v3
    v_cmp_eq_u32 s[30:31], 0, v126
    s_nop 1
    v_cndmask_b32 v126, 1.0, 0, s[30:31]
    s_mov_b32 s32, 0x00000000
    s_mov_b32 s33, 0x41f00000
    v_mfma_f32_32x32x16_bf16 v[96:111], a[76:79], v[76:79], v[96:111]
    s_add_u32 s26, s89, 10543104
    buffer_load_dwordx4 v[72:75], v12, s[4:7], s26 offen sc1
    buffer_load_dwordx4 v[76:79], v13, s[4:7], s26 offen sc1
    v_mfma_f32_32x32x16_bf16 v[16:31], a[80:83], v[80:83], v[16:31]
    v_mfma_f32_32x32x16_bf16 a[16:31], a[84:87], v[80:83], a[16:31]
    s_waitcnt vmcnt(13)
    v_max_u32 v14, v91, v95
    v_mfma_f32_32x32x16_bf16 a[0:15], a[80:83], v[84:87], a[0:15]
    v_cmp_eq_u32 vcc, -1, v14
    s_cbranch_vccnz R_mh0_7
B_mh0_7:
    v_mfma_f32_32x32x16_bf16 v[96:111], a[84:87], v[84:87], v[96:111]
    s_add_u32 s26, s83, 10600448
    buffer_load_dwordx4 v[80:83], v12, s[4:7], s26 offen sc1
    buffer_load_dwordx4 v[84:87], v13, s[4:7], s26 offen sc1
    v_mfma_f32_32x32x16_bf16 v[16:31], a[88:91], v[88:91], v[16:31]
    v_mfma_f32_32x32x16_bf16 a[16:31], a[92:95], v[88:91], a[16:31]
    s_waitcnt vmcnt(13)
    v_max_u32 v14, v35, v39
    v_mfma_f32_32x32x16_bf16 a[0:15], a[88:91], v[92:95], a[0:15]
    v_cmp_eq_u32 vcc, -1, v14
    s_cbranch_vccnz R_mh0_8
B_mh0_8:
    v_mfma_f32_32x32x16_bf16 v[96:111], a[92:95], v[92:95], v[96:111]
    s_add_u32 s26, s84, 10600448
    buffer_load_dwordx4 v[88:91], v12, s[4:7], s26 offen sc1
    buffer_load_dwordx4 v[92:95], v13, s[4:7], s26 offen sc1
    v_mfma_f32_32x32x16_bf16 v[16:31], a[96:99], v[32:35], v[16:31]
    v_mfma_f32_32x32x16_bf16 a[16:31], a[100:103], v[32:35], a[16:31]
    s_waitcnt vmcnt(13)
    v_max_u32 v14, v43, v47
    v_mfma_f32_32x32x16_bf16 a[0:15], a[96:99], v[36:39], a[0:15]
    v_cmp_eq_u32 vcc, -1, v14
    s_cbranch_vccnz R_mh0_9
B_mh0_9:
    v_mfma_f32_32x32x16_bf16 v[96:111], a[100:103], v[36:39], v[96:111]
    s_add_u32 s26, s85, 10600448
    buffer_load_dwordx4 v[32:35], v12, s[4:7], s26 offen sc1
    buffer_load_dwordx4 v[36:39], v13, s[4:7], s26 offen sc1
    v_mfma_f32_32x32x16_bf16 v[16:31], a[104:107], v[40:43], v[16:31]
    v_mfma_f32_32x32x16_bf16 a[16:31], a[108:111], v[40:43], a[16:31]
    s_waitcnt vmcnt(13)
    v_max_u32 v14, v51, v55
    v_mfma_f32_32x32x16_bf16 a[0:15], a[104:107], v[44:47], a[0:15]
    v_cmp_eq_u32 vcc, -1, v14
    s_cbranch_vccnz R_mh0_10
B_mh0_10:
    v_mfma_f32_32x32x16_bf16 v[96:111], a[108:111], v[44:47], v[96:111]
    s_add_u32 s26, s86, 10600448
    buffer_load_dwordx4 v[40:43], v12, s[4:7], s26 offen sc1
    buffer_load_dwordx4 v[44:47], v13, s[4:7], s26 offen sc1
    v_mfma_f32_32x32x16_bf16 v[16:31], a[112:115], v[48:51], v[16:31]
    v_mfma_f32_32x32x16_bf16 a[16:31], a[116:119], v[48:51], a[16:31]
    s_waitcnt vmcnt(12)
    v_max_u32 v14, v59, v63
    v_mfma_f32_32x32x16_bf16 a[0:15], a[112:115], v[52:55], a[0:15]
    v_cmp_eq_u32 vcc, -1, v14
    s_cbranch_vccnz R_mh0_11
B_mh0_11:
    v_mfma_f32_32x32x16_bf16 v[96:111], a[116:119], v[52:55], v[96:111]
    s_add_u32 s26, s87, 10600448
    buffer_load_dwordx4 v[48:51], v12, s[4:7], s26 offen sc1
    buffer_load_dwordx4 v[52:55], v13, s[4:7], s26 offen sc1
    v_mfma_f32_32x32x16_bf16 v[16:31], a[120:123], v[56:59], v[16:31]
    v_mfma_f32_32x32x16_bf16 a[16:31], a[124:127], v[56:59], a[16:31]
    s_waitcnt vmcnt(12)
    v_max_u32 v14, v67, v71
    v_mfma_f32_32x32x16_bf16 a[0:15], a[120:123], v[60:63], a[0:15]
    v_cmp_eq_u32 vcc, -1, v14
    s_cbranch_vccnz R_mh0_12
B_mh0_12:
    v_mfma_f32_32x32x16_bf16 v[96:111], a[124:127], v[60:63], v[96:111]
    s_add_u32 s26, s88, 10600448
    buffer_load_dwordx4 v[56:59], v12, s[4:7], s26 offen sc1
    buffer_load_dwordx4 v[60:63], v13, s[4:7], s26 offen sc1
    v_mfma_f32_32x32x16_bf16 v[16:31], a[128:131], v[64:67], v[16:31]
    v_mfma_f32_32x32x16_bf16 a[16:31], a[132:135], v[64:67], a[16:31]
    s_waitcnt vmcnt(12)
    v_max_u32 v14, v75, v79
    v_mfma_f32_32x32x16_bf16 a[0:15], a[128:131], v[68:71], a[0:15]
    v_cmp_eq_u32 vcc, -1, v14
    s_cbranch_vccnz R_mh0_13
B_mh0_13:
    v_mfma_f32_32x32x16_bf16 v[96:111], a[132:135], v[68:71], v[96:111]
    s_add_u32 s26, s89, 10600448
    buffer_load_dwordx4 v[64:67], v12, s[4:7], s26 offen sc1
    buffer_load_dwordx4 v[68:71], v13, s[4:7], s26 offen sc1
    v_mfma_f32_32x32x16_bf16 v[16:31], a[136:139], v[72:75], v[16:31]
    v_mfma_f32_32x32x16_bf16 a[16:31], a[140:143], v[72:75], a[16:31]
    s_waitcnt vmcnt(12)
    v_max_u32 v14, v83, v87
    v_mfma_f32_32x32x16_bf16 a[0:15], a[136:139], v[76:79], a[0:15]
    v_cmp_eq_u32 vcc, -1, v14
    s_cbranch_vccnz R_mh0_14
B_mh0_14:
    v_mfma_f32_32x32x16_bf16 v[96:111], a[140:143], v[76:79], v[96:111]
    s_add_u32 s26, s83, 10657792
    buffer_load_dwordx4 v[72:75], v12, s[4:7], s26 offen sc1
    buffer_load_dwordx4 v[76:79], v13, s[4:7], s26 offen sc1
    v_mfma_f32_32x32x16_bf16 v[16:31], a[144:147], v[80:83], v[16:31]
    v_mfma_f32_32x32x16_bf16 a[16:31], a[148:151], v[80:83], a[16:31]
    s_waitcnt vmcnt(12)
    v_max_u32 v14, v91, v95
    v_mfma_f32_32x32x16_bf16 a[0:15], a[144:147], v[84:87], a[0:15]
    v_cmp_eq_u32 vcc, -1, v14
    s_cbranch_vccnz R_mh0_15
B_mh0_15:
    v_mfma_f32_32x32x16_bf16 v[96:111], a[148:151], v[84:87], v[96:111]
    s_add_u32 s26, s84, 10657792
    buffer_load_dwordx4 v[80:83], v12, s[4:7], s26 offen sc1
    buffer_load_dwordx4 v[84:87], v13, s[4:7], s26 offen sc1
    v_mfma_f32_32x32x16_bf16 v[16:31], a[152:155], v[88:91], v[16:31]
    v_mfma_f32_32x32x16_bf16 a[16:31], a[156:159], v[88:91], a[16:31]
    s_waitcnt vmcnt(12)
    v_max_u32 v14, v35, v39
    v_mfma_f32_32x32x16_bf16 a[0:15], a[152:155], v[92:95], a[0:15]
    v_cmp_eq_u32 vcc, -1, v14
    s_cbranch_vccnz R_mh0_16
B_mh0_16:
    v_mfma_f32_32x32x16_bf16 v[96:111], a[156:159], v[92:95], v[96:111]
    s_add_u32 s26, s85, 10657792
    buffer_load_dwordx4 v[88:91], v12, s[4:7], s26 offen sc1
    buffer_load_dwordx4 v[92:95], v13, s[4:7], s26 offen sc1
    v_mfma_f32_32x32x16_bf16 v[16:31], a[160:163], v[32:35], v[16:31]
    v_mfma_f32_32x32x16_bf16 a[16:31], a[164:167], v[32:35], a[16:31]
    s_waitcnt vmcnt(12)
    v_max_u32 v14, v43, v47
    v_mfma_f32_32x32x16_bf16 a[0:15], a[160:163], v[36:39], a[0:15]
    v_cmp_eq_u32 vcc, -1, v14
    s_cbranch_vccnz R_mh0_17
B_mh0_17:
    v_mfma_f32_32x32x16_bf16 v[96:111], a[164:167], v[36:39], v[96:111]
    v_and_b32 v127, 7, v1
    v_and_b32 v5, 24, v1
    v_lshlrev_b32 v5, 3, v5
    v_lshl_add_u32 v127, v127, 11, v5
    s_mov_b32 s30, 1836800
    buffer_load_dword v127, v127, s[4:7], s30 offen offset:8 sc1
    s_add_u32 s26, s86, 10657792
    buffer_load_dwordx4 v[32:35], v12, s[4:7], s26 offen sc1
    buffer_load_dwordx4 v[36:39], v13, s[4:7], s26 offen sc1
    v_mfma_f32_32x32x16_bf16 v[16:31], a[168:171], v[40:43], v[16:31]
    v_mfma_f32_32x32x16_bf16 a[16:31], a[172:175], v[40:43], a[16:31]
    s_waitcnt vmcnt(13)
    v_max_u32 v14, v51, v55
    v_mfma_f32_32x32x16_bf16 a[0:15], a[168:171], v[44:47], a[0:15]
    v_cmp_eq_u32 vcc, -1, v14
    s_cbranch_vccnz R_mh0_18
B_mh0_18:
    v_mfma_f32_32x32x16_bf16 v[96:111], a[172:175], v[44:47], v[96:111]
    s_add_u32 s26, s87, 10657792
    buffer_load_dwordx4 v[40:43], v12, s[4:7], s26 offen sc1
    buffer_load_dwordx4 v[44:47], v13, s[4:7], s26 offen sc1
    v_mfma_f32_32x32x16_bf16 v[16:31], a[176:179], v[48:51], v[16:31]
    v_mfma_f32_32x32x16_bf16 a[16:31], a[180:183], v[48:51], a[16:31]
    s_waitcnt vmcnt(13)
    v_max_u32 v14, v59, v63
    v_mfma_f32_32x32x16_bf16 a[0:15], a[176:179], v[52:55], a[0:15]
    v_cmp_eq_u32 vcc, -1, v14
    s_cbranch_vccnz R_mh0_19
B_mh0_19:
    v_mfma_f32_32x32x16_bf16 v[96:111], a[180:183], v[52:55], v[96:111]
    s_add_u32 s26, s88, 10657792
    buffer_load_dwordx4 v[48:51], v12, s[4:7], s26 offen sc1
    buffer_load_dwordx4 v[52:55], v13, s[4:7], s26 offen sc1
    v_mfma_f32_32x32x16_bf16 v[16:31], a[184:187], v[56:59], v[16:31]
    v_mfma_f32_32x32x16_bf16 a[16:31], a[188:191], v[56:59], a[16:31]
    s_waitcnt vmcnt(13)
    v_max_u32 v14, v67, v71
    v_mfma_f32_32x32x16_bf16 a[0:15], a[184:187], v[60:63], a[0:15]
    v_cmp_eq_u32 vcc, -1, v14
    s_cbranch_vccnz R_mh0_20
B_mh0_20:
    v_mfma_f32_32x32x16_bf16 v[96:111], a[188:191], v[60:63], v[96:111]
    s_add_u32 s26, s89, 10657792
    buffer_load_dwordx4 v[56:59], v12, s[4:7], s26 offen sc1
    buffer_load_dwordx4 v[60:63], v13, s[4:7], s26 offen sc1
    v_mfma_f32_32x32x16_bf16 v[16:31], a[192:195], v[64:67], v[16:31]
    v_mfma_f32_32x32x16_bf16 a[16:31], a[196:199], v[64:67], a[16:31]
    s_waitcnt vmcnt(13)
    v_max_u32 v14, v75, v79
    v_mfma_f32_32x32x16_bf16 a[0:15], a[192:195], v[68:71], a[0:15]
    v_cmp_eq_u32 vcc, -1, v14
    s_cbranch_vccnz R_mh0_21
B_mh0_21:
    v_mfma_f32_32x32x16_bf16 v[96:111], a[196:199], v[68:71], v[96:111]
    v_mfma_f32_32x32x16_bf16 v[16:31], a[200:203], v[72:75], v[16:31]
    v_mfma_f32_32x32x16_bf16 a[16:31], a[204:207], v[72:75], a[16:31]
    s_waitcnt vmcnt(11)
    v_max_u32 v14, v83, v87
    v_mfma_f32_32x32x16_bf16 a[0:15], a[200:203], v[76:79], a[0:15]
    v_cmp_eq_u32 vcc, -1, v14
    s_cbranch_vccnz R_mh0_22
B_mh0_22:
    v_mfma_f32_32x32x16_bf16 v[96:111], a[204:207], v[76:79], v[96:111]
    v_mfma_f32_32x32x16_bf16 a[16:31], a[212:215], v[80:83], a[16:31]
    s_waitcnt vmcnt(9)
    v_max_u32 v14, v91, v95
    v_mfma_f32_32x32x16_bf16 a[0:15], a[208:211], v[84:87], a[0:15]
    v_cmp_eq_u32 vcc, -1, v14
    s_cbranch_vccnz R_mh0_23
B_mh0_23:
    v_mfma_f32_32x32x16_bf16 v[96:111], a[212:215], v[84:87], v[96:111]
    v_mfma_f32_32x32x16_bf16 a[16:31], a[220:223], v[88:91], a[16:31]
    s_waitcnt vmcnt(6)
    v_max_u32 v14, v35, v39
    v_mfma_f32_32x32x16_bf16 a[0:15], a[216:219], v[92:95], a[0:15]
    v_cmp_eq_u32 vcc, -1, v14
    s_cbranch_vccnz R_mh0_24
B_mh0_24:
    v_mfma_f32_32x32x16_bf16 v[96:111], a[220:223], v[92:95], v[96:111]
    s_waitcnt vmcnt(3)
    v_max3_u32 v14, v43, v47, v51
    v_mfma_f32_32x32x16_bf16 a[16:31], a[228:231], v[32:35], a[16:31]
    s_waitcnt vmcnt(1)
    v_max3_u32 v14, v14, v55, v59
    s_waitcnt vmcnt(0)
    v_max_u32 v14, v14, v63
    v_mfma_f32_32x32x16_bf16 a[0:15], a[224:227], v[36:39], a[0:15]
    v_cmp_eq_u32 vcc, -1, v14
    s_cbranch_vccnz R_mh0_25
B_mh0_25:
    v_mfma_f32_32x32x16_bf16 v[96:111], a[228:231], v[36:39], v[96:111]
    v_cmp_eq_u32 vcc, -1, v127
    s_cbranch_vccnz R_mc4
B_mc4:
    v_mfma_f32_32x32x16_bf16 a[0:15], a[232:235], v[44:47], a[0:15]
    v_mfma_f32_32x32x16_bf16 a[0:15], a[240:243], v[52:55], a[0:15]
    v_mfma_f32_32x32x16_bf16 a[0:15], a[248:251], v[60:63], a[0:15]
    v_mfma_f32_32x32x16_bf16 v[96:111], a[236:239], v[44:47], v[96:111]
    v_mfma_f32_32x32x16_bf16 v[96:111], a[244:247], v[52:55], v[96:111]
    s_nop 9
    ds_write_b128 v121, a[0:3] offset:0
    ds_write_b128 v121, a[4:7] offset:1024
    v_mfma_f32_32x32x16_bf16 v[96:111], a[252:255], v[60:63], v[96:111]
    ds_write_b128 v121, a[8:11] offset:2048
    ds_write_b128 v121, a[12:15] offset:3072
    v_mfma_f32_32x32x16_bf16 a[16:31], a[236:239], v[40:43], a[16:31]
    v_lshlrev_b32 v176, 16, v112
    v_and_b32 v177, 0xffff0000, v112
    v_lshlrev_b32 v178, 16, v113
    v_and_b32 v179, 0xffff0000, v113
    v_lshlrev_b32 v180, 16, v114
    v_and_b32 v181, 0xffff0000, v114
    v_lshlrev_b32 v182, 16, v115
    v_and_b32 v183, 0xffff0000, v115
    v_lshlrev_b32 v184, 16, v116
    v_and_b32 v185, 0xffff0000, v116
    v_lshlrev_b32 v186, 16, v117
    v_and_b32 v187, 0xffff0000, v117
    v_lshlrev_b32 v188, 16, v118
    v_and_b32 v189, 0xffff0000, v118
    v_lshlrev_b32 v190, 16, v119
    v_and_b32 v191, 0xffff0000, v119
    v_mfma_f32_32x32x16_bf16 a[16:31], a[244:247], v[48:51], a[16:31]
    ds_write_b128 v123, v[96:99] offset:0
    ds_write_b128 v123, v[100:103] offset:1024
    v_mfma_f32_32x32x16_bf16 a[16:31], a[252:255], v[56:59], a[16:31]
    ds_write_b128 v123, v[104:107] offset:2048
    ds_write_b128 v123, v[108:111] offset:3072
    v_mfma_f32_32x32x16_bf16 v[16:31], a[208:211], v[80:83], v[16:31]
    v_mfma_f32_32x32x16_bf16 v[16:31], a[216:219], v[88:91], v[16:31]
    s_nop 7
    ds_write_b128 v122, a[16:19] offset:0
    ds_write_b128 v122, a[20:23] offset:1024
    v_mfma_f32_32x32x16_bf16 v[16:31], a[224:227], v[32:35], v[16:31]
    ds_write_b128 v122, a[24:27] offset:2048
    ds_write_b128 v122, a[28:31] offset:3072
    s_waitcnt lgkmcnt(0)
    s_barrier
    ds_read_b128 v[128:131], v120 offset:0
    ds_read_b128 v[132:135], v120 offset:1024
    ds_read_b128 v[136:139], v120 offset:2048
    ds_read_b128 v[140:143], v120 offset:3072
    v_mfma_f32_32x32x16_bf16 v[16:31], a[232:235], v[40:43], v[16:31]
    ds_read_b128 v[144:147], v120 offset:4096
    ds_read_b128 v[148:151], v120 offset:5120
    ds_read_b128 v[152:155], v120 offset:6144
    ds_read_b128 v[156:159], v120 offset:7168
    v_mfma_f32_32x32x16_bf16 v[16:31], a[240:243], v[48:51], v[16:31]
    ds_read_b128 v[160:163], v120 offset:8192
    ds_read_b128 v[164:167], v120 offset:9216
    ds_read_b128 v[168:171], v120 offset:10240
    ds_read_b128 v[172:175], v120 offset:11264
    v_mfma_f32_32x32x16_bf16 v[16:31], a[248:251], v[56:59], v[16:31]
    s_mov_b32 s30, 0xc0088e99
    s_mov_b32 s31, 0xc0088e99
    s_waitcnt lgkmcnt(11)
    v_pk_fma_f32 v[176:177], v[128:129], s[30:31], v[176:177]
    v_pk_fma_f32 v[178:179], v[130:131], s[30:31], v[178:179]
    s_waitcnt lgkmcnt(10)
    v_pk_fma_f32 v[180:181], v[132:133], s[30:31], v[180:181]
    v_pk_fma_f32 v[182:183], v[134:135], s[30:31], v[182:183]
    s_waitcnt lgkmcnt(9)
    v_pk_fma_f32 v[184:185], v[136:137], s[30:31], v[184:185]
    v_pk_fma_f32 v[186:187], v[138:139], s[30:31], v[186:187]
    s_waitcnt lgkmcnt(8)
    v_pk_fma_f32 v[188:189], v[140:141], s[30:31], v[188:189]
    v_pk_fma_f32 v[190:191], v[142:143], s[30:31], v[190:191]
    s_waitcnt lgkmcnt(7)
    v_pk_fma_f32 v[176:177], v[144:145], s[30:31], v[176:177]
    v_pk_fma_f32 v[178:179], v[146:147], s[30:31], v[178:179]
    s_waitcnt lgkmcnt(6)
    v_pk_fma_f32 v[180:181], v[148:149], s[30:31], v[180:181]
    v_pk_fma_f32 v[182:183], v[150:151], s[30:31], v[182:183]
    s_waitcnt lgkmcnt(5)
    v_pk_fma_f32 v[184:185], v[152:153], s[30:31], v[184:185]
    v_pk_fma_f32 v[186:187], v[154:155], s[30:31], v[186:187]
    s_waitcnt lgkmcnt(4)
    v_pk_fma_f32 v[188:189], v[156:157], s[30:31], v[188:189]
    v_pk_fma_f32 v[190:191], v[158:159], s[30:31], v[190:191]
    s_waitcnt lgkmcnt(3)
    v_pk_fma_f32 v[176:177], v[160:161], s[30:31], v[176:177]
    v_pk_fma_f32 v[178:179], v[162:163], s[30:31], v[178:179]
    s_waitcnt lgkmcnt(2)
    v_pk_fma_f32 v[180:181], v[164:165], s[30:31], v[180:181]
    v_pk_fma_f32 v[182:183], v[166:167], s[30:31], v[182:183]
    s_waitcnt lgkmcnt(1)
    v_pk_fma_f32 v[184:185], v[168:169], s[30:31], v[184:185]
    v_pk_fma_f32 v[186:187], v[170:171], s[30:31], v[186:187]
    s_waitcnt lgkmcnt(0)
    v_pk_fma_f32 v[188:189], v[172:173], s[30:31], v[188:189]
    v_pk_fma_f32 v[190:191], v[174:175], s[30:31], v[190:191]
    v_pk_fma_f32 v[16:17], v[16:17], s[30:31], v[176:177]
    v_pk_fma_f32 v[18:19], v[18:19], s[30:31], v[178:179]
    v_pk_fma_f32 v[20:21], v[20:21], s[30:31], v[180:181]
    v_pk_fma_f32 v[22:23], v[22:23], s[30:31], v[182:183]
    v_pk_fma_f32 v[24:25], v[24:25], s[30:31], v[184:185]
    v_pk_fma_f32 v[26:27], v[26:27], s[30:31], v[186:187]
    v_pk_fma_f32 v[28:29], v[28:29], s[30:31], v[188:189]
    v_pk_fma_f32 v[30:31], v[30:31], s[30:31], v[190:191]
    v_mul_f32 v177, v17, v126
    v_mov_b32 v176, v16
    v_pk_mul_f32 v[10:11], v[176:177], v[176:177]
    v_pk_mul_f32 v[12:13], v[18:19], v[18:19]
    v_pk_fma_f32 v[10:11], v[20:21], v[20:21], v[10:11]
    v_pk_fma_f32 v[12:13], v[22:23], v[22:23], v[12:13]
    v_pk_fma_f32 v[10:11], v[24:25], v[24:25], v[10:11]
    v_pk_fma_f32 v[12:13], v[26:27], v[26:27], v[12:13]
    v_pk_fma_f32 v[10:11], v[28:29], v[28:29], v[10:11]
    v_pk_fma_f32 v[12:13], v[30:31], v[30:31], v[12:13]
    v_pk_add_f32 v[10:11], v[10:11], v[12:13]
    v_add_f32 v10, v10, v11
    v_mov_b32 v11, v10
    v_cvt_pk_bf16_f32 v112, v16, v17
    v_cvt_pk_bf16_f32 v113, v18, v19
    v_permlane32_swap_b32 v10, v11
    v_add_f32 v10, v10, v11
    v_cvt_f64_f32 v[10:11], v10
    v_add_f64 v[10:11], v[10:11], s[32:33]
    s_mov_b64 exec, 0xffffffff
    buffer_atomic_add_f64 v[10:11], v125, s[4:7], s28 offen sc1
    s_mov_b64 exec, -1
    s_add_u32 s31, s25, 0
    buffer_store_dword v112, v124, s[4:7], s31 offen sc1
    s_add_u32 s31, s25, 8192
    buffer_store_dword v113, v124, s[4:7], s31 offen sc1
    v_cvt_pk_bf16_f32 v114, v20, v21
    s_add_u32 s31, s25, 32768
    buffer_store_dword v114, v124, s[4:7], s31 offen sc1
    v_cvt_pk_bf16_f32 v115, v22, v23
    s_add_u32 s31, s25, 40960
    buffer_store_dword v115, v124, s[4:7], s31 offen sc1
    v_cvt_pk_bf16_f32 v116, v24, v25
    s_add_u32 s31, s25, 65536
    buffer_store_dword v116, v124, s[4:7], s31 offen sc1
    v_cvt_pk_bf16_f32 v117, v26, v27
    s_add_u32 s31, s25, 73728
    buffer_store_dword v117, v124, s[4:7], s31 offen sc1
    v_cvt_pk_bf16_f32 v118, v28, v29
    s_add_u32 s31, s25, 98304
    buffer_store_dword v118, v124, s[4:7], s31 offen sc1
    v_cvt_pk_bf16_f32 v119, v30, v31
    s_add_u32 s31, s25, 106496
    buffer_store_dword v119, v124, s[4:7], s31 offen sc1
    s_barrier
    v_lshrrev_b32 v3, 4, v1
    v_lshlrev_b32 v6, 11, v2
    v_lshl_add_u32 v6, v3, 9, v6
    v_and_b32 v3, 15, v1
    v_lshl_add_u32 v5, v3, 4, v6
    v_and_b32 v3, 3, v1
    v_lshl_add_u32 v6, v3, 6, v6
    v_and_b32 v3, 4, v1
    v_lshl_add_u32 v6, v3, 3, v6
    v_and_b32 v3, 8, v1
    v_lshl_add_u32 v6, v3, 5, v6
    s_add_u32 s100, s100, 3932160
    s_mov_b32 s25, 1966080
    v_lshlrev_b32 v14, 1, v5
    buffer_load_dwordx4 v[48:51], v6, s[4:7], s101 offen offset:0 sc1
    buffer_load_dwordx4 v[52:55], v6, s[4:7], s101 offen offset:16 sc1
    s_cmp_eq_u32 s3, 0
    s_cselect_b32 s28, 0, 1.0
    s_cselect_b32 s29, 0, -1.0
    v_add_u32 v7, 114688, v5
    v_and_b32 v8, 0x7ff, v5
    v_add_u32 v8, 114688, v8
    v_lshrrev_b32 v4, 4, v0
    v_bfe_u32 v3, v1, 3, 1
    v_lshl_add_u32 v4, v4, 2, v3
    v_mul_u32_u24 v4, 28672, v4
    v_and_b32 v3, 0x70, v15
    v_add_u32 v4, v4, v3
    v_accvgpr_write_b32 a0, -1
    v_accvgpr_write_b32 a1, -1
    v_accvgpr_write_b32 a2, -1
    v_accvgpr_write_b32 a3, -1
    v_and_b32 v3, 31, v1
    v_lshlrev_b32 v3, 7, v3
    s_mov_b32 s30, 1925120
    buffer_load_dword v3, v3, s[4:7], s30 offen sc1
    s_mov_b32 s32, 0x92492492
    s_mov_b32 s33, 0x3f624924
    v_mov_b32 v10, 0xfffffd61
    v_mov_b32 v11, 0xc19fffff
    v_mov_b32 v9, 0x422c0000
    v_and_b32 v229, 15, v1
    v_lshrrev_b32 v230, 4, v1
    v_lshl_add_u32 v224, v2, 4, v229
    v_cvt_f32_u32 v224, v224
    v_lshlrev_b32 v225, 2, v230
    v_cvt_f32_u32 v225, v225
    v_cvt_f32_u32 v226, v229
    v_mul_f32 v227, 0x3c800000, v224
    v_mul_f32 v228, v227, v225
    v_bfe_i32 v231, v1, 0, 1
    v_and_b32 v231, 0x80008000, v231
    v_fmamk_f32 v229, v227, 0x00000000, v228
    v_fmamk_f32 v230, v227, 0x3f800000, v228
    v_cos_f32 v132, v229
    v_sin_f32 v229, v229
    v_cos_f32 v133, v230
    v_sin_f32 v230, v230
    v_cvt_pk_bf16_f32 v128, v132, v229
    v_cvt_pk_bf16_f32 v132, -v229, v132
    v_cvt_pk_bf16_f32 v129, v133, v230
    v_cvt_pk_bf16_f32 v133, -v230, v133
    v_fmamk_f32 v229, v227, 0x40000000, v228
    v_fmamk_f32 v230, v227, 0x40400000, v228
    v_cos_f32 v134, v229
    v_sin_f32 v229, v229
    v_cos_f32 v135, v230
    v_sin_f32 v230, v230
    v_cvt_pk_bf16_f32 v130, v134, v229
    v_cvt_pk_bf16_f32 v134, -v229, v134
    v_cvt_pk_bf16_f32 v131, v135, v230
    v_cvt_pk_bf16_f32 v135, -v230, v135
    v_fmamk_f32 v229, v227, 0x41800000, v228
    v_fmamk_f32 v230, v227, 0x41880000, v228
    v_cos_f32 v140, v229
    v_sin_f32 v229, v229
    v_cos_f32 v141, v230
    v_sin_f32 v230, v230
    v_cvt_pk_bf16_f32 v136, v140, v229
    v_cvt_pk_bf16_f32 v140, -v229, v140
    v_cvt_pk_bf16_f32 v137, v141, v230
    v_cvt_pk_bf16_f32 v141, -v230, v141
    v_fmamk_f32 v229, v227, 0x41900000, v228
    v_fmamk_f32 v230, v227, 0x41980000, v228
    v_cos_f32 v142, v229
    v_sin_f32 v229, v229
    v_cos_f32 v143, v230
    v_sin_f32 v230, v230
    v_cvt_pk_bf16_f32 v138, v142, v229
    v_cvt_pk_bf16_f32 v142, -v229, v142
    v_cvt_pk_bf16_f32 v139, v143, v230
    v_cvt_pk_bf16_f32 v143, -v230, v143
    v_xor_b32 v144, v231, v128
    v_xor_b32 v145, v231, v129
    v_xor_b32 v146, v231, v130
    v_xor_b32 v147, v231, v131
    v_xor_b32 v148, v231, v132
    v_xor_b32 v149, v231, v133
    v_xor_b32 v150, v231, v134
    v_xor_b32 v151, v231, v135
    v_xor_b32 v152, v231, v136
    v_xor_b32 v153, v231, v137
    v_xor_b32 v154, v231, v138
    v_xor_b32 v155, v231, v139
    v_xor_b32 v156, v231, v140
    v_xor_b32 v157, v231, v141
    v_xor_b32 v158, v231, v142
    v_xor_b32 v159, v231, v143
    v_mul_f32 v227, 0x3a000000, v224
    v_mul_f32 v228, v227, v225
    v_fmamk_f32 v229, v227, 0x00000000, v228
    v_cos_f32 v192, v229
    v_sin_f32 v200, v229
    v_fmamk_f32 v230, v227, 0x3f800000, v228
    v_cos_f32 v193, v230
    v_sin_f32 v201, v230
    v_fmamk_f32 v229, v227, 0x40000000, v228
    v_cos_f32 v194, v229
    v_sin_f32 v202, v229
    v_fmamk_f32 v230, v227, 0x40400000, v228
    v_cos_f32 v195, v230
    v_sin_f32 v203, v230
    v_fmamk_f32 v229, v227, 0x41800000, v228
    v_cos_f32 v196, v229
    v_sin_f32 v204, v229
    v_fmamk_f32 v230, v227, 0x41880000, v228
    v_cos_f32 v197, v230
    v_sin_f32 v205, v230
    v_fmamk_f32 v229, v227, 0x41900000, v228
    v_cos_f32 v198, v229
    v_sin_f32 v206, v229
    v_fmamk_f32 v230, v227, 0x41980000, v228
    v_cos_f32 v199, v230
    v_sin_f32 v207, v230
    v_mul_f32 v227, 0x3d000000, v226
    v_mul_f32 v228, v227, v225
    v_fmamk_f32 v229, v227, 0x00000000, v228
    v_fmamk_f32 v230, v227, 0x3f800000, v228
    v_cos_f32 v164, v229
    v_sin_f32 v229, v229
    v_cos_f32 v165, v230
    v_sin_f32 v230, v230
    v_cvt_pk_bf16_f32 v160, v164, v229
    v_cvt_pk_bf16_f32 v164, -v229, v164
    v_cvt_pk_bf16_f32 v161, v165, v230
    v_cvt_pk_bf16_f32 v165, -v230, v165
    v_fmamk_f32 v229, v227, 0x40000000, v228
    v_fmamk_f32 v230, v227, 0x40400000, v228
    v_cos_f32 v166, v229
    v_sin_f32 v229, v229
    v_cos_f32 v167, v230
    v_sin_f32 v230, v230
    v_cvt_pk_bf16_f32 v162, v166, v229
    v_cvt_pk_bf16_f32 v166, -v229, v166
    v_cvt_pk_bf16_f32 v163, v167, v230
    v_cvt_pk_bf16_f32 v167, -v230, v167
    v_xor_b32 v168, v231, v160
    v_xor_b32 v169, v231, v161
    v_xor_b32 v170, v231, v162
    v_xor_b32 v171, v231, v163
    v_xor_b32 v172, v231, v164
    v_xor_b32 v173, v231, v165
    v_xor_b32 v174, v231, v166
    v_xor_b32 v175, v231, v167
    v_mov_b32 v176, v160
    v_xor_b32 v177, 0x80008000, v161
    v_mov_b32 v178, v162
    v_xor_b32 v179, 0x80008000, v163
    v_mov_b32 v180, v164
    v_xor_b32 v181, 0x80008000, v165
    v_mov_b32 v182, v166
    v_xor_b32 v183, 0x80008000, v167
    v_mov_b32 v184, v168
    v_xor_b32 v185, 0x80008000, v169
    v_mov_b32 v186, v170
    v_xor_b32 v187, 0x80008000, v171
    v_mov_b32 v188, v172
    v_xor_b32 v189, 0x80008000, v173
    v_mov_b32 v190, v174
    v_xor_b32 v191, 0x80008000, v175
    v_lshlrev_b32 v229, 4, v2
    v_cvt_f32_u32 v229, v229
    v_add_f32 v225, v225, v229
    v_add_f32 v227, 0x00000000, v226
    v_mul_f32 v227, 0x3a000000, v227
    v_mul_f32 v228, v227, v225
    v_fmamk_f32 v229, v227, 0x00000000, v228
    v_cos_f32 v208, v229
    v_sin_f32 v216, v229
    v_fmamk_f32 v230, v227, 0x3f800000, v228
    v_cos_f32 v209, v230
    v_sin_f32 v217, v230
    v_fmamk_f32 v229, v227, 0x40000000, v228
    v_cos_f32 v210, v229
    v_sin_f32 v218, v229
    v_fmamk_f32 v230, v227, 0x40400000, v228
    v_cos_f32 v211, v230
    v_sin_f32 v219, v230
    v_add_f32 v227, 0x41800000, v226
    v_mul_f32 v227, 0x3a000000, v227
    v_mul_f32 v228, v227, v225
    v_fmamk_f32 v229, v227, 0x00000000, v228
    v_cos_f32 v212, v229
    v_sin_f32 v220, v229
    v_fmamk_f32 v230, v227, 0x3f800000, v228
    v_cos_f32 v213, v230
    v_sin_f32 v221, v230
    v_fmamk_f32 v229, v227, 0x40000000, v228
    v_cos_f32 v214, v229
    v_sin_f32 v222, v229
    v_fmamk_f32 v230, v227, 0x40400000, v228
    v_cos_f32 v215, v230
    v_sin_f32 v223, v230
    buffer_load_dwordx4 v[16:19], v5, s[4:7], s100 offen offset:0 sc1
    buffer_load_dwordx4 v[20:23], v5, s[4:7], s100 offen offset:256 sc1
    s_waitcnt vmcnt(1)
    v_max3_u32 v13, v16, v17, v18
    s_waitcnt vmcnt(0)
    v_max3_u32 v13, v13, v19, v20
    v_max3_u32 v13, v13, v21, v22
    v_max_u32 v13, v13, v23
    v_cmp_eq_u32 vcc, -1, v13
    s_cbranch_vccnz R_mc
B_mc:
    buffer_load_dwordx4 v[32:35], v14, s[4:7], s25 offen offset:0 sc1
    buffer_load_dwordx4 v[36:39], v14, s[4:7], s25 offen offset:16 sc1
    buffer_load_dwordx4 v[40:43], v14, s[4:7], s25 offen offset:512 sc1
    buffer_load_dwordx4 v[44:47], v14, s[4:7], s25 offen offset:528 sc1
    s_mov_b32 s30, 0x3a000000
    s_mov_b32 s31, 0x3a000000
    v_lshlrev_b32 v72, 16, v48
    v_and_b32 v73, 0xffff0000, v48
    v_lshlrev_b32 v80, 16, v50
    v_and_b32 v81, 0xffff0000, v50
    v_lshlrev_b32 v74, 16, v49
    v_and_b32 v75, 0xffff0000, v49
    v_lshlrev_b32 v82, 16, v51
    v_and_b32 v83, 0xffff0000, v51
    v_lshlrev_b32 v76, 16, v52
    v_and_b32 v77, 0xffff0000, v52
    v_lshlrev_b32 v84, 16, v54
    v_and_b32 v85, 0xffff0000, v54
    v_lshlrev_b32 v78, 16, v53
    v_and_b32 v79, 0xffff0000, v53
    v_lshlrev_b32 v86, 16, v55
    v_and_b32 v87, 0xffff0000, v55
    v_pk_mul_f32 v[72:73], v[72:73], s[30:31]
    v_pk_mul_f32 v[80:81], v[80:81], s[30:31]
    v_pk_mul_f32 v[74:75], v[74:75], s[30:31]
    v_pk_mul_f32 v[82:83], v[82:83], s[30:31]
    v_pk_mul_f32 v[76:77], v[76:77], s[30:31]
    v_pk_mul_f32 v[84:85], v[84:85], s[30:31]
    v_pk_mul_f32 v[78:79], v[78:79], s[30:31]
    v_pk_mul_f32 v[86:87], v[86:87], s[30:31]
    v_lshlrev_b32 v56, 16, v16
    v_and_b32 v64, 0xffff0000, v16
    v_lshlrev_b32 v57, 16, v17
    v_and_b32 v65, 0xffff0000, v17
    v_lshlrev_b32 v58, 16, v18
    v_and_b32 v66, 0xffff0000, v18
    v_lshlrev_b32 v59, 16, v19
    v_and_b32 v67, 0xffff0000, v19
    v_lshlrev_b32 v60, 16, v20
    v_and_b32 v68, 0xffff0000, v20
    v_lshlrev_b32 v61, 16, v21
    v_and_b32 v69, 0xffff0000, v21
    v_lshlrev_b32 v62, 16, v22
    v_and_b32 v70, 0xffff0000, v22
    v_lshlrev_b32 v63, 16, v23
    v_and_b32 v71, 0xffff0000, v23
    s_waitcnt vmcnt(2)
    v_min3_u32 v12, v33, v35, v37
    s_waitcnt vmcnt(1)
    v_min3_u32 v12, v12, v39, v41
    s_waitcnt vmcnt(0)
    v_min3_u32 v12, v12, v43, v45
    v_min_u32 v12, v12, v47
    v_cmp_lt_u32 vcc, v12, v9
    s_cbranch_vccnz R_mcq
B_mcq:
    v_fma_f64 v[32:33], v[32:33], s[32:33], v[10:11]
    v_fma_f64 v[34:35], v[34:35], s[32:33], v[10:11]
    v_fma_f64 v[36:37], v[36:37], s[32:33], v[10:11]
    v_fma_f64 v[38:39], v[38:39], s[32:33], v[10:11]
    v_fma_f64 v[40:41], v[40:41], s[32:33], v[10:11]
    v_fma_f64 v[42:43], v[42:43], s[32:33], v[10:11]
    v_fma_f64 v[44:45], v[44:45], s[32:33], v[10:11]
    v_fma_f64 v[46:47], v[46:47], s[32:33], v[10:11]
    v_cvt_f32_f64 v24, v[32:33]
    v_cvt_f32_f64 v25, v[34:35]
    v_cvt_f32_f64 v26, v[36:37]
    v_cvt_f32_f64 v27, v[38:39]
    v_cvt_f32_f64 v28, v[40:41]
    v_cvt_f32_f64 v29, v[42:43]
    v_cvt_f32_f64 v30, v[44:45]
    v_cvt_f32_f64 v31, v[46:47]
    v_rsq_f32 v24, v24
    v_rsq_f32 v25, v25
    v_rsq_f32 v26, v26
    v_rsq_f32 v27, v27
    v_rsq_f32 v28, v28
    v_rsq_f32 v29, v29
    v_rsq_f32 v30, v30
    v_rsq_f32 v31, v31
    v_pk_mul_f32 v[104:105], v[56:57], v[24:25]
    v_pk_mul_f32 v[112:113], v[64:65], v[24:25]
    v_pk_mul_f32 v[112:113], v[112:113], s[28:29] op_sel_hi:[1,0]
    v_pk_mul_f32 v[106:107], v[58:59], v[26:27]
    v_pk_mul_f32 v[114:115], v[66:67], v[26:27]
    v_pk_mul_f32 v[114:115], v[114:115], s[28:29] op_sel_hi:[1,0]
    v_pk_mul_f32 v[108:109], v[60:61], v[28:29]
    v_pk_mul_f32 v[116:117], v[68:69], v[28:29]
    v_pk_mul_f32 v[116:117], v[116:117], s[28:29] op_sel_hi:[1,0]
    v_pk_mul_f32 v[110:111], v[62:63], v[30:31]
    v_pk_mul_f32 v[118:119], v[70:71], v[30:31]
    v_pk_mul_f32 v[118:119], v[118:119], s[28:29] op_sel_hi:[1,0]
    v_cvt_pk_bf16_f32 v120, v104, v112
    v_cvt_pk_bf16_f32 v121, v105, v113
    v_cvt_pk_bf16_f32 v122, v106, v114
    v_cvt_pk_bf16_f32 v123, v107, v115
    v_cvt_pk_bf16_f32 v124, v108, v116
    v_cvt_pk_bf16_f32 v125, v109, v117
    v_cvt_pk_bf16_f32 v126, v110, v118
    v_cvt_pk_bf16_f32 v127, v111, v119
    ds_write_b128 v7, v[120:123] offset:0
    ds_write_b128 v7, v[124:127] offset:256
    s_add_u32 s38, s90, 23068672
    buffer_load_dwordx4 a[32:35], v15, s[4:7], s38 offen
    s_xor_b32 s38, s38, 1024
    buffer_load_dwordx4 a[36:39], v15, s[4:7], s38 offen
    s_waitcnt lgkmcnt(0)
    s_barrier
    ds_read_b128 v[224:227], v8 offset:0
    ds_read_b128 v[228:231], v8 offset:2048
    ds_read_b128 v[232:235], v8 offset:4096
    ds_read_b128 v[236:239], v8 offset:6144
    ds_read_b128 v[240:243], v8 offset:256
    ds_read_b128 v[244:247], v8 offset:2304
    ds_read_b128 v[248:251], v8 offset:4352
    ds_read_b128 v[252:255], v8 offset:6400
    s_cmp_eq_u32 s98, 0
    s_cbranch_scc1 A_9
    s_add_u32 s23, s99, 10485760
    buffer_store_dwordx4 a[0:3], v15, s[4:7], s23 offen offset:0
    buffer_store_dwordx4 a[0:3], v15, s[4:7], s23 offen offset:2048
    s_add_u32 s23, s99, 10543104
    buffer_store_dwordx4 a[0:3], v15, s[4:7], s23 offen offset:0
    buffer_store_dwordx4 a[0:3], v15, s[4:7], s23 offen offset:2048
    s_add_u32 s23, s99, 10600448
    buffer_store_dwordx4 a[0:3], v15, s[4:7], s23 offen offset:0
    buffer_store_dwordx4 a[0:3], v15, s[4:7], s23 offen offset:2048
    s_add_u32 s23, s99, 10657792
    buffer_store_dwordx4 a[0:3], v15, s[4:7], s23 offen offset:0
    buffer_store_dwordx4 a[0:3], v15, s[4:7], s23 offen offset:2048
AB_9:
    s_waitcnt lgkmcnt(7)
    v_mfma_f32_16x16x32_bf16 v[88:91], v[224:227], v[128:131], 0
    v_mfma_f32_16x16x32_bf16 v[92:95], v[224:227], v[132:135], 0
    s_waitcnt lgkmcnt(6)
    v_mfma_f32_16x16x32_bf16 v[88:91], v[228:231], v[136:139], v[88:91]
    v_mfma_f32_16x16x32_bf16 v[92:95], v[228:231], v[140:143], v[92:95]
    s_waitcnt lgkmcnt(5)
    v_mfma_f32_16x16x32_bf16 v[88:91], v[232:235], v[144:147], v[88:91]
    v_mfma_f32_16x16x32_bf16 v[92:95], v[232:235], v[148:151], v[92:95]
    s_waitcnt lgkmcnt(4)
    v_mfma_f32_16x16x32_bf16 v[88:91], v[236:239], v[152:155], v[88:91]
    v_mfma_f32_16x16x32_bf16 v[92:95], v[236:239], v[156:159], v[92:95]
    s_waitcnt lgkmcnt(3)
    v_mfma_f32_16x16x32_bf16 v[96:99], v[240:243], v[128:131], 0
    v_mfma_f32_16x16x32_bf16 v[100:103], v[240:243], v[132:135], 0
    s_waitcnt lgkmcnt(2)
    v_mfma_f32_16x16x32_bf16 v[96:99], v[244:247], v[136:139], v[96:99]
    v_mfma_f32_16x16x32_bf16 v[100:103], v[244:247], v[140:143], v[100:103]
    s_waitcnt lgkmcnt(1)
    v_mfma_f32_16x16x32_bf16 v[96:99], v[248:251], v[144:147], v[96:99]
    v_mfma_f32_16x16x32_bf16 v[100:103], v[248:251], v[148:151], v[100:103]
    s_waitcnt lgkmcnt(0)
    v_mfma_f32_16x16x32_bf16 v[96:99], v[252:255], v[152:155], v[96:99]
    v_mfma_f32_16x16x32_bf16 v[100:103], v[252:255], v[156:159], v[100:103]
    v_pk_mul_f32 v[104:105], v[88:89], v[192:193]
    v_pk_mul_f32 v[112:113], v[92:93], v[192:193]
    v_pk_fma_f32 v[104:105], v[92:93], v[200:201], v[104:105]
    v_pk_fma_f32 v[112:113], v[88:89], v[200:201], v[112:113] neg_lo:[1,0,0] neg_hi:[1,0,0]
    v_pk_mul_f32 v[106:107], v[90:91], v[194:195]
    v_pk_mul_f32 v[114:115], v[94:95], v[194:195]
    v_pk_fma_f32 v[106:107], v[94:95], v[202:203], v[106:107]
    v_pk_fma_f32 v[114:115], v[90:91], v[202:203], v[114:115] neg_lo:[1,0,0] neg_hi:[1,0,0]
    v_cvt_pk_bf16_f32 v120, v104, v112
    v_cvt_pk_bf16_f32 v121, v105, v113
    v_cvt_pk_bf16_f32 v122, v106, v114
    v_cvt_pk_bf16_f32 v123, v107, v115
    v_pk_mul_f32 v[108:109], v[96:97], v[196:197]
    v_pk_mul_f32 v[116:117], v[100:101], v[196:197]
    v_pk_fma_f32 v[108:109], v[100:101], v[204:205], v[108:109]
    v_pk_fma_f32 v[116:117], v[96:97], v[204:205], v[116:117] neg_lo:[1,0,0] neg_hi:[1,0,0]
    v_pk_mul_f32 v[110:111], v[98:99], v[198:199]
    v_pk_mul_f32 v[118:119], v[102:103], v[198:199]
    v_pk_fma_f32 v[110:111], v[102:103], v[206:207], v[110:111]
    v_pk_fma_f32 v[118:119], v[98:99], v[206:207], v[118:119] neg_lo:[1,0,0] neg_hi:[1,0,0]
    v_cvt_pk_bf16_f32 v124, v108, v116
    v_cvt_pk_bf16_f32 v125, v109, v117
    v_cvt_pk_bf16_f32 v126, v110, v118
    v_cvt_pk_bf16_f32 v127, v111, v119
    v_mfma_f32_16x16x32_bf16 v[88:91], v[160:163], v[120:123], 0
    v_mfma_f32_16x16x32_bf16 v[92:95], v[164:167], v[120:123], 0
    v_mfma_f32_16x16x32_bf16 v[88:91], v[168:171], v[124:127], v[88:91]
    v_mfma_f32_16x16x32_bf16 v[92:95], v[172:175], v[124:127], v[92:95]
    v_mfma_f32_16x16x32_bf16 v[96:99], v[176:179], v[120:123], 0
    v_mfma_f32_16x16x32_bf16 v[100:103], v[180:183], v[120:123], 0
    v_mfma_f32_16x16x32_bf16 v[96:99], v[184:187], v[124:127], v[96:99]
    v_mfma_f32_16x16x32_bf16 v[100:103], v[188:191], v[124:127], v[100:103]
    s_add_u32 s38, s91, 23068672
    buffer_load_dwordx4 a[40:43], v15, s[4:7], s38 offen
    s_xor_b32 s38, s38, 1024
    buffer_load_dwordx4 a[44:47], v15, s[4:7], s38 offen
    v_pk_mul_f32 v[104:105], v[88:89], v[72:73]
    v_pk_mul_f32 v[112:113], v[88:89], v[80:81]
    v_pk_fma_f32 v[104:105], v[92:93], v[80:81], v[104:105] neg_lo:[1,0,0] neg_hi:[1,0,0]
    v_pk_fma_f32 v[112:113], v[92:93], v[72:73], v[112:113]
    v_pk_mul_f32 v[106:107], v[90:91], v[74:75]
    v_pk_mul_f32 v[114:115], v[90:91], v[82:83]
    v_pk_fma_f32 v[106:107], v[94:95], v[82:83], v[106:107] neg_lo:[1,0,0] neg_hi:[1,0,0]
    v_pk_fma_f32 v[114:115], v[94:95], v[74:75], v[114:115]
    v_cvt_pk_bf16_f32 v120, v104, -v112
    v_cvt_pk_bf16_f32 v121, v105, -v113
    v_cvt_pk_bf16_f32 v122, v106, -v114
    v_cvt_pk_bf16_f32 v123, v107, -v115
    v_pk_mul_f32 v[108:109], v[96:97], v[76:77]
    v_pk_mul_f32 v[116:117], v[96:97], v[84:85]
    v_pk_fma_f32 v[108:109], v[100:101], v[84:85], v[108:109] neg_lo:[1,0,0] neg_hi:[1,0,0]
    v_pk_fma_f32 v[116:117], v[100:101], v[76:77], v[116:117]
    v_pk_mul_f32 v[110:111], v[98:99], v[78:79]
    v_pk_mul_f32 v[118:119], v[98:99], v[86:87]
    v_pk_fma_f32 v[110:111], v[102:103], v[86:87], v[110:111] neg_lo:[1,0,0] neg_hi:[1,0,0]
    v_pk_fma_f32 v[118:119], v[102:103], v[78:79], v[118:119]
    v_cvt_pk_bf16_f32 v124, v108, -v116
    v_cvt_pk_bf16_f32 v125, v109, -v117
    v_cvt_pk_bf16_f32 v126, v110, -v118
    v_cvt_pk_bf16_f32 v127, v111, -v119
    v_mfma_f32_16x16x32_bf16 v[88:91], v[120:123], v[160:163], 0
    v_mfma_f32_16x16x32_bf16 v[92:95], v[120:123], v[164:167], 0
    v_mfma_f32_16x16x32_bf16 v[88:91], v[124:127], v[168:171], v[88:91]
    v_mfma_f32_16x16x32_bf16 v[92:95], v[124:127], v[172:175], v[92:95]
    v_mfma_f32_16x16x32_bf16 v[96:99], v[120:123], v[176:179], 0
    v_mfma_f32_16x16x32_bf16 v[100:103], v[120:123], v[180:183], 0
    v_mfma_f32_16x16x32_bf16 v[96:99], v[124:127], v[184:187], v[96:99]
    v_mfma_f32_16x16x32_bf16 v[100:103], v[124:127], v[188:191], v[100:103]
    s_add_u32 s38, s92, 23068672
    buffer_load_dwordx4 a[48:51], v15, s[4:7], s38 offen
    s_xor_b32 s38, s38, 1024
    buffer_load_dwordx4 a[52:55], v15, s[4:7], s38 offen
    v_pk_mul_f32 v[104:105], v[88:89], v[208:209]
    v_pk_mul_f32 v[112:113], v[92:93], v[208:209]
    v_pk_fma_f32 v[104:105], v[92:93], v[216:217], v[104:105]
    v_pk_fma_f32 v[112:113], v[88:89], v[216:217], v[112:113] neg_lo:[1,0,0] neg_hi:[1,0,0]
    v_pk_mul_f32 v[106:107], v[90:91], v[210:211]
    v_pk_mul_f32 v[114:115], v[94:95], v[210:211]
    v_pk_fma_f32 v[106:107], v[94:95], v[218:219], v[106:107]
    v_pk_fma_f32 v[114:115], v[90:91], v[218:219], v[114:115] neg_lo:[1,0,0] neg_hi:[1,0,0]
    v_cvt_pk_bf16_f32 v120, v104, v112
    v_cvt_pk_bf16_f32 v121, v105, v113
    v_cvt_pk_bf16_f32 v122, v106, v114
    v_cvt_pk_bf16_f32 v123, v107, v115
    v_pk_mul_f32 v[108:109], v[96:97], v[212:213]
    v_pk_mul_f32 v[116:117], v[100:101], v[212:213]
    v_pk_fma_f32 v[108:109], v[100:101], v[220:221], v[108:109]
    v_pk_fma_f32 v[116:117], v[96:97], v[220:221], v[116:117] neg_lo:[1,0,0] neg_hi:[1,0,0]
    v_pk_mul_f32 v[110:111], v[98:99], v[214:215]
    v_pk_mul_f32 v[118:119], v[102:103], v[214:215]
    v_pk_fma_f32 v[110:111], v[102:103], v[222:223], v[110:111]
    v_pk_fma_f32 v[118:119], v[98:99], v[222:223], v[118:119] neg_lo:[1,0,0] neg_hi:[1,0,0]
    v_cvt_pk_bf16_f32 v124, v108, v116
    v_cvt_pk_bf16_f32 v125, v109, v117
    v_cvt_pk_bf16_f32 v126, v110, v118
    v_cvt_pk_bf16_f32 v127, v111, v119
    ds_write_b128 v7, v[120:123] offset:8192
    ds_write_b128 v7, v[124:127] offset:8448
    s_lshl_b32 s23, s3, 7
    s_add_u32 s24, s23, 5767168
    s_add_u32 s25, s23, 5824512
    s_waitcnt vmcnt(4)
    s_waitcnt lgkmcnt(0)
    s_barrier
    v_cmp_eq_u32 vcc, -1, v3
    s_cbranch_vccnz R_mc31
B_mc31:
    ds_read_b128 v[224:227], v8 offset:8192
    ds_read_b128 v[228:231], v8 offset:10240
    ds_read_b128 v[232:235], v8 offset:12288
    ds_read_b128 v[236:239], v8 offset:14336
    ds_read_b128 v[240:243], v8 offset:8448
    ds_read_b128 v[244:247], v8 offset:10496
    ds_read_b128 v[248:251], v8 offset:12544
    ds_read_b128 v[252:255], v8 offset:14592
    s_lshl_b32 s22, s16, 5
    s_add_u32 s22, s22, s3
    s_cmp_gt_u32 s22, 31
    s_cbranch_scc1 L_nogo1
    s_add_u32 s23, s23, 1921024
    s_mov_b64 exec, 1
    buffer_store_dword v1, v1, s[4:7], s23 offen sc1
    s_mov_b64 exec, -1
L_nogo1:
    s_waitcnt lgkmcnt(7)
    v_mfma_f32_16x16x32_bf16 v[88:91], v[128:131], v[224:227], 0
    v_mfma_f32_16x16x32_bf16 v[92:95], v[132:135], v[224:227], 0
    s_waitcnt lgkmcnt(6)
    v_mfma_f32_16x16x32_bf16 v[88:91], v[136:139], v[228:231], v[88:91]
    v_mfma_f32_16x16x32_bf16 v[92:95], v[140:143], v[228:231], v[92:95]
    s_waitcnt lgkmcnt(5)
    v_mfma_f32_16x16x32_bf16 v[88:91], v[144:147], v[232:235], v[88:91]
    v_mfma_f32_16x16x32_bf16 v[92:95], v[148:151], v[232:235], v[92:95]
    s_waitcnt lgkmcnt(4)
    v_mfma_f32_16x16x32_bf16 v[88:91], v[152:155], v[236:239], v[88:91]
    v_mfma_f32_16x16x32_bf16 v[92:95], v[156:159], v[236:239], v[92:95]
    s_waitcnt lgkmcnt(3)
    v_mfma_f32_16x16x32_bf16 v[96:99], v[128:131], v[240:243], 0
    v_mfma_f32_16x16x32_bf16 v[100:103], v[132:135], v[240:243], 0
    s_waitcnt lgkmcnt(2)
    v_mfma_f32_16x16x32_bf16 v[96:99], v[136:139], v[244:247], v[96:99]
    v_mfma_f32_16x16x32_bf16 v[100:103], v[140:143], v[244:247], v[100:103]
    s_waitcnt lgkmcnt(1)
    v_mfma_f32_16x16x32_bf16 v[96:99], v[144:147], v[248:251], v[96:99]
    v_mfma_f32_16x16x32_bf16 v[100:103], v[148:151], v[248:251], v[100:103]
    s_waitcnt lgkmcnt(0)
    v_mfma_f32_16x16x32_bf16 v[96:99], v[152:155], v[252:255], v[96:99]
    v_mfma_f32_16x16x32_bf16 v[100:103], v[156:159], v[252:255], v[100:103]
    v_pk_add_f32 v[104:105], v[56:57], v[88:89]
    v_pk_fma_f32 v[112:113], v[92:93], s[28:29], v[64:65] op_sel:[0,1,0] op_sel_hi:[1,1,1]
    v_pk_add_f32 v[106:107], v[58:59], v[90:91]
    v_pk_fma_f32 v[114:115], v[94:95], s[28:29], v[66:67] op_sel:[0,1,0] op_sel_hi:[1,1,1]
    v_cvt_pk_bf16_f32 v120, v104, v105
    v_cvt_pk_bf16_f32 v121, v106, v107
    v_cvt_pk_bf16_f32 v122, v112, v113
    v_cvt_pk_bf16_f32 v123, v114, v115
    buffer_store_dwordx4 v[120:123], v4, s[4:7], s24 offen sc1
    v_pk_add_f32 v[108:109], v[60:61], v[96:97]
    v_pk_fma_f32 v[116:117], v[100:101], s[28:29], v[68:69] op_sel:[0,1,0] op_sel_hi:[1,1,1]
    v_pk_add_f32 v[110:111], v[62:63], v[98:99]
    v_pk_fma_f32 v[118:119], v[102:103], s[28:29], v[70:71] op_sel:[0,1,0] op_sel_hi:[1,1,1]
    v_cvt_pk_bf16_f32 v124, v108, v109
    v_cvt_pk_bf16_f32 v125, v110, v111
    v_cvt_pk_bf16_f32 v126, v116, v117
    v_cvt_pk_bf16_f32 v127, v118, v119
    buffer_store_dwordx4 v[124:127], v4, s[4:7], s25 offen sc1
    v_and_b32 v8, 0x31, v1
    v_lshlrev_b32 v8, 2, v8
    v_and_or_b32 v8, v1, 8, v8
    v_and_b32 v9, 6, v1
    v_lshl_or_b32 v8, v9, 3, v8
    s_lshl_b32 s23, s19, 8
    buffer_load_dword v8, v8, s[12:15], s23 offen
    s_add_u32 s38, s93, 23068672
    buffer_load_dwordx4 a[56:59], v15, s[4:7], s38 offen
    s_xor_b32 s38, s38, 1024
    buffer_load_dwordx4 a[60:63], v15, s[4:7], s38 offen
    s_add_u32 s38, s94, 23068672
    buffer_load_dwordx4 a[64:67], v15, s[4:7], s38 offen
    s_xor_b32 s38, s38, 1024
    buffer_load_dwordx4 a[68:71], v15, s[4:7], s38 offen
    v_lshrrev_b32 v3, 5, v1
    v_and_b32 v4, 31, v1
    v_and_b32 v6, 3, v1
    v_lshlrev_b32 v6, 4, v6
    v_and_b32 v5, 4, v1
    v_lshl_or_b32 v6, v5, 1, v6
    v_and_b32 v5, 8, v1
    v_lshl_or_b32 v6, v5, 4, v6
    v_and_b32 v5, 16, v1
    v_lshl_or_b32 v6, v5, 2, v6
    v_and_b32 v5, 32, v1
    v_lshl_or_b32 v6, v5, 3, v6
    v_add_u32 v6, s36, v6
    v_lshlrev_b32 v7, 2, v4
    v_add_u32 v5, 0x10000, v15
    s_lshl_b32 s22, s16, 10
    s_add_u32 s22, s22, 114688
    s_lshl2_add_u32 s27, s97, s16
    s_lshl_b32 s27, s27, 7
    s_add_u32 s27, s27, 1867776
    s_lshr_b32 s31, s16, 1
    s_lshl1_add_u32 s30, s18, s31
    s_and_b32 s33, s16, 1
    s_lshl1_add_u32 s32, s17, s33
    s_mul_i32 s29, s32, 28672
    s_lshl_b32 s23, s30, 11
    s_add_u32 s20, s23, s29
    s_add_u32 s20, s20, 7602176
    s_and_b32 s23, s32, 3
    s_lshl4_add_u32 s23, s97, s23
    s_mul_i32 s29, s23, 7168
    s_lshl_b32 s23, s30, 6
    s_add_u32 s25, s29, s23
    s_waitcnt vmcnt(4)
    v_lshlrev_b32 v12, 16, v8
    v_and_b32 v13, 0xffff0000, v8
    v_mul_f32 v12, 0xbeeff558, v12
    v_mul_f32 v13, 0xbeeff558, v13
    v_lshl_add_u32 v9, v1, 3, s22
    ds_write_b64 v9, v[12:13]
    v_lshl_add_u32 v9, v3, 6, s22
    v_add_u32 v8, 8192, v7
    s_lshl_b32 s23, s16, 10
    s_and_b32 s23, s23, 1024
    v_add_u32 v12, s23, v15
    v_xor_b32 v13, 1024, v12
    ds_read_b128 v[192:195], v15 offset:0
    ds_read_b128 v[196:199], v15 offset:28672
    ds_read_b128 v[200:203], v15 offset:57344
    ds_read_b128 v[204:207], v5 offset:20480
    ds_read_b128 v[208:211], v15 offset:1024
    ds_read_b128 v[212:215], v15 offset:29696
    ds_read_b128 v[216:219], v15 offset:58368
    ds_read_b128 v[220:223], v5 offset:21504
    s_add_u32 m0, s36, 0
    s_add_u32 s26, s76, 5767168
    buffer_load_dwordx4 v15, s[4:7], s26 offen offset:0 sc1 lds
    buffer_load_dwordx4 v15, s[4:7], s26 offen offset:1024 sc1 lds
    buffer_load_dwordx4 v15, s[4:7], s26 offen offset:2048 sc1 lds
    buffer_load_dwordx4 v15, s[4:7], s26 offen offset:3072 sc1 lds
    s_add_u32 m0, s36, 4096
    s_add_u32 s26, s77, 5767168
    buffer_load_dwordx4 v15, s[4:7], s26 offen offset:0 sc1 lds
    buffer_load_dwordx4 v15, s[4:7], s26 offen offset:1024 sc1 lds
    buffer_load_dwordx4 v15, s[4:7], s26 offen offset:2048 sc1 lds
    s_add_u32 s38, s95, 23068672
    buffer_load_dwordx4 a[72:75], v15, s[4:7], s38 offen
    s_xor_b32 s38, s38, 1024
    buffer_load_dwordx4 a[76:79], v15, s[4:7], s38 offen
    s_add_u32 s38, s96, 23068672
    buffer_load_dwordx4 a[80:83], v15, s[4:7], s38 offen
    s_xor_b32 s38, s38, 1024
    buffer_load_dwordx4 a[84:87], v15, s[4:7], s38 offen
    s_add_u32 s38, s90, 23470080
    buffer_load_dwordx4 a[88:91], v15, s[4:7], s38 offen
    s_xor_b32 s38, s38, 1024
    buffer_load_dwordx4 a[92:95], v15, s[4:7], s38 offen
    s_add_u32 s38, s91, 23470080
    buffer_load_dwordx4 a[96:99], v15, s[4:7], s38 offen
    s_xor_b32 s38, s38, 1024
    buffer_load_dwordx4 a[100:103], v15, s[4:7], s38 offen
    s_waitcnt vmcnt(14)
    ds_read_b64_tr_b16 v[16:17], v6 offset:0
    ds_read_b64_tr_b16 v[18:19], v6 offset:512
    s_waitcnt vmcnt(13)
    ds_read_b64_tr_b16 v[20:21], v6 offset:1024
    ds_read_b64_tr_b16 v[22:23], v6 offset:1536
    s_waitcnt lgkmcnt(2)
    v_max3_u32 v14, v16, v17, v18
    v_max_u32 v14, v14, v19
    v_cmp_eq_u32 vcc, -1, v14
    s_cbranch_vccnz R_mx1_0
B_mx1_0:
    v_mfma_f32_32x32x16_bf16 v[128:143], v[192:195], v[16:19], 0
    s_waitcnt vmcnt(12)
    ds_read_b64_tr_b16 v[24:25], v6 offset:2048
    ds_read_b128 v[224:227], v15 offset:2048
    v_mfma_f32_32x32x16_bf16 v[144:159], v[196:199], v[16:19], 0
    ds_read_b64_tr_b16 v[26:27], v6 offset:2560
    ds_read_b128 v[228:231], v15 offset:30720
    v_mfma_f32_32x32x16_bf16 v[160:175], v[200:203], v[16:19], 0
    ds_read_b128 v[232:235], v15 offset:59392
    s_waitcnt lgkmcnt(5)
    v_max3_u32 v14, v20, v21, v22
    v_max_u32 v14, v14, v23
    v_mfma_f32_32x32x16_bf16 v[176:191], v[204:207], v[16:19], 0
    ds_read_b128 v[236:239], v5 offset:22528
    v_cmp_eq_u32 vcc, -1, v14
    buffer_load_dwordx4 v15, s[4:7], s26 offen offset:3072 sc1 lds
    s_cbranch_vccnz R_mx1_1
B_mx1_1:
    v_mfma_f32_32x32x16_bf16 v[128:143], v[208:211], v[20:23], v[128:143]
    s_waitcnt vmcnt(12)
    ds_read_b64_tr_b16 v[28:29], v6 offset:3072
    ds_read_b128 v[240:243], v15 offset:3072
    v_mfma_f32_32x32x16_bf16 v[144:159], v[212:215], v[20:23], v[144:159]
    ds_read_b64_tr_b16 v[30:31], v6 offset:3584
    ds_read_b128 v[244:247], v15 offset:31744
    v_mfma_f32_32x32x16_bf16 v[160:175], v[216:219], v[20:23], v[160:175]
    ds_read_b128 v[248:251], v15 offset:60416
    s_waitcnt lgkmcnt(8)
    v_max3_u32 v14, v24, v25, v26
    v_max_u32 v14, v14, v27
    v_mfma_f32_32x32x16_bf16 v[176:191], v[220:223], v[20:23], v[176:191]
    ds_read_b128 v[252:255], v5 offset:23552
    v_cmp_eq_u32 vcc, -1, v14
    s_add_u32 m0, s36, 0
    s_add_u32 s26, s78, 5767168
    buffer_load_dwordx4 v15, s[4:7], s26 offen offset:0 sc1 lds
    s_cbranch_vccnz R_mx1_2
B_mx1_2:
    s_waitcnt lgkmcnt(6)
    v_mfma_f32_32x32x16_bf16 v[128:143], v[224:227], v[24:27], v[128:143]
    s_waitcnt vmcnt(12)
    ds_read_b64_tr_b16 v[32:33], v6 offset:4096
    ds_read_b128 v[192:195], v15 offset:4096
    v_mfma_f32_32x32x16_bf16 v[144:159], v[228:231], v[24:27], v[144:159]
    ds_read_b64_tr_b16 v[34:35], v6 offset:4608
    ds_read_b128 v[196:199], v15 offset:32768
    s_add_u32 s38, s92, 23470080
    buffer_load_dwordx4 a[104:107], v15, s[4:7], s38 offen
    v_mfma_f32_32x32x16_bf16 v[160:175], v[232:235], v[24:27], v[160:175]
    ds_read_b128 v[200:203], v15 offset:61440
    s_waitcnt lgkmcnt(8)
    v_max3_u32 v14, v28, v29, v30
    v_max_u32 v14, v14, v31
    v_mfma_f32_32x32x16_bf16 v[176:191], v[236:239], v[24:27], v[176:191]
    ds_read_b128 v[204:207], v5 offset:24576
    v_cmp_eq_u32 vcc, -1, v14
    buffer_load_dwordx4 v15, s[4:7], s26 offen offset:1024 sc1 lds
    s_cbranch_vccnz R_mx1_3
B_mx1_3:
    s_waitcnt lgkmcnt(6)
    v_mfma_f32_32x32x16_bf16 v[128:143], v[240:243], v[28:31], v[128:143]
    s_waitcnt vmcnt(13)
    ds_read_b64_tr_b16 v[36:37], v6 offset:5120
    ds_read_b128 v[208:211], v15 offset:5120
    v_mfma_f32_32x32x16_bf16 v[144:159], v[244:247], v[28:31], v[144:159]
    ds_read_b64_tr_b16 v[38:39], v6 offset:5632
    ds_read_b128 v[212:215], v15 offset:33792
    s_xor_b32 s38, s38, 1024
    buffer_load_dwordx4 a[108:111], v15, s[4:7], s38 offen
    v_mfma_f32_32x32x16_bf16 v[160:175], v[248:251], v[28:31], v[160:175]
    ds_read_b128 v[216:219], v15 offset:62464
    s_waitcnt lgkmcnt(8)
    v_max3_u32 v14, v32, v33, v34
    v_max_u32 v14, v14, v35
    v_mfma_f32_32x32x16_bf16 v[176:191], v[252:255], v[28:31], v[176:191]
    ds_read_b128 v[220:223], v5 offset:25600
    v_cmp_eq_u32 vcc, -1, v14
    buffer_load_dwordx4 v15, s[4:7], s26 offen offset:2048 sc1 lds
    s_cbranch_vccnz R_mx1_4
B_mx1_4:
    s_waitcnt lgkmcnt(6)
    v_mfma_f32_32x32x16_bf16 v[128:143], v[192:195], v[32:35], v[128:143]
    s_waitcnt vmcnt(14)
    ds_read_b64_tr_b16 v[40:41], v6 offset:6144
    ds_read_b128 v[224:227], v15 offset:6144
    v_mfma_f32_32x32x16_bf16 v[144:159], v[196:199], v[32:35], v[144:159]
    ds_read_b64_tr_b16 v[42:43], v6 offset:6656
    ds_read_b128 v[228:231], v15 offset:34816
    s_add_u32 s38, s93, 23470080
    buffer_load_dwordx4 a[112:115], v15, s[4:7], s38 offen
    v_mfma_f32_32x32x16_bf16 v[160:175], v[200:203], v[32:35], v[160:175]
    ds_read_b128 v[232:235], v15 offset:63488
    s_waitcnt lgkmcnt(8)
    v_max3_u32 v14, v36, v37, v38
    v_max_u32 v14, v14, v39
    v_mfma_f32_32x32x16_bf16 v[176:191], v[204:207], v[32:35], v[176:191]
    ds_read_b128 v[236:239], v5 offset:26624
    v_cmp_eq_u32 vcc, -1, v14
    buffer_load_dwordx4 v15, s[4:7], s26 offen offset:3072 sc1 lds
    s_cbranch_vccnz R_mx1_5
B_mx1_5:
    s_waitcnt lgkmcnt(6)
    v_mfma_f32_32x32x16_bf16 v[128:143], v[208:211], v[36:39], v[128:143]
    s_waitcnt vmcnt(7)
    ds_read_b64_tr_b16 v[44:45], v6 offset:7168
    ds_read_b128 v[240:243], v15 offset:7168
    v_mfma_f32_32x32x16_bf16 v[144:159], v[212:215], v[36:39], v[144:159]
    ds_read_b64_tr_b16 v[46:47], v6 offset:7680
    ds_read_b128 v[244:247], v15 offset:35840
    s_xor_b32 s38, s38, 1024
    buffer_load_dwordx4 a[116:119], v15, s[4:7], s38 offen
    v_mfma_f32_32x32x16_bf16 v[160:175], v[216:219], v[36:39], v[160:175]
    ds_read_b128 v[248:251], v15 offset:64512
    s_waitcnt lgkmcnt(8)
    v_max3_u32 v14, v40, v41, v42
    v_max_u32 v14, v14, v43
    v_mfma_f32_32x32x16_bf16 v[176:191], v[220:223], v[36:39], v[176:191]
    ds_read_b128 v[252:255], v5 offset:27648
    v_cmp_eq_u32 vcc, -1, v14
    s_add_u32 m0, s36, 4096
    s_add_u32 s26, s79, 5767168
    buffer_load_dwordx4 v15, s[4:7], s26 offen offset:0 sc1 lds
    s_cbranch_vccnz R_mx1_6
B_mx1_6:
    s_waitcnt lgkmcnt(6)
    v_mfma_f32_32x32x16_bf16 v[128:143], v[224:227], v[40:43], v[128:143]
    s_waitcnt vmcnt(8)
    ds_read_b64_tr_b16 v[48:49], v6 offset:0
    ds_read_b128 v[192:195], v15 offset:8192
    v_mfma_f32_32x32x16_bf16 v[144:159], v[228:231], v[40:43], v[144:159]
    ds_read_b64_tr_b16 v[50:51], v6 offset:512
    ds_read_b128 v[196:199], v15 offset:36864
    s_add_u32 s38, s94, 23470080
    buffer_load_dwordx4 a[120:123], v15, s[4:7], s38 offen
    v_mfma_f32_32x32x16_bf16 v[160:175], v[232:235], v[40:43], v[160:175]
    ds_read_b128 v[200:203], v5 offset:0
    s_waitcnt lgkmcnt(8)
    v_max3_u32 v14, v44, v45, v46
    v_max_u32 v14, v14, v47
    v_mfma_f32_32x32x16_bf16 v[176:191], v[236:239], v[40:43], v[176:191]
    ds_read_b128 v[204:207], v5 offset:28672
    v_cmp_eq_u32 vcc, -1, v14
    buffer_load_dwordx4 v15, s[4:7], s26 offen offset:1024 sc1 lds
    s_cbranch_vccnz R_mx1_7
B_mx1_7:
    s_waitcnt lgkmcnt(6)
    v_mfma_f32_32x32x16_bf16 v[128:143], v[240:243], v[44:47], v[128:143]
    s_waitcnt vmcnt(8)
    ds_read_b64_tr_b16 v[52:53], v6 offset:1024
    ds_read_b128 v[208:211], v15 offset:9216
    v_mfma_f32_32x32x16_bf16 v[144:159], v[244:247], v[44:47], v[144:159]
    ds_read_b64_tr_b16 v[54:55], v6 offset:1536
    ds_read_b128 v[212:215], v15 offset:37888
    s_xor_b32 s38, s38, 1024
    buffer_load_dwordx4 a[124:127], v15, s[4:7], s38 offen
    v_mfma_f32_32x32x16_bf16 v[160:175], v[248:251], v[44:47], v[160:175]
    ds_read_b128 v[216:219], v5 offset:1024
    s_waitcnt lgkmcnt(8)
    v_max3_u32 v14, v48, v49, v50
    v_max_u32 v14, v14, v51
    v_mfma_f32_32x32x16_bf16 v[176:191], v[252:255], v[44:47], v[176:191]
    ds_read_b128 v[220:223], v5 offset:29696
    v_cmp_eq_u32 vcc, -1, v14
    buffer_load_dwordx4 v15, s[4:7], s26 offen offset:2048 sc1 lds
    s_cbranch_vccnz R_mx1_8
B_mx1_8:
    s_waitcnt lgkmcnt(6)
    v_mfma_f32_32x32x16_bf16 v[128:143], v[192:195], v[48:51], v[128:143]
    s_waitcnt vmcnt(8)
    ds_read_b64_tr_b16 v[56:57], v6 offset:2048
    ds_read_b128 v[224:227], v15 offset:10240
    v_mfma_f32_32x32x16_bf16 v[144:159], v[196:199], v[48:51], v[144:159]
    ds_read_b64_tr_b16 v[58:59], v6 offset:2560
    ds_read_b128 v[228:231], v15 offset:38912
    s_add_u32 s38, s95, 23470080
    buffer_load_dwordx4 a[128:131], v15, s[4:7], s38 offen
    v_mfma_f32_32x32x16_bf16 v[160:175], v[200:203], v[48:51], v[160:175]
    ds_read_b128 v[232:235], v5 offset:2048
    s_waitcnt lgkmcnt(8)
    v_max3_u32 v14, v52, v53, v54
    v_max_u32 v14, v14, v55
    v_mfma_f32_32x32x16_bf16 v[176:191], v[204:207], v[48:51], v[176:191]
    ds_read_b128 v[236:239], v5 offset:30720
    v_cmp_eq_u32 vcc, -1, v14
    buffer_load_dwordx4 v15, s[4:7], s26 offen offset:3072 sc1 lds
    s_cbranch_vccnz R_mx1_9
B_mx1_9:
    s_waitcnt lgkmcnt(6)
    v_mfma_f32_32x32x16_bf16 v[128:143], v[208:211], v[52:55], v[128:143]
    s_waitcnt vmcnt(8)
    ds_read_b64_tr_b16 v[60:61], v6 offset:3072
    ds_read_b128 v[240:243], v15 offset:11264
    v_mfma_f32_32x32x16_bf16 v[144:159], v[212:215], v[52:55], v[144:159]
    ds_read_b64_tr_b16 v[62:63], v6 offset:3584
    ds_read_b128 v[244:247], v15 offset:39936
    s_xor_b32 s38, s38, 1024
    buffer_load_dwordx4 a[132:135], v15, s[4:7], s38 offen
    v_mfma_f32_32x32x16_bf16 v[160:175], v[216:219], v[52:55], v[160:175]
    ds_read_b128 v[248:251], v5 offset:3072
    s_waitcnt lgkmcnt(8)
    v_max3_u32 v14, v56, v57, v58
    v_max_u32 v14, v14, v59
    v_mfma_f32_32x32x16_bf16 v[176:191], v[220:223], v[52:55], v[176:191]
    ds_read_b128 v[252:255], v5 offset:31744
    v_cmp_eq_u32 vcc, -1, v14
    s_add_u32 m0, s36, 0
    s_add_u32 s26, s80, 5767168
    buffer_load_dwordx4 v15, s[4:7], s26 offen offset:0 sc1 lds
    s_cbranch_vccnz R_mx1_10
B_mx1_10:
    s_waitcnt lgkmcnt(6)
    v_mfma_f32_32x32x16_bf16 v[128:143], v[224:227], v[56:59], v[128:143]
    s_waitcnt vmcnt(8)
    ds_read_b64_tr_b16 v[64:65], v6 offset:4096
    ds_read_b128 v[192:195], v15 offset:12288
    v_mfma_f32_32x32x16_bf16 v[144:159], v[228:231], v[56:59], v[144:159]
    ds_read_b64_tr_b16 v[66:67], v6 offset:4608
    ds_read_b128 v[196:199], v15 offset:40960
    s_add_u32 s38, s96, 23470080
    buffer_load_dwordx4 a[136:139], v15, s[4:7], s38 offen
    v_mfma_f32_32x32x16_bf16 v[160:175], v[232:235], v[56:59], v[160:175]
    ds_read_b128 v[200:203], v5 offset:4096
    s_waitcnt lgkmcnt(8)
    v_max3_u32 v14, v60, v61, v62
    v_max_u32 v14, v14, v63
    v_mfma_f32_32x32x16_bf16 v[176:191], v[236:239], v[56:59], v[176:191]
    ds_read_b128 v[204:207], v5 offset:32768
    v_cmp_eq_u32 vcc, -1, v14
    buffer_load_dwordx4 v15, s[4:7], s26 offen offset:1024 sc1 lds
    s_cbranch_vccnz R_mx1_11
B_mx1_11:
    s_waitcnt lgkmcnt(6)
    v_mfma_f32_32x32x16_bf16 v[128:143], v[240:243], v[60:63], v[128:143]
    s_waitcnt vmcnt(8)
    ds_read_b64_tr_b16 v[68:69], v6 offset:5120
    ds_read_b128 v[208:211], v15 offset:13312
    v_mfma_f32_32x32x16_bf16 v[144:159], v[244:247], v[60:63], v[144:159]
    ds_read_b64_tr_b16 v[70:71], v6 offset:5632
    ds_read_b128 v[212:215], v15 offset:41984
    s_xor_b32 s38, s38, 1024
    buffer_load_dwordx4 a[140:143], v15, s[4:7], s38 offen
    v_mfma_f32_32x32x16_bf16 v[160:175], v[248:251], v[60:63], v[160:175]
    ds_read_b128 v[216:219], v5 offset:5120
    s_waitcnt lgkmcnt(8)
    v_max3_u32 v14, v64, v65, v66
    v_max_u32 v14, v14, v67
    v_mfma_f32_32x32x16_bf16 v[176:191], v[252:255], v[60:63], v[176:191]
    ds_read_b128 v[220:223], v5 offset:33792
    v_cmp_eq_u32 vcc, -1, v14
    buffer_load_dwordx4 v15, s[4:7], s26 offen offset:2048 sc1 lds
    s_cbranch_vccnz R_mx1_12
B_mx1_12:
    s_waitcnt lgkmcnt(6)
    v_mfma_f32_32x32x16_bf16 v[128:143], v[192:195], v[64:67], v[128:143]
    s_waitcnt vmcnt(8)
    ds_read_b64_tr_b16 v[72:73], v6 offset:6144
    ds_read_b128 v[224:227], v15 offset:14336
    v_mfma_f32_32x32x16_bf16 v[144:159], v[196:199], v[64:67], v[144:159]
    ds_read_b64_tr_b16 v[74:75], v6 offset:6656
    ds_read_b128 v[228:231], v15 offset:43008
    s_add_u32 s38, s90, 23871488
    buffer_load_dwordx4 a[144:147], v15, s[4:7], s38 offen
    v_mfma_f32_32x32x16_bf16 v[160:175], v[200:203], v[64:67], v[160:175]
    ds_read_b128 v[232:235], v5 offset:6144
    s_waitcnt lgkmcnt(8)
    v_max3_u32 v14, v68, v69, v70
    v_max_u32 v14, v14, v71
    v_mfma_f32_32x32x16_bf16 v[176:191], v[204:207], v[64:67], v[176:191]
    ds_read_b128 v[236:239], v5 offset:34816
    v_cmp_eq_u32 vcc, -1, v14
    buffer_load_dwordx4 v15, s[4:7], s26 offen offset:3072 sc1 lds
    s_cbranch_vccnz R_mx1_13
B_mx1_13:
    s_waitcnt lgkmcnt(6)
    v_mfma_f32_32x32x16_bf16 v[128:143], v[208:211], v[68:71], v[128:143]
    s_waitcnt vmcnt(8)
    ds_read_b64_tr_b16 v[76:77], v6 offset:7168
    ds_read_b128 v[240:243], v15 offset:15360
    v_mfma_f32_32x32x16_bf16 v[144:159], v[212:215], v[68:71], v[144:159]
    ds_read_b64_tr_b16 v[78:79], v6 offset:7680
    ds_read_b128 v[244:247], v15 offset:44032
    s_xor_b32 s38, s38, 1024
    buffer_load_dwordx4 a[148:151], v15, s[4:7], s38 offen
    v_mfma_f32_32x32x16_bf16 v[160:175], v[216:219], v[68:71], v[160:175]
    ds_read_b128 v[248:251], v5 offset:7168
    s_waitcnt lgkmcnt(8)
    v_max3_u32 v14, v72, v73, v74
    v_max_u32 v14, v14, v75
    v_mfma_f32_32x32x16_bf16 v[176:191], v[220:223], v[68:71], v[176:191]
    ds_read_b128 v[252:255], v5 offset:35840
    v_cmp_eq_u32 vcc, -1, v14
    s_add_u32 m0, s36, 4096
    s_add_u32 s26, s81, 5767168
    buffer_load_dwordx4 v15, s[4:7], s26 offen offset:0 sc1 lds
    s_cbranch_vccnz R_mx1_14
B_mx1_14:
    s_waitcnt lgkmcnt(6)
    v_mfma_f32_32x32x16_bf16 v[128:143], v[224:227], v[72:75], v[128:143]
    s_waitcnt vmcnt(8)
    ds_read_b64_tr_b16 v[80:81], v6 offset:0
    ds_read_b128 v[192:195], v15 offset:16384
    v_mfma_f32_32x32x16_bf16 v[144:159], v[228:231], v[72:75], v[144:159]
    ds_read_b64_tr_b16 v[82:83], v6 offset:512
    ds_read_b128 v[196:199], v15 offset:45056
    s_add_u32 s38, s91, 23871488
    buffer_load_dwordx4 a[152:155], v15, s[4:7], s38 offen
    v_mfma_f32_32x32x16_bf16 v[160:175], v[232:235], v[72:75], v[160:175]
    ds_read_b128 v[200:203], v5 offset:8192
    s_waitcnt lgkmcnt(8)
    v_max3_u32 v14, v76, v77, v78
    v_max_u32 v14, v14, v79
    v_mfma_f32_32x32x16_bf16 v[176:191], v[236:239], v[72:75], v[176:191]
    ds_read_b128 v[204:207], v5 offset:36864
    v_cmp_eq_u32 vcc, -1, v14
    buffer_load_dwordx4 v15, s[4:7], s26 offen offset:1024 sc1 lds
    s_cbranch_vccnz R_mx1_15
B_mx1_15:
    s_waitcnt lgkmcnt(6)
    v_mfma_f32_32x32x16_bf16 v[128:143], v[240:243], v[76:79], v[128:143]
    s_waitcnt vmcnt(8)
    ds_read_b64_tr_b16 v[84:85], v6 offset:1024
    ds_read_b128 v[208:211], v15 offset:17408
    v_mfma_f32_32x32x16_bf16 v[144:159], v[244:247], v[76:79], v[144:159]
    ds_read_b64_tr_b16 v[86:87], v6 offset:1536
    ds_read_b128 v[212:215], v15 offset:46080
    s_xor_b32 s38, s38, 1024
    buffer_load_dwordx4 a[156:159], v15, s[4:7], s38 offen
    v_mfma_f32_32x32x16_bf16 v[160:175], v[248:251], v[76:79], v[160:175]
    ds_read_b128 v[216:219], v5 offset:9216
    s_waitcnt lgkmcnt(8)
    v_max3_u32 v14, v80, v81, v82
    v_max_u32 v14, v14, v83
    v_mfma_f32_32x32x16_bf16 v[176:191], v[252:255], v[76:79], v[176:191]
    ds_read_b128 v[220:223], v5 offset:37888
    v_cmp_eq_u32 vcc, -1, v14
    buffer_load_dwordx4 v15, s[4:7], s26 offen offset:2048 sc1 lds
    s_cbranch_vccnz R_mx1_16
B_mx1_16:
    s_waitcnt lgkmcnt(6)
    v_mfma_f32_32x32x16_bf16 v[128:143], v[192:195], v[80:83], v[128:143]
    s_waitcnt vmcnt(8)
    ds_read_b64_tr_b16 v[88:89], v6 offset:2048
    ds_read_b128 v[224:227], v15 offset:18432
    v_mfma_f32_32x32x16_bf16 v[144:159], v[196:199], v[80:83], v[144:159]
    ds_read_b64_tr_b16 v[90:91], v6 offset:2560
    ds_read_b128 v[228:231], v15 offset:47104
    s_add_u32 s38, s92, 23871488
    buffer_load_dwordx4 a[160:163], v15, s[4:7], s38 offen
    v_mfma_f32_32x32x16_bf16 v[160:175], v[200:203], v[80:83], v[160:175]
    ds_read_b128 v[232:235], v5 offset:10240
    s_waitcnt lgkmcnt(8)
    v_max3_u32 v14, v84, v85, v86
    v_max_u32 v14, v14, v87
    v_mfma_f32_32x32x16_bf16 v[176:191], v[204:207], v[80:83], v[176:191]
    ds_read_b128 v[236:239], v5 offset:38912
    v_cmp_eq_u32 vcc, -1, v14
    buffer_load_dwordx4 v15, s[4:7], s26 offen offset:3072 sc1 lds
    s_cbranch_vccnz R_mx1_17
B_mx1_17:
    s_waitcnt lgkmcnt(6)
    v_mfma_f32_32x32x16_bf16 v[128:143], v[208:211], v[84:87], v[128:143]
    s_waitcnt vmcnt(8)
    ds_read_b64_tr_b16 v[92:93], v6 offset:3072
    ds_read_b128 v[240:243], v15 offset:19456
    v_mfma_f32_32x32x16_bf16 v[144:159], v[212:215], v[84:87], v[144:159]
    ds_read_b64_tr_b16 v[94:95], v6 offset:3584
    ds_read_b128 v[244:247], v15 offset:48128
    s_xor_b32 s38, s38, 1024
    buffer_load_dwordx4 a[164:167], v15, s[4:7], s38 offen
    v_mfma_f32_32x32x16_bf16 v[160:175], v[216:219], v[84:87], v[160:175]
    ds_read_b128 v[248:251], v5 offset:11264
    s_waitcnt lgkmcnt(8)
    v_max3_u32 v14, v88, v89, v90
    v_max_u32 v14, v14, v91
    v_mfma_f32_32x32x16_bf16 v[176:191], v[220:223], v[84:87], v[176:191]
    ds_read_b128 v[252:255], v5 offset:39936
    v_cmp_eq_u32 vcc, -1, v14
    s_add_u32 m0, s36, 0
    s_add_u32 s26, s82, 5767168
    buffer_load_dwordx4 v15, s[4:7], s26 offen offset:0 sc1 lds
    s_cbranch_vccnz R_mx1_18
B_mx1_18:
    s_waitcnt lgkmcnt(6)
    v_mfma_f32_32x32x16_bf16 v[128:143], v[224:227], v[88:91], v[128:143]
    s_waitcnt vmcnt(8)
    ds_read_b64_tr_b16 v[96:97], v6 offset:4096
    ds_read_b128 v[192:195], v15 offset:20480
    v_mfma_f32_32x32x16_bf16 v[144:159], v[228:231], v[88:91], v[144:159]
    ds_read_b64_tr_b16 v[98:99], v6 offset:4608
    ds_read_b128 v[196:199], v15 offset:49152
    s_add_u32 s38, s93, 23871488
    buffer_load_dwordx4 a[168:171], v15, s[4:7], s38 offen
    v_mfma_f32_32x32x16_bf16 v[160:175], v[232:235], v[88:91], v[160:175]
    ds_read_b128 v[200:203], v5 offset:12288
    s_waitcnt lgkmcnt(8)
    v_max3_u32 v14, v92, v93, v94
    v_max_u32 v14, v14, v95
    v_mfma_f32_32x32x16_bf16 v[176:191], v[236:239], v[88:91], v[176:191]
    ds_read_b128 v[204:207], v5 offset:40960
    v_cmp_eq_u32 vcc, -1, v14
    buffer_load_dwordx4 v15, s[4:7], s26 offen offset:1024 sc1 lds
    s_cbranch_vccnz R_mx1_19
B_mx1_19:
    s_waitcnt lgkmcnt(6)
    v_mfma_f32_32x32x16_bf16 v[128:143], v[240:243], v[92:95], v[128:143]
    s_waitcnt vmcnt(8)
    ds_read_b64_tr_b16 v[100:101], v6 offset:5120
    ds_read_b128 v[208:211], v15 offset:21504
    v_mfma_f32_32x32x16_bf16 v[144:159], v[244:247], v[92:95], v[144:159]
    ds_read_b64_tr_b16 v[102:103], v6 offset:5632
    ds_read_b128 v[212:215], v15 offset:50176
    s_xor_b32 s38, s38, 1024
    buffer_load_dwordx4 a[172:175], v15, s[4:7], s38 offen
    v_mfma_f32_32x32x16_bf16 v[160:175], v[248:251], v[92:95], v[160:175]
    ds_read_b128 v[216:219], v5 offset:13312
    s_waitcnt lgkmcnt(8)
    v_max3_u32 v14, v96, v97, v98
    v_max_u32 v14, v14, v99
    v_mfma_f32_32x32x16_bf16 v[176:191], v[252:255], v[92:95], v[176:191]
    ds_read_b128 v[220:223], v5 offset:41984
    v_cmp_eq_u32 vcc, -1, v14
    buffer_load_dwordx4 v15, s[4:7], s26 offen offset:2048 sc1 lds
    s_cbranch_vccnz R_mx1_20
B_mx1_20:
    s_waitcnt lgkmcnt(6)
    v_mfma_f32_32x32x16_bf16 v[128:143], v[192:195], v[96:99], v[128:143]
    s_waitcnt vmcnt(8)
    ds_read_b64_tr_b16 v[104:105], v6 offset:6144
    ds_read_b128 v[224:227], v15 offset:22528
    v_mfma_f32_32x32x16_bf16 v[144:159], v[196:199], v[96:99], v[144:159]
    ds_read_b64_tr_b16 v[106:107], v6 offset:6656
    ds_read_b128 v[228:231], v15 offset:51200
    s_add_u32 s38, s94, 23871488
    buffer_load_dwordx4 a[176:179], v15, s[4:7], s38 offen
    v_mfma_f32_32x32x16_bf16 v[160:175], v[200:203], v[96:99], v[160:175]
    ds_read_b128 v[232:235], v5 offset:14336
    s_waitcnt lgkmcnt(8)
    v_max3_u32 v14, v100, v101, v102
    v_max_u32 v14, v14, v103
    v_mfma_f32_32x32x16_bf16 v[176:191], v[204:207], v[96:99], v[176:191]
    ds_read_b128 v[236:239], v5 offset:43008
    v_cmp_eq_u32 vcc, -1, v14
    buffer_load_dwordx4 v15, s[4:7], s26 offen offset:3072 sc1 lds
    s_cbranch_vccnz R_mx1_21
B_mx1_21:
    s_waitcnt lgkmcnt(6)
    v_mfma_f32_32x32x16_bf16 v[128:143], v[208:211], v[100:103], v[128:143]
    s_waitcnt vmcnt(8)
    ds_read_b64_tr_b16 v[108:109], v6 offset:7168
    ds_read_b128 v[240:243], v15 offset:23552
    v_mfma_f32_32x32x16_bf16 v[144:159], v[212:215], v[100:103], v[144:159]
    ds_read_b64_tr_b16 v[110:111], v6 offset:7680
    ds_read_b128 v[244:247], v15 offset:52224
    s_xor_b32 s38, s38, 1024
    buffer_load_dwordx4 a[180:183], v15, s[4:7], s38 offen
    v_mfma_f32_32x32x16_bf16 v[160:175], v[216:219], v[100:103], v[160:175]
    ds_read_b128 v[248:251], v5 offset:15360
    s_waitcnt lgkmcnt(8)
    v_max3_u32 v14, v104, v105, v106
    v_max_u32 v14, v14, v107
    v_mfma_f32_32x32x16_bf16 v[176:191], v[220:223], v[100:103], v[176:191]
    ds_read_b128 v[252:255], v5 offset:44032
    v_cmp_eq_u32 vcc, -1, v14
    buffer_load_dword v10, v7, s[4:7], s27 offen sc1
    buffer_load_dword v11, v8, s[4:7], s27 offen sc1
    s_cbranch_vccnz R_mx1_22
B_mx1_22:
    s_waitcnt lgkmcnt(6)
    v_mfma_f32_32x32x16_bf16 v[128:143], v[224:227], v[104:107], v[128:143]
    s_waitcnt vmcnt(9)
    ds_read_b64_tr_b16 v[112:113], v6 offset:0
    ds_read_b128 v[192:195], v15 offset:24576
    v_mfma_f32_32x32x16_bf16 v[144:159], v[228:231], v[104:107], v[144:159]
    ds_read_b64_tr_b16 v[114:115], v6 offset:512
    ds_read_b128 v[196:199], v15 offset:53248
    s_add_u32 s38, s95, 23871488
    buffer_load_dwordx4 a[184:187], v15, s[4:7], s38 offen
    v_mfma_f32_32x32x16_bf16 v[160:175], v[232:235], v[104:107], v[160:175]
    ds_read_b128 v[200:203], v5 offset:16384
    s_waitcnt lgkmcnt(8)
    v_max3_u32 v14, v108, v109, v110
    v_max_u32 v14, v14, v111
    v_mfma_f32_32x32x16_bf16 v[176:191], v[236:239], v[104:107], v[176:191]
    ds_read_b128 v[204:207], v5 offset:45056
    v_cmp_eq_u32 vcc, -1, v14
    s_xor_b32 s38, s38, 1024
    buffer_load_dwordx4 a[188:191], v15, s[4:7], s38 offen
    s_cbranch_vccnz R_mx1_23
B_mx1_23:
    s_waitcnt lgkmcnt(6)
    v_mfma_f32_32x32x16_bf16 v[128:143], v[240:243], v[108:111], v[128:143]
    s_waitcnt vmcnt(9)
    ds_read_b64_tr_b16 v[116:117], v6 offset:1024
    ds_read_b128 v[208:211], v15 offset:25600
    v_mfma_f32_32x32x16_bf16 v[144:159], v[244:247], v[108:111], v[144:159]
    ds_read_b64_tr_b16 v[118:119], v6 offset:1536
    ds_read_b128 v[212:215], v15 offset:54272
    s_add_u32 s38, s96, 23871488
    buffer_load_dwordx4 a[192:195], v15, s[4:7], s38 offen
    v_mfma_f32_32x32x16_bf16 v[160:175], v[248:251], v[108:111], v[160:175]
    ds_read_b128 v[216:219], v5 offset:17408
    s_waitcnt lgkmcnt(8)
    v_max3_u32 v14, v112, v113, v114
    v_max_u32 v14, v14, v115
    v_mfma_f32_32x32x16_bf16 v[176:191], v[252:255], v[108:111], v[176:191]
    ds_read_b128 v[220:223], v5 offset:46080
    v_cmp_eq_u32 vcc, -1, v14
    s_xor_b32 s38, s38, 1024
    buffer_load_dwordx4 a[196:199], v15, s[4:7], s38 offen
    s_cbranch_vccnz R_mx1_24
B_mx1_24:
    s_waitcnt lgkmcnt(6)
    v_mfma_f32_32x32x16_bf16 v[128:143], v[192:195], v[112:115], v[128:143]
    s_waitcnt vmcnt(9)
    ds_read_b64_tr_b16 v[120:121], v6 offset:2048
    ds_read_b128 v[224:227], v15 offset:26624
    v_mfma_f32_32x32x16_bf16 v[144:159], v[196:199], v[112:115], v[144:159]
    ds_read_b64_tr_b16 v[122:123], v6 offset:2560
    ds_read_b128 v[228:231], v15 offset:55296
    s_add_u32 s38, s90, 24272896
    buffer_load_dwordx4 a[200:203], v15, s[4:7], s38 offen
    v_mfma_f32_32x32x16_bf16 v[160:175], v[200:203], v[112:115], v[160:175]
    ds_read_b128 v[232:235], v5 offset:18432
    s_waitcnt lgkmcnt(8)
    v_max3_u32 v14, v116, v117, v118
    v_max_u32 v14, v14, v119
    v_mfma_f32_32x32x16_bf16 v[176:191], v[204:207], v[112:115], v[176:191]
    ds_read_b128 v[236:239], v5 offset:47104
    v_cmp_eq_u32 vcc, -1, v14
    s_xor_b32 s38, s38, 1024
    buffer_load_dwordx4 a[204:207], v15, s[4:7], s38 offen
    s_cbranch_vccnz R_mx1_25
B_mx1_25:
    s_waitcnt lgkmcnt(6)
    v_mfma_f32_32x32x16_bf16 v[128:143], v[208:211], v[116:119], v[128:143]
    s_waitcnt vmcnt(9)
    ds_read_b64_tr_b16 v[124:125], v6 offset:3072
    ds_read_b128 v[240:243], v15 offset:27648
    v_mfma_f32_32x32x16_bf16 v[144:159], v[212:215], v[116:119], v[144:159]
    ds_read_b64_tr_b16 v[126:127], v6 offset:3584
    ds_read_b128 v[244:247], v15 offset:56320
    s_add_u32 s38, s91, 24272896
    buffer_load_dwordx4 a[208:211], v15, s[4:7], s38 offen
    v_mfma_f32_32x32x16_bf16 v[160:175], v[216:219], v[116:119], v[160:175]
    ds_read_b128 v[248:251], v5 offset:19456
    s_waitcnt lgkmcnt(8)
    v_max3_u32 v14, v120, v121, v122
    v_max_u32 v14, v14, v123
    v_mfma_f32_32x32x16_bf16 v[176:191], v[220:223], v[116:119], v[176:191]
    ds_read_b128 v[252:255], v5 offset:48128
    v_cmp_eq_u32 vcc, -1, v14
    s_xor_b32 s38, s38, 1024
    buffer_load_dwordx4 a[212:215], v15, s[4:7], s38 offen
    s_cbranch_vccnz R_mx1_26
B_mx1_26:
    s_waitcnt lgkmcnt(6)
    v_mfma_f32_32x32x16_bf16 v[128:143], v[224:227], v[120:123], v[128:143]
    v_mfma_f32_32x32x16_bf16 v[144:159], v[228:231], v[120:123], v[144:159]
    s_add_u32 s38, s92, 24272896
    buffer_load_dwordx4 a[216:219], v15, s[4:7], s38 offen
    v_mfma_f32_32x32x16_bf16 v[160:175], v[232:235], v[120:123], v[160:175]
    s_waitcnt lgkmcnt(3)
    v_max3_u32 v14, v124, v125, v126
    v_max_u32 v14, v14, v127
    v_mfma_f32_32x32x16_bf16 v[176:191], v[236:239], v[120:123], v[176:191]
    v_cmp_eq_u32 vcc, -1, v14
    s_xor_b32 s38, s38, 1024
    buffer_load_dwordx4 a[220:223], v15, s[4:7], s38 offen
    s_cbranch_vccnz R_mx1_27
B_mx1_27:
    v_mfma_f32_32x32x16_bf16 v[128:143], v[240:243], v[124:127], v[128:143]
    s_waitcnt lgkmcnt(2)
    v_mfma_f32_32x32x16_bf16 v[144:159], v[244:247], v[124:127], v[144:159]
    s_add_u32 s38, s93, 24272896
    buffer_load_dwordx4 a[224:227], v15, s[4:7], s38 offen
    s_waitcnt lgkmcnt(1)
    v_mfma_f32_32x32x16_bf16 v[160:175], v[248:251], v[124:127], v[160:175]
    s_waitcnt lgkmcnt(0)
    v_mfma_f32_32x32x16_bf16 v[176:191], v[252:255], v[124:127], v[176:191]
    s_xor_b32 s38, s38, 1024
    buffer_load_dwordx4 a[228:231], v15, s[4:7], s38 offen
    s_waitcnt vmcnt(12)
    v_add_f32 v10, v10, v11
    v_cmp_u_f32 vcc, v10, v10
    s_cbranch_vccnz R_mrs1
B_mrs1:
    v_mov_b32 v11, 0x2ffa496c
    v_fmamk_f32 v10, v10, 0x3c268004, v11
    v_rsq_f32 v10, v10
    s_nop 0
    v_sub_f32 v10, 0, v10
    s_mov_b32 s32, 0x409d30fc
    s_mov_b32 s33, 0x409d30fc
    ds_read_b128 v[224:227], v9 offset:0
    ds_read_b128 v[228:231], v9 offset:16
    s_waitcnt lgkmcnt(1)
    v_pk_fma_f32 v[224:225], v[128:129], v[10:11], v[224:225] op_sel_hi:[1,0,1]
    v_pk_fma_f32 v[226:227], v[130:131], v[10:11], v[226:227] op_sel_hi:[1,0,1]
    s_waitcnt lgkmcnt(0)
    v_pk_fma_f32 v[228:229], v[132:133], v[10:11], v[228:229] op_sel_hi:[1,0,1]
    v_pk_fma_f32 v[230:231], v[134:135], v[10:11], v[230:231] op_sel_hi:[1,0,1]
    ds_read_b128 v[232:235], v9 offset:32
    ds_read_b128 v[236:239], v9 offset:48
    v_pk_fma_f32 v[240:241], v[224:225], v[224:225], s[32:33]
    v_pk_fma_f32 v[242:243], v[226:227], v[226:227], s[32:33]
    v_pk_fma_f32 v[244:245], v[228:229], v[228:229], s[32:33]
    v_pk_fma_f32 v[246:247], v[230:231], v[230:231], s[32:33]
    s_add_u32 s38, s94, 24272896
    buffer_load_dwordx4 a[232:235], v15, s[4:7], s38 offen
    v_pk_mul_f32 v[240:241], v[240:241], v[224:225]
    v_pk_mul_f32 v[242:243], v[242:243], v[226:227]
    v_pk_mul_f32 v[244:245], v[244:245], v[228:229]
    v_pk_mul_f32 v[246:247], v[246:247], v[230:231]
    v_exp_f32 v240, v240
    v_exp_f32 v241, v241
    v_exp_f32 v242, v242
    v_exp_f32 v243, v243
    v_exp_f32 v244, v244
    v_exp_f32 v245, v245
    v_exp_f32 v246, v246
    v_exp_f32 v247, v247
    v_pk_add_f32 v[240:241], v[240:241], 1.0 op_sel_hi:[1,0]
    s_xor_b32 s38, s38, 1024
    buffer_load_dwordx4 a[236:239], v15, s[4:7], s38 offen
    v_pk_add_f32 v[242:243], v[242:243], 1.0 op_sel_hi:[1,0]
    v_pk_add_f32 v[244:245], v[244:245], 1.0 op_sel_hi:[1,0]
    v_pk_add_f32 v[246:247], v[246:247], 1.0 op_sel_hi:[1,0]
    v_rcp_f32 v240, v240
    v_rcp_f32 v241, v241
    v_rcp_f32 v242, v242
    v_rcp_f32 v243, v243
    v_rcp_f32 v244, v244
    v_rcp_f32 v245, v245
    v_rcp_f32 v246, v246
    v_rcp_f32 v247, v247
    v_pk_mul_f32 v[240:241], v[240:241], v[224:225]
    v_pk_mul_f32 v[242:243], v[242:243], v[226:227]
    s_add_u32 s38, s95, 24272896
    buffer_load_dwordx4 a[240:243], v15, s[4:7], s38 offen
    v_pk_mul_f32 v[244:245], v[244:245], v[228:229]
    v_pk_mul_f32 v[246:247], v[246:247], v[230:231]
    v_cvt_pk_bf16_f32 v128, v240, v241
    v_cvt_pk_bf16_f32 v129, v242, v243
    v_cvt_pk_bf16_f32 v130, v244, v245
    v_cvt_pk_bf16_f32 v131, v246, v247
    s_add_u32 s23, s99, 10485760
    s_cmp_eq_u32 s98, 0
    s_cbranch_scc1 A_10
    buffer_store_dwordx4 v[128:131], v15, s[4:7], s23 offen offset:0
AB_10:
    s_waitcnt lgkmcnt(1)
    v_pk_fma_f32 v[232:233], v[136:137], v[10:11], v[232:233] op_sel_hi:[1,0,1]
    v_pk_fma_f32 v[234:235], v[138:139], v[10:11], v[234:235] op_sel_hi:[1,0,1]
    s_waitcnt lgkmcnt(0)
    v_pk_fma_f32 v[236:237], v[140:141], v[10:11], v[236:237] op_sel_hi:[1,0,1]
    v_pk_fma_f32 v[238:239], v[142:143], v[10:11], v[238:239] op_sel_hi:[1,0,1]
    ds_read_b128 v[224:227], v9 offset:128
    ds_read_b128 v[228:231], v9 offset:144
    s_xor_b32 s38, s38, 1024
    buffer_load_dwordx4 a[244:247], v15, s[4:7], s38 offen
    v_pk_fma_f32 v[248:249], v[232:233], v[232:233], s[32:33]
    v_pk_fma_f32 v[250:251], v[234:235], v[234:235], s[32:33]
    v_pk_fma_f32 v[252:253], v[236:237], v[236:237], s[32:33]
    v_pk_fma_f32 v[254:255], v[238:239], v[238:239], s[32:33]
    v_pk_mul_f32 v[248:249], v[248:249], v[232:233]
    v_pk_mul_f32 v[250:251], v[250:251], v[234:235]
    v_pk_mul_f32 v[252:253], v[252:253], v[236:237]
    v_pk_mul_f32 v[254:255], v[254:255], v[238:239]
    v_exp_f32 v248, v248
    v_exp_f32 v249, v249
    v_exp_f32 v250, v250
    v_exp_f32 v251, v251
    v_exp_f32 v252, v252
    s_add_u32 s38, s96, 24272896
    buffer_load_dwordx4 a[248:251], v15, s[4:7], s38 offen
    v_exp_f32 v253, v253
    v_exp_f32 v254, v254
    v_exp_f32 v255, v255
    v_pk_add_f32 v[248:249], v[248:249], 1.0 op_sel_hi:[1,0]
    v_pk_add_f32 v[250:251], v[250:251], 1.0 op_sel_hi:[1,0]
    v_pk_add_f32 v[252:253], v[252:253], 1.0 op_sel_hi:[1,0]
    v_pk_add_f32 v[254:255], v[254:255], 1.0 op_sel_hi:[1,0]
    v_rcp_f32 v248, v248
    v_rcp_f32 v249, v249
    v_rcp_f32 v250, v250
    v_rcp_f32 v251, v251
    v_rcp_f32 v252, v252
    v_rcp_f32 v253, v253
    s_xor_b32 s38, s38, 1024
    buffer_load_dwordx4 a[252:255], v15, s[4:7], s38 offen
    v_rcp_f32 v254, v254
    v_rcp_f32 v255, v255
    v_pk_mul_f32 v[248:249], v[248:249], v[232:233]
    v_pk_mul_f32 v[250:251], v[250:251], v[234:235]
    v_pk_mul_f32 v[252:253], v[252:253], v[236:237]
    v_pk_mul_f32 v[254:255], v[254:255], v[238:239]
    v_cvt_pk_bf16_f32 v136, v248, v249
    v_cvt_pk_bf16_f32 v137, v250, v251
    v_cvt_pk_bf16_f32 v138, v252, v253
    v_cvt_pk_bf16_f32 v139, v254, v255
    s_add_u32 s23, s99, 10485760
    s_cmp_eq_u32 s98, 0
    s_cbranch_scc1 A_11
    buffer_store_dwordx4 v[136:139], v15, s[4:7], s23 offen offset:2048
AB_11:
    s_waitcnt lgkmcnt(1)
    v_pk_fma_f32 v[224:225], v[144:145], v[10:11], v[224:225] op_sel_hi:[1,0,1]
    v_pk_fma_f32 v[226:227], v[146:147], v[10:11], v[226:227] op_sel_hi:[1,0,1]
    s_waitcnt lgkmcnt(0)
    v_pk_fma_f32 v[228:229], v[148:149], v[10:11], v[228:229] op_sel_hi:[1,0,1]
    v_pk_fma_f32 v[230:231], v[150:151], v[10:11], v[230:231] op_sel_hi:[1,0,1]
    ds_read_b128 v[232:235], v9 offset:160
    ds_read_b128 v[236:239], v9 offset:176
    v_pk_fma_f32 v[240:241], v[224:225], v[224:225], s[32:33]
    v_pk_fma_f32 v[242:243], v[226:227], v[226:227], s[32:33]
    v_pk_fma_f32 v[244:245], v[228:229], v[228:229], s[32:33]
    v_pk_fma_f32 v[246:247], v[230:231], v[230:231], s[32:33]
    v_pk_mul_f32 v[240:241], v[240:241], v[224:225]
    v_pk_mul_f32 v[242:243], v[242:243], v[226:227]
    v_pk_mul_f32 v[244:245], v[244:245], v[228:229]
    v_pk_mul_f32 v[246:247], v[246:247], v[230:231]
    v_exp_f32 v240, v240
    v_exp_f32 v241, v241
    v_exp_f32 v242, v242
    v_exp_f32 v243, v243
    v_exp_f32 v244, v244
    v_exp_f32 v245, v245
    v_exp_f32 v246, v246
    v_exp_f32 v247, v247
    v_pk_add_f32 v[240:241], v[240:241], 1.0 op_sel_hi:[1,0]
    v_pk_add_f32 v[242:243], v[242:243], 1.0 op_sel_hi:[1,0]
    v_pk_add_f32 v[244:245], v[244:245], 1.0 op_sel_hi:[1,0]
    v_pk_add_f32 v[246:247], v[246:247], 1.0 op_sel_hi:[1,0]
    v_rcp_f32 v240, v240
    v_rcp_f32 v241, v241
    v_rcp_f32 v242, v242
    v_rcp_f32 v243, v243
    v_rcp_f32 v244, v244
    v_rcp_f32 v245, v245
    v_rcp_f32 v246, v246
    v_rcp_f32 v247, v247
    v_pk_mul_f32 v[240:241], v[240:241], v[224:225]
    v_pk_mul_f32 v[242:243], v[242:243], v[226:227]
    v_pk_mul_f32 v[244:245], v[244:245], v[228:229]
    v_pk_mul_f32 v[246:247], v[246:247], v[230:231]
    v_cvt_pk_bf16_f32 v144, v240, v241
    v_cvt_pk_bf16_f32 v145, v242, v243
    v_cvt_pk_bf16_f32 v146, v244, v245
    v_cvt_pk_bf16_f32 v147, v246, v247
    s_add_u32 s23, s99, 10543104
    s_cmp_eq_u32 s98, 0
    s_cbranch_scc1 A_12
    buffer_store_dwordx4 v[144:147], v15, s[4:7], s23 offen offset:0
AB_12:
    s_waitcnt lgkmcnt(1)
    v_pk_fma_f32 v[232:233], v[152:153], v[10:11], v[232:233] op_sel_hi:[1,0,1]
    v_pk_fma_f32 v[234:235], v[154:155], v[10:11], v[234:235] op_sel_hi:[1,0,1]
    s_waitcnt lgkmcnt(0)
    v_pk_fma_f32 v[236:237], v[156:157], v[10:11], v[236:237] op_sel_hi:[1,0,1]
    v_pk_fma_f32 v[238:239], v[158:159], v[10:11], v[238:239] op_sel_hi:[1,0,1]
    ds_read_b128 v[224:227], v9 offset:256
    ds_read_b128 v[228:231], v9 offset:272
    v_pk_fma_f32 v[248:249], v[232:233], v[232:233], s[32:33]
    v_pk_fma_f32 v[250:251], v[234:235], v[234:235], s[32:33]
    v_pk_fma_f32 v[252:253], v[236:237], v[236:237], s[32:33]
    v_pk_fma_f32 v[254:255], v[238:239], v[238:239], s[32:33]
    v_pk_mul_f32 v[248:249], v[248:249], v[232:233]
    v_pk_mul_f32 v[250:251], v[250:251], v[234:235]
    v_pk_mul_f32 v[252:253], v[252:253], v[236:237]
    v_pk_mul_f32 v[254:255], v[254:255], v[238:239]
    v_exp_f32 v248, v248
    v_exp_f32 v249, v249
    v_exp_f32 v250, v250
    v_exp_f32 v251, v251
    v_exp_f32 v252, v252
    v_exp_f32 v253, v253
    v_exp_f32 v254, v254
    v_exp_f32 v255, v255
    v_pk_add_f32 v[248:249], v[248:249], 1.0 op_sel_hi:[1,0]
    v_pk_add_f32 v[250:251], v[250:251], 1.0 op_sel_hi:[1,0]
    v_pk_add_f32 v[252:253], v[252:253], 1.0 op_sel_hi:[1,0]
    v_pk_add_f32 v[254:255], v[254:255], 1.0 op_sel_hi:[1,0]
    v_rcp_f32 v248, v248
    v_rcp_f32 v249, v249
    v_rcp_f32 v250, v250
    v_rcp_f32 v251, v251
    v_rcp_f32 v252, v252
    v_rcp_f32 v253, v253
    v_rcp_f32 v254, v254
    v_rcp_f32 v255, v255
    v_pk_mul_f32 v[248:249], v[248:249], v[232:233]
    v_pk_mul_f32 v[250:251], v[250:251], v[234:235]
    v_pk_mul_f32 v[252:253], v[252:253], v[236:237]
    v_pk_mul_f32 v[254:255], v[254:255], v[238:239]
    v_cvt_pk_bf16_f32 v152, v248, v249
    v_cvt_pk_bf16_f32 v153, v250, v251
    v_cvt_pk_bf16_f32 v154, v252, v253
    v_cvt_pk_bf16_f32 v155, v254, v255
    s_add_u32 s23, s99, 10543104
    s_cmp_eq_u32 s98, 0
    s_cbranch_scc1 A_13
    buffer_store_dwordx4 v[152:155], v15, s[4:7], s23 offen offset:2048
AB_13:
    s_waitcnt lgkmcnt(1)
    v_pk_fma_f32 v[224:225], v[160:161], v[10:11], v[224:225] op_sel_hi:[1,0,1]
    v_pk_fma_f32 v[226:227], v[162:163], v[10:11], v[226:227] op_sel_hi:[1,0,1]
    s_waitcnt lgkmcnt(0)
    v_pk_fma_f32 v[228:229], v[164:165], v[10:11], v[228:229] op_sel_hi:[1,0,1]
    v_pk_fma_f32 v[230:231], v[166:167], v[10:11], v[230:231] op_sel_hi:[1,0,1]
    ds_read_b128 v[232:235], v9 offset:288
    ds_read_b128 v[236:239], v9 offset:304
    v_pk_fma_f32 v[240:241], v[224:225], v[224:225], s[32:33]
    v_pk_fma_f32 v[242:243], v[226:227], v[226:227], s[32:33]
    v_pk_fma_f32 v[244:245], v[228:229], v[228:229], s[32:33]
    v_pk_fma_f32 v[246:247], v[230:231], v[230:231], s[32:33]
    v_pk_mul_f32 v[240:241], v[240:241], v[224:225]
    v_pk_mul_f32 v[242:243], v[242:243], v[226:227]
    v_pk_mul_f32 v[244:245], v[244:245], v[228:229]
    v_pk_mul_f32 v[246:247], v[246:247], v[230:231]
    v_exp_f32 v240, v240
    v_exp_f32 v241, v241
    v_exp_f32 v242, v242
    v_exp_f32 v243, v243
    v_exp_f32 v244, v244
    v_exp_f32 v245, v245
    v_exp_f32 v246, v246
    v_exp_f32 v247, v247
    v_pk_add_f32 v[240:241], v[240:241], 1.0 op_sel_hi:[1,0]
    v_pk_add_f32 v[242:243], v[242:243], 1.0 op_sel_hi:[1,0]
    v_pk_add_f32 v[244:245], v[244:245], 1.0 op_sel_hi:[1,0]
    v_pk_add_f32 v[246:247], v[246:247], 1.0 op_sel_hi:[1,0]
    v_rcp_f32 v240, v240
    v_rcp_f32 v241, v241
    v_rcp_f32 v242, v242
    v_rcp_f32 v243, v243
    v_rcp_f32 v244, v244
    v_rcp_f32 v245, v245
    v_rcp_f32 v246, v246
    v_rcp_f32 v247, v247
    v_pk_mul_f32 v[240:241], v[240:241], v[224:225]
    s_add_u32 s26, s83, 10485760
    buffer_load_dwordx4 v[32:35], v12, s[4:7], s26 offen sc1
    buffer_load_dwordx4 v[36:39], v13, s[4:7], s26 offen sc1
    v_pk_mul_f32 v[242:243], v[242:243], v[226:227]
    v_pk_mul_f32 v[244:245], v[244:245], v[228:229]
    v_pk_mul_f32 v[246:247], v[246:247], v[230:231]
    v_cvt_pk_bf16_f32 v160, v240, v241
    v_cvt_pk_bf16_f32 v161, v242, v243
    v_cvt_pk_bf16_f32 v162, v244, v245
    v_cvt_pk_bf16_f32 v163, v246, v247
    s_add_u32 s23, s99, 10600448
    s_cmp_eq_u32 s98, 0
    s_cbranch_scc1 A_14
    buffer_store_dwordx4 v[160:163], v15, s[4:7], s23 offen offset:0
AB_14:
    s_waitcnt lgkmcnt(1)
    v_pk_fma_f32 v[232:233], v[168:169], v[10:11], v[232:233] op_sel_hi:[1,0,1]
    v_pk_fma_f32 v[234:235], v[170:171], v[10:11], v[234:235] op_sel_hi:[1,0,1]
    s_waitcnt lgkmcnt(0)
    v_pk_fma_f32 v[236:237], v[172:173], v[10:11], v[236:237] op_sel_hi:[1,0,1]
    v_pk_fma_f32 v[238:239], v[174:175], v[10:11], v[238:239] op_sel_hi:[1,0,1]
    ds_read_b128 v[224:227], v9 offset:384
    ds_read_b128 v[228:231], v9 offset:400
    v_pk_fma_f32 v[248:249], v[232:233], v[232:233], s[32:33]
    v_pk_fma_f32 v[250:251], v[234:235], v[234:235], s[32:33]
    s_add_u32 s26, s84, 10485760
    buffer_load_dwordx4 v[40:43], v12, s[4:7], s26 offen sc1
    buffer_load_dwordx4 v[44:47], v13, s[4:7], s26 offen sc1
    v_pk_fma_f32 v[252:253], v[236:237], v[236:237], s[32:33]
    v_pk_fma_f32 v[254:255], v[238:239], v[238:239], s[32:33]
    v_pk_mul_f32 v[248:249], v[248:249], v[232:233]
    v_pk_mul_f32 v[250:251], v[250:251], v[234:235]
    v_pk_mul_f32 v[252:253], v[252:253], v[236:237]
    v_pk_mul_f32 v[254:255], v[254:255], v[238:239]
    v_exp_f32 v248, v248
    v_exp_f32 v249, v249
    v_exp_f32 v250, v250
    v_exp_f32 v251, v251
    v_exp_f32 v252, v252
    v_exp_f32 v253, v253
    v_exp_f32 v254, v254
    v_exp_f32 v255, v255
    v_pk_add_f32 v[248:249], v[248:249], 1.0 op_sel_hi:[1,0]
    v_pk_add_f32 v[250:251], v[250:251], 1.0 op_sel_hi:[1,0]
    s_add_u32 s26, s85, 10485760
    buffer_load_dwordx4 v[48:51], v12, s[4:7], s26 offen sc1
    buffer_load_dwordx4 v[52:55], v13, s[4:7], s26 offen sc1
    v_pk_add_f32 v[252:253], v[252:253], 1.0 op_sel_hi:[1,0]
    v_pk_add_f32 v[254:255], v[254:255], 1.0 op_sel_hi:[1,0]
    v_rcp_f32 v248, v248
    v_rcp_f32 v249, v249
    v_rcp_f32 v250, v250
    v_rcp_f32 v251, v251
    v_rcp_f32 v252, v252
    v_rcp_f32 v253, v253
    v_rcp_f32 v254, v254
    v_rcp_f32 v255, v255
    v_pk_mul_f32 v[248:249], v[248:249], v[232:233]
    v_pk_mul_f32 v[250:251], v[250:251], v[234:235]
    v_pk_mul_f32 v[252:253], v[252:253], v[236:237]
    v_pk_mul_f32 v[254:255], v[254:255], v[238:239]
    v_cvt_pk_bf16_f32 v168, v248, v249
    v_cvt_pk_bf16_f32 v169, v250, v251
    s_add_u32 s26, s86, 10485760
    buffer_load_dwordx4 v[56:59], v12, s[4:7], s26 offen sc1
    buffer_load_dwordx4 v[60:63], v13, s[4:7], s26 offen sc1
    v_cvt_pk_bf16_f32 v170, v252, v253
    v_cvt_pk_bf16_f32 v171, v254, v255
    s_add_u32 s23, s99, 10600448
    s_cmp_eq_u32 s98, 0
    s_cbranch_scc1 A_15
    buffer_store_dwordx4 v[168:171], v15, s[4:7], s23 offen offset:2048
AB_15:
    s_waitcnt lgkmcnt(1)
    v_pk_fma_f32 v[224:225], v[176:177], v[10:11], v[224:225] op_sel_hi:[1,0,1]
    v_pk_fma_f32 v[226:227], v[178:179], v[10:11], v[226:227] op_sel_hi:[1,0,1]
    s_waitcnt lgkmcnt(0)
    v_pk_fma_f32 v[228:229], v[180:181], v[10:11], v[228:229] op_sel_hi:[1,0,1]
    v_pk_fma_f32 v[230:231], v[182:183], v[10:11], v[230:231] op_sel_hi:[1,0,1]
    ds_read_b128 v[232:235], v9 offset:416
    ds_read_b128 v[236:239], v9 offset:432
    v_pk_fma_f32 v[240:241], v[224:225], v[224:225], s[32:33]
    v_pk_fma_f32 v[242:243], v[226:227], v[226:227], s[32:33]
    v_pk_fma_f32 v[244:245], v[228:229], v[228:229], s[32:33]
    v_pk_fma_f32 v[246:247], v[230:231], v[230:231], s[32:33]
    v_pk_mul_f32 v[240:241], v[240:241], v[224:225]
    v_pk_mul_f32 v[242:243], v[242:243], v[226:227]
    v_pk_mul_f32 v[244:245], v[244:245], v[228:229]
    s_add_u32 s26, s87, 10485760
    buffer_load_dwordx4 v[64:67], v12, s[4:7], s26 offen sc1
    buffer_load_dwordx4 v[68:71], v13, s[4:7], s26 offen sc1
    v_pk_mul_f32 v[246:247], v[246:247], v[230:231]
    v_exp_f32 v240, v240
    v_exp_f32 v241, v241
    v_exp_f32 v242, v242
    v_exp_f32 v243, v243
    v_exp_f32 v244, v244
    v_exp_f32 v245, v245
    v_exp_f32 v246, v246
    v_exp_f32 v247, v247
    v_pk_add_f32 v[240:241], v[240:241], 1.0 op_sel_hi:[1,0]
    v_pk_add_f32 v[242:243], v[242:243], 1.0 op_sel_hi:[1,0]
    v_pk_add_f32 v[244:245], v[244:245], 1.0 op_sel_hi:[1,0]
    v_pk_add_f32 v[246:247], v[246:247], 1.0 op_sel_hi:[1,0]
    v_rcp_f32 v240, v240
    v_rcp_f32 v241, v241
    v_rcp_f32 v242, v242
    s_add_u32 s26, s88, 10485760
    buffer_load_dwordx4 v[72:75], v12, s[4:7], s26 offen sc1
    buffer_load_dwordx4 v[76:79], v13, s[4:7], s26 offen sc1
    v_rcp_f32 v243, v243
    v_rcp_f32 v244, v244
    v_rcp_f32 v245, v245
    v_rcp_f32 v246, v246
    v_rcp_f32 v247, v247
    v_pk_mul_f32 v[240:241], v[240:241], v[224:225]
    v_pk_mul_f32 v[242:243], v[242:243], v[226:227]
    v_pk_mul_f32 v[244:245], v[244:245], v[228:229]
    v_pk_mul_f32 v[246:247], v[246:247], v[230:231]
    v_cvt_pk_bf16_f32 v176, v240, v241
    v_cvt_pk_bf16_f32 v177, v242, v243
    v_cvt_pk_bf16_f32 v178, v244, v245
    v_cvt_pk_bf16_f32 v179, v246, v247
    s_add_u32 s23, s99, 10657792
    s_cmp_eq_u32 s98, 0
    s_cbranch_scc1 A_16
    buffer_store_dwordx4 v[176:179], v15, s[4:7], s23 offen offset:0
AB_16:
    s_waitcnt lgkmcnt(1)
    v_pk_fma_f32 v[232:233], v[184:185], v[10:11], v[232:233] op_sel_hi:[1,0,1]
    v_pk_fma_f32 v[234:235], v[186:187], v[10:11], v[234:235] op_sel_hi:[1,0,1]
    s_add_u32 s26, s89, 10485760
    buffer_load_dwordx4 v[80:83], v12, s[4:7], s26 offen sc1
    buffer_load_dwordx4 v[84:87], v13, s[4:7], s26 offen sc1
    s_waitcnt lgkmcnt(0)
    v_pk_fma_f32 v[236:237], v[188:189], v[10:11], v[236:237] op_sel_hi:[1,0,1]
    v_pk_fma_f32 v[238:239], v[190:191], v[10:11], v[238:239] op_sel_hi:[1,0,1]
    v_pk_fma_f32 v[248:249], v[232:233], v[232:233], s[32:33]
    v_pk_fma_f32 v[250:251], v[234:235], v[234:235], s[32:33]
    v_pk_fma_f32 v[252:253], v[236:237], v[236:237], s[32:33]
    v_pk_fma_f32 v[254:255], v[238:239], v[238:239], s[32:33]
    v_pk_mul_f32 v[248:249], v[248:249], v[232:233]
    v_pk_mul_f32 v[250:251], v[250:251], v[234:235]
    v_pk_mul_f32 v[252:253], v[252:253], v[236:237]
    v_pk_mul_f32 v[254:255], v[254:255], v[238:239]
    v_exp_f32 v248, v248
    v_exp_f32 v249, v249
    v_exp_f32 v250, v250
    v_exp_f32 v251, v251
    v_exp_f32 v252, v252
    v_exp_f32 v253, v253
    s_add_u32 s26, s83, 10543104
    buffer_load_dwordx4 v[88:91], v12, s[4:7], s26 offen sc1
    buffer_load_dwordx4 v[92:95], v13, s[4:7], s26 offen sc1
    s_waitcnt vmcnt(17)
    v_max_u32 v14, v35, v39
    v_cmp_eq_u32 vcc, -1, v14
    s_cbranch_vccnz R_mh1_0
B_mh1_0:
    v_mfma_f32_32x32x16_bf16 v[16:31], a[32:35], v[32:35], 0
    v_exp_f32 v254, v254
    v_exp_f32 v255, v255
    v_mfma_f32_32x32x16_bf16 a[16:31], a[36:39], v[32:35], 0
    s_waitcnt vmcnt(14)
    v_max_u32 v14, v43, v47
    v_pk_add_f32 v[248:249], v[248:249], 1.0 op_sel_hi:[1,0]
    v_pk_add_f32 v[250:251], v[250:251], 1.0 op_sel_hi:[1,0]
    v_pk_add_f32 v[252:253], v[252:253], 1.0 op_sel_hi:[1,0]
    v_mfma_f32_32x32x16_bf16 a[0:15], a[32:35], v[36:39], 0
    v_cmp_eq_u32 vcc, -1, v14
    s_cbranch_vccnz R_mh1_1
B_mh1_1:
    v_pk_add_f32 v[254:255], v[254:255], 1.0 op_sel_hi:[1,0]
    v_rcp_f32 v248, v248
    v_mfma_f32_32x32x16_bf16 v[96:111], a[36:39], v[36:39], 0
    s_add_u32 s26, s84, 10543104
    buffer_load_dwordx4 v[32:35], v12, s[4:7], s26 offen sc1
    buffer_load_dwordx4 v[36:39], v13, s[4:7], s26 offen sc1
    v_rcp_f32 v249, v249
    v_mfma_f32_32x32x16_bf16 v[16:31], a[40:43], v[40:43], v[16:31]
    v_rcp_f32 v250, v250
    v_mfma_f32_32x32x16_bf16 a[16:31], a[44:47], v[40:43], a[16:31]
    s_waitcnt vmcnt(14)
    v_max_u32 v14, v51, v55
    v_rcp_f32 v251, v251
    v_mfma_f32_32x32x16_bf16 a[0:15], a[40:43], v[44:47], a[0:15]
    v_cmp_eq_u32 vcc, -1, v14
    s_cbranch_vccnz R_mh1_2
B_mh1_2:
    v_rcp_f32 v252, v252
    v_rcp_f32 v253, v253
    v_mfma_f32_32x32x16_bf16 v[96:111], a[44:47], v[44:47], v[96:111]
    s_add_u32 s26, s85, 10543104
    buffer_load_dwordx4 v[40:43], v12, s[4:7], s26 offen sc1
    buffer_load_dwordx4 v[44:47], v13, s[4:7], s26 offen sc1
    v_rcp_f32 v254, v254
    v_mfma_f32_32x32x16_bf16 v[16:31], a[48:51], v[48:51], v[16:31]
    v_rcp_f32 v255, v255
    v_mfma_f32_32x32x16_bf16 a[16:31], a[52:55], v[48:51], a[16:31]
    s_waitcnt vmcnt(14)
    v_max_u32 v14, v59, v63
    v_pk_mul_f32 v[248:249], v[248:249], v[232:233]
    v_pk_mul_f32 v[250:251], v[250:251], v[234:235]
    v_pk_mul_f32 v[252:253], v[252:253], v[236:237]
    v_mfma_f32_32x32x16_bf16 a[0:15], a[48:51], v[52:55], a[0:15]
    v_cmp_eq_u32 vcc, -1, v14
    s_cbranch_vccnz R_mh1_3
B_mh1_3:
    v_pk_mul_f32 v[254:255], v[254:255], v[238:239]
    v_cvt_pk_bf16_f32 v184, v248, v249
    v_cvt_pk_bf16_f32 v185, v250, v251
    v_mfma_f32_32x32x16_bf16 v[96:111], a[52:55], v[52:55], v[96:111]
    s_add_u32 s26, s86, 10543104
    buffer_load_dwordx4 v[48:51], v12, s[4:7], s26 offen sc1
    buffer_load_dwordx4 v[52:55], v13, s[4:7], s26 offen sc1
    v_cvt_pk_bf16_f32 v186, v252, v253
    v_mfma_f32_32x32x16_bf16 v[16:31], a[56:59], v[56:59], v[16:31]
    v_cvt_pk_bf16_f32 v187, v254, v255
    v_mfma_f32_32x32x16_bf16 a[16:31], a[60:63], v[56:59], a[16:31]
    s_waitcnt vmcnt(13)
    v_max_u32 v14, v67, v71
    s_add_u32 s23, s99, 10657792
    s_cmp_eq_u32 s98, 0
    s_cbranch_scc1 A_17
    buffer_store_dwordx4 v[184:187], v15, s[4:7], s23 offen offset:2048
AB_17:
    v_mfma_f32_32x32x16_bf16 a[0:15], a[56:59], v[60:63], a[0:15]
    v_cmp_eq_u32 vcc, -1, v14
    s_cbranch_vccnz R_mh1_4
B_mh1_4:
    s_barrier
    v_mfma_f32_32x32x16_bf16 v[96:111], a[60:63], v[60:63], v[96:111]
    s_add_u32 s26, s87, 10543104
    buffer_load_dwordx4 v[56:59], v12, s[4:7], s26 offen sc1
    buffer_load_dwordx4 v[60:63], v13, s[4:7], s26 offen sc1
    s_xor_b32 s30, s16, 0
    s_mul_i32 s30, s30, 12288
    s_add_u32 s30, s30, 114688
    v_add_u32 v120, s30, v15
    s_xor_b32 s30, s16, 1
    s_mul_i32 s30, s30, 12288
    s_add_u32 s30, s30, 114688
    v_add_u32 v121, s30, v15
    s_xor_b32 s30, s16, 2
    s_mul_i32 s30, s30, 12288
    s_add_u32 s30, s30, 118784
    v_add_u32 v122, s30, v15
    s_xor_b32 s30, s16, 3
    s_mul_i32 s30, s30, 12288
    s_add_u32 s30, s30, 122880
    v_add_u32 v123, s30, v15
    v_mfma_f32_32x32x16_bf16 v[16:31], a[64:67], v[64:67], v[16:31]
    v_mfma_f32_32x32x16_bf16 a[16:31], a[68:71], v[64:67], a[16:31]
    s_waitcnt vmcnt(14)
    v_max_u32 v14, v75, v79
    v_and_b32 v124, 3, v1
    v_lshrrev_b32 v125, 2, v4
    v_mfma_f32_32x32x16_bf16 a[0:15], a[64:67], v[68:71], a[0:15]
    v_cmp_eq_u32 vcc, -1, v14
    s_cbranch_vccnz R_mh1_5
B_mh1_5:
    v_lshl_add_u32 v124, v124, 5, v125
    v_mul_u32_u24 v124, 896, v124
    v_lshl_add_u32 v124, v3, 4, v124
    v_mfma_f32_32x32x16_bf16 v[96:111], a[68:71], v[68:71], v[96:111]
    s_add_u32 s26, s88, 10543104
    buffer_load_dwordx4 v[64:67], v12, s[4:7], s26 offen sc1
    buffer_load_dwordx4 v[68:71], v13, s[4:7], s26 offen sc1
    v_mfma_f32_32x32x16_bf16 v[16:31], a[72:75], v[72:75], v[16:31]
    v_mfma_f32_32x32x16_bf16 a[16:31], a[76:79], v[72:75], a[16:31]
    s_waitcnt vmcnt(13)
    v_max_u32 v14, v83, v87
    v_mfma_f32_32x32x16_bf16 a[0:15], a[72:75], v[76:79], a[0:15]
    v_cmp_eq_u32 vcc, -1, v14
    s_cbranch_vccnz R_mh1_6
B_mh1_6:
    v_mfma_f32_32x32x16_bf16 v[96:111], a[76:79], v[76:79], v[96:111]
    s_add_u32 s26, s89, 10543104
    buffer_load_dwordx4 v[72:75], v12, s[4:7], s26 offen sc1
    buffer_load_dwordx4 v[76:79], v13, s[4:7], s26 offen sc1
    v_mfma_f32_32x32x16_bf16 v[16:31], a[80:83], v[80:83], v[16:31]
    v_mfma_f32_32x32x16_bf16 a[16:31], a[84:87], v[80:83], a[16:31]
    s_waitcnt vmcnt(13)
    v_max_u32 v14, v91, v95
    v_mfma_f32_32x32x16_bf16 a[0:15], a[80:83], v[84:87], a[0:15]
    v_cmp_eq_u32 vcc, -1, v14
    s_cbranch_vccnz R_mh1_7
B_mh1_7:
    v_mfma_f32_32x32x16_bf16 v[96:111], a[84:87], v[84:87], v[96:111]
    s_add_u32 s26, s83, 10600448
    buffer_load_dwordx4 v[80:83], v12, s[4:7], s26 offen sc1
    buffer_load_dwordx4 v[84:87], v13, s[4:7], s26 offen sc1
    v_mfma_f32_32x32x16_bf16 v[16:31], a[88:91], v[88:91], v[16:31]
    v_mfma_f32_32x32x16_bf16 a[16:31], a[92:95], v[88:91], a[16:31]
    s_waitcnt vmcnt(13)
    v_max_u32 v14, v35, v39
    v_mfma_f32_32x32x16_bf16 a[0:15], a[88:91], v[92:95], a[0:15]
    v_cmp_eq_u32 vcc, -1, v14
    s_cbranch_vccnz R_mh1_8
B_mh1_8:
    v_mfma_f32_32x32x16_bf16 v[96:111], a[92:95], v[92:95], v[96:111]
    s_add_u32 s26, s84, 10600448
    buffer_load_dwordx4 v[88:91], v12, s[4:7], s26 offen sc1
    buffer_load_dwordx4 v[92:95], v13, s[4:7], s26 offen sc1
    v_mfma_f32_32x32x16_bf16 v[16:31], a[96:99], v[32:35], v[16:31]
    v_mfma_f32_32x32x16_bf16 a[16:31], a[100:103], v[32:35], a[16:31]
    s_waitcnt vmcnt(13)
    v_max_u32 v14, v43, v47
    v_mfma_f32_32x32x16_bf16 a[0:15], a[96:99], v[36:39], a[0:15]
    v_cmp_eq_u32 vcc, -1, v14
    s_cbranch_vccnz R_mh1_9
B_mh1_9:
    v_mfma_f32_32x32x16_bf16 v[96:111], a[100:103], v[36:39], v[96:111]
    s_add_u32 s26, s85, 10600448
    buffer_load_dwordx4 v[32:35], v12, s[4:7], s26 offen sc1
    buffer_load_dwordx4 v[36:39], v13, s[4:7], s26 offen sc1
    v_mfma_f32_32x32x16_bf16 v[16:31], a[104:107], v[40:43], v[16:31]
    v_mfma_f32_32x32x16_bf16 a[16:31], a[108:111], v[40:43], a[16:31]
    s_waitcnt vmcnt(13)
    v_max_u32 v14, v51, v55
    v_mfma_f32_32x32x16_bf16 a[0:15], a[104:107], v[44:47], a[0:15]
    v_cmp_eq_u32 vcc, -1, v14
    s_cbranch_vccnz R_mh1_10
B_mh1_10:
    v_mfma_f32_32x32x16_bf16 v[96:111], a[108:111], v[44:47], v[96:111]
    s_add_u32 s26, s86, 10600448
    buffer_load_dwordx4 v[40:43], v12, s[4:7], s26 offen sc1
    buffer_load_dwordx4 v[44:47], v13, s[4:7], s26 offen sc1
    v_mfma_f32_32x32x16_bf16 v[16:31], a[112:115], v[48:51], v[16:31]
    v_mfma_f32_32x32x16_bf16 a[16:31], a[116:119], v[48:51], a[16:31]
    s_waitcnt vmcnt(12)
    v_max_u32 v14, v59, v63
    v_mfma_f32_32x32x16_bf16 a[0:15], a[112:115], v[52:55], a[0:15]
    v_cmp_eq_u32 vcc, -1, v14
    s_cbranch_vccnz R_mh1_11
B_mh1_11:
    v_mfma_f32_32x32x16_bf16 v[96:111], a[116:119], v[52:55], v[96:111]
    s_add_u32 s26, s87, 10600448
    buffer_load_dwordx4 v[48:51], v12, s[4:7], s26 offen sc1
    buffer_load_dwordx4 v[52:55], v13, s[4:7], s26 offen sc1
    v_mfma_f32_32x32x16_bf16 v[16:31], a[120:123], v[56:59], v[16:31]
    v_mfma_f32_32x32x16_bf16 a[16:31], a[124:127], v[56:59], a[16:31]
    s_waitcnt vmcnt(12)
    v_max_u32 v14, v67, v71
    v_mfma_f32_32x32x16_bf16 a[0:15], a[120:123], v[60:63], a[0:15]
    v_cmp_eq_u32 vcc, -1, v14
    s_cbranch_vccnz R_mh1_12
B_mh1_12:
    v_mfma_f32_32x32x16_bf16 v[96:111], a[124:127], v[60:63], v[96:111]
    s_add_u32 s26, s88, 10600448
    buffer_load_dwordx4 v[56:59], v12, s[4:7], s26 offen sc1
    buffer_load_dwordx4 v[60:63], v13, s[4:7], s26 offen sc1
    v_mfma_f32_32x32x16_bf16 v[16:31], a[128:131], v[64:67], v[16:31]
    v_mfma_f32_32x32x16_bf16 a[16:31], a[132:135], v[64:67], a[16:31]
    s_waitcnt vmcnt(12)
    v_max_u32 v14, v75, v79
    v_mfma_f32_32x32x16_bf16 a[0:15], a[128:131], v[68:71], a[0:15]
    v_cmp_eq_u32 vcc, -1, v14
    s_cbranch_vccnz R_mh1_13
B_mh1_13:
    v_mfma_f32_32x32x16_bf16 v[96:111], a[132:135], v[68:71], v[96:111]
    s_add_u32 s26, s89, 10600448
    buffer_load_dwordx4 v[64:67], v12, s[4:7], s26 offen sc1
    buffer_load_dwordx4 v[68:71], v13, s[4:7], s26 offen sc1
    v_mfma_f32_32x32x16_bf16 v[16:31], a[136:139], v[72:75], v[16:31]
    v_mfma_f32_32x32x16_bf16 a[16:31], a[140:143], v[72:75], a[16:31]
    s_waitcnt vmcnt(12)
    v_max_u32 v14, v83, v87
    v_mfma_f32_32x32x16_bf16 a[0:15], a[136:139], v[76:79], a[0:15]
    v_cmp_eq_u32 vcc, -1, v14
    s_cbranch_vccnz R_mh1_14
B_mh1_14:
    v_mfma_f32_32x32x16_bf16 v[96:111], a[140:143], v[76:79], v[96:111]
    s_add_u32 s26, s83, 10657792
    buffer_load_dwordx4 v[72:75], v12, s[4:7], s26 offen sc1
    buffer_load_dwordx4 v[76:79], v13, s[4:7], s26 offen sc1
    v_mfma_f32_32x32x16_bf16 v[16:31], a[144:147], v[80:83], v[16:31]
    v_mfma_f32_32x32x16_bf16 a[16:31], a[148:151], v[80:83], a[16:31]
    s_waitcnt vmcnt(12)
    v_max_u32 v14, v91, v95
    v_mfma_f32_32x32x16_bf16 a[0:15], a[144:147], v[84:87], a[0:15]
    v_cmp_eq_u32 vcc, -1, v14
    s_cbranch_vccnz R_mh1_15
B_mh1_15:
    v_mfma_f32_32x32x16_bf16 v[96:111], a[148:151], v[84:87], v[96:111]
    s_add_u32 s26, s84, 10657792
    buffer_load_dwordx4 v[80:83], v12, s[4:7], s26 offen sc1
    buffer_load_dwordx4 v[84:87], v13, s[4:7], s26 offen sc1
    v_mfma_f32_32x32x16_bf16 v[16:31], a[152:155], v[88:91], v[16:31]
    v_mfma_f32_32x32x16_bf16 a[16:31], a[156:159], v[88:91], a[16:31]
    s_waitcnt vmcnt(12)
    v_max_u32 v14, v35, v39
    v_mfma_f32_32x32x16_bf16 a[0:15], a[152:155], v[92:95], a[0:15]
    v_cmp_eq_u32 vcc, -1, v14
    s_cbranch_vccnz R_mh1_16
B_mh1_16:
    v_mfma_f32_32x32x16_bf16 v[96:111], a[156:159], v[92:95], v[96:111]
    s_add_u32 s26, s85, 10657792
    buffer_load_dwordx4 v[88:91], v12, s[4:7], s26 offen sc1
    buffer_load_dwordx4 v[92:95], v13, s[4:7], s26 offen sc1
    v_mfma_f32_32x32x16_bf16 v[16:31], a[160:163], v[32:35], v[16:31]
    v_mfma_f32_32x32x16_bf16 a[16:31], a[164:167], v[32:35], a[16:31]
    s_waitcnt vmcnt(12)
    v_max_u32 v14, v43, v47
    v_mfma_f32_32x32x16_bf16 a[0:15], a[160:163], v[36:39], a[0:15]
    v_cmp_eq_u32 vcc, -1, v14
    s_cbranch_vccnz R_mh1_17
B_mh1_17:
    v_mfma_f32_32x32x16_bf16 v[96:111], a[164:167], v[36:39], v[96:111]
    s_add_u32 s26, s86, 10657792
    buffer_load_dwordx4 v[32:35], v12, s[4:7], s26 offen sc1
    buffer_load_dwordx4 v[36:39], v13, s[4:7], s26 offen sc1
    v_mfma_f32_32x32x16_bf16 v[16:31], a[168:171], v[40:43], v[16:31]
    v_mfma_f32_32x32x16_bf16 a[16:31], a[172:175], v[40:43], a[16:31]
    s_waitcnt vmcnt(12)
    v_max_u32 v14, v51, v55
    v_mfma_f32_32x32x16_bf16 a[0:15], a[168:171], v[44:47], a[0:15]
    v_cmp_eq_u32 vcc, -1, v14
    s_cbranch_vccnz R_mh1_18
B_mh1_18:
    v_mfma_f32_32x32x16_bf16 v[96:111], a[172:175], v[44:47], v[96:111]
    s_add_u32 s26, s87, 10657792
    buffer_load_dwordx4 v[40:43], v12, s[4:7], s26 offen sc1
    buffer_load_dwordx4 v[44:47], v13, s[4:7], s26 offen sc1
    v_mfma_f32_32x32x16_bf16 v[16:31], a[176:179], v[48:51], v[16:31]
    v_mfma_f32_32x32x16_bf16 a[16:31], a[180:183], v[48:51], a[16:31]
    s_waitcnt vmcnt(12)
    v_max_u32 v14, v59, v63
    v_mfma_f32_32x32x16_bf16 a[0:15], a[176:179], v[52:55], a[0:15]
    v_cmp_eq_u32 vcc, -1, v14
    s_cbranch_vccnz R_mh1_19
B_mh1_19:
    v_mfma_f32_32x32x16_bf16 v[96:111], a[180:183], v[52:55], v[96:111]
    s_add_u32 s26, s88, 10657792
    buffer_load_dwordx4 v[48:51], v12, s[4:7], s26 offen sc1
    buffer_load_dwordx4 v[52:55], v13, s[4:7], s26 offen sc1
    v_mfma_f32_32x32x16_bf16 v[16:31], a[184:187], v[56:59], v[16:31]
    v_mfma_f32_32x32x16_bf16 a[16:31], a[188:191], v[56:59], a[16:31]
    s_waitcnt vmcnt(12)
    v_max_u32 v14, v67, v71
    v_mfma_f32_32x32x16_bf16 a[0:15], a[184:187], v[60:63], a[0:15]
    v_cmp_eq_u32 vcc, -1, v14
    s_cbranch_vccnz R_mh1_20
B_mh1_20:
    v_mfma_f32_32x32x16_bf16 v[96:111], a[188:191], v[60:63], v[96:111]
    s_add_u32 s26, s89, 10657792
    buffer_load_dwordx4 v[56:59], v12, s[4:7], s26 offen sc1
    buffer_load_dwordx4 v[60:63], v13, s[4:7], s26 offen sc1
    v_mfma_f32_32x32x16_bf16 v[16:31], a[192:195], v[64:67], v[16:31]
    v_mfma_f32_32x32x16_bf16 a[16:31], a[196:199], v[64:67], a[16:31]
    s_waitcnt vmcnt(12)
    v_max_u32 v14, v75, v79
    v_mfma_f32_32x32x16_bf16 a[0:15], a[192:195], v[68:71], a[0:15]
    v_cmp_eq_u32 vcc, -1, v14
    s_cbranch_vccnz R_mh1_21
B_mh1_21:
    v_mfma_f32_32x32x16_bf16 v[96:111], a[196:199], v[68:71], v[96:111]
    buffer_load_dwordx4 v[112:115], v15, s[4:7], s20 offen offset:0 sc1
    buffer_load_dwordx4 v[116:119], v15, s[4:7], s20 offen offset:1024 sc1
    v_mfma_f32_32x32x16_bf16 v[16:31], a[200:203], v[72:75], v[16:31]
    v_mfma_f32_32x32x16_bf16 a[16:31], a[204:207], v[72:75], a[16:31]
    s_waitcnt vmcnt(12)
    v_max_u32 v14, v83, v87
    v_mfma_f32_32x32x16_bf16 a[0:15], a[200:203], v[76:79], a[0:15]
    v_cmp_eq_u32 vcc, -1, v14
    s_cbranch_vccnz R_mh1_22
B_mh1_22:
    v_mfma_f32_32x32x16_bf16 v[96:111], a[204:207], v[76:79], v[96:111]
    v_mfma_f32_32x32x16_bf16 a[16:31], a[212:215], v[80:83], a[16:31]
    s_waitcnt vmcnt(10)
    v_max_u32 v14, v91, v95
    v_mfma_f32_32x32x16_bf16 a[0:15], a[208:211], v[84:87], a[0:15]
    v_cmp_eq_u32 vcc, -1, v14
    s_cbranch_vccnz R_mh1_23
B_mh1_23:
    v_mfma_f32_32x32x16_bf16 v[96:111], a[212:215], v[84:87], v[96:111]
    v_mfma_f32_32x32x16_bf16 a[16:31], a[220:223], v[88:91], a[16:31]
    s_waitcnt vmcnt(8)
    v_max_u32 v14, v35, v39
    v_mfma_f32_32x32x16_bf16 a[0:15], a[216:219], v[92:95], a[0:15]
    v_cmp_eq_u32 vcc, -1, v14
    s_cbranch_vccnz R_mh1_24
B_mh1_24:
    v_mfma_f32_32x32x16_bf16 v[96:111], a[220:223], v[92:95], v[96:111]
    s_waitcnt vmcnt(5)
    v_max3_u32 v14, v43, v47, v51
    v_mfma_f32_32x32x16_bf16 a[16:31], a[228:231], v[32:35], a[16:31]
    s_waitcnt vmcnt(3)
    v_max3_u32 v14, v14, v55, v59
    s_waitcnt vmcnt(2)
    v_max_u32 v14, v14, v63
    v_mfma_f32_32x32x16_bf16 a[0:15], a[224:227], v[36:39], a[0:15]
    v_cmp_eq_u32 vcc, -1, v14
    s_cbranch_vccnz R_mh1_25
B_mh1_25:
    v_mfma_f32_32x32x16_bf16 v[96:111], a[228:231], v[36:39], v[96:111]
    v_mfma_f32_32x32x16_bf16 a[0:15], a[232:235], v[44:47], a[0:15]
    v_mfma_f32_32x32x16_bf16 a[0:15], a[240:243], v[52:55], a[0:15]
    v_mfma_f32_32x32x16_bf16 a[0:15], a[248:251], v[60:63], a[0:15]
    s_waitcnt vmcnt(0)
    v_max_u32 v14, v115, v119
    v_cmp_eq_u32 vcc, -1, v14
    s_cbranch_vccnz R_mr1
B_mr1:
    v_mfma_f32_32x32x16_bf16 v[96:111], a[236:239], v[44:47], v[96:111]
    v_mfma_f32_32x32x16_bf16 v[96:111], a[244:247], v[52:55], v[96:111]
    s_nop 5
    ds_write_b128 v121, a[0:3] offset:0
    ds_write_b128 v121, a[4:7] offset:1024
    v_mfma_f32_32x32x16_bf16 v[96:111], a[252:255], v[60:63], v[96:111]
    ds_write_b128 v121, a[8:11] offset:2048
    ds_write_b128 v121, a[12:15] offset:3072
    v_mfma_f32_32x32x16_bf16 a[16:31], a[236:239], v[40:43], a[16:31]
    v_lshlrev_b32 v176, 16, v112
    v_and_b32 v177, 0xffff0000, v112
    v_lshlrev_b32 v178, 16, v113
    v_and_b32 v179, 0xffff0000, v113
    v_lshlrev_b32 v180, 16, v114
    v_and_b32 v181, 0xffff0000, v114
    v_lshlrev_b32 v182, 16, v115
    v_and_b32 v183, 0xffff0000, v115
    v_lshlrev_b32 v184, 16, v116
    v_and_b32 v185, 0xffff0000, v116
    v_lshlrev_b32 v186, 16, v117
    v_and_b32 v187, 0xffff0000, v117
    v_lshlrev_b32 v188, 16, v118
    v_and_b32 v189, 0xffff0000, v118
    v_lshlrev_b32 v190, 16, v119
    v_and_b32 v191, 0xffff0000, v119
    v_mfma_f32_32x32x16_bf16 a[16:31], a[244:247], v[48:51], a[16:31]
    ds_write_b128 v123, v[96:99] offset:0
    ds_write_b128 v123, v[100:103] offset:1024
    v_mfma_f32_32x32x16_bf16 a[16:31], a[252:255], v[56:59], a[16:31]
    ds_write_b128 v123, v[104:107] offset:2048
    ds_write_b128 v123, v[108:111] offset:3072
    v_mfma_f32_32x32x16_bf16 v[16:31], a[208:211], v[80:83], v[16:31]
    v_mfma_f32_32x32x16_bf16 v[16:31], a[216:219], v[88:91], v[16:31]
    s_nop 7
    ds_write_b128 v122, a[16:19] offset:0
    ds_write_b128 v122, a[20:23] offset:1024
    v_mfma_f32_32x32x16_bf16 v[16:31], a[224:227], v[32:35], v[16:31]
    ds_write_b128 v122, a[24:27] offset:2048
    ds_write_b128 v122, a[28:31] offset:3072
    s_waitcnt lgkmcnt(0)
    s_barrier
    ds_read_b128 v[128:131], v120 offset:0
    ds_read_b128 v[132:135], v120 offset:1024
    ds_read_b128 v[136:139], v120 offset:2048
    ds_read_b128 v[140:143], v120 offset:3072
    v_mfma_f32_32x32x16_bf16 v[16:31], a[232:235], v[40:43], v[16:31]
    ds_read_b128 v[144:147], v120 offset:4096
    ds_read_b128 v[148:151], v120 offset:5120
    ds_read_b128 v[152:155], v120 offset:6144
    ds_read_b128 v[156:159], v120 offset:7168
    v_mfma_f32_32x32x16_bf16 v[16:31], a[240:243], v[48:51], v[16:31]
    ds_read_b128 v[160:163], v120 offset:8192
    ds_read_b128 v[164:167], v120 offset:9216
    ds_read_b128 v[168:171], v120 offset:10240
    ds_read_b128 v[172:175], v120 offset:11264
    v_mfma_f32_32x32x16_bf16 v[16:31], a[248:251], v[56:59], v[16:31]
    s_mov_b32 s30, 0xc0088e99
    s_mov_b32 s31, 0xc0088e99
    s_waitcnt lgkmcnt(11)
    v_pk_fma_f32 v[176:177], v[128:129], s[30:31], v[176:177]
    v_pk_fma_f32 v[178:179], v[130:131], s[30:31], v[178:179]
    s_waitcnt lgkmcnt(10)
    v_pk_fma_f32 v[180:181], v[132:133], s[30:31], v[180:181]
    v_pk_fma_f32 v[182:183], v[134:135], s[30:31], v[182:183]
    s_waitcnt lgkmcnt(9)
    v_pk_fma_f32 v[184:185], v[136:137], s[30:31], v[184:185]
    v_pk_fma_f32 v[186:187], v[138:139], s[30:31], v[186:187]
    s_waitcnt lgkmcnt(8)
    v_pk_fma_f32 v[188:189], v[140:141], s[30:31], v[188:189]
    v_pk_fma_f32 v[190:191], v[142:143], s[30:31], v[190:191]
    s_waitcnt lgkmcnt(7)
    v_pk_fma_f32 v[176:177], v[144:145], s[30:31], v[176:177]
    v_pk_fma_f32 v[178:179], v[146:147], s[30:31], v[178:179]
    s_waitcnt lgkmcnt(6)
    v_pk_fma_f32 v[180:181], v[148:149], s[30:31], v[180:181]
    v_pk_fma_f32 v[182:183], v[150:151], s[30:31], v[182:183]
    s_waitcnt lgkmcnt(5)
    v_pk_fma_f32 v[184:185], v[152:153], s[30:31], v[184:185]
    v_pk_fma_f32 v[186:187], v[154:155], s[30:31], v[186:187]
    s_waitcnt lgkmcnt(4)
    v_pk_fma_f32 v[188:189], v[156:157], s[30:31], v[188:189]
    v_pk_fma_f32 v[190:191], v[158:159], s[30:31], v[190:191]
    s_waitcnt lgkmcnt(3)
    v_pk_fma_f32 v[176:177], v[160:161], s[30:31], v[176:177]
    v_pk_fma_f32 v[178:179], v[162:163], s[30:31], v[178:179]
    s_waitcnt lgkmcnt(2)
    v_pk_fma_f32 v[180:181], v[164:165], s[30:31], v[180:181]
    v_pk_fma_f32 v[182:183], v[166:167], s[30:31], v[182:183]
    s_waitcnt lgkmcnt(1)
    v_pk_fma_f32 v[184:185], v[168:169], s[30:31], v[184:185]
    v_pk_fma_f32 v[186:187], v[170:171], s[30:31], v[186:187]
    s_waitcnt lgkmcnt(0)
    v_pk_fma_f32 v[188:189], v[172:173], s[30:31], v[188:189]
    v_pk_fma_f32 v[190:191], v[174:175], s[30:31], v[190:191]
    v_pk_fma_f32 v[16:17], v[16:17], s[30:31], v[176:177]
    v_pk_fma_f32 v[18:19], v[18:19], s[30:31], v[178:179]
    v_pk_fma_f32 v[20:21], v[20:21], s[30:31], v[180:181]
    v_pk_fma_f32 v[22:23], v[22:23], s[30:31], v[182:183]
    v_pk_fma_f32 v[24:25], v[24:25], s[30:31], v[184:185]
    v_pk_fma_f32 v[26:27], v[26:27], s[30:31], v[186:187]
    v_pk_fma_f32 v[28:29], v[28:29], s[30:31], v[188:189]
    v_pk_fma_f32 v[30:31], v[30:31], s[30:31], v[190:191]
    v_cvt_pk_bf16_f32 v112, v16, v17
    v_cvt_pk_bf16_f32 v113, v18, v19
    v_cvt_pk_bf16_f32 v114, v20, v21
    v_cvt_pk_bf16_f32 v115, v22, v23
    v_cvt_pk_bf16_f32 v116, v24, v25
    v_cvt_pk_bf16_f32 v117, v26, v27
    v_cvt_pk_bf16_f32 v118, v28, v29
    v_cvt_pk_bf16_f32 v119, v30, v31
    v_permlane32_swap_b32 v112, v114
    v_permlane32_swap_b32 v113, v115
    v_permlane32_swap_b32 v116, v118
    v_permlane32_swap_b32 v117, v119
    buffer_store_dwordx4 v[112:115], v124, s[8:11], s25 offen offset:0
    buffer_store_dwordx4 v[116:119], v124, s[8:11], s25 offen offset:32
    s_endpgm
R_mdX:
    s_add_u32 s21, s21, 1
    s_cmp_gt_u32 s21, 4096
    s_cbranch_scc1 B_mdX
    s_sleep 2
    v_and_b32 v120, 0xf0, v15
    buffer_load_dword v120, v120, s[84:87], 0 offen sc1
    s_waitcnt vmcnt(0)
    v_cmp_eq_u32 vcc, 0, v120
    s_cbranch_vccnz R_mdX
    v_mov_b32 v126, -1
    s_mov_b64 exec, 1
    buffer_store_dword v1, v1, s[4:7], s39 offen sc1
    s_mov_b64 exec, -1
    s_waitcnt vmcnt(0)
    s_branch B_mdX
R_mxfX:
    s_add_u32 s21, s21, 1
    s_cmp_gt_u32 s21, 4096
    s_cbranch_scc1 B_mxfX
    s_sleep 4
    buffer_load_dword v126, v46, s[4:7], 0 offen sc1
    s_waitcnt vmcnt(0)
    v_cmp_eq_u32 vcc, -1, v126
    s_nop 0
    s_lshl_b64 vcc, vcc, 32
    s_cbranch_vccnz R_mxfX
    s_branch B_mxfX
R_mdU:
    s_add_u32 s21, s21, 1
    s_cmp_gt_u32 s21, 4096
    s_cbranch_scc1 B_mdU
    s_sleep 2
    v_and_b32 v120, 0xf0, v15
    buffer_load_dword v120, v120, s[84:87], 0 offen sc1
    s_waitcnt vmcnt(0)
    v_cmp_eq_u32 vcc, 0, v120
    s_cbranch_vccnz R_mdU
    v_mov_b32 v126, -1
    s_branch B_mdU
R_mxfU:
    s_add_u32 s21, s21, 1
    s_cmp_gt_u32 s21, 4096
    s_cbranch_scc1 B_mxfU
    s_sleep 4
    buffer_load_dword v126, v46, s[4:7], 0 offen sc1
    s_waitcnt vmcnt(0)
    v_cmp_eq_u32 vcc, -1, v126
    s_nop 0
    s_lshl_b64 vcc, vcc, 32
    s_cbranch_vccnz R_mxfU
    s_branch B_mxfU
R_mvU:
    s_add_u32 s21, s21, 1
    s_cmp_gt_u32 s21, 4096
    s_cbranch_scc1 B_mvU
    s_sleep 4
    buffer_load_dword v36, v45, s[4:7], 0 offen sc1
    s_waitcnt vmcnt(0)
    v_cmp_eq_u32 vcc, -1, v36
    s_cbranch_vccnz R_mvU
    s_branch B_mvU
R_mf1:
    s_add_u32 s21, s21, 1
    s_cmp_gt_u32 s21, 4096
    s_cbranch_scc1 B_mf1
    s_sleep 4
    s_lshl2_add_u32 s22, s19, s16
    s_lshr_b32 s22, s22, 1
    s_lshl_b32 s22, s22, 10
    s_add_u32 s22, s22, 1884160
    v_min_u32 v3, 13, v1
    v_lshlrev_b32 v3, 6, v3
    buffer_load_dword v3, v3, s[4:7], s22 offen sc1
    s_waitcnt vmcnt(0)
    v_cmp_eq_u32 vcc, -1, v3
    s_cbranch_vccnz R_mf1
    s_branch B_mf1
R_mc0:
    s_add_u32 s21, s21, 1
    s_cmp_gt_u32 s21, 4096
    s_cbranch_scc1 B_mc0
    buffer_load_dwordx4 v[16:19], v5, s[4:7], s100 offen offset:0 sc1
    buffer_load_dwordx4 v[20:23], v5, s[4:7], s100 offen offset:256 sc1
    s_waitcnt vmcnt(0) lgkmcnt(0)
    v_max3_u32 v13, v16, v17, v18
    v_max3_u32 v13, v13, v19, v20
    v_max3_u32 v13, v13, v21, v22
    v_max_u32 v13, v13, v23
    v_cmp_eq_u32 vcc, -1, v13
    s_cbranch_vccnz R_mc0
    s_branch B_mc0
R_mwf:
    s_add_u32 s21, s21, 1
    s_cmp_gt_u32 s21, 4096
    s_cbranch_scc1 B_mwf
    s_sleep 2
    buffer_load_dword v34, v46, s[4:7], 0 offen sc1
    s_waitcnt vmcnt(0) lgkmcnt(0)
    v_cmp_eq_u32 vcc, -1, v34
    s_nop 0
    s_lshr_b64 vcc, vcc, 32
    s_cbranch_vccnz R_mwf
    s_branch B_mwf
R_mq0:
    s_add_u32 s21, s21, 1
    s_cmp_gt_u32 s21, 4096
    s_cbranch_scc1 B_mq0
    s_mov_b32 s31, 1957888
    buffer_load_dwordx4 v[24:27], v5, s[4:7], s31 offen offset:0 sc1
    buffer_load_dwordx4 v[28:31], v5, s[4:7], s31 offen offset:256 sc1
    s_waitcnt vmcnt(0)
    v_max3_u32 v13, v24, v25, v26
    v_max3_u32 v13, v13, v27, v28
    v_max3_u32 v13, v13, v29, v30
    v_max_u32 v13, v13, v31
    v_cmp_eq_u32 vcc, -1, v13
    s_cbranch_vccnz R_mq0
    s_branch B_mq0
R_mc30:
    s_add_u32 s21, s21, 1
    s_cmp_gt_u32 s21, 4096
    s_cbranch_scc1 B_mc30
    s_sleep 4
    buffer_load_dword v35, v47, s[4:7], 0 offen offset:4 sc1
    s_waitcnt vmcnt(0)
    v_cmp_eq_u32 vcc, -1, v35
    s_cbranch_vccnz R_mc30
    s_branch B_mc30
R_mx0_0:
    s_add_u32 s21, s21, 1
    s_cmp_gt_u32 s21, 4096
    s_cbranch_scc1 B_mx0_0
    s_waitcnt lgkmcnt(0)
    s_add_u32 m0, s36, 0
    s_add_u32 s26, s76, 2097152
    buffer_load_dwordx4 v15, s[4:7], s26 offen offset:0 sc1 lds
    buffer_load_dwordx4 v15, s[4:7], s26 offen offset:1024 sc1 lds
    buffer_load_dwordx4 v15, s[4:7], s26 offen offset:2048 sc1 lds
    buffer_load_dwordx4 v15, s[4:7], s26 offen offset:3072 sc1 lds
    s_add_u32 m0, s36, 4096
    s_add_u32 s26, s77, 2097152
    buffer_load_dwordx4 v15, s[4:7], s26 offen offset:0 sc1 lds
    buffer_load_dwordx4 v15, s[4:7], s26 offen offset:1024 sc1 lds
    buffer_load_dwordx4 v15, s[4:7], s26 offen offset:2048 sc1 lds
    s_waitcnt vmcnt(0)
    ds_read_b64_tr_b16 v[16:17], v6 offset:0
    ds_read_b64_tr_b16 v[18:19], v6 offset:512
    ds_read_b64_tr_b16 v[20:21], v6 offset:1024
    ds_read_b64_tr_b16 v[22:23], v6 offset:1536
    s_waitcnt lgkmcnt(0)
    v_max3_u32 v14, v16, v17, v18
    v_max_u32 v14, v14, v19
    v_cmp_eq_u32 vcc, -1, v14
    s_cbranch_vccnz R_mx0_0
    s_branch B_mx0_0
R_mx0_1:
    s_add_u32 s21, s21, 1
    s_cmp_gt_u32 s21, 4096
    s_cbranch_scc1 B_mx0_1
    s_waitcnt lgkmcnt(0)
    s_add_u32 m0, s36, 0
    s_add_u32 s26, s76, 2097152
    buffer_load_dwordx4 v15, s[4:7], s26 offen offset:1024 sc1 lds
    buffer_load_dwordx4 v15, s[4:7], s26 offen offset:2048 sc1 lds
    buffer_load_dwordx4 v15, s[4:7], s26 offen offset:3072 sc1 lds
    s_add_u32 m0, s36, 4096
    s_add_u32 s26, s77, 2097152
    buffer_load_dwordx4 v15, s[4:7], s26 offen offset:0 sc1 lds
    buffer_load_dwordx4 v15, s[4:7], s26 offen offset:1024 sc1 lds
    buffer_load_dwordx4 v15, s[4:7], s26 offen offset:2048 sc1 lds
    buffer_load_dwordx4 v15, s[4:7], s26 offen offset:3072 sc1 lds
    s_waitcnt vmcnt(0)
    ds_read_b64_tr_b16 v[20:21], v6 offset:1024
    ds_read_b64_tr_b16 v[22:23], v6 offset:1536
    ds_read_b64_tr_b16 v[24:25], v6 offset:2048
    ds_read_b64_tr_b16 v[26:27], v6 offset:2560
    s_waitcnt lgkmcnt(0)
    v_max3_u32 v14, v20, v21, v22
    v_max_u32 v14, v14, v23
    v_cmp_eq_u32 vcc, -1, v14
    s_cbranch_vccnz R_mx0_1
    s_branch B_mx0_1
R_mx0_2:
    s_add_u32 s21, s21, 1
    s_cmp_gt_u32 s21, 4096
    s_cbranch_scc1 B_mx0_2
    s_waitcnt lgkmcnt(0)
    s_add_u32 m0, s36, 0
    s_add_u32 s26, s76, 2097152
    buffer_load_dwordx4 v15, s[4:7], s26 offen offset:2048 sc1 lds
    buffer_load_dwordx4 v15, s[4:7], s26 offen offset:3072 sc1 lds
    s_add_u32 m0, s36, 4096
    s_add_u32 s26, s77, 2097152
    buffer_load_dwordx4 v15, s[4:7], s26 offen offset:0 sc1 lds
    buffer_load_dwordx4 v15, s[4:7], s26 offen offset:1024 sc1 lds
    buffer_load_dwordx4 v15, s[4:7], s26 offen offset:2048 sc1 lds
    buffer_load_dwordx4 v15, s[4:7], s26 offen offset:3072 sc1 lds
    s_add_u32 m0, s36, 0
    s_add_u32 s26, s78, 2097152
    buffer_load_dwordx4 v15, s[4:7], s26 offen offset:0 sc1 lds
    s_waitcnt vmcnt(0)
    ds_read_b64_tr_b16 v[24:25], v6 offset:2048
    ds_read_b64_tr_b16 v[26:27], v6 offset:2560
    ds_read_b64_tr_b16 v[28:29], v6 offset:3072
    ds_read_b64_tr_b16 v[30:31], v6 offset:3584
    s_waitcnt lgkmcnt(0)
    v_max3_u32 v14, v24, v25, v26
    v_max_u32 v14, v14, v27
    v_cmp_eq_u32 vcc, -1, v14
    s_cbranch_vccnz R_mx0_2
    s_branch B_mx0_2
R_mx0_3:
    s_add_u32 s21, s21, 1
    s_cmp_gt_u32 s21, 4096
    s_cbranch_scc1 B_mx0_3
    s_waitcnt lgkmcnt(0)
    s_add_u32 m0, s36, 0
    s_add_u32 s26, s76, 2097152
    buffer_load_dwordx4 v15, s[4:7], s26 offen offset:3072 sc1 lds
    s_add_u32 m0, s36, 4096
    s_add_u32 s26, s77, 2097152
    buffer_load_dwordx4 v15, s[4:7], s26 offen offset:0 sc1 lds
    buffer_load_dwordx4 v15, s[4:7], s26 offen offset:1024 sc1 lds
    buffer_load_dwordx4 v15, s[4:7], s26 offen offset:2048 sc1 lds
    buffer_load_dwordx4 v15, s[4:7], s26 offen offset:3072 sc1 lds
    s_add_u32 m0, s36, 0
    s_add_u32 s26, s78, 2097152
    buffer_load_dwordx4 v15, s[4:7], s26 offen offset:0 sc1 lds
    buffer_load_dwordx4 v15, s[4:7], s26 offen offset:1024 sc1 lds
    s_waitcnt vmcnt(0)
    ds_read_b64_tr_b16 v[28:29], v6 offset:3072
    ds_read_b64_tr_b16 v[30:31], v6 offset:3584
    ds_read_b64_tr_b16 v[32:33], v6 offset:4096
    ds_read_b64_tr_b16 v[34:35], v6 offset:4608
    s_waitcnt lgkmcnt(0)
    v_max3_u32 v14, v28, v29, v30
    v_max_u32 v14, v14, v31
    v_cmp_eq_u32 vcc, -1, v14
    s_cbranch_vccnz R_mx0_3
    s_branch B_mx0_3
R_mf2:
    s_add_u32 s21, s21, 1
    s_cmp_gt_u32 s21, 4096
    s_cbranch_scc1 B_mf2
    s_sleep 4
    s_mul_i32 s30, s16, 14
    v_and_b32 v10, 48, v1
    s_and_b32 s30, s30, 60
    v_lshlrev_b32 v10, 2, v10
    s_lshl3_add_u32 s31, s18, 1912832
    v_add3_u32 v10, v10, v1, s30
    v_min_u32 v10, 56, v10
    v_lshlrev_b32 v10, 6, v10
    buffer_load_dwordx2 v[10:11], v10, s[4:7], s31 offen sc1
    s_waitcnt vmcnt(0) lgkmcnt(0)
    v_max_u32 v10, v10, v11
    v_cmp_eq_u32 vcc, -1, v10
    s_cbranch_vccnz R_mf2
    s_branch B_mf2
R_mx0_4:
    s_add_u32 s21, s21, 1
    s_cmp_gt_u32 s21, 4096
    s_cbranch_scc1 B_mx0_4
    s_waitcnt lgkmcnt(0)
    s_add_u32 m0, s36, 4096
    s_add_u32 s26, s77, 2097152
    buffer_load_dwordx4 v15, s[4:7], s26 offen offset:0 sc1 lds
    buffer_load_dwordx4 v15, s[4:7], s26 offen offset:1024 sc1 lds
    buffer_load_dwordx4 v15, s[4:7], s26 offen offset:2048 sc1 lds
    buffer_load_dwordx4 v15, s[4:7], s26 offen offset:3072 sc1 lds
    s_add_u32 m0, s36, 0
    s_add_u32 s26, s78, 2097152
    buffer_load_dwordx4 v15, s[4:7], s26 offen offset:0 sc1 lds
    buffer_load_dwordx4 v15, s[4:7], s26 offen offset:1024 sc1 lds
    buffer_load_dwordx4 v15, s[4:7], s26 offen offset:2048 sc1 lds
    s_waitcnt vmcnt(0)
    ds_read_b64_tr_b16 v[32:33], v6 offset:4096
    ds_read_b64_tr_b16 v[34:35], v6 offset:4608
    ds_read_b64_tr_b16 v[36:37], v6 offset:5120
    ds_read_b64_tr_b16 v[38:39], v6 offset:5632
    s_waitcnt lgkmcnt(0)
    v_max3_u32 v14, v32, v33, v34
    v_max_u32 v14, v14, v35
    v_cmp_eq_u32 vcc, -1, v14
    s_cbranch_vccnz R_mx0_4
    s_branch B_mx0_4
R_mx0_5:
    s_add_u32 s21, s21, 1
    s_cmp_gt_u32 s21, 4096
    s_cbranch_scc1 B_mx0_5
    s_waitcnt lgkmcnt(0)
    s_add_u32 m0, s36, 4096
    s_add_u32 s26, s77, 2097152
    buffer_load_dwordx4 v15, s[4:7], s26 offen offset:1024 sc1 lds
    buffer_load_dwordx4 v15, s[4:7], s26 offen offset:2048 sc1 lds
    buffer_load_dwordx4 v15, s[4:7], s26 offen offset:3072 sc1 lds
    s_add_u32 m0, s36, 0
    s_add_u32 s26, s78, 2097152
    buffer_load_dwordx4 v15, s[4:7], s26 offen offset:0 sc1 lds
    buffer_load_dwordx4 v15, s[4:7], s26 offen offset:1024 sc1 lds
    buffer_load_dwordx4 v15, s[4:7], s26 offen offset:2048 sc1 lds
    buffer_load_dwordx4 v15, s[4:7], s26 offen offset:3072 sc1 lds
    s_waitcnt vmcnt(0)
    ds_read_b64_tr_b16 v[36:37], v6 offset:5120
    ds_read_b64_tr_b16 v[38:39], v6 offset:5632
    ds_read_b64_tr_b16 v[40:41], v6 offset:6144
    ds_read_b64_tr_b16 v[42:43], v6 offset:6656
    s_waitcnt lgkmcnt(0)
    v_max3_u32 v14, v36, v37, v38
    v_max_u32 v14, v14, v39
    v_cmp_eq_u32 vcc, -1, v14
    s_cbranch_vccnz R_mx0_5
    s_branch B_mx0_5
R_mx0_6:
    s_add_u32 s21, s21, 1
    s_cmp_gt_u32 s21, 4096
    s_cbranch_scc1 B_mx0_6
    s_waitcnt lgkmcnt(0)
    s_add_u32 m0, s36, 4096
    s_add_u32 s26, s77, 2097152
    buffer_load_dwordx4 v15, s[4:7], s26 offen offset:2048 sc1 lds
    buffer_load_dwordx4 v15, s[4:7], s26 offen offset:3072 sc1 lds
    s_add_u32 m0, s36, 0
    s_add_u32 s26, s78, 2097152
    buffer_load_dwordx4 v15, s[4:7], s26 offen offset:0 sc1 lds
    buffer_load_dwordx4 v15, s[4:7], s26 offen offset:1024 sc1 lds
    buffer_load_dwordx4 v15, s[4:7], s26 offen offset:2048 sc1 lds
    buffer_load_dwordx4 v15, s[4:7], s26 offen offset:3072 sc1 lds
    s_add_u32 m0, s36, 4096
    s_add_u32 s26, s79, 2097152
    buffer_load_dwordx4 v15, s[4:7], s26 offen offset:0 sc1 lds
    s_waitcnt vmcnt(0)
    ds_read_b64_tr_b16 v[40:41], v6 offset:6144
    ds_read_b64_tr_b16 v[42:43], v6 offset:6656
    ds_read_b64_tr_b16 v[44:45], v6 offset:7168
    ds_read_b64_tr_b16 v[46:47], v6 offset:7680
    s_waitcnt lgkmcnt(0)
    v_max3_u32 v14, v40, v41, v42
    v_max_u32 v14, v14, v43
    v_cmp_eq_u32 vcc, -1, v14
    s_cbranch_vccnz R_mx0_6
    s_branch B_mx0_6
R_mx0_7:
    s_add_u32 s21, s21, 1
    s_cmp_gt_u32 s21, 4096
    s_cbranch_scc1 B_mx0_7
    s_waitcnt lgkmcnt(0)
    s_add_u32 m0, s36, 4096
    s_add_u32 s26, s77, 2097152
    buffer_load_dwordx4 v15, s[4:7], s26 offen offset:3072 sc1 lds
    s_add_u32 m0, s36, 0
    s_add_u32 s26, s78, 2097152
    buffer_load_dwordx4 v15, s[4:7], s26 offen offset:0 sc1 lds
    buffer_load_dwordx4 v15, s[4:7], s26 offen offset:1024 sc1 lds
    buffer_load_dwordx4 v15, s[4:7], s26 offen offset:2048 sc1 lds
    buffer_load_dwordx4 v15, s[4:7], s26 offen offset:3072 sc1 lds
    s_add_u32 m0, s36, 4096
    s_add_u32 s26, s79, 2097152
    buffer_load_dwordx4 v15, s[4:7], s26 offen offset:0 sc1 lds
    buffer_load_dwordx4 v15, s[4:7], s26 offen offset:1024 sc1 lds
    s_waitcnt vmcnt(0)
    ds_read_b64_tr_b16 v[44:45], v6 offset:7168
    ds_read_b64_tr_b16 v[46:47], v6 offset:7680
    ds_read_b64_tr_b16 v[48:49], v6 offset:0
    ds_read_b64_tr_b16 v[50:51], v6 offset:512
    s_waitcnt lgkmcnt(0)
    v_max3_u32 v14, v44, v45, v46
    v_max_u32 v14, v14, v47
    v_cmp_eq_u32 vcc, -1, v14
    s_cbranch_vccnz R_mx0_7
    s_branch B_mx0_7
R_mx0_8:
    s_add_u32 s21, s21, 1
    s_cmp_gt_u32 s21, 4096
    s_cbranch_scc1 B_mx0_8
    s_waitcnt lgkmcnt(0)
    s_add_u32 m0, s36, 0
    s_add_u32 s26, s78, 2097152
    buffer_load_dwordx4 v15, s[4:7], s26 offen offset:0 sc1 lds
    buffer_load_dwordx4 v15, s[4:7], s26 offen offset:1024 sc1 lds
    buffer_load_dwordx4 v15, s[4:7], s26 offen offset:2048 sc1 lds
    buffer_load_dwordx4 v15, s[4:7], s26 offen offset:3072 sc1 lds
    s_add_u32 m0, s36, 4096
    s_add_u32 s26, s79, 2097152
    buffer_load_dwordx4 v15, s[4:7], s26 offen offset:0 sc1 lds
    buffer_load_dwordx4 v15, s[4:7], s26 offen offset:1024 sc1 lds
    buffer_load_dwordx4 v15, s[4:7], s26 offen offset:2048 sc1 lds
    s_waitcnt vmcnt(0)
    ds_read_b64_tr_b16 v[48:49], v6 offset:0
    ds_read_b64_tr_b16 v[50:51], v6 offset:512
    ds_read_b64_tr_b16 v[52:53], v6 offset:1024
    ds_read_b64_tr_b16 v[54:55], v6 offset:1536
    s_waitcnt lgkmcnt(0)
    v_max3_u32 v14, v48, v49, v50
    v_max_u32 v14, v14, v51
    v_cmp_eq_u32 vcc, -1, v14
    s_cbranch_vccnz R_mx0_8
    s_branch B_mx0_8
R_mx0_9:
    s_add_u32 s21, s21, 1
    s_cmp_gt_u32 s21, 4096
    s_cbranch_scc1 B_mx0_9
    s_waitcnt lgkmcnt(0)
    s_add_u32 m0, s36, 0
    s_add_u32 s26, s78, 2097152
    buffer_load_dwordx4 v15, s[4:7], s26 offen offset:1024 sc1 lds
    buffer_load_dwordx4 v15, s[4:7], s26 offen offset:2048 sc1 lds
    buffer_load_dwordx4 v15, s[4:7], s26 offen offset:3072 sc1 lds
    s_add_u32 m0, s36, 4096
    s_add_u32 s26, s79, 2097152
    buffer_load_dwordx4 v15, s[4:7], s26 offen offset:0 sc1 lds
    buffer_load_dwordx4 v15, s[4:7], s26 offen offset:1024 sc1 lds
    buffer_load_dwordx4 v15, s[4:7], s26 offen offset:2048 sc1 lds
    buffer_load_dwordx4 v15, s[4:7], s26 offen offset:3072 sc1 lds
    s_waitcnt vmcnt(0)
    ds_read_b64_tr_b16 v[52:53], v6 offset:1024
    ds_read_b64_tr_b16 v[54:55], v6 offset:1536
    ds_read_b64_tr_b16 v[56:57], v6 offset:2048
    ds_read_b64_tr_b16 v[58:59], v6 offset:2560
    s_waitcnt lgkmcnt(0)
    v_max3_u32 v14, v52, v53, v54
    v_max_u32 v14, v14, v55
    v_cmp_eq_u32 vcc, -1, v14
    s_cbranch_vccnz R_mx0_9
    s_branch B_mx0_9
R_mx0_10:
    s_add_u32 s21, s21, 1
    s_cmp_gt_u32 s21, 4096
    s_cbranch_scc1 B_mx0_10
    s_waitcnt lgkmcnt(0)
    s_add_u32 m0, s36, 0
    s_add_u32 s26, s78, 2097152
    buffer_load_dwordx4 v15, s[4:7], s26 offen offset:2048 sc1 lds
    buffer_load_dwordx4 v15, s[4:7], s26 offen offset:3072 sc1 lds
    s_add_u32 m0, s36, 4096
    s_add_u32 s26, s79, 2097152
    buffer_load_dwordx4 v15, s[4:7], s26 offen offset:0 sc1 lds
    buffer_load_dwordx4 v15, s[4:7], s26 offen offset:1024 sc1 lds
    buffer_load_dwordx4 v15, s[4:7], s26 offen offset:2048 sc1 lds
    buffer_load_dwordx4 v15, s[4:7], s26 offen offset:3072 sc1 lds
    s_add_u32 m0, s36, 0
    s_add_u32 s26, s80, 2097152
    buffer_load_dwordx4 v15, s[4:7], s26 offen offset:0 sc1 lds
    s_waitcnt vmcnt(0)
    ds_read_b64_tr_b16 v[56:57], v6 offset:2048
    ds_read_b64_tr_b16 v[58:59], v6 offset:2560
    ds_read_b64_tr_b16 v[60:61], v6 offset:3072
    ds_read_b64_tr_b16 v[62:63], v6 offset:3584
    s_waitcnt lgkmcnt(0)
    v_max3_u32 v14, v56, v57, v58
    v_max_u32 v14, v14, v59
    v_cmp_eq_u32 vcc, -1, v14
    s_cbranch_vccnz R_mx0_10
    s_branch B_mx0_10
R_mx0_11:
    s_add_u32 s21, s21, 1
    s_cmp_gt_u32 s21, 4096
    s_cbranch_scc1 B_mx0_11
    s_waitcnt lgkmcnt(0)
    s_add_u32 m0, s36, 0
    s_add_u32 s26, s78, 2097152
    buffer_load_dwordx4 v15, s[4:7], s26 offen offset:3072 sc1 lds
    s_add_u32 m0, s36, 4096
    s_add_u32 s26, s79, 2097152
    buffer_load_dwordx4 v15, s[4:7], s26 offen offset:0 sc1 lds
    buffer_load_dwordx4 v15, s[4:7], s26 offen offset:1024 sc1 lds
    buffer_load_dwordx4 v15, s[4:7], s26 offen offset:2048 sc1 lds
    buffer_load_dwordx4 v15, s[4:7], s26 offen offset:3072 sc1 lds
    s_add_u32 m0, s36, 0
    s_add_u32 s26, s80, 2097152
    buffer_load_dwordx4 v15, s[4:7], s26 offen offset:0 sc1 lds
    buffer_load_dwordx4 v15, s[4:7], s26 offen offset:1024 sc1 lds
    s_waitcnt vmcnt(0)
    ds_read_b64_tr_b16 v[60:61], v6 offset:3072
    ds_read_b64_tr_b16 v[62:63], v6 offset:3584
    ds_read_b64_tr_b16 v[64:65], v6 offset:4096
    ds_read_b64_tr_b16 v[66:67], v6 offset:4608
    s_waitcnt lgkmcnt(0)
    v_max3_u32 v14, v60, v61, v62
    v_max_u32 v14, v14, v63
    v_cmp_eq_u32 vcc, -1, v14
    s_cbranch_vccnz R_mx0_11
    s_branch B_mx0_11
R_mx0_12:
    s_add_u32 s21, s21, 1
    s_cmp_gt_u32 s21, 4096
    s_cbranch_scc1 B_mx0_12
    s_waitcnt lgkmcnt(0)
    s_add_u32 m0, s36, 4096
    s_add_u32 s26, s79, 2097152
    buffer_load_dwordx4 v15, s[4:7], s26 offen offset:0 sc1 lds
    buffer_load_dwordx4 v15, s[4:7], s26 offen offset:1024 sc1 lds
    buffer_load_dwordx4 v15, s[4:7], s26 offen offset:2048 sc1 lds
    buffer_load_dwordx4 v15, s[4:7], s26 offen offset:3072 sc1 lds
    s_add_u32 m0, s36, 0
    s_add_u32 s26, s80, 2097152
    buffer_load_dwordx4 v15, s[4:7], s26 offen offset:0 sc1 lds
    buffer_load_dwordx4 v15, s[4:7], s26 offen offset:1024 sc1 lds
    buffer_load_dwordx4 v15, s[4:7], s26 offen offset:2048 sc1 lds
    s_waitcnt vmcnt(0)
    ds_read_b64_tr_b16 v[64:65], v6 offset:4096
    ds_read_b64_tr_b16 v[66:67], v6 offset:4608
    ds_read_b64_tr_b16 v[68:69], v6 offset:5120
    ds_read_b64_tr_b16 v[70:71], v6 offset:5632
    s_waitcnt lgkmcnt(0)
    v_max3_u32 v14, v64, v65, v66
    v_max_u32 v14, v14, v67
    v_cmp_eq_u32 vcc, -1, v14
    s_cbranch_vccnz R_mx0_12
    s_branch B_mx0_12
R_mx0_13:
    s_add_u32 s21, s21, 1
    s_cmp_gt_u32 s21, 4096
    s_cbranch_scc1 B_mx0_13
    s_waitcnt lgkmcnt(0)
    s_add_u32 m0, s36, 4096
    s_add_u32 s26, s79, 2097152
    buffer_load_dwordx4 v15, s[4:7], s26 offen offset:1024 sc1 lds
    buffer_load_dwordx4 v15, s[4:7], s26 offen offset:2048 sc1 lds
    buffer_load_dwordx4 v15, s[4:7], s26 offen offset:3072 sc1 lds
    s_add_u32 m0, s36, 0
    s_add_u32 s26, s80, 2097152
    buffer_load_dwordx4 v15, s[4:7], s26 offen offset:0 sc1 lds
    buffer_load_dwordx4 v15, s[4:7], s26 offen offset:1024 sc1 lds
    buffer_load_dwordx4 v15, s[4:7], s26 offen offset:2048 sc1 lds
    buffer_load_dwordx4 v15, s[4:7], s26 offen offset:3072 sc1 lds
    s_waitcnt vmcnt(0)
    ds_read_b64_tr_b16 v[68:69], v6 offset:5120
    ds_read_b64_tr_b16 v[70:71], v6 offset:5632
    ds_read_b64_tr_b16 v[72:73], v6 offset:6144
    ds_read_b64_tr_b16 v[74:75], v6 offset:6656
    s_waitcnt lgkmcnt(0)
    v_max3_u32 v14, v68, v69, v70
    v_max_u32 v14, v14, v71
    v_cmp_eq_u32 vcc, -1, v14
    s_cbranch_vccnz R_mx0_13
    s_branch B_mx0_13
R_mx0_14:
    s_add_u32 s21, s21, 1
    s_cmp_gt_u32 s21, 4096
    s_cbranch_scc1 B_mx0_14
    s_waitcnt lgkmcnt(0)
    s_add_u32 m0, s36, 4096
    s_add_u32 s26, s79, 2097152
    buffer_load_dwordx4 v15, s[4:7], s26 offen offset:2048 sc1 lds
    buffer_load_dwordx4 v15, s[4:7], s26 offen offset:3072 sc1 lds
    s_add_u32 m0, s36, 0
    s_add_u32 s26, s80, 2097152
    buffer_load_dwordx4 v15, s[4:7], s26 offen offset:0 sc1 lds
    buffer_load_dwordx4 v15, s[4:7], s26 offen offset:1024 sc1 lds
    buffer_load_dwordx4 v15, s[4:7], s26 offen offset:2048 sc1 lds
    buffer_load_dwordx4 v15, s[4:7], s26 offen offset:3072 sc1 lds
    s_add_u32 m0, s36, 4096
    s_add_u32 s26, s81, 2097152
    buffer_load_dwordx4 v15, s[4:7], s26 offen offset:0 sc1 lds
    s_waitcnt vmcnt(0)
    ds_read_b64_tr_b16 v[72:73], v6 offset:6144
    ds_read_b64_tr_b16 v[74:75], v6 offset:6656
    ds_read_b64_tr_b16 v[76:77], v6 offset:7168
    ds_read_b64_tr_b16 v[78:79], v6 offset:7680
    s_waitcnt lgkmcnt(0)
    v_max3_u32 v14, v72, v73, v74
    v_max_u32 v14, v14, v75
    v_cmp_eq_u32 vcc, -1, v14
    s_cbranch_vccnz R_mx0_14
    s_branch B_mx0_14
R_mx0_15:
    s_add_u32 s21, s21, 1
    s_cmp_gt_u32 s21, 4096
    s_cbranch_scc1 B_mx0_15
    s_waitcnt lgkmcnt(0)
    s_add_u32 m0, s36, 4096
    s_add_u32 s26, s79, 2097152
    buffer_load_dwordx4 v15, s[4:7], s26 offen offset:3072 sc1 lds
    s_add_u32 m0, s36, 0
    s_add_u32 s26, s80, 2097152
    buffer_load_dwordx4 v15, s[4:7], s26 offen offset:0 sc1 lds
    buffer_load_dwordx4 v15, s[4:7], s26 offen offset:1024 sc1 lds
    buffer_load_dwordx4 v15, s[4:7], s26 offen offset:2048 sc1 lds
    buffer_load_dwordx4 v15, s[4:7], s26 offen offset:3072 sc1 lds
    s_add_u32 m0, s36, 4096
    s_add_u32 s26, s81, 2097152
    buffer_load_dwordx4 v15, s[4:7], s26 offen offset:0 sc1 lds
    buffer_load_dwordx4 v15, s[4:7], s26 offen offset:1024 sc1 lds
    s_waitcnt vmcnt(0)
    ds_read_b64_tr_b16 v[76:77], v6 offset:7168
    ds_read_b64_tr_b16 v[78:79], v6 offset:7680
    ds_read_b64_tr_b16 v[80:81], v6 offset:0
    ds_read_b64_tr_b16 v[82:83], v6 offset:512
    s_waitcnt lgkmcnt(0)
    v_max3_u32 v14, v76, v77, v78
    v_max_u32 v14, v14, v79
    v_cmp_eq_u32 vcc, -1, v14
    s_cbranch_vccnz R_mx0_15
    s_branch B_mx0_15
R_mx0_16:
    s_add_u32 s21, s21, 1
    s_cmp_gt_u32 s21, 4096
    s_cbranch_scc1 B_mx0_16
    s_waitcnt lgkmcnt(0)
    s_add_u32 m0, s36, 0
    s_add_u32 s26, s80, 2097152
    buffer_load_dwordx4 v15, s[4:7], s26 offen offset:0 sc1 lds
    buffer_load_dwordx4 v15, s[4:7], s26 offen offset:1024 sc1 lds
    buffer_load_dwordx4 v15, s[4:7], s26 offen offset:2048 sc1 lds
    buffer_load_dwordx4 v15, s[4:7], s26 offen offset:3072 sc1 lds
    s_add_u32 m0, s36, 4096
    s_add_u32 s26, s81, 2097152
    buffer_load_dwordx4 v15, s[4:7], s26 offen offset:0 sc1 lds
    buffer_load_dwordx4 v15, s[4:7], s26 offen offset:1024 sc1 lds
    buffer_load_dwordx4 v15, s[4:7], s26 offen offset:2048 sc1 lds
    s_waitcnt vmcnt(0)
    ds_read_b64_tr_b16 v[80:81], v6 offset:0
    ds_read_b64_tr_b16 v[82:83], v6 offset:512
    ds_read_b64_tr_b16 v[84:85], v6 offset:1024
    ds_read_b64_tr_b16 v[86:87], v6 offset:1536
    s_waitcnt lgkmcnt(0)
    v_max3_u32 v14, v80, v81, v82
    v_max_u32 v14, v14, v83
    v_cmp_eq_u32 vcc, -1, v14
    s_cbranch_vccnz R_mx0_16
    s_branch B_mx0_16
R_mx0_17:
    s_add_u32 s21, s21, 1
    s_cmp_gt_u32 s21, 4096
    s_cbranch_scc1 B_mx0_17
    s_waitcnt lgkmcnt(0)
    s_add_u32 m0, s36, 0
    s_add_u32 s26, s80, 2097152
    buffer_load_dwordx4 v15, s[4:7], s26 offen offset:1024 sc1 lds
    buffer_load_dwordx4 v15, s[4:7], s26 offen offset:2048 sc1 lds
    buffer_load_dwordx4 v15, s[4:7], s26 offen offset:3072 sc1 lds
    s_add_u32 m0, s36, 4096
    s_add_u32 s26, s81, 2097152
    buffer_load_dwordx4 v15, s[4:7], s26 offen offset:0 sc1 lds
    buffer_load_dwordx4 v15, s[4:7], s26 offen offset:1024 sc1 lds
    buffer_load_dwordx4 v15, s[4:7], s26 offen offset:2048 sc1 lds
    buffer_load_dwordx4 v15, s[4:7], s26 offen offset:3072 sc1 lds
    s_waitcnt vmcnt(0)
    ds_read_b64_tr_b16 v[84:85], v6 offset:1024
    ds_read_b64_tr_b16 v[86:87], v6 offset:1536
    ds_read_b64_tr_b16 v[88:89], v6 offset:2048
    ds_read_b64_tr_b16 v[90:91], v6 offset:2560
    s_waitcnt lgkmcnt(0)
    v_max3_u32 v14, v84, v85, v86
    v_max_u32 v14, v14, v87
    v_cmp_eq_u32 vcc, -1, v14
    s_cbranch_vccnz R_mx0_17
    s_branch B_mx0_17
R_mx0_18:
    s_add_u32 s21, s21, 1
    s_cmp_gt_u32 s21, 4096
    s_cbranch_scc1 B_mx0_18
    s_waitcnt lgkmcnt(0)
    s_add_u32 m0, s36, 0
    s_add_u32 s26, s80, 2097152
    buffer_load_dwordx4 v15, s[4:7], s26 offen offset:2048 sc1 lds
    buffer_load_dwordx4 v15, s[4:7], s26 offen offset:3072 sc1 lds
    s_add_u32 m0, s36, 4096
    s_add_u32 s26, s81, 2097152
    buffer_load_dwordx4 v15, s[4:7], s26 offen offset:0 sc1 lds
    buffer_load_dwordx4 v15, s[4:7], s26 offen offset:1024 sc1 lds
    buffer_load_dwordx4 v15, s[4:7], s26 offen offset:2048 sc1 lds
    buffer_load_dwordx4 v15, s[4:7], s26 offen offset:3072 sc1 lds
    s_add_u32 m0, s36, 0
    s_add_u32 s26, s82, 2097152
    buffer_load_dwordx4 v15, s[4:7], s26 offen offset:0 sc1 lds
    s_waitcnt vmcnt(0)
    ds_read_b64_tr_b16 v[88:89], v6 offset:2048
    ds_read_b64_tr_b16 v[90:91], v6 offset:2560
    ds_read_b64_tr_b16 v[92:93], v6 offset:3072
    ds_read_b64_tr_b16 v[94:95], v6 offset:3584
    s_waitcnt lgkmcnt(0)
    v_max3_u32 v14, v88, v89, v90
    v_max_u32 v14, v14, v91
    v_cmp_eq_u32 vcc, -1, v14
    s_cbranch_vccnz R_mx0_18
    s_branch B_mx0_18
R_mx0_19:
    s_add_u32 s21, s21, 1
    s_cmp_gt_u32 s21, 4096
    s_cbranch_scc1 B_mx0_19
    s_waitcnt lgkmcnt(0)
    s_add_u32 m0, s36, 0
    s_add_u32 s26, s80, 2097152
    buffer_load_dwordx4 v15, s[4:7], s26 offen offset:3072 sc1 lds
    s_add_u32 m0, s36, 4096
    s_add_u32 s26, s81, 2097152
    buffer_load_dwordx4 v15, s[4:7], s26 offen offset:0 sc1 lds
    buffer_load_dwordx4 v15, s[4:7], s26 offen offset:1024 sc1 lds
    buffer_load_dwordx4 v15, s[4:7], s26 offen offset:2048 sc1 lds
    buffer_load_dwordx4 v15, s[4:7], s26 offen offset:3072 sc1 lds
    s_add_u32 m0, s36, 0
    s_add_u32 s26, s82, 2097152
    buffer_load_dwordx4 v15, s[4:7], s26 offen offset:0 sc1 lds
    buffer_load_dwordx4 v15, s[4:7], s26 offen offset:1024 sc1 lds
    s_waitcnt vmcnt(0)
    ds_read_b64_tr_b16 v[92:93], v6 offset:3072
    ds_read_b64_tr_b16 v[94:95], v6 offset:3584
    ds_read_b64_tr_b16 v[96:97], v6 offset:4096
    ds_read_b64_tr_b16 v[98:99], v6 offset:4608
    s_waitcnt lgkmcnt(0)
    v_max3_u32 v14, v92, v93, v94
    v_max_u32 v14, v14, v95
    v_cmp_eq_u32 vcc, -1, v14
    s_cbranch_vccnz R_mx0_19
    s_branch B_mx0_19
R_mx0_20:
    s_add_u32 s21, s21, 1
    s_cmp_gt_u32 s21, 4096
    s_cbranch_scc1 B_mx0_20
    s_waitcnt lgkmcnt(0)
    s_add_u32 m0, s36, 4096
    s_add_u32 s26, s81, 2097152
    buffer_load_dwordx4 v15, s[4:7], s26 offen offset:0 sc1 lds
    buffer_load_dwordx4 v15, s[4:7], s26 offen offset:1024 sc1 lds
    buffer_load_dwordx4 v15, s[4:7], s26 offen offset:2048 sc1 lds
    buffer_load_dwordx4 v15, s[4:7], s26 offen offset:3072 sc1 lds
    s_add_u32 m0, s36, 0
    s_add_u32 s26, s82, 2097152
    buffer_load_dwordx4 v15, s[4:7], s26 offen offset:0 sc1 lds
    buffer_load_dwordx4 v15, s[4:7], s26 offen offset:1024 sc1 lds
    buffer_load_dwordx4 v15, s[4:7], s26 offen offset:2048 sc1 lds
    s_waitcnt vmcnt(0)
    ds_read_b64_tr_b16 v[96:97], v6 offset:4096
    ds_read_b64_tr_b16 v[98:99], v6 offset:4608
    ds_read_b64_tr_b16 v[100:101], v6 offset:5120
    ds_read_b64_tr_b16 v[102:103], v6 offset:5632
    s_waitcnt lgkmcnt(0)
    v_max3_u32 v14, v96, v97, v98
    v_max_u32 v14, v14, v99
    v_cmp_eq_u32 vcc, -1, v14
    s_cbranch_vccnz R_mx0_20
    s_branch B_mx0_20
R_mx0_21:
    s_add_u32 s21, s21, 1
    s_cmp_gt_u32 s21, 4096
    s_cbranch_scc1 B_mx0_21
    s_waitcnt lgkmcnt(0)
    s_add_u32 m0, s36, 4096
    s_add_u32 s26, s81, 2097152
    buffer_load_dwordx4 v15, s[4:7], s26 offen offset:1024 sc1 lds
    buffer_load_dwordx4 v15, s[4:7], s26 offen offset:2048 sc1 lds
    buffer_load_dwordx4 v15, s[4:7], s26 offen offset:3072 sc1 lds
    s_add_u32 m0, s36, 0
    s_add_u32 s26, s82, 2097152
    buffer_load_dwordx4 v15, s[4:7], s26 offen offset:0 sc1 lds
    buffer_load_dwordx4 v15, s[4:7], s26 offen offset:1024 sc1 lds
    buffer_load_dwordx4 v15, s[4:7], s26 offen offset:2048 sc1 lds
    buffer_load_dwordx4 v15, s[4:7], s26 offen offset:3072 sc1 lds
    s_waitcnt vmcnt(0)
    ds_read_b64_tr_b16 v[100:101], v6 offset:5120
    ds_read_b64_tr_b16 v[102:103], v6 offset:5632
    ds_read_b64_tr_b16 v[104:105], v6 offset:6144
    ds_read_b64_tr_b16 v[106:107], v6 offset:6656
    s_waitcnt lgkmcnt(0)
    v_max3_u32 v14, v100, v101, v102
    v_max_u32 v14, v14, v103
    v_cmp_eq_u32 vcc, -1, v14
    s_cbranch_vccnz R_mx0_21
    s_branch B_mx0_21
R_mx0_22:
    s_add_u32 s21, s21, 1
    s_cmp_gt_u32 s21, 4096
    s_cbranch_scc1 B_mx0_22
    s_waitcnt lgkmcnt(0)
    s_add_u32 m0, s36, 4096
    s_add_u32 s26, s81, 2097152
    buffer_load_dwordx4 v15, s[4:7], s26 offen offset:2048 sc1 lds
    buffer_load_dwordx4 v15, s[4:7], s26 offen offset:3072 sc1 lds
    s_add_u32 m0, s36, 0
    s_add_u32 s26, s82, 2097152
    buffer_load_dwordx4 v15, s[4:7], s26 offen offset:0 sc1 lds
    buffer_load_dwordx4 v15, s[4:7], s26 offen offset:1024 sc1 lds
    buffer_load_dwordx4 v15, s[4:7], s26 offen offset:2048 sc1 lds
    buffer_load_dwordx4 v15, s[4:7], s26 offen offset:3072 sc1 lds
    s_waitcnt vmcnt(0)
    ds_read_b64_tr_b16 v[104:105], v6 offset:6144
    ds_read_b64_tr_b16 v[106:107], v6 offset:6656
    ds_read_b64_tr_b16 v[108:109], v6 offset:7168
    ds_read_b64_tr_b16 v[110:111], v6 offset:7680
    s_waitcnt lgkmcnt(0)
    v_max3_u32 v14, v104, v105, v106
    v_max_u32 v14, v14, v107
    v_cmp_eq_u32 vcc, -1, v14
    s_cbranch_vccnz R_mx0_22
    s_branch B_mx0_22
R_mx0_23:
    s_add_u32 s21, s21, 1
    s_cmp_gt_u32 s21, 4096
    s_cbranch_scc1 B_mx0_23
    s_waitcnt lgkmcnt(0)
    s_add_u32 m0, s36, 4096
    s_add_u32 s26, s81, 2097152
    buffer_load_dwordx4 v15, s[4:7], s26 offen offset:3072 sc1 lds
    s_add_u32 m0, s36, 0
    s_add_u32 s26, s82, 2097152
    buffer_load_dwordx4 v15, s[4:7], s26 offen offset:0 sc1 lds
    buffer_load_dwordx4 v15, s[4:7], s26 offen offset:1024 sc1 lds
    buffer_load_dwordx4 v15, s[4:7], s26 offen offset:2048 sc1 lds
    buffer_load_dwordx4 v15, s[4:7], s26 offen offset:3072 sc1 lds
    s_waitcnt vmcnt(0)
    ds_read_b64_tr_b16 v[108:109], v6 offset:7168
    ds_read_b64_tr_b16 v[110:111], v6 offset:7680
    ds_read_b64_tr_b16 v[112:113], v6 offset:0
    ds_read_b64_tr_b16 v[114:115], v6 offset:512
    s_waitcnt lgkmcnt(0)
    v_max3_u32 v14, v108, v109, v110
    v_max_u32 v14, v14, v111
    v_cmp_eq_u32 vcc, -1, v14
    s_cbranch_vccnz R_mx0_23
    s_branch B_mx0_23
R_mx0_24:
    s_add_u32 s21, s21, 1
    s_cmp_gt_u32 s21, 4096
    s_cbranch_scc1 B_mx0_24
    s_waitcnt lgkmcnt(0)
    s_add_u32 m0, s36, 0
    s_add_u32 s26, s82, 2097152
    buffer_load_dwordx4 v15, s[4:7], s26 offen offset:0 sc1 lds
    buffer_load_dwordx4 v15, s[4:7], s26 offen offset:1024 sc1 lds
    buffer_load_dwordx4 v15, s[4:7], s26 offen offset:2048 sc1 lds
    buffer_load_dwordx4 v15, s[4:7], s26 offen offset:3072 sc1 lds
    s_waitcnt vmcnt(0)
    ds_read_b64_tr_b16 v[112:113], v6 offset:0
    ds_read_b64_tr_b16 v[114:115], v6 offset:512
    ds_read_b64_tr_b16 v[116:117], v6 offset:1024
    ds_read_b64_tr_b16 v[118:119], v6 offset:1536
    s_waitcnt lgkmcnt(0)
    v_max3_u32 v14, v112, v113, v114
    v_max_u32 v14, v14, v115
    v_cmp_eq_u32 vcc, -1, v14
    s_cbranch_vccnz R_mx0_24
    s_branch B_mx0_24
R_mx0_25:
    s_add_u32 s21, s21, 1
    s_cmp_gt_u32 s21, 4096
    s_cbranch_scc1 B_mx0_25
    s_waitcnt lgkmcnt(0)
    s_add_u32 m0, s36, 0
    s_add_u32 s26, s82, 2097152
    buffer_load_dwordx4 v15, s[4:7], s26 offen offset:1024 sc1 lds
    buffer_load_dwordx4 v15, s[4:7], s26 offen offset:2048 sc1 lds
    buffer_load_dwordx4 v15, s[4:7], s26 offen offset:3072 sc1 lds
    s_waitcnt vmcnt(0)
    ds_read_b64_tr_b16 v[116:117], v6 offset:1024
    ds_read_b64_tr_b16 v[118:119], v6 offset:1536
    ds_read_b64_tr_b16 v[120:121], v6 offset:2048
    ds_read_b64_tr_b16 v[122:123], v6 offset:2560
    s_waitcnt lgkmcnt(0)
    v_max3_u32 v14, v116, v117, v118
    v_max_u32 v14, v14, v119
    v_cmp_eq_u32 vcc, -1, v14
    s_cbranch_vccnz R_mx0_25
    s_branch B_mx0_25
R_mx0_26:
    s_add_u32 s21, s21, 1
    s_cmp_gt_u32 s21, 4096
    s_cbranch_scc1 B_mx0_26
    s_waitcnt lgkmcnt(0)
    s_add_u32 m0, s36, 0
    s_add_u32 s26, s82, 2097152
    buffer_load_dwordx4 v15, s[4:7], s26 offen offset:2048 sc1 lds
    buffer_load_dwordx4 v15, s[4:7], s26 offen offset:3072 sc1 lds
    s_waitcnt vmcnt(0)
    ds_read_b64_tr_b16 v[120:121], v6 offset:2048
    ds_read_b64_tr_b16 v[122:123], v6 offset:2560
    ds_read_b64_tr_b16 v[124:125], v6 offset:3072
    ds_read_b64_tr_b16 v[126:127], v6 offset:3584
    s_waitcnt lgkmcnt(0)
    v_max3_u32 v14, v120, v121, v122
    v_max_u32 v14, v14, v123
    v_cmp_eq_u32 vcc, -1, v14
    s_cbranch_vccnz R_mx0_26
    s_branch B_mx0_26
R_mx0_27:
    s_add_u32 s21, s21, 1
    s_cmp_gt_u32 s21, 4096
    s_cbranch_scc1 B_mx0_27
    s_waitcnt lgkmcnt(0)
    s_add_u32 m0, s36, 0
    s_add_u32 s26, s82, 2097152
    buffer_load_dwordx4 v15, s[4:7], s26 offen offset:3072 sc1 lds
    s_waitcnt vmcnt(0)
    ds_read_b64_tr_b16 v[124:125], v6 offset:3072
    ds_read_b64_tr_b16 v[126:127], v6 offset:3584
    s_waitcnt lgkmcnt(0)
    v_max3_u32 v14, v124, v125, v126
    v_max_u32 v14, v14, v127
    v_cmp_eq_u32 vcc, -1, v14
    s_cbranch_vccnz R_mx0_27
    s_branch B_mx0_27
R_mrs0:
    s_add_u32 s21, s21, 1
    s_cmp_gt_u32 s21, 4096
    s_cbranch_scc1 B_mrs0
    buffer_load_dword v10, v7, s[4:7], s27 offen sc1
    buffer_load_dword v11, v8, s[4:7], s27 offen sc1
    s_waitcnt vmcnt(0)
    v_add_f32 v10, v10, v11
    v_cmp_u_f32 vcc, v10, v10
    s_cbranch_vccnz R_mrs0
    s_branch B_mrs0
R_mh0_0:
    s_add_u32 s21, s21, 1
    s_cmp_gt_u32 s21, 4096
    s_cbranch_scc1 B_mh0_0
    s_add_u32 s26, s83, 10485760
    buffer_load_dwordx4 v[32:35], v12, s[4:7], s26 offen sc1
    buffer_load_dwordx4 v[36:39], v13, s[4:7], s26 offen sc1
    s_add_u32 s26, s84, 10485760
    s_waitcnt vmcnt(17)
    buffer_load_dwordx4 v[40:43], v12, s[4:7], s26 offen sc1
    s_waitcnt vmcnt(17)
    buffer_load_dwordx4 v[44:47], v13, s[4:7], s26 offen sc1
    s_add_u32 s26, s85, 10485760
    s_waitcnt vmcnt(17)
    buffer_load_dwordx4 v[48:51], v12, s[4:7], s26 offen sc1
    s_waitcnt vmcnt(17)
    buffer_load_dwordx4 v[52:55], v13, s[4:7], s26 offen sc1
    s_add_u32 s26, s86, 10485760
    s_waitcnt vmcnt(17)
    buffer_load_dwordx4 v[56:59], v12, s[4:7], s26 offen sc1
    s_waitcnt vmcnt(17)
    buffer_load_dwordx4 v[60:63], v13, s[4:7], s26 offen sc1
    s_add_u32 s26, s87, 10485760
    s_waitcnt vmcnt(16)
    buffer_load_dwordx4 v[64:67], v12, s[4:7], s26 offen sc1
    s_waitcnt vmcnt(16)
    buffer_load_dwordx4 v[68:71], v13, s[4:7], s26 offen sc1
    s_add_u32 s26, s88, 10485760
    s_waitcnt vmcnt(16)
    buffer_load_dwordx4 v[72:75], v12, s[4:7], s26 offen sc1
    s_waitcnt vmcnt(16)
    buffer_load_dwordx4 v[76:79], v13, s[4:7], s26 offen sc1
    s_add_u32 s26, s89, 10485760
    s_waitcnt vmcnt(15)
    buffer_load_dwordx4 v[80:83], v12, s[4:7], s26 offen sc1
    s_waitcnt vmcnt(15)
    buffer_load_dwordx4 v[84:87], v13, s[4:7], s26 offen sc1
    s_add_u32 s26, s83, 10543104
    s_waitcnt vmcnt(15)
    buffer_load_dwordx4 v[88:91], v12, s[4:7], s26 offen sc1
    s_waitcnt vmcnt(15)
    buffer_load_dwordx4 v[92:95], v13, s[4:7], s26 offen sc1
    s_waitcnt vmcnt(0)
    v_max_u32 v14, v35, v39
    v_cmp_eq_u32 vcc, -1, v14
    s_cbranch_vccnz R_mh0_0
    s_branch B_mh0_0
R_mh0_1:
    s_add_u32 s21, s21, 1
    s_cmp_gt_u32 s21, 4096
    s_cbranch_scc1 B_mh0_1
    s_add_u32 s26, s84, 10485760
    buffer_load_dwordx4 v[40:43], v12, s[4:7], s26 offen sc1
    buffer_load_dwordx4 v[44:47], v13, s[4:7], s26 offen sc1
    s_add_u32 s26, s85, 10485760
    s_waitcnt vmcnt(15)
    buffer_load_dwordx4 v[48:51], v12, s[4:7], s26 offen sc1
    s_waitcnt vmcnt(15)
    buffer_load_dwordx4 v[52:55], v13, s[4:7], s26 offen sc1
    s_add_u32 s26, s86, 10485760
    s_waitcnt vmcnt(15)
    buffer_load_dwordx4 v[56:59], v12, s[4:7], s26 offen sc1
    s_waitcnt vmcnt(15)
    buffer_load_dwordx4 v[60:63], v13, s[4:7], s26 offen sc1
    s_add_u32 s26, s87, 10485760
    s_waitcnt vmcnt(14)
    buffer_load_dwordx4 v[64:67], v12, s[4:7], s26 offen sc1
    s_waitcnt vmcnt(14)
    buffer_load_dwordx4 v[68:71], v13, s[4:7], s26 offen sc1
    s_add_u32 s26, s88, 10485760
    s_waitcnt vmcnt(14)
    buffer_load_dwordx4 v[72:75], v12, s[4:7], s26 offen sc1
    s_waitcnt vmcnt(14)
    buffer_load_dwordx4 v[76:79], v13, s[4:7], s26 offen sc1
    s_add_u32 s26, s89, 10485760
    s_waitcnt vmcnt(13)
    buffer_load_dwordx4 v[80:83], v12, s[4:7], s26 offen sc1
    s_waitcnt vmcnt(13)
    buffer_load_dwordx4 v[84:87], v13, s[4:7], s26 offen sc1
    s_add_u32 s26, s83, 10543104
    s_waitcnt vmcnt(13)
    buffer_load_dwordx4 v[88:91], v12, s[4:7], s26 offen sc1
    s_waitcnt vmcnt(13)
    buffer_load_dwordx4 v[92:95], v13, s[4:7], s26 offen sc1
    s_waitcnt vmcnt(0)
    v_max_u32 v14, v43, v47
    v_cmp_eq_u32 vcc, -1, v14
    s_cbranch_vccnz R_mh0_1
    s_branch B_mh0_1
R_mh0_2:
    s_add_u32 s21, s21, 1
    s_cmp_gt_u32 s21, 4096
    s_cbranch_scc1 B_mh0_2
    s_add_u32 s26, s85, 10485760
    buffer_load_dwordx4 v[48:51], v12, s[4:7], s26 offen sc1
    buffer_load_dwordx4 v[52:55], v13, s[4:7], s26 offen sc1
    s_add_u32 s26, s86, 10485760
    s_waitcnt vmcnt(15)
    buffer_load_dwordx4 v[56:59], v12, s[4:7], s26 offen sc1
    s_waitcnt vmcnt(15)
    buffer_load_dwordx4 v[60:63], v13, s[4:7], s26 offen sc1
    s_add_u32 s26, s87, 10485760
    s_waitcnt vmcnt(14)
    buffer_load_dwordx4 v[64:67], v12, s[4:7], s26 offen sc1
    s_waitcnt vmcnt(14)
    buffer_load_dwordx4 v[68:71], v13, s[4:7], s26 offen sc1
    s_add_u32 s26, s88, 10485760
    s_waitcnt vmcnt(14)
    buffer_load_dwordx4 v[72:75], v12, s[4:7], s26 offen sc1
    s_waitcnt vmcnt(14)
    buffer_load_dwordx4 v[76:79], v13, s[4:7], s26 offen sc1
    s_add_u32 s26, s89, 10485760
    s_waitcnt vmcnt(13)
    buffer_load_dwordx4 v[80:83], v12, s[4:7], s26 offen sc1
    s_waitcnt vmcnt(13)
    buffer_load_dwordx4 v[84:87], v13, s[4:7], s26 offen sc1
    s_add_u32 s26, s83, 10543104
    s_waitcnt vmcnt(13)
    buffer_load_dwordx4 v[88:91], v12, s[4:7], s26 offen sc1
    s_waitcnt vmcnt(13)
    buffer_load_dwordx4 v[92:95], v13, s[4:7], s26 offen sc1
    s_add_u32 s26, s84, 10543104
    s_waitcnt vmcnt(13)
    buffer_load_dwordx4 v[32:35], v12, s[4:7], s26 offen sc1
    s_waitcnt vmcnt(13)
    buffer_load_dwordx4 v[36:39], v13, s[4:7], s26 offen sc1
    s_waitcnt vmcnt(0)
    v_max_u32 v14, v51, v55
    v_cmp_eq_u32 vcc, -1, v14
    s_cbranch_vccnz R_mh0_2
    s_branch B_mh0_2
R_mh0_3:
    s_add_u32 s21, s21, 1
    s_cmp_gt_u32 s21, 4096
    s_cbranch_scc1 B_mh0_3
    s_add_u32 s26, s86, 10485760
    buffer_load_dwordx4 v[56:59], v12, s[4:7], s26 offen sc1
    buffer_load_dwordx4 v[60:63], v13, s[4:7], s26 offen sc1
    s_add_u32 s26, s87, 10485760
    s_waitcnt vmcnt(14)
    buffer_load_dwordx4 v[64:67], v12, s[4:7], s26 offen sc1
    s_waitcnt vmcnt(14)
    buffer_load_dwordx4 v[68:71], v13, s[4:7], s26 offen sc1
    s_add_u32 s26, s88, 10485760
    s_waitcnt vmcnt(14)
    buffer_load_dwordx4 v[72:75], v12, s[4:7], s26 offen sc1
    s_waitcnt vmcnt(14)
    buffer_load_dwordx4 v[76:79], v13, s[4:7], s26 offen sc1
    s_add_u32 s26, s89, 10485760
    s_waitcnt vmcnt(13)
    buffer_load_dwordx4 v[80:83], v12, s[4:7], s26 offen sc1
    s_waitcnt vmcnt(13)
    buffer_load_dwordx4 v[84:87], v13, s[4:7], s26 offen sc1
    s_add_u32 s26, s83, 10543104
    s_waitcnt vmcnt(13)
    buffer_load_dwordx4 v[88:91], v12, s[4:7], s26 offen sc1
    s_waitcnt vmcnt(13)
    buffer_load_dwordx4 v[92:95], v13, s[4:7], s26 offen sc1
    s_add_u32 s26, s84, 10543104
    s_waitcnt vmcnt(13)
    buffer_load_dwordx4 v[32:35], v12, s[4:7], s26 offen sc1
    s_waitcnt vmcnt(13)
    buffer_load_dwordx4 v[36:39], v13, s[4:7], s26 offen sc1
    s_add_u32 s26, s85, 10543104
    s_waitcnt vmcnt(13)
    buffer_load_dwordx4 v[40:43], v12, s[4:7], s26 offen sc1
    s_waitcnt vmcnt(13)
    buffer_load_dwordx4 v[44:47], v13, s[4:7], s26 offen sc1
    s_waitcnt vmcnt(0)
    v_max_u32 v14, v59, v63
    v_cmp_eq_u32 vcc, -1, v14
    s_cbranch_vccnz R_mh0_3
    s_branch B_mh0_3
R_mh0_4:
    s_add_u32 s21, s21, 1
    s_cmp_gt_u32 s21, 4096
    s_cbranch_scc1 B_mh0_4
    s_add_u32 s26, s87, 10485760
    buffer_load_dwordx4 v[64:67], v12, s[4:7], s26 offen sc1
    buffer_load_dwordx4 v[68:71], v13, s[4:7], s26 offen sc1
    s_add_u32 s26, s88, 10485760
    s_waitcnt vmcnt(15)
    buffer_load_dwordx4 v[72:75], v12, s[4:7], s26 offen sc1
    s_waitcnt vmcnt(15)
    buffer_load_dwordx4 v[76:79], v13, s[4:7], s26 offen sc1
    s_add_u32 s26, s89, 10485760
    s_waitcnt vmcnt(14)
    buffer_load_dwordx4 v[80:83], v12, s[4:7], s26 offen sc1
    s_waitcnt vmcnt(14)
    buffer_load_dwordx4 v[84:87], v13, s[4:7], s26 offen sc1
    s_add_u32 s26, s83, 10543104
    s_waitcnt vmcnt(14)
    buffer_load_dwordx4 v[88:91], v12, s[4:7], s26 offen sc1
    s_waitcnt vmcnt(14)
    buffer_load_dwordx4 v[92:95], v13, s[4:7], s26 offen sc1
    s_add_u32 s26, s84, 10543104
    s_waitcnt vmcnt(14)
    buffer_load_dwordx4 v[32:35], v12, s[4:7], s26 offen sc1
    s_waitcnt vmcnt(14)
    buffer_load_dwordx4 v[36:39], v13, s[4:7], s26 offen sc1
    s_add_u32 s26, s85, 10543104
    s_waitcnt vmcnt(14)
    buffer_load_dwordx4 v[40:43], v12, s[4:7], s26 offen sc1
    s_waitcnt vmcnt(14)
    buffer_load_dwordx4 v[44:47], v13, s[4:7], s26 offen sc1
    s_add_u32 s26, s86, 10543104
    s_waitcnt vmcnt(14)
    buffer_load_dwordx4 v[48:51], v12, s[4:7], s26 offen sc1
    s_waitcnt vmcnt(14)
    buffer_load_dwordx4 v[52:55], v13, s[4:7], s26 offen sc1
    s_waitcnt vmcnt(0)
    v_max_u32 v14, v67, v71
    v_cmp_eq_u32 vcc, -1, v14
    s_cbranch_vccnz R_mh0_4
    s_branch B_mh0_4
R_mr0:
    s_add_u32 s21, s21, 1
    s_cmp_gt_u32 s21, 4096
    s_cbranch_scc1 B_mr0
    s_mov_b32 m0, s36
    s_nop 0
    buffer_load_dwordx4 v15, s[4:7], s20 offen offset:0 sc1 lds
    buffer_load_dwordx4 v15, s[4:7], s20 offen offset:1024 sc1 lds
    s_waitcnt vmcnt(0)
    ds_read_b64_tr_b16 v[112:113], v6 offset:0
    ds_read_b64_tr_b16 v[114:115], v6 offset:512
    ds_read_b64_tr_b16 v[116:117], v6 offset:1024
    ds_read_b64_tr_b16 v[118:119], v6 offset:1536
    s_waitcnt lgkmcnt(0)
    v_max3_u32 v5, v112, v113, v114
    v_max3_u32 v5, v5, v115, v116
    v_max3_u32 v5, v5, v117, v118
    v_max_u32 v5, v5, v119
    v_cmp_eq_u32 vcc, -1, v5
    s_cbranch_vccnz R_mr0
    s_branch B_mr0
R_mh0_5:
    s_add_u32 s21, s21, 1
    s_cmp_gt_u32 s21, 4096
    s_cbranch_scc1 B_mh0_5
    s_add_u32 s26, s88, 10485760
    buffer_load_dwordx4 v[72:75], v12, s[4:7], s26 offen sc1
    buffer_load_dwordx4 v[76:79], v13, s[4:7], s26 offen sc1
    s_add_u32 s26, s89, 10485760
    s_waitcnt vmcnt(14)
    buffer_load_dwordx4 v[80:83], v12, s[4:7], s26 offen sc1
    s_waitcnt vmcnt(14)
    buffer_load_dwordx4 v[84:87], v13, s[4:7], s26 offen sc1
    s_add_u32 s26, s83, 10543104
    s_waitcnt vmcnt(14)
    buffer_load_dwordx4 v[88:91], v12, s[4:7], s26 offen sc1
    s_waitcnt vmcnt(14)
    buffer_load_dwordx4 v[92:95], v13, s[4:7], s26 offen sc1
    s_add_u32 s26, s84, 10543104
    s_waitcnt vmcnt(14)
    buffer_load_dwordx4 v[32:35], v12, s[4:7], s26 offen sc1
    s_waitcnt vmcnt(14)
    buffer_load_dwordx4 v[36:39], v13, s[4:7], s26 offen sc1
    s_add_u32 s26, s85, 10543104
    s_waitcnt vmcnt(14)
    buffer_load_dwordx4 v[40:43], v12, s[4:7], s26 offen sc1
    s_waitcnt vmcnt(14)
    buffer_load_dwordx4 v[44:47], v13, s[4:7], s26 offen sc1
    s_add_u32 s26, s86, 10543104
    s_waitcnt vmcnt(14)
    buffer_load_dwordx4 v[48:51], v12, s[4:7], s26 offen sc1
    s_waitcnt vmcnt(14)
    buffer_load_dwordx4 v[52:55], v13, s[4:7], s26 offen sc1
    s_add_u32 s26, s87, 10543104
    s_waitcnt vmcnt(13)
    buffer_load_dwordx4 v[56:59], v12, s[4:7], s26 offen sc1
    s_waitcnt vmcnt(13)
    buffer_load_dwordx4 v[60:63], v13, s[4:7], s26 offen sc1
    s_waitcnt vmcnt(0)
    v_max_u32 v14, v75, v79
    v_cmp_eq_u32 vcc, -1, v14
    s_cbranch_vccnz R_mh0_5
    s_branch B_mh0_5
R_mh0_6:
    s_add_u32 s21, s21, 1
    s_cmp_gt_u32 s21, 4096
    s_cbranch_scc1 B_mh0_6
    s_add_u32 s26, s89, 10485760
    buffer_load_dwordx4 v[80:83], v12, s[4:7], s26 offen sc1
    buffer_load_dwordx4 v[84:87], v13, s[4:7], s26 offen sc1
    s_add_u32 s26, s83, 10543104
    s_waitcnt vmcnt(14)
    buffer_load_dwordx4 v[88:91], v12, s[4:7], s26 offen sc1
    s_waitcnt vmcnt(14)
    buffer_load_dwordx4 v[92:95], v13, s[4:7], s26 offen sc1
    s_add_u32 s26, s84, 10543104
    s_waitcnt vmcnt(14)
    buffer_load_dwordx4 v[32:35], v12, s[4:7], s26 offen sc1
    s_waitcnt vmcnt(14)
    buffer_load_dwordx4 v[36:39], v13, s[4:7], s26 offen sc1
    s_add_u32 s26, s85, 10543104
    s_waitcnt vmcnt(14)
    buffer_load_dwordx4 v[40:43], v12, s[4:7], s26 offen sc1
    s_waitcnt vmcnt(14)
    buffer_load_dwordx4 v[44:47], v13, s[4:7], s26 offen sc1
    s_add_u32 s26, s86, 10543104
    s_waitcnt vmcnt(14)
    buffer_load_dwordx4 v[48:51], v12, s[4:7], s26 offen sc1
    s_waitcnt vmcnt(14)
    buffer_load_dwordx4 v[52:55], v13, s[4:7], s26 offen sc1
    s_add_u32 s26, s87, 10543104
    s_waitcnt vmcnt(13)
    buffer_load_dwordx4 v[56:59], v12, s[4:7], s26 offen sc1
    s_waitcnt vmcnt(13)
    buffer_load_dwordx4 v[60:63], v13, s[4:7], s26 offen sc1
    s_add_u32 s26, s88, 10543104
    s_waitcnt vmcnt(13)
    buffer_load_dwordx4 v[64:67], v12, s[4:7], s26 offen sc1
    s_waitcnt vmcnt(13)
    buffer_load_dwordx4 v[68:71], v13, s[4:7], s26 offen sc1
    s_waitcnt vmcnt(0)
    v_max_u32 v14, v83, v87
    v_cmp_eq_u32 vcc, -1, v14
    s_cbranch_vccnz R_mh0_6
    s_branch B_mh0_6
R_mh0_7:
    s_add_u32 s21, s21, 1
    s_cmp_gt_u32 s21, 4096
    s_cbranch_scc1 B_mh0_7
    s_add_u32 s26, s83, 10543104
    buffer_load_dwordx4 v[88:91], v12, s[4:7], s26 offen sc1
    buffer_load_dwordx4 v[92:95], v13, s[4:7], s26 offen sc1
    s_add_u32 s26, s84, 10543104
    s_waitcnt vmcnt(14)
    buffer_load_dwordx4 v[32:35], v12, s[4:7], s26 offen sc1
    s_waitcnt vmcnt(14)
    buffer_load_dwordx4 v[36:39], v13, s[4:7], s26 offen sc1
    s_add_u32 s26, s85, 10543104
    s_waitcnt vmcnt(14)
    buffer_load_dwordx4 v[40:43], v12, s[4:7], s26 offen sc1
    s_waitcnt vmcnt(14)
    buffer_load_dwordx4 v[44:47], v13, s[4:7], s26 offen sc1
    s_add_u32 s26, s86, 10543104
    s_waitcnt vmcnt(14)
    buffer_load_dwordx4 v[48:51], v12, s[4:7], s26 offen sc1
    s_waitcnt vmcnt(14)
    buffer_load_dwordx4 v[52:55], v13, s[4:7], s26 offen sc1
    s_add_u32 s26, s87, 10543104
    s_waitcnt vmcnt(13)
    buffer_load_dwordx4 v[56:59], v12, s[4:7], s26 offen sc1
    s_waitcnt vmcnt(13)
    buffer_load_dwordx4 v[60:63], v13, s[4:7], s26 offen sc1
    s_add_u32 s26, s88, 10543104
    s_waitcnt vmcnt(13)
    buffer_load_dwordx4 v[64:67], v12, s[4:7], s26 offen sc1
    s_waitcnt vmcnt(13)
    buffer_load_dwordx4 v[68:71], v13, s[4:7], s26 offen sc1
    s_add_u32 s26, s89, 10543104
    s_waitcnt vmcnt(13)
    buffer_load_dwordx4 v[72:75], v12, s[4:7], s26 offen sc1
    s_waitcnt vmcnt(13)
    buffer_load_dwordx4 v[76:79], v13, s[4:7], s26 offen sc1
    s_waitcnt vmcnt(0)
    v_max_u32 v14, v91, v95
    v_cmp_eq_u32 vcc, -1, v14
    s_cbranch_vccnz R_mh0_7
    s_branch B_mh0_7
R_mh0_8:
    s_add_u32 s21, s21, 1
    s_cmp_gt_u32 s21, 4096
    s_cbranch_scc1 B_mh0_8
    s_add_u32 s26, s84, 10543104
    buffer_load_dwordx4 v[32:35], v12, s[4:7], s26 offen sc1
    buffer_load_dwordx4 v[36:39], v13, s[4:7], s26 offen sc1
    s_add_u32 s26, s85, 10543104
    s_waitcnt vmcnt(14)
    buffer_load_dwordx4 v[40:43], v12, s[4:7], s26 offen sc1
    s_waitcnt vmcnt(14)
    buffer_load_dwordx4 v[44:47], v13, s[4:7], s26 offen sc1
    s_add_u32 s26, s86, 10543104
    s_waitcnt vmcnt(14)
    buffer_load_dwordx4 v[48:51], v12, s[4:7], s26 offen sc1
    s_waitcnt vmcnt(14)
    buffer_load_dwordx4 v[52:55], v13, s[4:7], s26 offen sc1
    s_add_u32 s26, s87, 10543104
    s_waitcnt vmcnt(13)
    buffer_load_dwordx4 v[56:59], v12, s[4:7], s26 offen sc1
    s_waitcnt vmcnt(13)
    buffer_load_dwordx4 v[60:63], v13, s[4:7], s26 offen sc1
    s_add_u32 s26, s88, 10543104
    s_waitcnt vmcnt(13)
    buffer_load_dwordx4 v[64:67], v12, s[4:7], s26 offen sc1
    s_waitcnt vmcnt(13)
    buffer_load_dwordx4 v[68:71], v13, s[4:7], s26 offen sc1
    s_add_u32 s26, s89, 10543104
    s_waitcnt vmcnt(13)
    buffer_load_dwordx4 v[72:75], v12, s[4:7], s26 offen sc1
    s_waitcnt vmcnt(13)
    buffer_load_dwordx4 v[76:79], v13, s[4:7], s26 offen sc1
    s_add_u32 s26, s83, 10600448
    s_waitcnt vmcnt(13)
    buffer_load_dwordx4 v[80:83], v12, s[4:7], s26 offen sc1
    s_waitcnt vmcnt(13)
    buffer_load_dwordx4 v[84:87], v13, s[4:7], s26 offen sc1
    s_waitcnt vmcnt(0)
    v_max_u32 v14, v35, v39
    v_cmp_eq_u32 vcc, -1, v14
    s_cbranch_vccnz R_mh0_8
    s_branch B_mh0_8
R_mh0_9:
    s_add_u32 s21, s21, 1
    s_cmp_gt_u32 s21, 4096
    s_cbranch_scc1 B_mh0_9
    s_add_u32 s26, s85, 10543104
    buffer_load_dwordx4 v[40:43], v12, s[4:7], s26 offen sc1
    buffer_load_dwordx4 v[44:47], v13, s[4:7], s26 offen sc1
    s_add_u32 s26, s86, 10543104
    s_waitcnt vmcnt(14)
    buffer_load_dwordx4 v[48:51], v12, s[4:7], s26 offen sc1
    s_waitcnt vmcnt(14)
    buffer_load_dwordx4 v[52:55], v13, s[4:7], s26 offen sc1
    s_add_u32 s26, s87, 10543104
    s_waitcnt vmcnt(13)
    buffer_load_dwordx4 v[56:59], v12, s[4:7], s26 offen sc1
    s_waitcnt vmcnt(13)
    buffer_load_dwordx4 v[60:63], v13, s[4:7], s26 offen sc1
    s_add_u32 s26, s88, 10543104
    s_waitcnt vmcnt(13)
    buffer_load_dwordx4 v[64:67], v12, s[4:7], s26 offen sc1
    s_waitcnt vmcnt(13)
    buffer_load_dwordx4 v[68:71], v13, s[4:7], s26 offen sc1
    s_add_u32 s26, s89, 10543104
    s_waitcnt vmcnt(13)
    buffer_load_dwordx4 v[72:75], v12, s[4:7], s26 offen sc1
    s_waitcnt vmcnt(13)
    buffer_load_dwordx4 v[76:79], v13, s[4:7], s26 offen sc1
    s_add_u32 s26, s83, 10600448
    s_waitcnt vmcnt(13)
    buffer_load_dwordx4 v[80:83], v12, s[4:7], s26 offen sc1
    s_waitcnt vmcnt(13)
    buffer_load_dwordx4 v[84:87], v13, s[4:7], s26 offen sc1
    s_add_u32 s26, s84, 10600448
    s_waitcnt vmcnt(13)
    buffer_load_dwordx4 v[88:91], v12, s[4:7], s26 offen sc1
    s_waitcnt vmcnt(13)
    buffer_load_dwordx4 v[92:95], v13, s[4:7], s26 offen sc1
    s_waitcnt vmcnt(0)
    v_max_u32 v14, v43, v47
    v_cmp_eq_u32 vcc, -1, v14
    s_cbranch_vccnz R_mh0_9
    s_branch B_mh0_9
R_mh0_10:
    s_add_u32 s21, s21, 1
    s_cmp_gt_u32 s21, 4096
    s_cbranch_scc1 B_mh0_10
    s_add_u32 s26, s86, 10543104
    buffer_load_dwordx4 v[48:51], v12, s[4:7], s26 offen sc1
    buffer_load_dwordx4 v[52:55], v13, s[4:7], s26 offen sc1
    s_add_u32 s26, s87, 10543104
    s_waitcnt vmcnt(13)
    buffer_load_dwordx4 v[56:59], v12, s[4:7], s26 offen sc1
    s_waitcnt vmcnt(13)
    buffer_load_dwordx4 v[60:63], v13, s[4:7], s26 offen sc1
    s_add_u32 s26, s88, 10543104
    s_waitcnt vmcnt(13)
    buffer_load_dwordx4 v[64:67], v12, s[4:7], s26 offen sc1
    s_waitcnt vmcnt(13)
    buffer_load_dwordx4 v[68:71], v13, s[4:7], s26 offen sc1
    s_add_u32 s26, s89, 10543104
    s_waitcnt vmcnt(13)
    buffer_load_dwordx4 v[72:75], v12, s[4:7], s26 offen sc1
    s_waitcnt vmcnt(13)
    buffer_load_dwordx4 v[76:79], v13, s[4:7], s26 offen sc1
    s_add_u32 s26, s83, 10600448
    s_waitcnt vmcnt(13)
    buffer_load_dwordx4 v[80:83], v12, s[4:7], s26 offen sc1
    s_waitcnt vmcnt(13)
    buffer_load_dwordx4 v[84:87], v13, s[4:7], s26 offen sc1
    s_add_u32 s26, s84, 10600448
    s_waitcnt vmcnt(13)
    buffer_load_dwordx4 v[88:91], v12, s[4:7], s26 offen sc1
    s_waitcnt vmcnt(13)
    buffer_load_dwordx4 v[92:95], v13, s[4:7], s26 offen sc1
    s_add_u32 s26, s85, 10600448
    s_waitcnt vmcnt(13)
    buffer_load_dwordx4 v[32:35], v12, s[4:7], s26 offen sc1
    s_waitcnt vmcnt(13)
    buffer_load_dwordx4 v[36:39], v13, s[4:7], s26 offen sc1
    s_waitcnt vmcnt(0)
    v_max_u32 v14, v51, v55
    v_cmp_eq_u32 vcc, -1, v14
    s_cbranch_vccnz R_mh0_10
    s_branch B_mh0_10
R_mh0_11:
    s_add_u32 s21, s21, 1
    s_cmp_gt_u32 s21, 4096
    s_cbranch_scc1 B_mh0_11
    s_add_u32 s26, s87, 10543104
    buffer_load_dwordx4 v[56:59], v12, s[4:7], s26 offen sc1
    buffer_load_dwordx4 v[60:63], v13, s[4:7], s26 offen sc1
    s_add_u32 s26, s88, 10543104
    s_waitcnt vmcnt(13)
    buffer_load_dwordx4 v[64:67], v12, s[4:7], s26 offen sc1
    s_waitcnt vmcnt(13)
    buffer_load_dwordx4 v[68:71], v13, s[4:7], s26 offen sc1
    s_add_u32 s26, s89, 10543104
    s_waitcnt vmcnt(13)
    buffer_load_dwordx4 v[72:75], v12, s[4:7], s26 offen sc1
    s_waitcnt vmcnt(13)
    buffer_load_dwordx4 v[76:79], v13, s[4:7], s26 offen sc1
    s_add_u32 s26, s83, 10600448
    s_waitcnt vmcnt(13)
    buffer_load_dwordx4 v[80:83], v12, s[4:7], s26 offen sc1
    s_waitcnt vmcnt(13)
    buffer_load_dwordx4 v[84:87], v13, s[4:7], s26 offen sc1
    s_add_u32 s26, s84, 10600448
    s_waitcnt vmcnt(13)
    buffer_load_dwordx4 v[88:91], v12, s[4:7], s26 offen sc1
    s_waitcnt vmcnt(13)
    buffer_load_dwordx4 v[92:95], v13, s[4:7], s26 offen sc1
    s_add_u32 s26, s85, 10600448
    s_waitcnt vmcnt(13)
    buffer_load_dwordx4 v[32:35], v12, s[4:7], s26 offen sc1
    s_waitcnt vmcnt(13)
    buffer_load_dwordx4 v[36:39], v13, s[4:7], s26 offen sc1
    s_add_u32 s26, s86, 10600448
    s_waitcnt vmcnt(13)
    buffer_load_dwordx4 v[40:43], v12, s[4:7], s26 offen sc1
    s_waitcnt vmcnt(13)
    buffer_load_dwordx4 v[44:47], v13, s[4:7], s26 offen sc1
    s_waitcnt vmcnt(0)
    v_max_u32 v14, v59, v63
    v_cmp_eq_u32 vcc, -1, v14
    s_cbranch_vccnz R_mh0_11
    s_branch B_mh0_11
R_mh0_12:
    s_add_u32 s21, s21, 1
    s_cmp_gt_u32 s21, 4096
    s_cbranch_scc1 B_mh0_12
    s_add_u32 s26, s88, 10543104
    buffer_load_dwordx4 v[64:67], v12, s[4:7], s26 offen sc1
    buffer_load_dwordx4 v[68:71], v13, s[4:7], s26 offen sc1
    s_add_u32 s26, s89, 10543104
    s_waitcnt vmcnt(13)
    buffer_load_dwordx4 v[72:75], v12, s[4:7], s26 offen sc1
    s_waitcnt vmcnt(13)
    buffer_load_dwordx4 v[76:79], v13, s[4:7], s26 offen sc1
    s_add_u32 s26, s83, 10600448
    s_waitcnt vmcnt(13)
    buffer_load_dwordx4 v[80:83], v12, s[4:7], s26 offen sc1
    s_waitcnt vmcnt(13)
    buffer_load_dwordx4 v[84:87], v13, s[4:7], s26 offen sc1
    s_add_u32 s26, s84, 10600448
    s_waitcnt vmcnt(13)
    buffer_load_dwordx4 v[88:91], v12, s[4:7], s26 offen sc1
    s_waitcnt vmcnt(13)
    buffer_load_dwordx4 v[92:95], v13, s[4:7], s26 offen sc1
    s_add_u32 s26, s85, 10600448
    s_waitcnt vmcnt(13)
    buffer_load_dwordx4 v[32:35], v12, s[4:7], s26 offen sc1
    s_waitcnt vmcnt(13)
    buffer_load_dwordx4 v[36:39], v13, s[4:7], s26 offen sc1
    s_add_u32 s26, s86, 10600448
    s_waitcnt vmcnt(13)
    buffer_load_dwordx4 v[40:43], v12, s[4:7], s26 offen sc1
    s_waitcnt vmcnt(13)
    buffer_load_dwordx4 v[44:47], v13, s[4:7], s26 offen sc1
    s_add_u32 s26, s87, 10600448
    s_waitcnt vmcnt(13)
    buffer_load_dwordx4 v[48:51], v12, s[4:7], s26 offen sc1
    s_waitcnt vmcnt(13)
    buffer_load_dwordx4 v[52:55], v13, s[4:7], s26 offen sc1
    s_waitcnt vmcnt(0)
    v_max_u32 v14, v67, v71
    v_cmp_eq_u32 vcc, -1, v14
    s_cbranch_vccnz R_mh0_12
    s_branch B_mh0_12
R_mh0_13:
    s_add_u32 s21, s21, 1
    s_cmp_gt_u32 s21, 4096
    s_cbranch_scc1 B_mh0_13
    s_add_u32 s26, s89, 10543104
    buffer_load_dwordx4 v[72:75], v12, s[4:7], s26 offen sc1
    buffer_load_dwordx4 v[76:79], v13, s[4:7], s26 offen sc1
    s_add_u32 s26, s83, 10600448
    s_waitcnt vmcnt(13)
    buffer_load_dwordx4 v[80:83], v12, s[4:7], s26 offen sc1
    s_waitcnt vmcnt(13)
    buffer_load_dwordx4 v[84:87], v13, s[4:7], s26 offen sc1
    s_add_u32 s26, s84, 10600448
    s_waitcnt vmcnt(13)
    buffer_load_dwordx4 v[88:91], v12, s[4:7], s26 offen sc1
    s_waitcnt vmcnt(13)
    buffer_load_dwordx4 v[92:95], v13, s[4:7], s26 offen sc1
    s_add_u32 s26, s85, 10600448
    s_waitcnt vmcnt(13)
    buffer_load_dwordx4 v[32:35], v12, s[4:7], s26 offen sc1
    s_waitcnt vmcnt(13)
    buffer_load_dwordx4 v[36:39], v13, s[4:7], s26 offen sc1
    s_add_u32 s26, s86, 10600448
    s_waitcnt vmcnt(13)
    buffer_load_dwordx4 v[40:43], v12, s[4:7], s26 offen sc1
    s_waitcnt vmcnt(13)
    buffer_load_dwordx4 v[44:47], v13, s[4:7], s26 offen sc1
    s_add_u32 s26, s87, 10600448
    s_waitcnt vmcnt(13)
    buffer_load_dwordx4 v[48:51], v12, s[4:7], s26 offen sc1
    s_waitcnt vmcnt(13)
    buffer_load_dwordx4 v[52:55], v13, s[4:7], s26 offen sc1
    s_add_u32 s26, s88, 10600448
    s_waitcnt vmcnt(13)
    buffer_load_dwordx4 v[56:59], v12, s[4:7], s26 offen sc1
    s_waitcnt vmcnt(13)
    buffer_load_dwordx4 v[60:63], v13, s[4:7], s26 offen sc1
    s_waitcnt vmcnt(0)
    v_max_u32 v14, v75, v79
    v_cmp_eq_u32 vcc, -1, v14
    s_cbranch_vccnz R_mh0_13
    s_branch B_mh0_13
R_mh0_14:
    s_add_u32 s21, s21, 1
    s_cmp_gt_u32 s21, 4096
    s_cbranch_scc1 B_mh0_14
    s_add_u32 s26, s83, 10600448
    buffer_load_dwordx4 v[80:83], v12, s[4:7], s26 offen sc1
    buffer_load_dwordx4 v[84:87], v13, s[4:7], s26 offen sc1
    s_add_u32 s26, s84, 10600448
    s_waitcnt vmcnt(13)
    buffer_load_dwordx4 v[88:91], v12, s[4:7], s26 offen sc1
    s_waitcnt vmcnt(13)
    buffer_load_dwordx4 v[92:95], v13, s[4:7], s26 offen sc1
    s_add_u32 s26, s85, 10600448
    s_waitcnt vmcnt(13)
    buffer_load_dwordx4 v[32:35], v12, s[4:7], s26 offen sc1
    s_waitcnt vmcnt(13)
    buffer_load_dwordx4 v[36:39], v13, s[4:7], s26 offen sc1
    s_add_u32 s26, s86, 10600448
    s_waitcnt vmcnt(13)
    buffer_load_dwordx4 v[40:43], v12, s[4:7], s26 offen sc1
    s_waitcnt vmcnt(13)
    buffer_load_dwordx4 v[44:47], v13, s[4:7], s26 offen sc1
    s_add_u32 s26, s87, 10600448
    s_waitcnt vmcnt(13)
    buffer_load_dwordx4 v[48:51], v12, s[4:7], s26 offen sc1
    s_waitcnt vmcnt(13)
    buffer_load_dwordx4 v[52:55], v13, s[4:7], s26 offen sc1
    s_add_u32 s26, s88, 10600448
    s_waitcnt vmcnt(13)
    buffer_load_dwordx4 v[56:59], v12, s[4:7], s26 offen sc1
    s_waitcnt vmcnt(13)
    buffer_load_dwordx4 v[60:63], v13, s[4:7], s26 offen sc1
    s_add_u32 s26, s89, 10600448
    s_waitcnt vmcnt(13)
    buffer_load_dwordx4 v[64:67], v12, s[4:7], s26 offen sc1
    s_waitcnt vmcnt(13)
    buffer_load_dwordx4 v[68:71], v13, s[4:7], s26 offen sc1
    s_waitcnt vmcnt(0)
    v_max_u32 v14, v83, v87
    v_cmp_eq_u32 vcc, -1, v14
    s_cbranch_vccnz R_mh0_14
    s_branch B_mh0_14
R_mh0_15:
    s_add_u32 s21, s21, 1
    s_cmp_gt_u32 s21, 4096
    s_cbranch_scc1 B_mh0_15
    s_add_u32 s26, s84, 10600448
    buffer_load_dwordx4 v[88:91], v12, s[4:7], s26 offen sc1
    buffer_load_dwordx4 v[92:95], v13, s[4:7], s26 offen sc1
    s_add_u32 s26, s85, 10600448
    s_waitcnt vmcnt(13)
    buffer_load_dwordx4 v[32:35], v12, s[4:7], s26 offen sc1
    s_waitcnt vmcnt(13)
    buffer_load_dwordx4 v[36:39], v13, s[4:7], s26 offen sc1
    s_add_u32 s26, s86, 10600448
    s_waitcnt vmcnt(13)
    buffer_load_dwordx4 v[40:43], v12, s[4:7], s26 offen sc1
    s_waitcnt vmcnt(13)
    buffer_load_dwordx4 v[44:47], v13, s[4:7], s26 offen sc1
    s_add_u32 s26, s87, 10600448
    s_waitcnt vmcnt(13)
    buffer_load_dwordx4 v[48:51], v12, s[4:7], s26 offen sc1
    s_waitcnt vmcnt(13)
    buffer_load_dwordx4 v[52:55], v13, s[4:7], s26 offen sc1
    s_add_u32 s26, s88, 10600448
    s_waitcnt vmcnt(13)
    buffer_load_dwordx4 v[56:59], v12, s[4:7], s26 offen sc1
    s_waitcnt vmcnt(13)
    buffer_load_dwordx4 v[60:63], v13, s[4:7], s26 offen sc1
    s_add_u32 s26, s89, 10600448
    s_waitcnt vmcnt(13)
    buffer_load_dwordx4 v[64:67], v12, s[4:7], s26 offen sc1
    s_waitcnt vmcnt(13)
    buffer_load_dwordx4 v[68:71], v13, s[4:7], s26 offen sc1
    s_add_u32 s26, s83, 10657792
    s_waitcnt vmcnt(13)
    buffer_load_dwordx4 v[72:75], v12, s[4:7], s26 offen sc1
    s_waitcnt vmcnt(13)
    buffer_load_dwordx4 v[76:79], v13, s[4:7], s26 offen sc1
    s_waitcnt vmcnt(0)
    v_max_u32 v14, v91, v95
    v_cmp_eq_u32 vcc, -1, v14
    s_cbranch_vccnz R_mh0_15
    s_branch B_mh0_15
R_mh0_16:
    s_add_u32 s21, s21, 1
    s_cmp_gt_u32 s21, 4096
    s_cbranch_scc1 B_mh0_16
    s_add_u32 s26, s85, 10600448
    buffer_load_dwordx4 v[32:35], v12, s[4:7], s26 offen sc1
    buffer_load_dwordx4 v[36:39], v13, s[4:7], s26 offen sc1
    s_add_u32 s26, s86, 10600448
    s_waitcnt vmcnt(13)
    buffer_load_dwordx4 v[40:43], v12, s[4:7], s26 offen sc1
    s_waitcnt vmcnt(13)
    buffer_load_dwordx4 v[44:47], v13, s[4:7], s26 offen sc1
    s_add_u32 s26, s87, 10600448
    s_waitcnt vmcnt(13)
    buffer_load_dwordx4 v[48:51], v12, s[4:7], s26 offen sc1
    s_waitcnt vmcnt(13)
    buffer_load_dwordx4 v[52:55], v13, s[4:7], s26 offen sc1
    s_add_u32 s26, s88, 10600448
    s_waitcnt vmcnt(13)
    buffer_load_dwordx4 v[56:59], v12, s[4:7], s26 offen sc1
    s_waitcnt vmcnt(13)
    buffer_load_dwordx4 v[60:63], v13, s[4:7], s26 offen sc1
    s_add_u32 s26, s89, 10600448
    s_waitcnt vmcnt(13)
    buffer_load_dwordx4 v[64:67], v12, s[4:7], s26 offen sc1
    s_waitcnt vmcnt(13)
    buffer_load_dwordx4 v[68:71], v13, s[4:7], s26 offen sc1
    s_add_u32 s26, s83, 10657792
    s_waitcnt vmcnt(13)
    buffer_load_dwordx4 v[72:75], v12, s[4:7], s26 offen sc1
    s_waitcnt vmcnt(13)
    buffer_load_dwordx4 v[76:79], v13, s[4:7], s26 offen sc1
    s_add_u32 s26, s84, 10657792
    s_waitcnt vmcnt(13)
    buffer_load_dwordx4 v[80:83], v12, s[4:7], s26 offen sc1
    s_waitcnt vmcnt(13)
    buffer_load_dwordx4 v[84:87], v13, s[4:7], s26 offen sc1
    s_waitcnt vmcnt(0)
    v_max_u32 v14, v35, v39
    v_cmp_eq_u32 vcc, -1, v14
    s_cbranch_vccnz R_mh0_16
    s_branch B_mh0_16
R_mh0_17:
    s_add_u32 s21, s21, 1
    s_cmp_gt_u32 s21, 4096
    s_cbranch_scc1 B_mh0_17
    s_add_u32 s26, s86, 10600448
    buffer_load_dwordx4 v[40:43], v12, s[4:7], s26 offen sc1
    buffer_load_dwordx4 v[44:47], v13, s[4:7], s26 offen sc1
    s_add_u32 s26, s87, 10600448
    s_waitcnt vmcnt(13)
    buffer_load_dwordx4 v[48:51], v12, s[4:7], s26 offen sc1
    s_waitcnt vmcnt(13)
    buffer_load_dwordx4 v[52:55], v13, s[4:7], s26 offen sc1
    s_add_u32 s26, s88, 10600448
    s_waitcnt vmcnt(13)
    buffer_load_dwordx4 v[56:59], v12, s[4:7], s26 offen sc1
    s_waitcnt vmcnt(13)
    buffer_load_dwordx4 v[60:63], v13, s[4:7], s26 offen sc1
    s_add_u32 s26, s89, 10600448
    s_waitcnt vmcnt(13)
    buffer_load_dwordx4 v[64:67], v12, s[4:7], s26 offen sc1
    s_waitcnt vmcnt(13)
    buffer_load_dwordx4 v[68:71], v13, s[4:7], s26 offen sc1
    s_add_u32 s26, s83, 10657792
    s_waitcnt vmcnt(13)
    buffer_load_dwordx4 v[72:75], v12, s[4:7], s26 offen sc1
    s_waitcnt vmcnt(13)
    buffer_load_dwordx4 v[76:79], v13, s[4:7], s26 offen sc1
    s_add_u32 s26, s84, 10657792
    s_waitcnt vmcnt(13)
    buffer_load_dwordx4 v[80:83], v12, s[4:7], s26 offen sc1
    s_waitcnt vmcnt(13)
    buffer_load_dwordx4 v[84:87], v13, s[4:7], s26 offen sc1
    s_add_u32 s26, s85, 10657792
    s_waitcnt vmcnt(13)
    buffer_load_dwordx4 v[88:91], v12, s[4:7], s26 offen sc1
    s_waitcnt vmcnt(13)
    buffer_load_dwordx4 v[92:95], v13, s[4:7], s26 offen sc1
    s_waitcnt vmcnt(0)
    v_max_u32 v14, v43, v47
    v_cmp_eq_u32 vcc, -1, v14
    s_cbranch_vccnz R_mh0_17
    s_branch B_mh0_17
R_mh0_18:
    s_add_u32 s21, s21, 1
    s_cmp_gt_u32 s21, 4096
    s_cbranch_scc1 B_mh0_18
    s_add_u32 s26, s87, 10600448
    buffer_load_dwordx4 v[48:51], v12, s[4:7], s26 offen sc1
    buffer_load_dwordx4 v[52:55], v13, s[4:7], s26 offen sc1
    s_add_u32 s26, s88, 10600448
    s_waitcnt vmcnt(14)
    buffer_load_dwordx4 v[56:59], v12, s[4:7], s26 offen sc1
    s_waitcnt vmcnt(14)
    buffer_load_dwordx4 v[60:63], v13, s[4:7], s26 offen sc1
    s_add_u32 s26, s89, 10600448
    s_waitcnt vmcnt(14)
    buffer_load_dwordx4 v[64:67], v12, s[4:7], s26 offen sc1
    s_waitcnt vmcnt(14)
    buffer_load_dwordx4 v[68:71], v13, s[4:7], s26 offen sc1
    s_add_u32 s26, s83, 10657792
    s_waitcnt vmcnt(14)
    buffer_load_dwordx4 v[72:75], v12, s[4:7], s26 offen sc1
    s_waitcnt vmcnt(14)
    buffer_load_dwordx4 v[76:79], v13, s[4:7], s26 offen sc1
    s_add_u32 s26, s84, 10657792
    s_waitcnt vmcnt(14)
    buffer_load_dwordx4 v[80:83], v12, s[4:7], s26 offen sc1
    s_waitcnt vmcnt(14)
    buffer_load_dwordx4 v[84:87], v13, s[4:7], s26 offen sc1
    s_add_u32 s26, s85, 10657792
    s_waitcnt vmcnt(14)
    buffer_load_dwordx4 v[88:91], v12, s[4:7], s26 offen sc1
    s_waitcnt vmcnt(14)
    buffer_load_dwordx4 v[92:95], v13, s[4:7], s26 offen sc1
    s_add_u32 s26, s86, 10657792
    s_waitcnt vmcnt(13)
    buffer_load_dwordx4 v[32:35], v12, s[4:7], s26 offen sc1
    s_waitcnt vmcnt(13)
    buffer_load_dwordx4 v[36:39], v13, s[4:7], s26 offen sc1
    s_waitcnt vmcnt(0)
    v_max_u32 v14, v51, v55
    v_cmp_eq_u32 vcc, -1, v14
    s_cbranch_vccnz R_mh0_18
    s_branch B_mh0_18
R_mh0_19:
    s_add_u32 s21, s21, 1
    s_cmp_gt_u32 s21, 4096
    s_cbranch_scc1 B_mh0_19
    s_add_u32 s26, s88, 10600448
    buffer_load_dwordx4 v[56:59], v12, s[4:7], s26 offen sc1
    buffer_load_dwordx4 v[60:63], v13, s[4:7], s26 offen sc1
    s_add_u32 s26, s89, 10600448
    s_waitcnt vmcnt(14)
    buffer_load_dwordx4 v[64:67], v12, s[4:7], s26 offen sc1
    s_waitcnt vmcnt(14)
    buffer_load_dwordx4 v[68:71], v13, s[4:7], s26 offen sc1
    s_add_u32 s26, s83, 10657792
    s_waitcnt vmcnt(14)
    buffer_load_dwordx4 v[72:75], v12, s[4:7], s26 offen sc1
    s_waitcnt vmcnt(14)
    buffer_load_dwordx4 v[76:79], v13, s[4:7], s26 offen sc1
    s_add_u32 s26, s84, 10657792
    s_waitcnt vmcnt(14)
    buffer_load_dwordx4 v[80:83], v12, s[4:7], s26 offen sc1
    s_waitcnt vmcnt(14)
    buffer_load_dwordx4 v[84:87], v13, s[4:7], s26 offen sc1
    s_add_u32 s26, s85, 10657792
    s_waitcnt vmcnt(14)
    buffer_load_dwordx4 v[88:91], v12, s[4:7], s26 offen sc1
    s_waitcnt vmcnt(14)
    buffer_load_dwordx4 v[92:95], v13, s[4:7], s26 offen sc1
    s_add_u32 s26, s86, 10657792
    s_waitcnt vmcnt(13)
    buffer_load_dwordx4 v[32:35], v12, s[4:7], s26 offen sc1
    s_waitcnt vmcnt(13)
    buffer_load_dwordx4 v[36:39], v13, s[4:7], s26 offen sc1
    s_add_u32 s26, s87, 10657792
    s_waitcnt vmcnt(13)
    buffer_load_dwordx4 v[40:43], v12, s[4:7], s26 offen sc1
    s_waitcnt vmcnt(13)
    buffer_load_dwordx4 v[44:47], v13, s[4:7], s26 offen sc1
    s_waitcnt vmcnt(0)
    v_max_u32 v14, v59, v63
    v_cmp_eq_u32 vcc, -1, v14
    s_cbranch_vccnz R_mh0_19
    s_branch B_mh0_19
R_mh0_20:
    s_add_u32 s21, s21, 1
    s_cmp_gt_u32 s21, 4096
    s_cbranch_scc1 B_mh0_20
    s_add_u32 s26, s89, 10600448
    buffer_load_dwordx4 v[64:67], v12, s[4:7], s26 offen sc1
    buffer_load_dwordx4 v[68:71], v13, s[4:7], s26 offen sc1
    s_add_u32 s26, s83, 10657792
    s_waitcnt vmcnt(14)
    buffer_load_dwordx4 v[72:75], v12, s[4:7], s26 offen sc1
    s_waitcnt vmcnt(14)
    buffer_load_dwordx4 v[76:79], v13, s[4:7], s26 offen sc1
    s_add_u32 s26, s84, 10657792
    s_waitcnt vmcnt(14)
    buffer_load_dwordx4 v[80:83], v12, s[4:7], s26 offen sc1
    s_waitcnt vmcnt(14)
    buffer_load_dwordx4 v[84:87], v13, s[4:7], s26 offen sc1
    s_add_u32 s26, s85, 10657792
    s_waitcnt vmcnt(14)
    buffer_load_dwordx4 v[88:91], v12, s[4:7], s26 offen sc1
    s_waitcnt vmcnt(14)
    buffer_load_dwordx4 v[92:95], v13, s[4:7], s26 offen sc1
    s_add_u32 s26, s86, 10657792
    s_waitcnt vmcnt(13)
    buffer_load_dwordx4 v[32:35], v12, s[4:7], s26 offen sc1
    s_waitcnt vmcnt(13)
    buffer_load_dwordx4 v[36:39], v13, s[4:7], s26 offen sc1
    s_add_u32 s26, s87, 10657792
    s_waitcnt vmcnt(13)
    buffer_load_dwordx4 v[40:43], v12, s[4:7], s26 offen sc1
    s_waitcnt vmcnt(13)
    buffer_load_dwordx4 v[44:47], v13, s[4:7], s26 offen sc1
    s_add_u32 s26, s88, 10657792
    s_waitcnt vmcnt(13)
    buffer_load_dwordx4 v[48:51], v12, s[4:7], s26 offen sc1
    s_waitcnt vmcnt(13)
    buffer_load_dwordx4 v[52:55], v13, s[4:7], s26 offen sc1
    s_waitcnt vmcnt(0)
    v_max_u32 v14, v67, v71
    v_cmp_eq_u32 vcc, -1, v14
    s_cbranch_vccnz R_mh0_20
    s_branch B_mh0_20
R_mh0_21:
    s_add_u32 s21, s21, 1
    s_cmp_gt_u32 s21, 4096
    s_cbranch_scc1 B_mh0_21
    s_add_u32 s26, s83, 10657792
    buffer_load_dwordx4 v[72:75], v12, s[4:7], s26 offen sc1
    buffer_load_dwordx4 v[76:79], v13, s[4:7], s26 offen sc1
    s_add_u32 s26, s84, 10657792
    s_waitcnt vmcnt(14)
    buffer_load_dwordx4 v[80:83], v12, s[4:7], s26 offen sc1
    s_waitcnt vmcnt(14)
    buffer_load_dwordx4 v[84:87], v13, s[4:7], s26 offen sc1
    s_add_u32 s26, s85, 10657792
    s_waitcnt vmcnt(14)
    buffer_load_dwordx4 v[88:91], v12, s[4:7], s26 offen sc1
    s_waitcnt vmcnt(14)
    buffer_load_dwordx4 v[92:95], v13, s[4:7], s26 offen sc1
    s_add_u32 s26, s86, 10657792
    s_waitcnt vmcnt(13)
    buffer_load_dwordx4 v[32:35], v12, s[4:7], s26 offen sc1
    s_waitcnt vmcnt(13)
    buffer_load_dwordx4 v[36:39], v13, s[4:7], s26 offen sc1
    s_add_u32 s26, s87, 10657792
    s_waitcnt vmcnt(13)
    buffer_load_dwordx4 v[40:43], v12, s[4:7], s26 offen sc1
    s_waitcnt vmcnt(13)
    buffer_load_dwordx4 v[44:47], v13, s[4:7], s26 offen sc1
    s_add_u32 s26, s88, 10657792
    s_waitcnt vmcnt(13)
    buffer_load_dwordx4 v[48:51], v12, s[4:7], s26 offen sc1
    s_waitcnt vmcnt(13)
    buffer_load_dwordx4 v[52:55], v13, s[4:7], s26 offen sc1
    s_add_u32 s26, s89, 10657792
    s_waitcnt vmcnt(13)
    buffer_load_dwordx4 v[56:59], v12, s[4:7], s26 offen sc1
    s_waitcnt vmcnt(13)
    buffer_load_dwordx4 v[60:63], v13, s[4:7], s26 offen sc1
    s_waitcnt vmcnt(0)
    v_max_u32 v14, v75, v79
    v_cmp_eq_u32 vcc, -1, v14
    s_cbranch_vccnz R_mh0_21
    s_branch B_mh0_21
R_mh0_22:
    s_add_u32 s21, s21, 1
    s_cmp_gt_u32 s21, 4096
    s_cbranch_scc1 B_mh0_22
    s_add_u32 s26, s84, 10657792
    buffer_load_dwordx4 v[80:83], v12, s[4:7], s26 offen sc1
    buffer_load_dwordx4 v[84:87], v13, s[4:7], s26 offen sc1
    s_add_u32 s26, s85, 10657792
    s_waitcnt vmcnt(12)
    buffer_load_dwordx4 v[88:91], v12, s[4:7], s26 offen sc1
    s_waitcnt vmcnt(12)
    buffer_load_dwordx4 v[92:95], v13, s[4:7], s26 offen sc1
    s_add_u32 s26, s86, 10657792
    s_waitcnt vmcnt(11)
    buffer_load_dwordx4 v[32:35], v12, s[4:7], s26 offen sc1
    s_waitcnt vmcnt(11)
    buffer_load_dwordx4 v[36:39], v13, s[4:7], s26 offen sc1
    s_add_u32 s26, s87, 10657792
    s_waitcnt vmcnt(11)
    buffer_load_dwordx4 v[40:43], v12, s[4:7], s26 offen sc1
    s_waitcnt vmcnt(11)
    buffer_load_dwordx4 v[44:47], v13, s[4:7], s26 offen sc1
    s_add_u32 s26, s88, 10657792
    s_waitcnt vmcnt(11)
    buffer_load_dwordx4 v[48:51], v12, s[4:7], s26 offen sc1
    s_waitcnt vmcnt(11)
    buffer_load_dwordx4 v[52:55], v13, s[4:7], s26 offen sc1
    s_add_u32 s26, s89, 10657792
    s_waitcnt vmcnt(11)
    buffer_load_dwordx4 v[56:59], v12, s[4:7], s26 offen sc1
    s_waitcnt vmcnt(11)
    buffer_load_dwordx4 v[60:63], v13, s[4:7], s26 offen sc1
    s_waitcnt vmcnt(0)
    v_max_u32 v14, v83, v87
    v_cmp_eq_u32 vcc, -1, v14
    s_cbranch_vccnz R_mh0_22
    s_branch B_mh0_22
R_mh0_23:
    s_add_u32 s21, s21, 1
    s_cmp_gt_u32 s21, 4096
    s_cbranch_scc1 B_mh0_23
    s_add_u32 s26, s85, 10657792
    buffer_load_dwordx4 v[88:91], v12, s[4:7], s26 offen sc1
    buffer_load_dwordx4 v[92:95], v13, s[4:7], s26 offen sc1
    s_add_u32 s26, s86, 10657792
    s_waitcnt vmcnt(9)
    buffer_load_dwordx4 v[32:35], v12, s[4:7], s26 offen sc1
    s_waitcnt vmcnt(9)
    buffer_load_dwordx4 v[36:39], v13, s[4:7], s26 offen sc1
    s_add_u32 s26, s87, 10657792
    s_waitcnt vmcnt(9)
    buffer_load_dwordx4 v[40:43], v12, s[4:7], s26 offen sc1
    s_waitcnt vmcnt(9)
    buffer_load_dwordx4 v[44:47], v13, s[4:7], s26 offen sc1
    s_add_u32 s26, s88, 10657792
    s_waitcnt vmcnt(9)
    buffer_load_dwordx4 v[48:51], v12, s[4:7], s26 offen sc1
    s_waitcnt vmcnt(9)
    buffer_load_dwordx4 v[52:55], v13, s[4:7], s26 offen sc1
    s_add_u32 s26, s89, 10657792
    s_waitcnt vmcnt(9)
    buffer_load_dwordx4 v[56:59], v12, s[4:7], s26 offen sc1
    s_waitcnt vmcnt(9)
    buffer_load_dwordx4 v[60:63], v13, s[4:7], s26 offen sc1
    s_waitcnt vmcnt(0)
    v_max_u32 v14, v91, v95
    v_cmp_eq_u32 vcc, -1, v14
    s_cbranch_vccnz R_mh0_23
    s_branch B_mh0_23
R_mh0_24:
    s_add_u32 s21, s21, 1
    s_cmp_gt_u32 s21, 4096
    s_cbranch_scc1 B_mh0_24
    s_add_u32 s26, s86, 10657792
    buffer_load_dwordx4 v[32:35], v12, s[4:7], s26 offen sc1
    buffer_load_dwordx4 v[36:39], v13, s[4:7], s26 offen sc1
    s_add_u32 s26, s87, 10657792
    s_waitcnt vmcnt(7)
    buffer_load_dwordx4 v[40:43], v12, s[4:7], s26 offen sc1
    s_waitcnt vmcnt(7)
    buffer_load_dwordx4 v[44:47], v13, s[4:7], s26 offen sc1
    s_add_u32 s26, s88, 10657792
    s_waitcnt vmcnt(7)
    buffer_load_dwordx4 v[48:51], v12, s[4:7], s26 offen sc1
    s_waitcnt vmcnt(7)
    buffer_load_dwordx4 v[52:55], v13, s[4:7], s26 offen sc1
    s_add_u32 s26, s89, 10657792
    s_waitcnt vmcnt(7)
    buffer_load_dwordx4 v[56:59], v12, s[4:7], s26 offen sc1
    s_waitcnt vmcnt(7)
    buffer_load_dwordx4 v[60:63], v13, s[4:7], s26 offen sc1
    s_waitcnt vmcnt(0)
    v_max_u32 v14, v35, v39
    v_cmp_eq_u32 vcc, -1, v14
    s_cbranch_vccnz R_mh0_24
    s_branch B_mh0_24
R_mh0_25:
    s_add_u32 s21, s21, 1
    s_cmp_gt_u32 s21, 4096
    s_cbranch_scc1 B_mh0_25
    s_add_u32 s26, s87, 10657792
    buffer_load_dwordx4 v[40:43], v12, s[4:7], s26 offen sc1
    buffer_load_dwordx4 v[44:47], v13, s[4:7], s26 offen sc1
    s_add_u32 s26, s88, 10657792
    buffer_load_dwordx4 v[48:51], v12, s[4:7], s26 offen sc1
    buffer_load_dwordx4 v[52:55], v13, s[4:7], s26 offen sc1
    s_add_u32 s26, s89, 10657792
    buffer_load_dwordx4 v[56:59], v12, s[4:7], s26 offen sc1
    buffer_load_dwordx4 v[60:63], v13, s[4:7], s26 offen sc1
    s_waitcnt vmcnt(0)
    v_max3_u32 v14, v43, v47, v51
    v_max3_u32 v14, v14, v55, v59
    v_max_u32 v14, v14, v63
    v_cmp_eq_u32 vcc, -1, v14
    s_cbranch_vccnz R_mh0_25
    s_branch B_mh0_25
R_mc4:
    s_add_u32 s21, s21, 1
    s_cmp_gt_u32 s21, 4096
    s_cbranch_scc1 B_mc4
    v_and_b32 v127, 7, v1
    v_and_b32 v5, 24, v1
    v_lshlrev_b32 v5, 3, v5
    v_lshl_add_u32 v127, v127, 11, v5
    s_mov_b32 s30, 1836800
    buffer_load_dword v127, v127, s[4:7], s30 offen offset:8 sc1
    s_waitcnt vmcnt(0)
    v_cmp_eq_u32 vcc, -1, v127
    s_cbranch_vccnz R_mc4
    s_branch B_mc4
R_mc:
    s_add_u32 s21, s21, 1
    s_cmp_gt_u32 s21, 4096
    s_cbranch_scc1 B_mc
    buffer_load_dwordx4 v[16:19], v5, s[4:7], s100 offen offset:0 sc1
    buffer_load_dwordx4 v[20:23], v5, s[4:7], s100 offen offset:256 sc1
    s_waitcnt vmcnt(0)
    v_max3_u32 v13, v16, v17, v18
    v_max3_u32 v13, v13, v19, v20
    v_max3_u32 v13, v13, v21, v22
    v_max_u32 v13, v13, v23
    v_cmp_eq_u32 vcc, -1, v13
    s_cbranch_vccnz R_mc
    s_branch B_mc
R_mcq:
    s_add_u32 s21, s21, 1
    s_cmp_gt_u32 s21, 4096
    s_cbranch_scc1 B_mcq
    buffer_load_dwordx4 v[32:35], v14, s[4:7], s25 offen offset:0 sc1
    buffer_load_dwordx4 v[36:39], v14, s[4:7], s25 offen offset:16 sc1
    buffer_load_dwordx4 v[40:43], v14, s[4:7], s25 offen offset:512 sc1
    buffer_load_dwordx4 v[44:47], v14, s[4:7], s25 offen offset:528 sc1
    s_waitcnt vmcnt(0)
    v_min3_u32 v12, v33, v35, v37
    v_min3_u32 v12, v12, v39, v41
    v_min3_u32 v12, v12, v43, v45
    v_min_u32 v12, v12, v47
    v_cmp_lt_u32 vcc, v12, v9
    s_cbranch_vccnz R_mcq
    s_branch B_mcq
R_mc31:
    s_add_u32 s21, s21, 1
    s_cmp_gt_u32 s21, 4096
    s_cbranch_scc1 B_mc31
    s_sleep 4
    v_and_b32 v3, 31, v1
    v_lshlrev_b32 v3, 7, v3
    s_mov_b32 s30, 1925120
    buffer_load_dword v3, v3, s[4:7], s30 offen sc1
    s_waitcnt vmcnt(0)
    v_cmp_eq_u32 vcc, -1, v3
    s_cbranch_vccnz R_mc31
    s_branch B_mc31
R_mx1_0:
    s_add_u32 s21, s21, 1
    s_cmp_gt_u32 s21, 4096
    s_cbranch_scc1 B_mx1_0
    s_waitcnt lgkmcnt(0)
    s_add_u32 m0, s36, 0
    s_add_u32 s26, s76, 5767168
    buffer_load_dwordx4 v15, s[4:7], s26 offen offset:0 sc1 lds
    buffer_load_dwordx4 v15, s[4:7], s26 offen offset:1024 sc1 lds
    buffer_load_dwordx4 v15, s[4:7], s26 offen offset:2048 sc1 lds
    buffer_load_dwordx4 v15, s[4:7], s26 offen offset:3072 sc1 lds
    s_add_u32 m0, s36, 4096
    s_add_u32 s26, s77, 5767168
    buffer_load_dwordx4 v15, s[4:7], s26 offen offset:0 sc1 lds
    buffer_load_dwordx4 v15, s[4:7], s26 offen offset:1024 sc1 lds
    buffer_load_dwordx4 v15, s[4:7], s26 offen offset:2048 sc1 lds
    s_waitcnt vmcnt(0)
    ds_read_b64_tr_b16 v[16:17], v6 offset:0
    ds_read_b64_tr_b16 v[18:19], v6 offset:512
    ds_read_b64_tr_b16 v[20:21], v6 offset:1024
    ds_read_b64_tr_b16 v[22:23], v6 offset:1536
    s_waitcnt lgkmcnt(0)
    v_max3_u32 v14, v16, v17, v18
    v_max_u32 v14, v14, v19
    v_cmp_eq_u32 vcc, -1, v14
    s_cbranch_vccnz R_mx1_0
    s_branch B_mx1_0
R_mx1_1:
    s_add_u32 s21, s21, 1
    s_cmp_gt_u32 s21, 4096
    s_cbranch_scc1 B_mx1_1
    s_waitcnt lgkmcnt(0)
    s_add_u32 m0, s36, 0
    s_add_u32 s26, s76, 5767168
    buffer_load_dwordx4 v15, s[4:7], s26 offen offset:1024 sc1 lds
    buffer_load_dwordx4 v15, s[4:7], s26 offen offset:2048 sc1 lds
    buffer_load_dwordx4 v15, s[4:7], s26 offen offset:3072 sc1 lds
    s_add_u32 m0, s36, 4096
    s_add_u32 s26, s77, 5767168
    buffer_load_dwordx4 v15, s[4:7], s26 offen offset:0 sc1 lds
    buffer_load_dwordx4 v15, s[4:7], s26 offen offset:1024 sc1 lds
    buffer_load_dwordx4 v15, s[4:7], s26 offen offset:2048 sc1 lds
    buffer_load_dwordx4 v15, s[4:7], s26 offen offset:3072 sc1 lds
    s_waitcnt vmcnt(0)
    ds_read_b64_tr_b16 v[20:21], v6 offset:1024
    ds_read_b64_tr_b16 v[22:23], v6 offset:1536
    ds_read_b64_tr_b16 v[24:25], v6 offset:2048
    ds_read_b64_tr_b16 v[26:27], v6 offset:2560
    s_waitcnt lgkmcnt(0)
    v_max3_u32 v14, v20, v21, v22
    v_max_u32 v14, v14, v23
    v_cmp_eq_u32 vcc, -1, v14
    s_cbranch_vccnz R_mx1_1
    s_branch B_mx1_1
R_mx1_2:
    s_add_u32 s21, s21, 1
    s_cmp_gt_u32 s21, 4096
    s_cbranch_scc1 B_mx1_2
    s_waitcnt lgkmcnt(0)
    s_add_u32 m0, s36, 0
    s_add_u32 s26, s76, 5767168
    buffer_load_dwordx4 v15, s[4:7], s26 offen offset:2048 sc1 lds
    buffer_load_dwordx4 v15, s[4:7], s26 offen offset:3072 sc1 lds
    s_add_u32 m0, s36, 4096
    s_add_u32 s26, s77, 5767168
    buffer_load_dwordx4 v15, s[4:7], s26 offen offset:0 sc1 lds
    buffer_load_dwordx4 v15, s[4:7], s26 offen offset:1024 sc1 lds
    buffer_load_dwordx4 v15, s[4:7], s26 offen offset:2048 sc1 lds
    buffer_load_dwordx4 v15, s[4:7], s26 offen offset:3072 sc1 lds
    s_add_u32 m0, s36, 0
    s_add_u32 s26, s78, 5767168
    buffer_load_dwordx4 v15, s[4:7], s26 offen offset:0 sc1 lds
    s_waitcnt vmcnt(0)
    ds_read_b64_tr_b16 v[24:25], v6 offset:2048
    ds_read_b64_tr_b16 v[26:27], v6 offset:2560
    ds_read_b64_tr_b16 v[28:29], v6 offset:3072
    ds_read_b64_tr_b16 v[30:31], v6 offset:3584
    s_waitcnt lgkmcnt(0)
    v_max3_u32 v14, v24, v25, v26
    v_max_u32 v14, v14, v27
    v_cmp_eq_u32 vcc, -1, v14
    s_cbranch_vccnz R_mx1_2
    s_branch B_mx1_2
R_mx1_3:
    s_add_u32 s21, s21, 1
    s_cmp_gt_u32 s21, 4096
    s_cbranch_scc1 B_mx1_3
    s_waitcnt lgkmcnt(0)
    s_add_u32 m0, s36, 0
    s_add_u32 s26, s76, 5767168
    buffer_load_dwordx4 v15, s[4:7], s26 offen offset:3072 sc1 lds
    s_add_u32 m0, s36, 4096
    s_add_u32 s26, s77, 5767168
    buffer_load_dwordx4 v15, s[4:7], s26 offen offset:0 sc1 lds
    buffer_load_dwordx4 v15, s[4:7], s26 offen offset:1024 sc1 lds
    buffer_load_dwordx4 v15, s[4:7], s26 offen offset:2048 sc1 lds
    buffer_load_dwordx4 v15, s[4:7], s26 offen offset:3072 sc1 lds
    s_add_u32 m0, s36, 0
    s_add_u32 s26, s78, 5767168
    buffer_load_dwordx4 v15, s[4:7], s26 offen offset:0 sc1 lds
    buffer_load_dwordx4 v15, s[4:7], s26 offen offset:1024 sc1 lds
    s_waitcnt vmcnt(0)
    ds_read_b64_tr_b16 v[28:29], v6 offset:3072
    ds_read_b64_tr_b16 v[30:31], v6 offset:3584
    ds_read_b64_tr_b16 v[32:33], v6 offset:4096
    ds_read_b64_tr_b16 v[34:35], v6 offset:4608
    s_waitcnt lgkmcnt(0)
    v_max3_u32 v14, v28, v29, v30
    v_max_u32 v14, v14, v31
    v_cmp_eq_u32 vcc, -1, v14
    s_cbranch_vccnz R_mx1_3
    s_branch B_mx1_3
R_mx1_4:
    s_add_u32 s21, s21, 1
    s_cmp_gt_u32 s21, 4096
    s_cbranch_scc1 B_mx1_4
    s_waitcnt lgkmcnt(0)
    s_add_u32 m0, s36, 4096
    s_add_u32 s26, s77, 5767168
    buffer_load_dwordx4 v15, s[4:7], s26 offen offset:0 sc1 lds
    buffer_load_dwordx4 v15, s[4:7], s26 offen offset:1024 sc1 lds
    buffer_load_dwordx4 v15, s[4:7], s26 offen offset:2048 sc1 lds
    buffer_load_dwordx4 v15, s[4:7], s26 offen offset:3072 sc1 lds
    s_add_u32 m0, s36, 0
    s_add_u32 s26, s78, 5767168
    buffer_load_dwordx4 v15, s[4:7], s26 offen offset:0 sc1 lds
    buffer_load_dwordx4 v15, s[4:7], s26 offen offset:1024 sc1 lds
    buffer_load_dwordx4 v15, s[4:7], s26 offen offset:2048 sc1 lds
    s_waitcnt vmcnt(0)
    ds_read_b64_tr_b16 v[32:33], v6 offset:4096
    ds_read_b64_tr_b16 v[34:35], v6 offset:4608
    ds_read_b64_tr_b16 v[36:37], v6 offset:5120
    ds_read_b64_tr_b16 v[38:39], v6 offset:5632
    s_waitcnt lgkmcnt(0)
    v_max3_u32 v14, v32, v33, v34
    v_max_u32 v14, v14, v35
    v_cmp_eq_u32 vcc, -1, v14
    s_cbranch_vccnz R_mx1_4
    s_branch B_mx1_4
R_mx1_5:
    s_add_u32 s21, s21, 1
    s_cmp_gt_u32 s21, 4096
    s_cbranch_scc1 B_mx1_5
    s_waitcnt lgkmcnt(0)
    s_add_u32 m0, s36, 4096
    s_add_u32 s26, s77, 5767168
    buffer_load_dwordx4 v15, s[4:7], s26 offen offset:1024 sc1 lds
    buffer_load_dwordx4 v15, s[4:7], s26 offen offset:2048 sc1 lds
    buffer_load_dwordx4 v15, s[4:7], s26 offen offset:3072 sc1 lds
    s_add_u32 m0, s36, 0
    s_add_u32 s26, s78, 5767168
    buffer_load_dwordx4 v15, s[4:7], s26 offen offset:0 sc1 lds
    buffer_load_dwordx4 v15, s[4:7], s26 offen offset:1024 sc1 lds
    buffer_load_dwordx4 v15, s[4:7], s26 offen offset:2048 sc1 lds
    buffer_load_dwordx4 v15, s[4:7], s26 offen offset:3072 sc1 lds
    s_waitcnt vmcnt(0)
    ds_read_b64_tr_b16 v[36:37], v6 offset:5120
    ds_read_b64_tr_b16 v[38:39], v6 offset:5632
    ds_read_b64_tr_b16 v[40:41], v6 offset:6144
    ds_read_b64_tr_b16 v[42:43], v6 offset:6656
    s_waitcnt lgkmcnt(0)
    v_max3_u32 v14, v36, v37, v38
    v_max_u32 v14, v14, v39
    v_cmp_eq_u32 vcc, -1, v14
    s_cbranch_vccnz R_mx1_5
    s_branch B_mx1_5
R_mx1_6:
    s_add_u32 s21, s21, 1
    s_cmp_gt_u32 s21, 4096
    s_cbranch_scc1 B_mx1_6
    s_waitcnt lgkmcnt(0)
    s_add_u32 m0, s36, 4096
    s_add_u32 s26, s77, 5767168
    buffer_load_dwordx4 v15, s[4:7], s26 offen offset:2048 sc1 lds
    buffer_load_dwordx4 v15, s[4:7], s26 offen offset:3072 sc1 lds
    s_add_u32 m0, s36, 0
    s_add_u32 s26, s78, 5767168
    buffer_load_dwordx4 v15, s[4:7], s26 offen offset:0 sc1 lds
    buffer_load_dwordx4 v15, s[4:7], s26 offen offset:1024 sc1 lds
    buffer_load_dwordx4 v15, s[4:7], s26 offen offset:2048 sc1 lds
    buffer_load_dwordx4 v15, s[4:7], s26 offen offset:3072 sc1 lds
    s_add_u32 m0, s36, 4096
    s_add_u32 s26, s79, 5767168
    buffer_load_dwordx4 v15, s[4:7], s26 offen offset:0 sc1 lds
    s_waitcnt vmcnt(0)
    ds_read_b64_tr_b16 v[40:41], v6 offset:6144
    ds_read_b64_tr_b16 v[42:43], v6 offset:6656
    ds_read_b64_tr_b16 v[44:45], v6 offset:7168
    ds_read_b64_tr_b16 v[46:47], v6 offset:7680
    s_waitcnt lgkmcnt(0)
    v_max3_u32 v14, v40, v41, v42
    v_max_u32 v14, v14, v43
    v_cmp_eq_u32 vcc, -1, v14
    s_cbranch_vccnz R_mx1_6
    s_branch B_mx1_6
R_mx1_7:
    s_add_u32 s21, s21, 1
    s_cmp_gt_u32 s21, 4096
    s_cbranch_scc1 B_mx1_7
    s_waitcnt lgkmcnt(0)
    s_add_u32 m0, s36, 4096
    s_add_u32 s26, s77, 5767168
    buffer_load_dwordx4 v15, s[4:7], s26 offen offset:3072 sc1 lds
    s_add_u32 m0, s36, 0
    s_add_u32 s26, s78, 5767168
    buffer_load_dwordx4 v15, s[4:7], s26 offen offset:0 sc1 lds
    buffer_load_dwordx4 v15, s[4:7], s26 offen offset:1024 sc1 lds
    buffer_load_dwordx4 v15, s[4:7], s26 offen offset:2048 sc1 lds
    buffer_load_dwordx4 v15, s[4:7], s26 offen offset:3072 sc1 lds
    s_add_u32 m0, s36, 4096
    s_add_u32 s26, s79, 5767168
    buffer_load_dwordx4 v15, s[4:7], s26 offen offset:0 sc1 lds
    buffer_load_dwordx4 v15, s[4:7], s26 offen offset:1024 sc1 lds
    s_waitcnt vmcnt(0)
    ds_read_b64_tr_b16 v[44:45], v6 offset:7168
    ds_read_b64_tr_b16 v[46:47], v6 offset:7680
    ds_read_b64_tr_b16 v[48:49], v6 offset:0
    ds_read_b64_tr_b16 v[50:51], v6 offset:512
    s_waitcnt lgkmcnt(0)
    v_max3_u32 v14, v44, v45, v46
    v_max_u32 v14, v14, v47
    v_cmp_eq_u32 vcc, -1, v14
    s_cbranch_vccnz R_mx1_7
    s_branch B_mx1_7
R_mx1_8:
    s_add_u32 s21, s21, 1
    s_cmp_gt_u32 s21, 4096
    s_cbranch_scc1 B_mx1_8
    s_waitcnt lgkmcnt(0)
    s_add_u32 m0, s36, 0
    s_add_u32 s26, s78, 5767168
    buffer_load_dwordx4 v15, s[4:7], s26 offen offset:0 sc1 lds
    buffer_load_dwordx4 v15, s[4:7], s26 offen offset:1024 sc1 lds
    buffer_load_dwordx4 v15, s[4:7], s26 offen offset:2048 sc1 lds
    buffer_load_dwordx4 v15, s[4:7], s26 offen offset:3072 sc1 lds
    s_add_u32 m0, s36, 4096
    s_add_u32 s26, s79, 5767168
    buffer_load_dwordx4 v15, s[4:7], s26 offen offset:0 sc1 lds
    buffer_load_dwordx4 v15, s[4:7], s26 offen offset:1024 sc1 lds
    buffer_load_dwordx4 v15, s[4:7], s26 offen offset:2048 sc1 lds
    s_waitcnt vmcnt(0)
    ds_read_b64_tr_b16 v[48:49], v6 offset:0
    ds_read_b64_tr_b16 v[50:51], v6 offset:512
    ds_read_b64_tr_b16 v[52:53], v6 offset:1024
    ds_read_b64_tr_b16 v[54:55], v6 offset:1536
    s_waitcnt lgkmcnt(0)
    v_max3_u32 v14, v48, v49, v50
    v_max_u32 v14, v14, v51
    v_cmp_eq_u32 vcc, -1, v14
    s_cbranch_vccnz R_mx1_8
    s_branch B_mx1_8
R_mx1_9:
    s_add_u32 s21, s21, 1
    s_cmp_gt_u32 s21, 4096
    s_cbranch_scc1 B_mx1_9
    s_waitcnt lgkmcnt(0)
    s_add_u32 m0, s36, 0
    s_add_u32 s26, s78, 5767168
    buffer_load_dwordx4 v15, s[4:7], s26 offen offset:1024 sc1 lds
    buffer_load_dwordx4 v15, s[4:7], s26 offen offset:2048 sc1 lds
    buffer_load_dwordx4 v15, s[4:7], s26 offen offset:3072 sc1 lds
    s_add_u32 m0, s36, 4096
    s_add_u32 s26, s79, 5767168
    buffer_load_dwordx4 v15, s[4:7], s26 offen offset:0 sc1 lds
    buffer_load_dwordx4 v15, s[4:7], s26 offen offset:1024 sc1 lds
    buffer_load_dwordx4 v15, s[4:7], s26 offen offset:2048 sc1 lds
    buffer_load_dwordx4 v15, s[4:7], s26 offen offset:3072 sc1 lds
    s_waitcnt vmcnt(0)
    ds_read_b64_tr_b16 v[52:53], v6 offset:1024
    ds_read_b64_tr_b16 v[54:55], v6 offset:1536
    ds_read_b64_tr_b16 v[56:57], v6 offset:2048
    ds_read_b64_tr_b16 v[58:59], v6 offset:2560
    s_waitcnt lgkmcnt(0)
    v_max3_u32 v14, v52, v53, v54
    v_max_u32 v14, v14, v55
    v_cmp_eq_u32 vcc, -1, v14
    s_cbranch_vccnz R_mx1_9
    s_branch B_mx1_9
R_mx1_10:
    s_add_u32 s21, s21, 1
    s_cmp_gt_u32 s21, 4096
    s_cbranch_scc1 B_mx1_10
    s_waitcnt lgkmcnt(0)
    s_add_u32 m0, s36, 0
    s_add_u32 s26, s78, 5767168
    buffer_load_dwordx4 v15, s[4:7], s26 offen offset:2048 sc1 lds
    buffer_load_dwordx4 v15, s[4:7], s26 offen offset:3072 sc1 lds
    s_add_u32 m0, s36, 4096
    s_add_u32 s26, s79, 5767168
    buffer_load_dwordx4 v15, s[4:7], s26 offen offset:0 sc1 lds
    buffer_load_dwordx4 v15, s[4:7], s26 offen offset:1024 sc1 lds
    buffer_load_dwordx4 v15, s[4:7], s26 offen offset:2048 sc1 lds
    buffer_load_dwordx4 v15, s[4:7], s26 offen offset:3072 sc1 lds
    s_add_u32 m0, s36, 0
    s_add_u32 s26, s80, 5767168
    buffer_load_dwordx4 v15, s[4:7], s26 offen offset:0 sc1 lds
    s_waitcnt vmcnt(0)
    ds_read_b64_tr_b16 v[56:57], v6 offset:2048
    ds_read_b64_tr_b16 v[58:59], v6 offset:2560
    ds_read_b64_tr_b16 v[60:61], v6 offset:3072
    ds_read_b64_tr_b16 v[62:63], v6 offset:3584
    s_waitcnt lgkmcnt(0)
    v_max3_u32 v14, v56, v57, v58
    v_max_u32 v14, v14, v59
    v_cmp_eq_u32 vcc, -1, v14
    s_cbranch_vccnz R_mx1_10
    s_branch B_mx1_10
R_mx1_11:
    s_add_u32 s21, s21, 1
    s_cmp_gt_u32 s21, 4096
    s_cbranch_scc1 B_mx1_11
    s_waitcnt lgkmcnt(0)
    s_add_u32 m0, s36, 0
    s_add_u32 s26, s78, 5767168
    buffer_load_dwordx4 v15, s[4:7], s26 offen offset:3072 sc1 lds
    s_add_u32 m0, s36, 4096
    s_add_u32 s26, s79, 5767168
    buffer_load_dwordx4 v15, s[4:7], s26 offen offset:0 sc1 lds
    buffer_load_dwordx4 v15, s[4:7], s26 offen offset:1024 sc1 lds
    buffer_load_dwordx4 v15, s[4:7], s26 offen offset:2048 sc1 lds
    buffer_load_dwordx4 v15, s[4:7], s26 offen offset:3072 sc1 lds
    s_add_u32 m0, s36, 0
    s_add_u32 s26, s80, 5767168
    buffer_load_dwordx4 v15, s[4:7], s26 offen offset:0 sc1 lds
    buffer_load_dwordx4 v15, s[4:7], s26 offen offset:1024 sc1 lds
    s_waitcnt vmcnt(0)
    ds_read_b64_tr_b16 v[60:61], v6 offset:3072
    ds_read_b64_tr_b16 v[62:63], v6 offset:3584
    ds_read_b64_tr_b16 v[64:65], v6 offset:4096
    ds_read_b64_tr_b16 v[66:67], v6 offset:4608
    s_waitcnt lgkmcnt(0)
    v_max3_u32 v14, v60, v61, v62
    v_max_u32 v14, v14, v63
    v_cmp_eq_u32 vcc, -1, v14
    s_cbranch_vccnz R_mx1_11
    s_branch B_mx1_11
R_mx1_12:
    s_add_u32 s21, s21, 1
    s_cmp_gt_u32 s21, 4096
    s_cbranch_scc1 B_mx1_12
    s_waitcnt lgkmcnt(0)
    s_add_u32 m0, s36, 4096
    s_add_u32 s26, s79, 5767168
    buffer_load_dwordx4 v15, s[4:7], s26 offen offset:0 sc1 lds
    buffer_load_dwordx4 v15, s[4:7], s26 offen offset:1024 sc1 lds
    buffer_load_dwordx4 v15, s[4:7], s26 offen offset:2048 sc1 lds
    buffer_load_dwordx4 v15, s[4:7], s26 offen offset:3072 sc1 lds
    s_add_u32 m0, s36, 0
    s_add_u32 s26, s80, 5767168
    buffer_load_dwordx4 v15, s[4:7], s26 offen offset:0 sc1 lds
    buffer_load_dwordx4 v15, s[4:7], s26 offen offset:1024 sc1 lds
    buffer_load_dwordx4 v15, s[4:7], s26 offen offset:2048 sc1 lds
    s_waitcnt vmcnt(0)
    ds_read_b64_tr_b16 v[64:65], v6 offset:4096
    ds_read_b64_tr_b16 v[66:67], v6 offset:4608
    ds_read_b64_tr_b16 v[68:69], v6 offset:5120
    ds_read_b64_tr_b16 v[70:71], v6 offset:5632
    s_waitcnt lgkmcnt(0)
    v_max3_u32 v14, v64, v65, v66
    v_max_u32 v14, v14, v67
    v_cmp_eq_u32 vcc, -1, v14
    s_cbranch_vccnz R_mx1_12
    s_branch B_mx1_12
R_mx1_13:
    s_add_u32 s21, s21, 1
    s_cmp_gt_u32 s21, 4096
    s_cbranch_scc1 B_mx1_13
    s_waitcnt lgkmcnt(0)
    s_add_u32 m0, s36, 4096
    s_add_u32 s26, s79, 5767168
    buffer_load_dwordx4 v15, s[4:7], s26 offen offset:1024 sc1 lds
    buffer_load_dwordx4 v15, s[4:7], s26 offen offset:2048 sc1 lds
    buffer_load_dwordx4 v15, s[4:7], s26 offen offset:3072 sc1 lds
    s_add_u32 m0, s36, 0
    s_add_u32 s26, s80, 5767168
    buffer_load_dwordx4 v15, s[4:7], s26 offen offset:0 sc1 lds
    buffer_load_dwordx4 v15, s[4:7], s26 offen offset:1024 sc1 lds
    buffer_load_dwordx4 v15, s[4:7], s26 offen offset:2048 sc1 lds
    buffer_load_dwordx4 v15, s[4:7], s26 offen offset:3072 sc1 lds
    s_waitcnt vmcnt(0)
    ds_read_b64_tr_b16 v[68:69], v6 offset:5120
    ds_read_b64_tr_b16 v[70:71], v6 offset:5632
    ds_read_b64_tr_b16 v[72:73], v6 offset:6144
    ds_read_b64_tr_b16 v[74:75], v6 offset:6656
    s_waitcnt lgkmcnt(0)
    v_max3_u32 v14, v68, v69, v70
    v_max_u32 v14, v14, v71
    v_cmp_eq_u32 vcc, -1, v14
    s_cbranch_vccnz R_mx1_13
    s_branch B_mx1_13
R_mx1_14:
    s_add_u32 s21, s21, 1
    s_cmp_gt_u32 s21, 4096
    s_cbranch_scc1 B_mx1_14
    s_waitcnt lgkmcnt(0)
    s_add_u32 m0, s36, 4096
    s_add_u32 s26, s79, 5767168
    buffer_load_dwordx4 v15, s[4:7], s26 offen offset:2048 sc1 lds
    buffer_load_dwordx4 v15, s[4:7], s26 offen offset:3072 sc1 lds
    s_add_u32 m0, s36, 0
    s_add_u32 s26, s80, 5767168
    buffer_load_dwordx4 v15, s[4:7], s26 offen offset:0 sc1 lds
    buffer_load_dwordx4 v15, s[4:7], s26 offen offset:1024 sc1 lds
    buffer_load_dwordx4 v15, s[4:7], s26 offen offset:2048 sc1 lds
    buffer_load_dwordx4 v15, s[4:7], s26 offen offset:3072 sc1 lds
    s_add_u32 m0, s36, 4096
    s_add_u32 s26, s81, 5767168
    buffer_load_dwordx4 v15, s[4:7], s26 offen offset:0 sc1 lds
    s_waitcnt vmcnt(0)
    ds_read_b64_tr_b16 v[72:73], v6 offset:6144
    ds_read_b64_tr_b16 v[74:75], v6 offset:6656
    ds_read_b64_tr_b16 v[76:77], v6 offset:7168
    ds_read_b64_tr_b16 v[78:79], v6 offset:7680
    s_waitcnt lgkmcnt(0)
    v_max3_u32 v14, v72, v73, v74
    v_max_u32 v14, v14, v75
    v_cmp_eq_u32 vcc, -1, v14
    s_cbranch_vccnz R_mx1_14
    s_branch B_mx1_14
R_mx1_15:
    s_add_u32 s21, s21, 1
    s_cmp_gt_u32 s21, 4096
    s_cbranch_scc1 B_mx1_15
    s_waitcnt lgkmcnt(0)
    s_add_u32 m0, s36, 4096
    s_add_u32 s26, s79, 5767168
    buffer_load_dwordx4 v15, s[4:7], s26 offen offset:3072 sc1 lds
    s_add_u32 m0, s36, 0
    s_add_u32 s26, s80, 5767168
    buffer_load_dwordx4 v15, s[4:7], s26 offen offset:0 sc1 lds
    buffer_load_dwordx4 v15, s[4:7], s26 offen offset:1024 sc1 lds
    buffer_load_dwordx4 v15, s[4:7], s26 offen offset:2048 sc1 lds
    buffer_load_dwordx4 v15, s[4:7], s26 offen offset:3072 sc1 lds
    s_add_u32 m0, s36, 4096
    s_add_u32 s26, s81, 5767168
    buffer_load_dwordx4 v15, s[4:7], s26 offen offset:0 sc1 lds
    buffer_load_dwordx4 v15, s[4:7], s26 offen offset:1024 sc1 lds
    s_waitcnt vmcnt(0)
    ds_read_b64_tr_b16 v[76:77], v6 offset:7168
    ds_read_b64_tr_b16 v[78:79], v6 offset:7680
    ds_read_b64_tr_b16 v[80:81], v6 offset:0
    ds_read_b64_tr_b16 v[82:83], v6 offset:512
    s_waitcnt lgkmcnt(0)
    v_max3_u32 v14, v76, v77, v78
    v_max_u32 v14, v14, v79
    v_cmp_eq_u32 vcc, -1, v14
    s_cbranch_vccnz R_mx1_15
    s_branch B_mx1_15
R_mx1_16:
    s_add_u32 s21, s21, 1
    s_cmp_gt_u32 s21, 4096
    s_cbranch_scc1 B_mx1_16
    s_waitcnt lgkmcnt(0)
    s_add_u32 m0, s36, 0
    s_add_u32 s26, s80, 5767168
    buffer_load_dwordx4 v15, s[4:7], s26 offen offset:0 sc1 lds
    buffer_load_dwordx4 v15, s[4:7], s26 offen offset:1024 sc1 lds
    buffer_load_dwordx4 v15, s[4:7], s26 offen offset:2048 sc1 lds
    buffer_load_dwordx4 v15, s[4:7], s26 offen offset:3072 sc1 lds
    s_add_u32 m0, s36, 4096
    s_add_u32 s26, s81, 5767168
    buffer_load_dwordx4 v15, s[4:7], s26 offen offset:0 sc1 lds
    buffer_load_dwordx4 v15, s[4:7], s26 offen offset:1024 sc1 lds
    buffer_load_dwordx4 v15, s[4:7], s26 offen offset:2048 sc1 lds
    s_waitcnt vmcnt(0)
    ds_read_b64_tr_b16 v[80:81], v6 offset:0
    ds_read_b64_tr_b16 v[82:83], v6 offset:512
    ds_read_b64_tr_b16 v[84:85], v6 offset:1024
    ds_read_b64_tr_b16 v[86:87], v6 offset:1536
    s_waitcnt lgkmcnt(0)
    v_max3_u32 v14, v80, v81, v82
    v_max_u32 v14, v14, v83
    v_cmp_eq_u32 vcc, -1, v14
    s_cbranch_vccnz R_mx1_16
    s_branch B_mx1_16
R_mx1_17:
    s_add_u32 s21, s21, 1
    s_cmp_gt_u32 s21, 4096
    s_cbranch_scc1 B_mx1_17
    s_waitcnt lgkmcnt(0)
    s_add_u32 m0, s36, 0
    s_add_u32 s26, s80, 5767168
    buffer_load_dwordx4 v15, s[4:7], s26 offen offset:1024 sc1 lds
    buffer_load_dwordx4 v15, s[4:7], s26 offen offset:2048 sc1 lds
    buffer_load_dwordx4 v15, s[4:7], s26 offen offset:3072 sc1 lds
    s_add_u32 m0, s36, 4096
    s_add_u32 s26, s81, 5767168
    buffer_load_dwordx4 v15, s[4:7], s26 offen offset:0 sc1 lds
    buffer_load_dwordx4 v15, s[4:7], s26 offen offset:1024 sc1 lds
    buffer_load_dwordx4 v15, s[4:7], s26 offen offset:2048 sc1 lds
    buffer_load_dwordx4 v15, s[4:7], s26 offen offset:3072 sc1 lds
    s_waitcnt vmcnt(0)
    ds_read_b64_tr_b16 v[84:85], v6 offset:1024
    ds_read_b64_tr_b16 v[86:87], v6 offset:1536
    ds_read_b64_tr_b16 v[88:89], v6 offset:2048
    ds_read_b64_tr_b16 v[90:91], v6 offset:2560
    s_waitcnt lgkmcnt(0)
    v_max3_u32 v14, v84, v85, v86
    v_max_u32 v14, v14, v87
    v_cmp_eq_u32 vcc, -1, v14
    s_cbranch_vccnz R_mx1_17
    s_branch B_mx1_17
R_mx1_18:
    s_add_u32 s21, s21, 1
    s_cmp_gt_u32 s21, 4096
    s_cbranch_scc1 B_mx1_18
    s_waitcnt lgkmcnt(0)
    s_add_u32 m0, s36, 0
    s_add_u32 s26, s80, 5767168
    buffer_load_dwordx4 v15, s[4:7], s26 offen offset:2048 sc1 lds
    buffer_load_dwordx4 v15, s[4:7], s26 offen offset:3072 sc1 lds
    s_add_u32 m0, s36, 4096
    s_add_u32 s26, s81, 5767168
    buffer_load_dwordx4 v15, s[4:7], s26 offen offset:0 sc1 lds
    buffer_load_dwordx4 v15, s[4:7], s26 offen offset:1024 sc1 lds
    buffer_load_dwordx4 v15, s[4:7], s26 offen offset:2048 sc1 lds
    buffer_load_dwordx4 v15, s[4:7], s26 offen offset:3072 sc1 lds
    s_add_u32 m0, s36, 0
    s_add_u32 s26, s82, 5767168
    buffer_load_dwordx4 v15, s[4:7], s26 offen offset:0 sc1 lds
    s_waitcnt vmcnt(0)
    ds_read_b64_tr_b16 v[88:89], v6 offset:2048
    ds_read_b64_tr_b16 v[90:91], v6 offset:2560
    ds_read_b64_tr_b16 v[92:93], v6 offset:3072
    ds_read_b64_tr_b16 v[94:95], v6 offset:3584
    s_waitcnt lgkmcnt(0)
    v_max3_u32 v14, v88, v89, v90
    v_max_u32 v14, v14, v91
    v_cmp_eq_u32 vcc, -1, v14
    s_cbranch_vccnz R_mx1_18
    s_branch B_mx1_18
R_mx1_19:
    s_add_u32 s21, s21, 1
    s_cmp_gt_u32 s21, 4096
    s_cbranch_scc1 B_mx1_19
    s_waitcnt lgkmcnt(0)
    s_add_u32 m0, s36, 0
    s_add_u32 s26, s80, 5767168
    buffer_load_dwordx4 v15, s[4:7], s26 offen offset:3072 sc1 lds
    s_add_u32 m0, s36, 4096
    s_add_u32 s26, s81, 5767168
    buffer_load_dwordx4 v15, s[4:7], s26 offen offset:0 sc1 lds
    buffer_load_dwordx4 v15, s[4:7], s26 offen offset:1024 sc1 lds
    buffer_load_dwordx4 v15, s[4:7], s26 offen offset:2048 sc1 lds
    buffer_load_dwordx4 v15, s[4:7], s26 offen offset:3072 sc1 lds
    s_add_u32 m0, s36, 0
    s_add_u32 s26, s82, 5767168
    buffer_load_dwordx4 v15, s[4:7], s26 offen offset:0 sc1 lds
    buffer_load_dwordx4 v15, s[4:7], s26 offen offset:1024 sc1 lds
    s_waitcnt vmcnt(0)
    ds_read_b64_tr_b16 v[92:93], v6 offset:3072
    ds_read_b64_tr_b16 v[94:95], v6 offset:3584
    ds_read_b64_tr_b16 v[96:97], v6 offset:4096
    ds_read_b64_tr_b16 v[98:99], v6 offset:4608
    s_waitcnt lgkmcnt(0)
    v_max3_u32 v14, v92, v93, v94
    v_max_u32 v14, v14, v95
    v_cmp_eq_u32 vcc, -1, v14
    s_cbranch_vccnz R_mx1_19
    s_branch B_mx1_19
R_mx1_20:
    s_add_u32 s21, s21, 1
    s_cmp_gt_u32 s21, 4096
    s_cbranch_scc1 B_mx1_20
    s_waitcnt lgkmcnt(0)
    s_add_u32 m0, s36, 4096
    s_add_u32 s26, s81, 5767168
    buffer_load_dwordx4 v15, s[4:7], s26 offen offset:0 sc1 lds
    buffer_load_dwordx4 v15, s[4:7], s26 offen offset:1024 sc1 lds
    buffer_load_dwordx4 v15, s[4:7], s26 offen offset:2048 sc1 lds
    buffer_load_dwordx4 v15, s[4:7], s26 offen offset:3072 sc1 lds
    s_add_u32 m0, s36, 0
    s_add_u32 s26, s82, 5767168
    buffer_load_dwordx4 v15, s[4:7], s26 offen offset:0 sc1 lds
    buffer_load_dwordx4 v15, s[4:7], s26 offen offset:1024 sc1 lds
    buffer_load_dwordx4 v15, s[4:7], s26 offen offset:2048 sc1 lds
    s_waitcnt vmcnt(0)
    ds_read_b64_tr_b16 v[96:97], v6 offset:4096
    ds_read_b64_tr_b16 v[98:99], v6 offset:4608
    ds_read_b64_tr_b16 v[100:101], v6 offset:5120
    ds_read_b64_tr_b16 v[102:103], v6 offset:5632
    s_waitcnt lgkmcnt(0)
    v_max3_u32 v14, v96, v97, v98
    v_max_u32 v14, v14, v99
    v_cmp_eq_u32 vcc, -1, v14
    s_cbranch_vccnz R_mx1_20
    s_branch B_mx1_20
R_mx1_21:
    s_add_u32 s21, s21, 1
    s_cmp_gt_u32 s21, 4096
    s_cbranch_scc1 B_mx1_21
    s_waitcnt lgkmcnt(0)
    s_add_u32 m0, s36, 4096
    s_add_u32 s26, s81, 5767168
    buffer_load_dwordx4 v15, s[4:7], s26 offen offset:1024 sc1 lds
    buffer_load_dwordx4 v15, s[4:7], s26 offen offset:2048 sc1 lds
    buffer_load_dwordx4 v15, s[4:7], s26 offen offset:3072 sc1 lds
    s_add_u32 m0, s36, 0
    s_add_u32 s26, s82, 5767168
    buffer_load_dwordx4 v15, s[4:7], s26 offen offset:0 sc1 lds
    buffer_load_dwordx4 v15, s[4:7], s26 offen offset:1024 sc1 lds
    buffer_load_dwordx4 v15, s[4:7], s26 offen offset:2048 sc1 lds
    buffer_load_dwordx4 v15, s[4:7], s26 offen offset:3072 sc1 lds
    s_waitcnt vmcnt(0)
    ds_read_b64_tr_b16 v[100:101], v6 offset:5120
    ds_read_b64_tr_b16 v[102:103], v6 offset:5632
    ds_read_b64_tr_b16 v[104:105], v6 offset:6144
    ds_read_b64_tr_b16 v[106:107], v6 offset:6656
    s_waitcnt lgkmcnt(0)
    v_max3_u32 v14, v100, v101, v102
    v_max_u32 v14, v14, v103
    v_cmp_eq_u32 vcc, -1, v14
    s_cbranch_vccnz R_mx1_21
    s_branch B_mx1_21
R_mx1_22:
    s_add_u32 s21, s21, 1
    s_cmp_gt_u32 s21, 4096
    s_cbranch_scc1 B_mx1_22
    s_waitcnt lgkmcnt(0)
    s_add_u32 m0, s36, 4096
    s_add_u32 s26, s81, 5767168
    buffer_load_dwordx4 v15, s[4:7], s26 offen offset:2048 sc1 lds
    buffer_load_dwordx4 v15, s[4:7], s26 offen offset:3072 sc1 lds
    s_add_u32 m0, s36, 0
    s_add_u32 s26, s82, 5767168
    buffer_load_dwordx4 v15, s[4:7], s26 offen offset:0 sc1 lds
    buffer_load_dwordx4 v15, s[4:7], s26 offen offset:1024 sc1 lds
    buffer_load_dwordx4 v15, s[4:7], s26 offen offset:2048 sc1 lds
    buffer_load_dwordx4 v15, s[4:7], s26 offen offset:3072 sc1 lds
    s_waitcnt vmcnt(0)
    ds_read_b64_tr_b16 v[104:105], v6 offset:6144
    ds_read_b64_tr_b16 v[106:107], v6 offset:6656
    ds_read_b64_tr_b16 v[108:109], v6 offset:7168
    ds_read_b64_tr_b16 v[110:111], v6 offset:7680
    s_waitcnt lgkmcnt(0)
    v_max3_u32 v14, v104, v105, v106
    v_max_u32 v14, v14, v107
    v_cmp_eq_u32 vcc, -1, v14
    s_cbranch_vccnz R_mx1_22
    s_branch B_mx1_22
R_mx1_23:
    s_add_u32 s21, s21, 1
    s_cmp_gt_u32 s21, 4096
    s_cbranch_scc1 B_mx1_23
    s_waitcnt lgkmcnt(0)
    s_add_u32 m0, s36, 4096
    s_add_u32 s26, s81, 5767168
    buffer_load_dwordx4 v15, s[4:7], s26 offen offset:3072 sc1 lds
    s_add_u32 m0, s36, 0
    s_add_u32 s26, s82, 5767168
    buffer_load_dwordx4 v15, s[4:7], s26 offen offset:0 sc1 lds
    buffer_load_dwordx4 v15, s[4:7], s26 offen offset:1024 sc1 lds
    buffer_load_dwordx4 v15, s[4:7], s26 offen offset:2048 sc1 lds
    buffer_load_dwordx4 v15, s[4:7], s26 offen offset:3072 sc1 lds
    s_waitcnt vmcnt(0)
    ds_read_b64_tr_b16 v[108:109], v6 offset:7168
    ds_read_b64_tr_b16 v[110:111], v6 offset:7680
    ds_read_b64_tr_b16 v[112:113], v6 offset:0
    ds_read_b64_tr_b16 v[114:115], v6 offset:512
    s_waitcnt lgkmcnt(0)
    v_max3_u32 v14, v108, v109, v110
    v_max_u32 v14, v14, v111
    v_cmp_eq_u32 vcc, -1, v14
    s_cbranch_vccnz R_mx1_23
    s_branch B_mx1_23
R_mx1_24:
    s_add_u32 s21, s21, 1
    s_cmp_gt_u32 s21, 4096
    s_cbranch_scc1 B_mx1_24
    s_waitcnt lgkmcnt(0)
    s_add_u32 m0, s36, 0
    s_add_u32 s26, s82, 5767168
    buffer_load_dwordx4 v15, s[4:7], s26 offen offset:0 sc1 lds
    buffer_load_dwordx4 v15, s[4:7], s26 offen offset:1024 sc1 lds
    buffer_load_dwordx4 v15, s[4:7], s26 offen offset:2048 sc1 lds
    buffer_load_dwordx4 v15, s[4:7], s26 offen offset:3072 sc1 lds
    s_waitcnt vmcnt(0)
    ds_read_b64_tr_b16 v[112:113], v6 offset:0
    ds_read_b64_tr_b16 v[114:115], v6 offset:512
    ds_read_b64_tr_b16 v[116:117], v6 offset:1024
    ds_read_b64_tr_b16 v[118:119], v6 offset:1536
    s_waitcnt lgkmcnt(0)
    v_max3_u32 v14, v112, v113, v114
    v_max_u32 v14, v14, v115
    v_cmp_eq_u32 vcc, -1, v14
    s_cbranch_vccnz R_mx1_24
    s_branch B_mx1_24
R_mx1_25:
    s_add_u32 s21, s21, 1
    s_cmp_gt_u32 s21, 4096
    s_cbranch_scc1 B_mx1_25
    s_waitcnt lgkmcnt(0)
    s_add_u32 m0, s36, 0
    s_add_u32 s26, s82, 5767168
    buffer_load_dwordx4 v15, s[4:7], s26 offen offset:1024 sc1 lds
    buffer_load_dwordx4 v15, s[4:7], s26 offen offset:2048 sc1 lds
    buffer_load_dwordx4 v15, s[4:7], s26 offen offset:3072 sc1 lds
    s_waitcnt vmcnt(0)
    ds_read_b64_tr_b16 v[116:117], v6 offset:1024
    ds_read_b64_tr_b16 v[118:119], v6 offset:1536
    ds_read_b64_tr_b16 v[120:121], v6 offset:2048
    ds_read_b64_tr_b16 v[122:123], v6 offset:2560
    s_waitcnt lgkmcnt(0)
    v_max3_u32 v14, v116, v117, v118
    v_max_u32 v14, v14, v119
    v_cmp_eq_u32 vcc, -1, v14
    s_cbranch_vccnz R_mx1_25
    s_branch B_mx1_25
R_mx1_26:
    s_add_u32 s21, s21, 1
    s_cmp_gt_u32 s21, 4096
    s_cbranch_scc1 B_mx1_26
    s_waitcnt lgkmcnt(0)
    s_add_u32 m0, s36, 0
    s_add_u32 s26, s82, 5767168
    buffer_load_dwordx4 v15, s[4:7], s26 offen offset:2048 sc1 lds
    buffer_load_dwordx4 v15, s[4:7], s26 offen offset:3072 sc1 lds
    s_waitcnt vmcnt(0)
    ds_read_b64_tr_b16 v[120:121], v6 offset:2048
    ds_read_b64_tr_b16 v[122:123], v6 offset:2560
    ds_read_b64_tr_b16 v[124:125], v6 offset:3072
    ds_read_b64_tr_b16 v[126:127], v6 offset:3584
    s_waitcnt lgkmcnt(0)
    v_max3_u32 v14, v120, v121, v122
    v_max_u32 v14, v14, v123
    v_cmp_eq_u32 vcc, -1, v14
    s_cbranch_vccnz R_mx1_26
    s_branch B_mx1_26
R_mx1_27:
    s_add_u32 s21, s21, 1
    s_cmp_gt_u32 s21, 4096
    s_cbranch_scc1 B_mx1_27
    s_waitcnt lgkmcnt(0)
    s_add_u32 m0, s36, 0
    s_add_u32 s26, s82, 5767168
    buffer_load_dwordx4 v15, s[4:7], s26 offen offset:3072 sc1 lds
    s_waitcnt vmcnt(0)
    ds_read_b64_tr_b16 v[124:125], v6 offset:3072
    ds_read_b64_tr_b16 v[126:127], v6 offset:3584
    s_waitcnt lgkmcnt(0)
    v_max3_u32 v14, v124, v125, v126
    v_max_u32 v14, v14, v127
    v_cmp_eq_u32 vcc, -1, v14
    s_cbranch_vccnz R_mx1_27
    s_branch B_mx1_27
R_mrs1:
    s_add_u32 s21, s21, 1
    s_cmp_gt_u32 s21, 4096
    s_cbranch_scc1 B_mrs1
    buffer_load_dword v10, v7, s[4:7], s27 offen sc1
    buffer_load_dword v11, v8, s[4:7], s27 offen sc1
    s_waitcnt vmcnt(0)
    v_add_f32 v10, v10, v11
    v_cmp_u_f32 vcc, v10, v10
    s_cbranch_vccnz R_mrs1
    s_branch B_mrs1
R_mh1_0:
    s_add_u32 s21, s21, 1
    s_cmp_gt_u32 s21, 4096
    s_cbranch_scc1 B_mh1_0
    s_add_u32 s26, s83, 10485760
    buffer_load_dwordx4 v[32:35], v12, s[4:7], s26 offen sc1
    buffer_load_dwordx4 v[36:39], v13, s[4:7], s26 offen sc1
    s_add_u32 s26, s84, 10485760
    s_waitcnt vmcnt(17)
    buffer_load_dwordx4 v[40:43], v12, s[4:7], s26 offen sc1
    s_waitcnt vmcnt(17)
    buffer_load_dwordx4 v[44:47], v13, s[4:7], s26 offen sc1
    s_add_u32 s26, s85, 10485760
    s_waitcnt vmcnt(17)
    buffer_load_dwordx4 v[48:51], v12, s[4:7], s26 offen sc1
    s_waitcnt vmcnt(17)
    buffer_load_dwordx4 v[52:55], v13, s[4:7], s26 offen sc1
    s_add_u32 s26, s86, 10485760
    s_waitcnt vmcnt(17)
    buffer_load_dwordx4 v[56:59], v12, s[4:7], s26 offen sc1
    s_waitcnt vmcnt(17)
    buffer_load_dwordx4 v[60:63], v13, s[4:7], s26 offen sc1
    s_add_u32 s26, s87, 10485760
    s_waitcnt vmcnt(16)
    buffer_load_dwordx4 v[64:67], v12, s[4:7], s26 offen sc1
    s_waitcnt vmcnt(16)
    buffer_load_dwordx4 v[68:71], v13, s[4:7], s26 offen sc1
    s_add_u32 s26, s88, 10485760
    s_waitcnt vmcnt(16)
    buffer_load_dwordx4 v[72:75], v12, s[4:7], s26 offen sc1
    s_waitcnt vmcnt(16)
    buffer_load_dwordx4 v[76:79], v13, s[4:7], s26 offen sc1
    s_add_u32 s26, s89, 10485760
    s_waitcnt vmcnt(15)
    buffer_load_dwordx4 v[80:83], v12, s[4:7], s26 offen sc1
    s_waitcnt vmcnt(15)
    buffer_load_dwordx4 v[84:87], v13, s[4:7], s26 offen sc1
    s_add_u32 s26, s83, 10543104
    s_waitcnt vmcnt(15)
    buffer_load_dwordx4 v[88:91], v12, s[4:7], s26 offen sc1
    s_waitcnt vmcnt(15)
    buffer_load_dwordx4 v[92:95], v13, s[4:7], s26 offen sc1
    s_waitcnt vmcnt(0)
    v_max_u32 v14, v35, v39
    v_cmp_eq_u32 vcc, -1, v14
    s_cbranch_vccnz R_mh1_0
    s_branch B_mh1_0
R_mh1_1:
    s_add_u32 s21, s21, 1
    s_cmp_gt_u32 s21, 4096
    s_cbranch_scc1 B_mh1_1
    s_add_u32 s26, s84, 10485760
    buffer_load_dwordx4 v[40:43], v12, s[4:7], s26 offen sc1
    buffer_load_dwordx4 v[44:47], v13, s[4:7], s26 offen sc1
    s_add_u32 s26, s85, 10485760
    s_waitcnt vmcnt(15)
    buffer_load_dwordx4 v[48:51], v12, s[4:7], s26 offen sc1
    s_waitcnt vmcnt(15)
    buffer_load_dwordx4 v[52:55], v13, s[4:7], s26 offen sc1
    s_add_u32 s26, s86, 10485760
    s_waitcnt vmcnt(15)
    buffer_load_dwordx4 v[56:59], v12, s[4:7], s26 offen sc1
    s_waitcnt vmcnt(15)
    buffer_load_dwordx4 v[60:63], v13, s[4:7], s26 offen sc1
    s_add_u32 s26, s87, 10485760
    s_waitcnt vmcnt(14)
    buffer_load_dwordx4 v[64:67], v12, s[4:7], s26 offen sc1
    s_waitcnt vmcnt(14)
    buffer_load_dwordx4 v[68:71], v13, s[4:7], s26 offen sc1
    s_add_u32 s26, s88, 10485760
    s_waitcnt vmcnt(14)
    buffer_load_dwordx4 v[72:75], v12, s[4:7], s26 offen sc1
    s_waitcnt vmcnt(14)
    buffer_load_dwordx4 v[76:79], v13, s[4:7], s26 offen sc1
    s_add_u32 s26, s89, 10485760
    s_waitcnt vmcnt(13)
    buffer_load_dwordx4 v[80:83], v12, s[4:7], s26 offen sc1
    s_waitcnt vmcnt(13)
    buffer_load_dwordx4 v[84:87], v13, s[4:7], s26 offen sc1
    s_add_u32 s26, s83, 10543104
    s_waitcnt vmcnt(13)
    buffer_load_dwordx4 v[88:91], v12, s[4:7], s26 offen sc1
    s_waitcnt vmcnt(13)
    buffer_load_dwordx4 v[92:95], v13, s[4:7], s26 offen sc1
    s_waitcnt vmcnt(0)
    v_max_u32 v14, v43, v47
    v_cmp_eq_u32 vcc, -1, v14
    s_cbranch_vccnz R_mh1_1
    s_branch B_mh1_1
R_mh1_2:
    s_add_u32 s21, s21, 1
    s_cmp_gt_u32 s21, 4096
    s_cbranch_scc1 B_mh1_2
    s_add_u32 s26, s85, 10485760
    buffer_load_dwordx4 v[48:51], v12, s[4:7], s26 offen sc1
    buffer_load_dwordx4 v[52:55], v13, s[4:7], s26 offen sc1
    s_add_u32 s26, s86, 10485760
    s_waitcnt vmcnt(15)
    buffer_load_dwordx4 v[56:59], v12, s[4:7], s26 offen sc1
    s_waitcnt vmcnt(15)
    buffer_load_dwordx4 v[60:63], v13, s[4:7], s26 offen sc1
    s_add_u32 s26, s87, 10485760
    s_waitcnt vmcnt(14)
    buffer_load_dwordx4 v[64:67], v12, s[4:7], s26 offen sc1
    s_waitcnt vmcnt(14)
    buffer_load_dwordx4 v[68:71], v13, s[4:7], s26 offen sc1
    s_add_u32 s26, s88, 10485760
    s_waitcnt vmcnt(14)
    buffer_load_dwordx4 v[72:75], v12, s[4:7], s26 offen sc1
    s_waitcnt vmcnt(14)
    buffer_load_dwordx4 v[76:79], v13, s[4:7], s26 offen sc1
    s_add_u32 s26, s89, 10485760
    s_waitcnt vmcnt(13)
    buffer_load_dwordx4 v[80:83], v12, s[4:7], s26 offen sc1
    s_waitcnt vmcnt(13)
    buffer_load_dwordx4 v[84:87], v13, s[4:7], s26 offen sc1
    s_add_u32 s26, s83, 10543104
    s_waitcnt vmcnt(13)
    buffer_load_dwordx4 v[88:91], v12, s[4:7], s26 offen sc1
    s_waitcnt vmcnt(13)
    buffer_load_dwordx4 v[92:95], v13, s[4:7], s26 offen sc1
    s_add_u32 s26, s84, 10543104
    s_waitcnt vmcnt(13)
    buffer_load_dwordx4 v[32:35], v12, s[4:7], s26 offen sc1
    s_waitcnt vmcnt(13)
    buffer_load_dwordx4 v[36:39], v13, s[4:7], s26 offen sc1
    s_waitcnt vmcnt(0)
    v_max_u32 v14, v51, v55
    v_cmp_eq_u32 vcc, -1, v14
    s_cbranch_vccnz R_mh1_2
    s_branch B_mh1_2
R_mh1_3:
    s_add_u32 s21, s21, 1
    s_cmp_gt_u32 s21, 4096
    s_cbranch_scc1 B_mh1_3
    s_add_u32 s26, s86, 10485760
    buffer_load_dwordx4 v[56:59], v12, s[4:7], s26 offen sc1
    buffer_load_dwordx4 v[60:63], v13, s[4:7], s26 offen sc1
    s_add_u32 s26, s87, 10485760
    s_waitcnt vmcnt(14)
    buffer_load_dwordx4 v[64:67], v12, s[4:7], s26 offen sc1
    s_waitcnt vmcnt(14)
    buffer_load_dwordx4 v[68:71], v13, s[4:7], s26 offen sc1
    s_add_u32 s26, s88, 10485760
    s_waitcnt vmcnt(14)
    buffer_load_dwordx4 v[72:75], v12, s[4:7], s26 offen sc1
    s_waitcnt vmcnt(14)
    buffer_load_dwordx4 v[76:79], v13, s[4:7], s26 offen sc1
    s_add_u32 s26, s89, 10485760
    s_waitcnt vmcnt(13)
    buffer_load_dwordx4 v[80:83], v12, s[4:7], s26 offen sc1
    s_waitcnt vmcnt(13)
    buffer_load_dwordx4 v[84:87], v13, s[4:7], s26 offen sc1
    s_add_u32 s26, s83, 10543104
    s_waitcnt vmcnt(13)
    buffer_load_dwordx4 v[88:91], v12, s[4:7], s26 offen sc1
    s_waitcnt vmcnt(13)
    buffer_load_dwordx4 v[92:95], v13, s[4:7], s26 offen sc1
    s_add_u32 s26, s84, 10543104
    s_waitcnt vmcnt(13)
    buffer_load_dwordx4 v[32:35], v12, s[4:7], s26 offen sc1
    s_waitcnt vmcnt(13)
    buffer_load_dwordx4 v[36:39], v13, s[4:7], s26 offen sc1
    s_add_u32 s26, s85, 10543104
    s_waitcnt vmcnt(13)
    buffer_load_dwordx4 v[40:43], v12, s[4:7], s26 offen sc1
    s_waitcnt vmcnt(13)
    buffer_load_dwordx4 v[44:47], v13, s[4:7], s26 offen sc1
    s_waitcnt vmcnt(0)
    v_max_u32 v14, v59, v63
    v_cmp_eq_u32 vcc, -1, v14
    s_cbranch_vccnz R_mh1_3
    s_branch B_mh1_3
R_mh1_4:
    s_add_u32 s21, s21, 1
    s_cmp_gt_u32 s21, 4096
    s_cbranch_scc1 B_mh1_4
    s_add_u32 s26, s87, 10485760
    buffer_load_dwordx4 v[64:67], v12, s[4:7], s26 offen sc1
    buffer_load_dwordx4 v[68:71], v13, s[4:7], s26 offen sc1
    s_add_u32 s26, s88, 10485760
    s_waitcnt vmcnt(15)
    buffer_load_dwordx4 v[72:75], v12, s[4:7], s26 offen sc1
    s_waitcnt vmcnt(15)
    buffer_load_dwordx4 v[76:79], v13, s[4:7], s26 offen sc1
    s_add_u32 s26, s89, 10485760
    s_waitcnt vmcnt(14)
    buffer_load_dwordx4 v[80:83], v12, s[4:7], s26 offen sc1
    s_waitcnt vmcnt(14)
    buffer_load_dwordx4 v[84:87], v13, s[4:7], s26 offen sc1
    s_add_u32 s26, s83, 10543104
    s_waitcnt vmcnt(14)
    buffer_load_dwordx4 v[88:91], v12, s[4:7], s26 offen sc1
    s_waitcnt vmcnt(14)
    buffer_load_dwordx4 v[92:95], v13, s[4:7], s26 offen sc1
    s_add_u32 s26, s84, 10543104
    s_waitcnt vmcnt(14)
    buffer_load_dwordx4 v[32:35], v12, s[4:7], s26 offen sc1
    s_waitcnt vmcnt(14)
    buffer_load_dwordx4 v[36:39], v13, s[4:7], s26 offen sc1
    s_add_u32 s26, s85, 10543104
    s_waitcnt vmcnt(14)
    buffer_load_dwordx4 v[40:43], v12, s[4:7], s26 offen sc1
    s_waitcnt vmcnt(14)
    buffer_load_dwordx4 v[44:47], v13, s[4:7], s26 offen sc1
    s_add_u32 s26, s86, 10543104
    s_waitcnt vmcnt(14)
    buffer_load_dwordx4 v[48:51], v12, s[4:7], s26 offen sc1
    s_waitcnt vmcnt(14)
    buffer_load_dwordx4 v[52:55], v13, s[4:7], s26 offen sc1
    s_waitcnt vmcnt(0)
    v_max_u32 v14, v67, v71
    v_cmp_eq_u32 vcc, -1, v14
    s_cbranch_vccnz R_mh1_4
    s_branch B_mh1_4
R_mh1_5:
    s_add_u32 s21, s21, 1
    s_cmp_gt_u32 s21, 4096
    s_cbranch_scc1 B_mh1_5
    s_add_u32 s26, s88, 10485760
    buffer_load_dwordx4 v[72:75], v12, s[4:7], s26 offen sc1
    buffer_load_dwordx4 v[76:79], v13, s[4:7], s26 offen sc1
    s_add_u32 s26, s89, 10485760
    s_waitcnt vmcnt(14)
    buffer_load_dwordx4 v[80:83], v12, s[4:7], s26 offen sc1
    s_waitcnt vmcnt(14)
    buffer_load_dwordx4 v[84:87], v13, s[4:7], s26 offen sc1
    s_add_u32 s26, s83, 10543104
    s_waitcnt vmcnt(14)
    buffer_load_dwordx4 v[88:91], v12, s[4:7], s26 offen sc1
    s_waitcnt vmcnt(14)
    buffer_load_dwordx4 v[92:95], v13, s[4:7], s26 offen sc1
    s_add_u32 s26, s84, 10543104
    s_waitcnt vmcnt(14)
    buffer_load_dwordx4 v[32:35], v12, s[4:7], s26 offen sc1
    s_waitcnt vmcnt(14)
    buffer_load_dwordx4 v[36:39], v13, s[4:7], s26 offen sc1
    s_add_u32 s26, s85, 10543104
    s_waitcnt vmcnt(14)
    buffer_load_dwordx4 v[40:43], v12, s[4:7], s26 offen sc1
    s_waitcnt vmcnt(14)
    buffer_load_dwordx4 v[44:47], v13, s[4:7], s26 offen sc1
    s_add_u32 s26, s86, 10543104
    s_waitcnt vmcnt(14)
    buffer_load_dwordx4 v[48:51], v12, s[4:7], s26 offen sc1
    s_waitcnt vmcnt(14)
    buffer_load_dwordx4 v[52:55], v13, s[4:7], s26 offen sc1
    s_add_u32 s26, s87, 10543104
    s_waitcnt vmcnt(13)
    buffer_load_dwordx4 v[56:59], v12, s[4:7], s26 offen sc1
    s_waitcnt vmcnt(13)
    buffer_load_dwordx4 v[60:63], v13, s[4:7], s26 offen sc1
    s_waitcnt vmcnt(0)
    v_max_u32 v14, v75, v79
    v_cmp_eq_u32 vcc, -1, v14
    s_cbranch_vccnz R_mh1_5
    s_branch B_mh1_5
R_mh1_6:
    s_add_u32 s21, s21, 1
    s_cmp_gt_u32 s21, 4096
    s_cbranch_scc1 B_mh1_6
    s_add_u32 s26, s89, 10485760
    buffer_load_dwordx4 v[80:83], v12, s[4:7], s26 offen sc1
    buffer_load_dwordx4 v[84:87], v13, s[4:7], s26 offen sc1
    s_add_u32 s26, s83, 10543104
    s_waitcnt vmcnt(14)
    buffer_load_dwordx4 v[88:91], v12, s[4:7], s26 offen sc1
    s_waitcnt vmcnt(14)
    buffer_load_dwordx4 v[92:95], v13, s[4:7], s26 offen sc1
    s_add_u32 s26, s84, 10543104
    s_waitcnt vmcnt(14)
    buffer_load_dwordx4 v[32:35], v12, s[4:7], s26 offen sc1
    s_waitcnt vmcnt(14)
    buffer_load_dwordx4 v[36:39], v13, s[4:7], s26 offen sc1
    s_add_u32 s26, s85, 10543104
    s_waitcnt vmcnt(14)
    buffer_load_dwordx4 v[40:43], v12, s[4:7], s26 offen sc1
    s_waitcnt vmcnt(14)
    buffer_load_dwordx4 v[44:47], v13, s[4:7], s26 offen sc1
    s_add_u32 s26, s86, 10543104
    s_waitcnt vmcnt(14)
    buffer_load_dwordx4 v[48:51], v12, s[4:7], s26 offen sc1
    s_waitcnt vmcnt(14)
    buffer_load_dwordx4 v[52:55], v13, s[4:7], s26 offen sc1
    s_add_u32 s26, s87, 10543104
    s_waitcnt vmcnt(13)
    buffer_load_dwordx4 v[56:59], v12, s[4:7], s26 offen sc1
    s_waitcnt vmcnt(13)
    buffer_load_dwordx4 v[60:63], v13, s[4:7], s26 offen sc1
    s_add_u32 s26, s88, 10543104
    s_waitcnt vmcnt(13)
    buffer_load_dwordx4 v[64:67], v12, s[4:7], s26 offen sc1
    s_waitcnt vmcnt(13)
    buffer_load_dwordx4 v[68:71], v13, s[4:7], s26 offen sc1
    s_waitcnt vmcnt(0)
    v_max_u32 v14, v83, v87
    v_cmp_eq_u32 vcc, -1, v14
    s_cbranch_vccnz R_mh1_6
    s_branch B_mh1_6
R_mh1_7:
    s_add_u32 s21, s21, 1
    s_cmp_gt_u32 s21, 4096
    s_cbranch_scc1 B_mh1_7
    s_add_u32 s26, s83, 10543104
    buffer_load_dwordx4 v[88:91], v12, s[4:7], s26 offen sc1
    buffer_load_dwordx4 v[92:95], v13, s[4:7], s26 offen sc1
    s_add_u32 s26, s84, 10543104
    s_waitcnt vmcnt(14)
    buffer_load_dwordx4 v[32:35], v12, s[4:7], s26 offen sc1
    s_waitcnt vmcnt(14)
    buffer_load_dwordx4 v[36:39], v13, s[4:7], s26 offen sc1
    s_add_u32 s26, s85, 10543104
    s_waitcnt vmcnt(14)
    buffer_load_dwordx4 v[40:43], v12, s[4:7], s26 offen sc1
    s_waitcnt vmcnt(14)
    buffer_load_dwordx4 v[44:47], v13, s[4:7], s26 offen sc1
    s_add_u32 s26, s86, 10543104
    s_waitcnt vmcnt(14)
    buffer_load_dwordx4 v[48:51], v12, s[4:7], s26 offen sc1
    s_waitcnt vmcnt(14)
    buffer_load_dwordx4 v[52:55], v13, s[4:7], s26 offen sc1
    s_add_u32 s26, s87, 10543104
    s_waitcnt vmcnt(13)
    buffer_load_dwordx4 v[56:59], v12, s[4:7], s26 offen sc1
    s_waitcnt vmcnt(13)
    buffer_load_dwordx4 v[60:63], v13, s[4:7], s26 offen sc1
    s_add_u32 s26, s88, 10543104
    s_waitcnt vmcnt(13)
    buffer_load_dwordx4 v[64:67], v12, s[4:7], s26 offen sc1
    s_waitcnt vmcnt(13)
    buffer_load_dwordx4 v[68:71], v13, s[4:7], s26 offen sc1
    s_add_u32 s26, s89, 10543104
    s_waitcnt vmcnt(13)
    buffer_load_dwordx4 v[72:75], v12, s[4:7], s26 offen sc1
    s_waitcnt vmcnt(13)
    buffer_load_dwordx4 v[76:79], v13, s[4:7], s26 offen sc1
    s_waitcnt vmcnt(0)
    v_max_u32 v14, v91, v95
    v_cmp_eq_u32 vcc, -1, v14
    s_cbranch_vccnz R_mh1_7
    s_branch B_mh1_7
R_mh1_8:
    s_add_u32 s21, s21, 1
    s_cmp_gt_u32 s21, 4096
    s_cbranch_scc1 B_mh1_8
    s_add_u32 s26, s84, 10543104
    buffer_load_dwordx4 v[32:35], v12, s[4:7], s26 offen sc1
    buffer_load_dwordx4 v[36:39], v13, s[4:7], s26 offen sc1
    s_add_u32 s26, s85, 10543104
    s_waitcnt vmcnt(14)
    buffer_load_dwordx4 v[40:43], v12, s[4:7], s26 offen sc1
    s_waitcnt vmcnt(14)
    buffer_load_dwordx4 v[44:47], v13, s[4:7], s26 offen sc1
    s_add_u32 s26, s86, 10543104
    s_waitcnt vmcnt(14)
    buffer_load_dwordx4 v[48:51], v12, s[4:7], s26 offen sc1
    s_waitcnt vmcnt(14)
    buffer_load_dwordx4 v[52:55], v13, s[4:7], s26 offen sc1
    s_add_u32 s26, s87, 10543104
    s_waitcnt vmcnt(13)
    buffer_load_dwordx4 v[56:59], v12, s[4:7], s26 offen sc1
    s_waitcnt vmcnt(13)
    buffer_load_dwordx4 v[60:63], v13, s[4:7], s26 offen sc1
    s_add_u32 s26, s88, 10543104
    s_waitcnt vmcnt(13)
    buffer_load_dwordx4 v[64:67], v12, s[4:7], s26 offen sc1
    s_waitcnt vmcnt(13)
    buffer_load_dwordx4 v[68:71], v13, s[4:7], s26 offen sc1
    s_add_u32 s26, s89, 10543104
    s_waitcnt vmcnt(13)
    buffer_load_dwordx4 v[72:75], v12, s[4:7], s26 offen sc1
    s_waitcnt vmcnt(13)
    buffer_load_dwordx4 v[76:79], v13, s[4:7], s26 offen sc1
    s_add_u32 s26, s83, 10600448
    s_waitcnt vmcnt(13)
    buffer_load_dwordx4 v[80:83], v12, s[4:7], s26 offen sc1
    s_waitcnt vmcnt(13)
    buffer_load_dwordx4 v[84:87], v13, s[4:7], s26 offen sc1
    s_waitcnt vmcnt(0)
    v_max_u32 v14, v35, v39
    v_cmp_eq_u32 vcc, -1, v14
    s_cbranch_vccnz R_mh1_8
    s_branch B_mh1_8
R_mh1_9:
    s_add_u32 s21, s21, 1
    s_cmp_gt_u32 s21, 4096
    s_cbranch_scc1 B_mh1_9
    s_add_u32 s26, s85, 10543104
    buffer_load_dwordx4 v[40:43], v12, s[4:7], s26 offen sc1
    buffer_load_dwordx4 v[44:47], v13, s[4:7], s26 offen sc1
    s_add_u32 s26, s86, 10543104
    s_waitcnt vmcnt(14)
    buffer_load_dwordx4 v[48:51], v12, s[4:7], s26 offen sc1
    s_waitcnt vmcnt(14)
    buffer_load_dwordx4 v[52:55], v13, s[4:7], s26 offen sc1
    s_add_u32 s26, s87, 10543104
    s_waitcnt vmcnt(13)
    buffer_load_dwordx4 v[56:59], v12, s[4:7], s26 offen sc1
    s_waitcnt vmcnt(13)
    buffer_load_dwordx4 v[60:63], v13, s[4:7], s26 offen sc1
    s_add_u32 s26, s88, 10543104
    s_waitcnt vmcnt(13)
    buffer_load_dwordx4 v[64:67], v12, s[4:7], s26 offen sc1
    s_waitcnt vmcnt(13)
    buffer_load_dwordx4 v[68:71], v13, s[4:7], s26 offen sc1
    s_add_u32 s26, s89, 10543104
    s_waitcnt vmcnt(13)
    buffer_load_dwordx4 v[72:75], v12, s[4:7], s26 offen sc1
    s_waitcnt vmcnt(13)
    buffer_load_dwordx4 v[76:79], v13, s[4:7], s26 offen sc1
    s_add_u32 s26, s83, 10600448
    s_waitcnt vmcnt(13)
    buffer_load_dwordx4 v[80:83], v12, s[4:7], s26 offen sc1
    s_waitcnt vmcnt(13)
    buffer_load_dwordx4 v[84:87], v13, s[4:7], s26 offen sc1
    s_add_u32 s26, s84, 10600448
    s_waitcnt vmcnt(13)
    buffer_load_dwordx4 v[88:91], v12, s[4:7], s26 offen sc1
    s_waitcnt vmcnt(13)
    buffer_load_dwordx4 v[92:95], v13, s[4:7], s26 offen sc1
    s_waitcnt vmcnt(0)
    v_max_u32 v14, v43, v47
    v_cmp_eq_u32 vcc, -1, v14
    s_cbranch_vccnz R_mh1_9
    s_branch B_mh1_9
R_mh1_10:
    s_add_u32 s21, s21, 1
    s_cmp_gt_u32 s21, 4096
    s_cbranch_scc1 B_mh1_10
    s_add_u32 s26, s86, 10543104
    buffer_load_dwordx4 v[48:51], v12, s[4:7], s26 offen sc1
    buffer_load_dwordx4 v[52:55], v13, s[4:7], s26 offen sc1
    s_add_u32 s26, s87, 10543104
    s_waitcnt vmcnt(13)
    buffer_load_dwordx4 v[56:59], v12, s[4:7], s26 offen sc1
    s_waitcnt vmcnt(13)
    buffer_load_dwordx4 v[60:63], v13, s[4:7], s26 offen sc1
    s_add_u32 s26, s88, 10543104
    s_waitcnt vmcnt(13)
    buffer_load_dwordx4 v[64:67], v12, s[4:7], s26 offen sc1
    s_waitcnt vmcnt(13)
    buffer_load_dwordx4 v[68:71], v13, s[4:7], s26 offen sc1
    s_add_u32 s26, s89, 10543104
    s_waitcnt vmcnt(13)
    buffer_load_dwordx4 v[72:75], v12, s[4:7], s26 offen sc1
    s_waitcnt vmcnt(13)
    buffer_load_dwordx4 v[76:79], v13, s[4:7], s26 offen sc1
    s_add_u32 s26, s83, 10600448
    s_waitcnt vmcnt(13)
    buffer_load_dwordx4 v[80:83], v12, s[4:7], s26 offen sc1
    s_waitcnt vmcnt(13)
    buffer_load_dwordx4 v[84:87], v13, s[4:7], s26 offen sc1
    s_add_u32 s26, s84, 10600448
    s_waitcnt vmcnt(13)
    buffer_load_dwordx4 v[88:91], v12, s[4:7], s26 offen sc1
    s_waitcnt vmcnt(13)
    buffer_load_dwordx4 v[92:95], v13, s[4:7], s26 offen sc1
    s_add_u32 s26, s85, 10600448
    s_waitcnt vmcnt(13)
    buffer_load_dwordx4 v[32:35], v12, s[4:7], s26 offen sc1
    s_waitcnt vmcnt(13)
    buffer_load_dwordx4 v[36:39], v13, s[4:7], s26 offen sc1
    s_waitcnt vmcnt(0)
    v_max_u32 v14, v51, v55
    v_cmp_eq_u32 vcc, -1, v14
    s_cbranch_vccnz R_mh1_10
    s_branch B_mh1_10
R_mh1_11:
    s_add_u32 s21, s21, 1
    s_cmp_gt_u32 s21, 4096
    s_cbranch_scc1 B_mh1_11
    s_add_u32 s26, s87, 10543104
    buffer_load_dwordx4 v[56:59], v12, s[4:7], s26 offen sc1
    buffer_load_dwordx4 v[60:63], v13, s[4:7], s26 offen sc1
    s_add_u32 s26, s88, 10543104
    s_waitcnt vmcnt(13)
    buffer_load_dwordx4 v[64:67], v12, s[4:7], s26 offen sc1
    s_waitcnt vmcnt(13)
    buffer_load_dwordx4 v[68:71], v13, s[4:7], s26 offen sc1
    s_add_u32 s26, s89, 10543104
    s_waitcnt vmcnt(13)
    buffer_load_dwordx4 v[72:75], v12, s[4:7], s26 offen sc1
    s_waitcnt vmcnt(13)
    buffer_load_dwordx4 v[76:79], v13, s[4:7], s26 offen sc1
    s_add_u32 s26, s83, 10600448
    s_waitcnt vmcnt(13)
    buffer_load_dwordx4 v[80:83], v12, s[4:7], s26 offen sc1
    s_waitcnt vmcnt(13)
    buffer_load_dwordx4 v[84:87], v13, s[4:7], s26 offen sc1
    s_add_u32 s26, s84, 10600448
    s_waitcnt vmcnt(13)
    buffer_load_dwordx4 v[88:91], v12, s[4:7], s26 offen sc1
    s_waitcnt vmcnt(13)
    buffer_load_dwordx4 v[92:95], v13, s[4:7], s26 offen sc1
    s_add_u32 s26, s85, 10600448
    s_waitcnt vmcnt(13)
    buffer_load_dwordx4 v[32:35], v12, s[4:7], s26 offen sc1
    s_waitcnt vmcnt(13)
    buffer_load_dwordx4 v[36:39], v13, s[4:7], s26 offen sc1
    s_add_u32 s26, s86, 10600448
    s_waitcnt vmcnt(13)
    buffer_load_dwordx4 v[40:43], v12, s[4:7], s26 offen sc1
    s_waitcnt vmcnt(13)
    buffer_load_dwordx4 v[44:47], v13, s[4:7], s26 offen sc1
    s_waitcnt vmcnt(0)
    v_max_u32 v14, v59, v63
    v_cmp_eq_u32 vcc, -1, v14
    s_cbranch_vccnz R_mh1_11
    s_branch B_mh1_11
R_mh1_12:
    s_add_u32 s21, s21, 1
    s_cmp_gt_u32 s21, 4096
    s_cbranch_scc1 B_mh1_12
    s_add_u32 s26, s88, 10543104
    buffer_load_dwordx4 v[64:67], v12, s[4:7], s26 offen sc1
    buffer_load_dwordx4 v[68:71], v13, s[4:7], s26 offen sc1
    s_add_u32 s26, s89, 10543104
    s_waitcnt vmcnt(13)
    buffer_load_dwordx4 v[72:75], v12, s[4:7], s26 offen sc1
    s_waitcnt vmcnt(13)
    buffer_load_dwordx4 v[76:79], v13, s[4:7], s26 offen sc1
    s_add_u32 s26, s83, 10600448
    s_waitcnt vmcnt(13)
    buffer_load_dwordx4 v[80:83], v12, s[4:7], s26 offen sc1
    s_waitcnt vmcnt(13)
    buffer_load_dwordx4 v[84:87], v13, s[4:7], s26 offen sc1
    s_add_u32 s26, s84, 10600448
    s_waitcnt vmcnt(13)
    buffer_load_dwordx4 v[88:91], v12, s[4:7], s26 offen sc1
    s_waitcnt vmcnt(13)
    buffer_load_dwordx4 v[92:95], v13, s[4:7], s26 offen sc1
    s_add_u32 s26, s85, 10600448
    s_waitcnt vmcnt(13)
    buffer_load_dwordx4 v[32:35], v12, s[4:7], s26 offen sc1
    s_waitcnt vmcnt(13)
    buffer_load_dwordx4 v[36:39], v13, s[4:7], s26 offen sc1
    s_add_u32 s26, s86, 10600448
    s_waitcnt vmcnt(13)
    buffer_load_dwordx4 v[40:43], v12, s[4:7], s26 offen sc1
    s_waitcnt vmcnt(13)
    buffer_load_dwordx4 v[44:47], v13, s[4:7], s26 offen sc1
    s_add_u32 s26, s87, 10600448
    s_waitcnt vmcnt(13)
    buffer_load_dwordx4 v[48:51], v12, s[4:7], s26 offen sc1
    s_waitcnt vmcnt(13)
    buffer_load_dwordx4 v[52:55], v13, s[4:7], s26 offen sc1
    s_waitcnt vmcnt(0)
    v_max_u32 v14, v67, v71
    v_cmp_eq_u32 vcc, -1, v14
    s_cbranch_vccnz R_mh1_12
    s_branch B_mh1_12
R_mh1_13:
    s_add_u32 s21, s21, 1
    s_cmp_gt_u32 s21, 4096
    s_cbranch_scc1 B_mh1_13
    s_add_u32 s26, s89, 10543104
    buffer_load_dwordx4 v[72:75], v12, s[4:7], s26 offen sc1
    buffer_load_dwordx4 v[76:79], v13, s[4:7], s26 offen sc1
    s_add_u32 s26, s83, 10600448
    s_waitcnt vmcnt(13)
    buffer_load_dwordx4 v[80:83], v12, s[4:7], s26 offen sc1
    s_waitcnt vmcnt(13)
    buffer_load_dwordx4 v[84:87], v13, s[4:7], s26 offen sc1
    s_add_u32 s26, s84, 10600448
    s_waitcnt vmcnt(13)
    buffer_load_dwordx4 v[88:91], v12, s[4:7], s26 offen sc1
    s_waitcnt vmcnt(13)
    buffer_load_dwordx4 v[92:95], v13, s[4:7], s26 offen sc1
    s_add_u32 s26, s85, 10600448
    s_waitcnt vmcnt(13)
    buffer_load_dwordx4 v[32:35], v12, s[4:7], s26 offen sc1
    s_waitcnt vmcnt(13)
    buffer_load_dwordx4 v[36:39], v13, s[4:7], s26 offen sc1
    s_add_u32 s26, s86, 10600448
    s_waitcnt vmcnt(13)
    buffer_load_dwordx4 v[40:43], v12, s[4:7], s26 offen sc1
    s_waitcnt vmcnt(13)
    buffer_load_dwordx4 v[44:47], v13, s[4:7], s26 offen sc1
    s_add_u32 s26, s87, 10600448
    s_waitcnt vmcnt(13)
    buffer_load_dwordx4 v[48:51], v12, s[4:7], s26 offen sc1
    s_waitcnt vmcnt(13)
    buffer_load_dwordx4 v[52:55], v13, s[4:7], s26 offen sc1
    s_add_u32 s26, s88, 10600448
    s_waitcnt vmcnt(13)
    buffer_load_dwordx4 v[56:59], v12, s[4:7], s26 offen sc1
    s_waitcnt vmcnt(13)
    buffer_load_dwordx4 v[60:63], v13, s[4:7], s26 offen sc1
    s_waitcnt vmcnt(0)
    v_max_u32 v14, v75, v79
    v_cmp_eq_u32 vcc, -1, v14
    s_cbranch_vccnz R_mh1_13
    s_branch B_mh1_13
R_mh1_14:
    s_add_u32 s21, s21, 1
    s_cmp_gt_u32 s21, 4096
    s_cbranch_scc1 B_mh1_14
    s_add_u32 s26, s83, 10600448
    buffer_load_dwordx4 v[80:83], v12, s[4:7], s26 offen sc1
    buffer_load_dwordx4 v[84:87], v13, s[4:7], s26 offen sc1
    s_add_u32 s26, s84, 10600448
    s_waitcnt vmcnt(13)
    buffer_load_dwordx4 v[88:91], v12, s[4:7], s26 offen sc1
    s_waitcnt vmcnt(13)
    buffer_load_dwordx4 v[92:95], v13, s[4:7], s26 offen sc1
    s_add_u32 s26, s85, 10600448
    s_waitcnt vmcnt(13)
    buffer_load_dwordx4 v[32:35], v12, s[4:7], s26 offen sc1
    s_waitcnt vmcnt(13)
    buffer_load_dwordx4 v[36:39], v13, s[4:7], s26 offen sc1
    s_add_u32 s26, s86, 10600448
    s_waitcnt vmcnt(13)
    buffer_load_dwordx4 v[40:43], v12, s[4:7], s26 offen sc1
    s_waitcnt vmcnt(13)
    buffer_load_dwordx4 v[44:47], v13, s[4:7], s26 offen sc1
    s_add_u32 s26, s87, 10600448
    s_waitcnt vmcnt(13)
    buffer_load_dwordx4 v[48:51], v12, s[4:7], s26 offen sc1
    s_waitcnt vmcnt(13)
    buffer_load_dwordx4 v[52:55], v13, s[4:7], s26 offen sc1
    s_add_u32 s26, s88, 10600448
    s_waitcnt vmcnt(13)
    buffer_load_dwordx4 v[56:59], v12, s[4:7], s26 offen sc1
    s_waitcnt vmcnt(13)
    buffer_load_dwordx4 v[60:63], v13, s[4:7], s26 offen sc1
    s_add_u32 s26, s89, 10600448
    s_waitcnt vmcnt(13)
    buffer_load_dwordx4 v[64:67], v12, s[4:7], s26 offen sc1
    s_waitcnt vmcnt(13)
    buffer_load_dwordx4 v[68:71], v13, s[4:7], s26 offen sc1
    s_waitcnt vmcnt(0)
    v_max_u32 v14, v83, v87
    v_cmp_eq_u32 vcc, -1, v14
    s_cbranch_vccnz R_mh1_14
    s_branch B_mh1_14
R_mh1_15:
    s_add_u32 s21, s21, 1
    s_cmp_gt_u32 s21, 4096
    s_cbranch_scc1 B_mh1_15
    s_add_u32 s26, s84, 10600448
    buffer_load_dwordx4 v[88:91], v12, s[4:7], s26 offen sc1
    buffer_load_dwordx4 v[92:95], v13, s[4:7], s26 offen sc1
    s_add_u32 s26, s85, 10600448
    s_waitcnt vmcnt(13)
    buffer_load_dwordx4 v[32:35], v12, s[4:7], s26 offen sc1
    s_waitcnt vmcnt(13)
    buffer_load_dwordx4 v[36:39], v13, s[4:7], s26 offen sc1
    s_add_u32 s26, s86, 10600448
    s_waitcnt vmcnt(13)
    buffer_load_dwordx4 v[40:43], v12, s[4:7], s26 offen sc1
    s_waitcnt vmcnt(13)
    buffer_load_dwordx4 v[44:47], v13, s[4:7], s26 offen sc1
    s_add_u32 s26, s87, 10600448
    s_waitcnt vmcnt(13)
    buffer_load_dwordx4 v[48:51], v12, s[4:7], s26 offen sc1
    s_waitcnt vmcnt(13)
    buffer_load_dwordx4 v[52:55], v13, s[4:7], s26 offen sc1
    s_add_u32 s26, s88, 10600448
    s_waitcnt vmcnt(13)
    buffer_load_dwordx4 v[56:59], v12, s[4:7], s26 offen sc1
    s_waitcnt vmcnt(13)
    buffer_load_dwordx4 v[60:63], v13, s[4:7], s26 offen sc1
    s_add_u32 s26, s89, 10600448
    s_waitcnt vmcnt(13)
    buffer_load_dwordx4 v[64:67], v12, s[4:7], s26 offen sc1
    s_waitcnt vmcnt(13)
    buffer_load_dwordx4 v[68:71], v13, s[4:7], s26 offen sc1
    s_add_u32 s26, s83, 10657792
    s_waitcnt vmcnt(13)
    buffer_load_dwordx4 v[72:75], v12, s[4:7], s26 offen sc1
    s_waitcnt vmcnt(13)
    buffer_load_dwordx4 v[76:79], v13, s[4:7], s26 offen sc1
    s_waitcnt vmcnt(0)
    v_max_u32 v14, v91, v95
    v_cmp_eq_u32 vcc, -1, v14
    s_cbranch_vccnz R_mh1_15
    s_branch B_mh1_15
R_mh1_16:
    s_add_u32 s21, s21, 1
    s_cmp_gt_u32 s21, 4096
    s_cbranch_scc1 B_mh1_16
    s_add_u32 s26, s85, 10600448
    buffer_load_dwordx4 v[32:35], v12, s[4:7], s26 offen sc1
    buffer_load_dwordx4 v[36:39], v13, s[4:7], s26 offen sc1
    s_add_u32 s26, s86, 10600448
    s_waitcnt vmcnt(13)
    buffer_load_dwordx4 v[40:43], v12, s[4:7], s26 offen sc1
    s_waitcnt vmcnt(13)
    buffer_load_dwordx4 v[44:47], v13, s[4:7], s26 offen sc1
    s_add_u32 s26, s87, 10600448
    s_waitcnt vmcnt(13)
    buffer_load_dwordx4 v[48:51], v12, s[4:7], s26 offen sc1
    s_waitcnt vmcnt(13)
    buffer_load_dwordx4 v[52:55], v13, s[4:7], s26 offen sc1
    s_add_u32 s26, s88, 10600448
    s_waitcnt vmcnt(13)
    buffer_load_dwordx4 v[56:59], v12, s[4:7], s26 offen sc1
    s_waitcnt vmcnt(13)
    buffer_load_dwordx4 v[60:63], v13, s[4:7], s26 offen sc1
    s_add_u32 s26, s89, 10600448
    s_waitcnt vmcnt(13)
    buffer_load_dwordx4 v[64:67], v12, s[4:7], s26 offen sc1
    s_waitcnt vmcnt(13)
    buffer_load_dwordx4 v[68:71], v13, s[4:7], s26 offen sc1
    s_add_u32 s26, s83, 10657792
    s_waitcnt vmcnt(13)
    buffer_load_dwordx4 v[72:75], v12, s[4:7], s26 offen sc1
    s_waitcnt vmcnt(13)
    buffer_load_dwordx4 v[76:79], v13, s[4:7], s26 offen sc1
    s_add_u32 s26, s84, 10657792
    s_waitcnt vmcnt(13)
    buffer_load_dwordx4 v[80:83], v12, s[4:7], s26 offen sc1
    s_waitcnt vmcnt(13)
    buffer_load_dwordx4 v[84:87], v13, s[4:7], s26 offen sc1
    s_waitcnt vmcnt(0)
    v_max_u32 v14, v35, v39
    v_cmp_eq_u32 vcc, -1, v14
    s_cbranch_vccnz R_mh1_16
    s_branch B_mh1_16
R_mh1_17:
    s_add_u32 s21, s21, 1
    s_cmp_gt_u32 s21, 4096
    s_cbranch_scc1 B_mh1_17
    s_add_u32 s26, s86, 10600448
    buffer_load_dwordx4 v[40:43], v12, s[4:7], s26 offen sc1
    buffer_load_dwordx4 v[44:47], v13, s[4:7], s26 offen sc1
    s_add_u32 s26, s87, 10600448
    s_waitcnt vmcnt(13)
    buffer_load_dwordx4 v[48:51], v12, s[4:7], s26 offen sc1
    s_waitcnt vmcnt(13)
    buffer_load_dwordx4 v[52:55], v13, s[4:7], s26 offen sc1
    s_add_u32 s26, s88, 10600448
    s_waitcnt vmcnt(13)
    buffer_load_dwordx4 v[56:59], v12, s[4:7], s26 offen sc1
    s_waitcnt vmcnt(13)
    buffer_load_dwordx4 v[60:63], v13, s[4:7], s26 offen sc1
    s_add_u32 s26, s89, 10600448
    s_waitcnt vmcnt(13)
    buffer_load_dwordx4 v[64:67], v12, s[4:7], s26 offen sc1
    s_waitcnt vmcnt(13)
    buffer_load_dwordx4 v[68:71], v13, s[4:7], s26 offen sc1
    s_add_u32 s26, s83, 10657792
    s_waitcnt vmcnt(13)
    buffer_load_dwordx4 v[72:75], v12, s[4:7], s26 offen sc1
    s_waitcnt vmcnt(13)
    buffer_load_dwordx4 v[76:79], v13, s[4:7], s26 offen sc1
    s_add_u32 s26, s84, 10657792
    s_waitcnt vmcnt(13)
    buffer_load_dwordx4 v[80:83], v12, s[4:7], s26 offen sc1
    s_waitcnt vmcnt(13)
    buffer_load_dwordx4 v[84:87], v13, s[4:7], s26 offen sc1
    s_add_u32 s26, s85, 10657792
    s_waitcnt vmcnt(13)
    buffer_load_dwordx4 v[88:91], v12, s[4:7], s26 offen sc1
    s_waitcnt vmcnt(13)
    buffer_load_dwordx4 v[92:95], v13, s[4:7], s26 offen sc1
    s_waitcnt vmcnt(0)
    v_max_u32 v14, v43, v47
    v_cmp_eq_u32 vcc, -1, v14
    s_cbranch_vccnz R_mh1_17
    s_branch B_mh1_17
R_mh1_18:
    s_add_u32 s21, s21, 1
    s_cmp_gt_u32 s21, 4096
    s_cbranch_scc1 B_mh1_18
    s_add_u32 s26, s87, 10600448
    buffer_load_dwordx4 v[48:51], v12, s[4:7], s26 offen sc1
    buffer_load_dwordx4 v[52:55], v13, s[4:7], s26 offen sc1
    s_add_u32 s26, s88, 10600448
    s_waitcnt vmcnt(13)
    buffer_load_dwordx4 v[56:59], v12, s[4:7], s26 offen sc1
    s_waitcnt vmcnt(13)
    buffer_load_dwordx4 v[60:63], v13, s[4:7], s26 offen sc1
    s_add_u32 s26, s89, 10600448
    s_waitcnt vmcnt(13)
    buffer_load_dwordx4 v[64:67], v12, s[4:7], s26 offen sc1
    s_waitcnt vmcnt(13)
    buffer_load_dwordx4 v[68:71], v13, s[4:7], s26 offen sc1
    s_add_u32 s26, s83, 10657792
    s_waitcnt vmcnt(13)
    buffer_load_dwordx4 v[72:75], v12, s[4:7], s26 offen sc1
    s_waitcnt vmcnt(13)
    buffer_load_dwordx4 v[76:79], v13, s[4:7], s26 offen sc1
    s_add_u32 s26, s84, 10657792
    s_waitcnt vmcnt(13)
    buffer_load_dwordx4 v[80:83], v12, s[4:7], s26 offen sc1
    s_waitcnt vmcnt(13)
    buffer_load_dwordx4 v[84:87], v13, s[4:7], s26 offen sc1
    s_add_u32 s26, s85, 10657792
    s_waitcnt vmcnt(13)
    buffer_load_dwordx4 v[88:91], v12, s[4:7], s26 offen sc1
    s_waitcnt vmcnt(13)
    buffer_load_dwordx4 v[92:95], v13, s[4:7], s26 offen sc1
    s_add_u32 s26, s86, 10657792
    s_waitcnt vmcnt(13)
    buffer_load_dwordx4 v[32:35], v12, s[4:7], s26 offen sc1
    s_waitcnt vmcnt(13)
    buffer_load_dwordx4 v[36:39], v13, s[4:7], s26 offen sc1
    s_waitcnt vmcnt(0)
    v_max_u32 v14, v51, v55
    v_cmp_eq_u32 vcc, -1, v14
    s_cbranch_vccnz R_mh1_18
    s_branch B_mh1_18
R_mh1_19:
    s_add_u32 s21, s21, 1
    s_cmp_gt_u32 s21, 4096
    s_cbranch_scc1 B_mh1_19
    s_add_u32 s26, s88, 10600448
    buffer_load_dwordx4 v[56:59], v12, s[4:7], s26 offen sc1
    buffer_load_dwordx4 v[60:63], v13, s[4:7], s26 offen sc1
    s_add_u32 s26, s89, 10600448
    s_waitcnt vmcnt(13)
    buffer_load_dwordx4 v[64:67], v12, s[4:7], s26 offen sc1
    s_waitcnt vmcnt(13)
    buffer_load_dwordx4 v[68:71], v13, s[4:7], s26 offen sc1
    s_add_u32 s26, s83, 10657792
    s_waitcnt vmcnt(13)
    buffer_load_dwordx4 v[72:75], v12, s[4:7], s26 offen sc1
    s_waitcnt vmcnt(13)
    buffer_load_dwordx4 v[76:79], v13, s[4:7], s26 offen sc1
    s_add_u32 s26, s84, 10657792
    s_waitcnt vmcnt(13)
    buffer_load_dwordx4 v[80:83], v12, s[4:7], s26 offen sc1
    s_waitcnt vmcnt(13)
    buffer_load_dwordx4 v[84:87], v13, s[4:7], s26 offen sc1
    s_add_u32 s26, s85, 10657792
    s_waitcnt vmcnt(13)
    buffer_load_dwordx4 v[88:91], v12, s[4:7], s26 offen sc1
    s_waitcnt vmcnt(13)
    buffer_load_dwordx4 v[92:95], v13, s[4:7], s26 offen sc1
    s_add_u32 s26, s86, 10657792
    s_waitcnt vmcnt(13)
    buffer_load_dwordx4 v[32:35], v12, s[4:7], s26 offen sc1
    s_waitcnt vmcnt(13)
    buffer_load_dwordx4 v[36:39], v13, s[4:7], s26 offen sc1
    s_add_u32 s26, s87, 10657792
    s_waitcnt vmcnt(13)
    buffer_load_dwordx4 v[40:43], v12, s[4:7], s26 offen sc1
    s_waitcnt vmcnt(13)
    buffer_load_dwordx4 v[44:47], v13, s[4:7], s26 offen sc1
    s_waitcnt vmcnt(0)
    v_max_u32 v14, v59, v63
    v_cmp_eq_u32 vcc, -1, v14
    s_cbranch_vccnz R_mh1_19
    s_branch B_mh1_19
R_mh1_20:
    s_add_u32 s21, s21, 1
    s_cmp_gt_u32 s21, 4096
    s_cbranch_scc1 B_mh1_20
    s_add_u32 s26, s89, 10600448
    buffer_load_dwordx4 v[64:67], v12, s[4:7], s26 offen sc1
    buffer_load_dwordx4 v[68:71], v13, s[4:7], s26 offen sc1
    s_add_u32 s26, s83, 10657792
    s_waitcnt vmcnt(13)
    buffer_load_dwordx4 v[72:75], v12, s[4:7], s26 offen sc1
    s_waitcnt vmcnt(13)
    buffer_load_dwordx4 v[76:79], v13, s[4:7], s26 offen sc1
    s_add_u32 s26, s84, 10657792
    s_waitcnt vmcnt(13)
    buffer_load_dwordx4 v[80:83], v12, s[4:7], s26 offen sc1
    s_waitcnt vmcnt(13)
    buffer_load_dwordx4 v[84:87], v13, s[4:7], s26 offen sc1
    s_add_u32 s26, s85, 10657792
    s_waitcnt vmcnt(13)
    buffer_load_dwordx4 v[88:91], v12, s[4:7], s26 offen sc1
    s_waitcnt vmcnt(13)
    buffer_load_dwordx4 v[92:95], v13, s[4:7], s26 offen sc1
    s_add_u32 s26, s86, 10657792
    s_waitcnt vmcnt(13)
    buffer_load_dwordx4 v[32:35], v12, s[4:7], s26 offen sc1
    s_waitcnt vmcnt(13)
    buffer_load_dwordx4 v[36:39], v13, s[4:7], s26 offen sc1
    s_add_u32 s26, s87, 10657792
    s_waitcnt vmcnt(13)
    buffer_load_dwordx4 v[40:43], v12, s[4:7], s26 offen sc1
    s_waitcnt vmcnt(13)
    buffer_load_dwordx4 v[44:47], v13, s[4:7], s26 offen sc1
    s_add_u32 s26, s88, 10657792
    s_waitcnt vmcnt(13)
    buffer_load_dwordx4 v[48:51], v12, s[4:7], s26 offen sc1
    s_waitcnt vmcnt(13)
    buffer_load_dwordx4 v[52:55], v13, s[4:7], s26 offen sc1
    s_waitcnt vmcnt(0)
    v_max_u32 v14, v67, v71
    v_cmp_eq_u32 vcc, -1, v14
    s_cbranch_vccnz R_mh1_20
    s_branch B_mh1_20
R_mh1_21:
    s_add_u32 s21, s21, 1
    s_cmp_gt_u32 s21, 4096
    s_cbranch_scc1 B_mh1_21
    s_add_u32 s26, s83, 10657792
    buffer_load_dwordx4 v[72:75], v12, s[4:7], s26 offen sc1
    buffer_load_dwordx4 v[76:79], v13, s[4:7], s26 offen sc1
    s_add_u32 s26, s84, 10657792
    s_waitcnt vmcnt(13)
    buffer_load_dwordx4 v[80:83], v12, s[4:7], s26 offen sc1
    s_waitcnt vmcnt(13)
    buffer_load_dwordx4 v[84:87], v13, s[4:7], s26 offen sc1
    s_add_u32 s26, s85, 10657792
    s_waitcnt vmcnt(13)
    buffer_load_dwordx4 v[88:91], v12, s[4:7], s26 offen sc1
    s_waitcnt vmcnt(13)
    buffer_load_dwordx4 v[92:95], v13, s[4:7], s26 offen sc1
    s_add_u32 s26, s86, 10657792
    s_waitcnt vmcnt(13)
    buffer_load_dwordx4 v[32:35], v12, s[4:7], s26 offen sc1
    s_waitcnt vmcnt(13)
    buffer_load_dwordx4 v[36:39], v13, s[4:7], s26 offen sc1
    s_add_u32 s26, s87, 10657792
    s_waitcnt vmcnt(13)
    buffer_load_dwordx4 v[40:43], v12, s[4:7], s26 offen sc1
    s_waitcnt vmcnt(13)
    buffer_load_dwordx4 v[44:47], v13, s[4:7], s26 offen sc1
    s_add_u32 s26, s88, 10657792
    s_waitcnt vmcnt(13)
    buffer_load_dwordx4 v[48:51], v12, s[4:7], s26 offen sc1
    s_waitcnt vmcnt(13)
    buffer_load_dwordx4 v[52:55], v13, s[4:7], s26 offen sc1
    s_add_u32 s26, s89, 10657792
    s_waitcnt vmcnt(13)
    buffer_load_dwordx4 v[56:59], v12, s[4:7], s26 offen sc1
    s_waitcnt vmcnt(13)
    buffer_load_dwordx4 v[60:63], v13, s[4:7], s26 offen sc1
    s_waitcnt vmcnt(0)
    v_max_u32 v14, v75, v79
    v_cmp_eq_u32 vcc, -1, v14
    s_cbranch_vccnz R_mh1_21
    s_branch B_mh1_21
R_mh1_22:
    s_add_u32 s21, s21, 1
    s_cmp_gt_u32 s21, 4096
    s_cbranch_scc1 B_mh1_22
    s_add_u32 s26, s84, 10657792
    buffer_load_dwordx4 v[80:83], v12, s[4:7], s26 offen sc1
    buffer_load_dwordx4 v[84:87], v13, s[4:7], s26 offen sc1
    s_add_u32 s26, s85, 10657792
    s_waitcnt vmcnt(13)
    buffer_load_dwordx4 v[88:91], v12, s[4:7], s26 offen sc1
    s_waitcnt vmcnt(13)
    buffer_load_dwordx4 v[92:95], v13, s[4:7], s26 offen sc1
    s_add_u32 s26, s86, 10657792
    s_waitcnt vmcnt(13)
    buffer_load_dwordx4 v[32:35], v12, s[4:7], s26 offen sc1
    s_waitcnt vmcnt(13)
    buffer_load_dwordx4 v[36:39], v13, s[4:7], s26 offen sc1
    s_add_u32 s26, s87, 10657792
    s_waitcnt vmcnt(13)
    buffer_load_dwordx4 v[40:43], v12, s[4:7], s26 offen sc1
    s_waitcnt vmcnt(13)
    buffer_load_dwordx4 v[44:47], v13, s[4:7], s26 offen sc1
    s_add_u32 s26, s88, 10657792
    s_waitcnt vmcnt(13)
    buffer_load_dwordx4 v[48:51], v12, s[4:7], s26 offen sc1
    s_waitcnt vmcnt(13)
    buffer_load_dwordx4 v[52:55], v13, s[4:7], s26 offen sc1
    s_add_u32 s26, s89, 10657792
    s_waitcnt vmcnt(13)
    buffer_load_dwordx4 v[56:59], v12, s[4:7], s26 offen sc1
    s_waitcnt vmcnt(13)
    buffer_load_dwordx4 v[60:63], v13, s[4:7], s26 offen sc1
    s_waitcnt vmcnt(0)
    v_max_u32 v14, v83, v87
    v_cmp_eq_u32 vcc, -1, v14
    s_cbranch_vccnz R_mh1_22
    s_branch B_mh1_22
R_mh1_23:
    s_add_u32 s21, s21, 1
    s_cmp_gt_u32 s21, 4096
    s_cbranch_scc1 B_mh1_23
    s_add_u32 s26, s85, 10657792
    buffer_load_dwordx4 v[88:91], v12, s[4:7], s26 offen sc1
    buffer_load_dwordx4 v[92:95], v13, s[4:7], s26 offen sc1
    s_add_u32 s26, s86, 10657792
    s_waitcnt vmcnt(11)
    buffer_load_dwordx4 v[32:35], v12, s[4:7], s26 offen sc1
    s_waitcnt vmcnt(11)
    buffer_load_dwordx4 v[36:39], v13, s[4:7], s26 offen sc1
    s_add_u32 s26, s87, 10657792
    s_waitcnt vmcnt(11)
    buffer_load_dwordx4 v[40:43], v12, s[4:7], s26 offen sc1
    s_waitcnt vmcnt(11)
    buffer_load_dwordx4 v[44:47], v13, s[4:7], s26 offen sc1
    s_add_u32 s26, s88, 10657792
    s_waitcnt vmcnt(11)
    buffer_load_dwordx4 v[48:51], v12, s[4:7], s26 offen sc1
    s_waitcnt vmcnt(11)
    buffer_load_dwordx4 v[52:55], v13, s[4:7], s26 offen sc1
    s_add_u32 s26, s89, 10657792
    s_waitcnt vmcnt(11)
    buffer_load_dwordx4 v[56:59], v12, s[4:7], s26 offen sc1
    s_waitcnt vmcnt(11)
    buffer_load_dwordx4 v[60:63], v13, s[4:7], s26 offen sc1
    s_waitcnt vmcnt(0)
    v_max_u32 v14, v91, v95
    v_cmp_eq_u32 vcc, -1, v14
    s_cbranch_vccnz R_mh1_23
    s_branch B_mh1_23
R_mh1_24:
    s_add_u32 s21, s21, 1
    s_cmp_gt_u32 s21, 4096
    s_cbranch_scc1 B_mh1_24
    s_add_u32 s26, s86, 10657792
    buffer_load_dwordx4 v[32:35], v12, s[4:7], s26 offen sc1
    buffer_load_dwordx4 v[36:39], v13, s[4:7], s26 offen sc1
    s_add_u32 s26, s87, 10657792
    s_waitcnt vmcnt(9)
    buffer_load_dwordx4 v[40:43], v12, s[4:7], s26 offen sc1
    s_waitcnt vmcnt(9)
    buffer_load_dwordx4 v[44:47], v13, s[4:7], s26 offen sc1
    s_add_u32 s26, s88, 10657792
    s_waitcnt vmcnt(9)
    buffer_load_dwordx4 v[48:51], v12, s[4:7], s26 offen sc1
    s_waitcnt vmcnt(9)
    buffer_load_dwordx4 v[52:55], v13, s[4:7], s26 offen sc1
    s_add_u32 s26, s89, 10657792
    s_waitcnt vmcnt(9)
    buffer_load_dwordx4 v[56:59], v12, s[4:7], s26 offen sc1
    s_waitcnt vmcnt(9)
    buffer_load_dwordx4 v[60:63], v13, s[4:7], s26 offen sc1
    s_waitcnt vmcnt(0)
    v_max_u32 v14, v35, v39
    v_cmp_eq_u32 vcc, -1, v14
    s_cbranch_vccnz R_mh1_24
    s_branch B_mh1_24
R_mh1_25:
    s_add_u32 s21, s21, 1
    s_cmp_gt_u32 s21, 4096
    s_cbranch_scc1 B_mh1_25
    s_add_u32 s26, s87, 10657792
    buffer_load_dwordx4 v[40:43], v12, s[4:7], s26 offen sc1
    buffer_load_dwordx4 v[44:47], v13, s[4:7], s26 offen sc1
    s_add_u32 s26, s88, 10657792
    buffer_load_dwordx4 v[48:51], v12, s[4:7], s26 offen sc1
    buffer_load_dwordx4 v[52:55], v13, s[4:7], s26 offen sc1
    s_add_u32 s26, s89, 10657792
    buffer_load_dwordx4 v[56:59], v12, s[4:7], s26 offen sc1
    buffer_load_dwordx4 v[60:63], v13, s[4:7], s26 offen sc1
    s_waitcnt vmcnt(0)
    v_max3_u32 v14, v43, v47, v51
    v_max3_u32 v14, v14, v55, v59
    v_max_u32 v14, v14, v63
    v_cmp_eq_u32 vcc, -1, v14
    s_cbranch_vccnz R_mh1_25
    s_branch B_mh1_25
R_mr1:
    s_add_u32 s21, s21, 1
    s_cmp_gt_u32 s21, 4096
    s_cbranch_scc1 B_mr1
    buffer_load_dwordx4 v[112:115], v15, s[4:7], s20 offen offset:0 sc1
    buffer_load_dwordx4 v[116:119], v15, s[4:7], s20 offen offset:1024 sc1
    s_waitcnt vmcnt(0)
    v_max_u32 v14, v115, v119
    v_cmp_eq_u32 vcc, -1, v14
    s_cbranch_vccnz R_mr1
    s_branch B_mr1
A_0:
    s_add_u32 s23, s99, 10485760
    buffer_store_dwordx4 a[0:3], v15, s[4:7], s23 offen offset:0 sc1
    buffer_store_dwordx4 a[0:3], v15, s[4:7], s23 offen offset:2048 sc1
    s_add_u32 s23, s99, 10543104
    buffer_store_dwordx4 a[0:3], v15, s[4:7], s23 offen offset:0 sc1
    buffer_store_dwordx4 a[0:3], v15, s[4:7], s23 offen offset:2048 sc1
    s_add_u32 s23, s99, 10600448
    buffer_store_dwordx4 a[0:3], v15, s[4:7], s23 offen offset:0 sc1
    buffer_store_dwordx4 a[0:3], v15, s[4:7], s23 offen offset:2048 sc1
    s_add_u32 s23, s99, 10657792
    buffer_store_dwordx4 a[0:3], v15, s[4:7], s23 offen offset:0 sc1
    buffer_store_dwordx4 a[0:3], v15, s[4:7], s23 offen offset:2048 sc1
    s_nop 1
    s_branch AB_0
A_1:
    buffer_store_dwordx4 v[128:131], v15, s[4:7], s23 offen offset:0 sc1
    s_nop 1
    s_branch AB_1
A_2:
    buffer_store_dwordx4 v[136:139], v15, s[4:7], s23 offen offset:2048 sc1
    s_nop 1
    s_branch AB_2
A_3:
    buffer_store_dwordx4 v[144:147], v15, s[4:7], s23 offen offset:0 sc1
    s_nop 1
    s_branch AB_3
A_4:
    buffer_store_dwordx4 v[152:155], v15, s[4:7], s23 offen offset:2048 sc1
    s_nop 1
    s_branch AB_4
A_5:
    buffer_store_dwordx4 v[160:163], v15, s[4:7], s23 offen offset:0 sc1
    s_nop 1
    s_branch AB_5
A_6:
    buffer_store_dwordx4 v[168:171], v15, s[4:7], s23 offen offset:2048 sc1
    s_nop 1
    s_branch AB_6
A_7:
    buffer_store_dwordx4 v[176:179], v15, s[4:7], s23 offen offset:0 sc1
    s_nop 1
    s_branch AB_7
A_8:
    buffer_store_dwordx4 v[184:187], v15, s[4:7], s23 offen offset:2048 sc1
    s_nop 1
    s_branch AB_8
A_9:
    s_add_u32 s23, s99, 10485760
    buffer_store_dwordx4 a[0:3], v15, s[4:7], s23 offen offset:0 sc1
    buffer_store_dwordx4 a[0:3], v15, s[4:7], s23 offen offset:2048 sc1
    s_add_u32 s23, s99, 10543104
    buffer_store_dwordx4 a[0:3], v15, s[4:7], s23 offen offset:0 sc1
    buffer_store_dwordx4 a[0:3], v15, s[4:7], s23 offen offset:2048 sc1
    s_add_u32 s23, s99, 10600448
    buffer_store_dwordx4 a[0:3], v15, s[4:7], s23 offen offset:0 sc1
    buffer_store_dwordx4 a[0:3], v15, s[4:7], s23 offen offset:2048 sc1
    s_add_u32 s23, s99, 10657792
    buffer_store_dwordx4 a[0:3], v15, s[4:7], s23 offen offset:0 sc1
    buffer_store_dwordx4 a[0:3], v15, s[4:7], s23 offen offset:2048 sc1
    s_nop 1
    s_branch AB_9
A_10:
    buffer_store_dwordx4 v[128:131], v15, s[4:7], s23 offen offset:0 sc1
    s_nop 1
    s_branch AB_10
A_11:
    buffer_store_dwordx4 v[136:139], v15, s[4:7], s23 offen offset:2048 sc1
    s_nop 1
    s_branch AB_11
A_12:
    buffer_store_dwordx4 v[144:147], v15, s[4:7], s23 offen offset:0 sc1
    s_nop 1
    s_branch AB_12
A_13:
    buffer_store_dwordx4 v[152:155], v15, s[4:7], s23 offen offset:2048 sc1
    s_nop 1
    s_branch AB_13
A_14:
    buffer_store_dwordx4 v[160:163], v15, s[4:7], s23 offen offset:0 sc1
    s_nop 1
    s_branch AB_14
A_15:
    buffer_store_dwordx4 v[168:171], v15, s[4:7], s23 offen offset:2048 sc1
    s_nop 1
    s_branch AB_15
A_16:
    buffer_store_dwordx4 v[176:179], v15, s[4:7], s23 offen offset:0 sc1
    s_nop 1
    s_branch AB_16
A_17:
    buffer_store_dwordx4 v[184:187], v15, s[4:7], s23 offen offset:2048 sc1
    s_nop 1
    s_branch AB_17

.p2align 6
J_help2:
    s_add_u32 s23, s18, 2097152
    buffer_store_dwordx4 a[252:255], v15, s[4:7], s23 offen sc1
    s_add_u32 s23, s18, 2098176
    buffer_store_dwordx4 a[252:255], v15, s[4:7], s23 offen sc1
    s_add_u32 s23, s18, 2099200
    buffer_store_dwordx4 a[252:255], v15, s[4:7], s23 offen sc1
    s_add_u32 s23, s18, 2100224
    buffer_store_dwordx4 a[252:255], v15, s[4:7], s23 offen sc1
    s_add_u32 s23, s18, 2101248
    buffer_store_dwordx4 a[252:255], v15, s[4:7], s23 offen sc1
    s_add_u32 s23, s18, 2102272
    buffer_store_dwordx4 a[252:255], v15, s[4:7], s23 offen sc1
    s_add_u32 s23, s18, 2103296
    buffer_store_dwordx4 a[252:255], v15, s[4:7], s23 offen sc1
    s_add_u32 s23, s18, 2104320
    buffer_store_dwordx4 a[252:255], v15, s[4:7], s23 offen sc1
    s_add_u32 s23, s18, 2105344
    buffer_store_dwordx4 a[252:255], v15, s[4:7], s23 offen sc1
    s_add_u32 s23, s18, 2106368
    buffer_store_dwordx4 a[252:255], v15, s[4:7], s23 offen sc1
    s_add_u32 s23, s18, 2107392
    buffer_store_dwordx4 a[252:255], v15, s[4:7], s23 offen sc1
    s_add_u32 s23, s18, 2108416
    buffer_store_dwordx4 a[252:255], v15, s[4:7], s23 offen sc1
    s_add_u32 s23, s18, 2109440
    buffer_store_dwordx4 a[252:255], v15, s[4:7], s23 offen sc1
    s_add_u32 s23, s18, 2110464
    buffer_store_dwordx4 a[252:255], v15, s[4:7], s23 offen sc1
    s_add_u32 s23, s18, 2111488
    buffer_store_dwordx4 a[252:255], v15, s[4:7], s23 offen sc1
    s_add_u32 s23, s18, 2112512
    buffer_store_dwordx4 a[252:255], v15, s[4:7], s23 offen sc1
    s_add_u32 s23, s18, 2113536
    buffer_store_dwordx4 a[252:255], v15, s[4:7], s23 offen sc1
    s_add_u32 s23, s18, 2114560
    buffer_store_dwordx4 a[252:255], v15, s[4:7], s23 offen sc1
    s_add_u32 s23, s18, 2115584
    buffer_store_dwordx4 a[252:255], v15, s[4:7], s23 offen sc1
    s_add_u32 s23, s18, 2116608
    buffer_store_dwordx4 a[252:255], v15, s[4:7], s23 offen sc1
    s_add_u32 s23, s18, 2117632
    buffer_store_dwordx4 a[252:255], v15, s[4:7], s23 offen sc1
    s_add_u32 s23, s18, 2118656
    buffer_store_dwordx4 a[252:255], v15, s[4:7], s23 offen sc1
    s_add_u32 s23, s18, 2119680
    buffer_store_dwordx4 a[252:255], v15, s[4:7], s23 offen sc1
    s_add_u32 s23, s18, 2120704
    buffer_store_dwordx4 a[252:255], v15, s[4:7], s23 offen sc1
    s_add_u32 s23, s18, 2121728
    buffer_store_dwordx4 a[252:255], v15, s[4:7], s23 offen sc1
    s_add_u32 s23, s18, 2122752
    buffer_store_dwordx4 a[252:255], v15, s[4:7], s23 offen sc1
    s_add_u32 s23, s18, 2123776
    buffer_store_dwordx4 a[252:255], v15, s[4:7], s23 offen sc1
    s_add_u32 s23, s18, 2124800
    buffer_store_dwordx4 a[252:255], v15, s[4:7], s23 offen sc1
    s_and_b32 s20, s3, 7
    s_lshr_b32 s35, s3, 3
    s_lshl_b32 s37, s20, 5
    s_add_u32 s37, s37, s35
    s_lshl_b32 s37, s37, 6
    s_add_u32 s37, s37, s36
    s_add_u32 s37, s37, 1836800
    v_and_b32 v14, 0xf0, v15
    buffer_load_dword v14, v14, s[84:87], 0 offen sc1
    s_waitcnt vmcnt(0)
    v_cmp_eq_u32 vcc, 0, v14
    s_cbranch_vccnz R_hdbg
B_hdbg:
    s_barrier
    s_mov_b64 exec, 1
    buffer_store_dword v1, v1, s[4:7], s37 offen offset:4 sc1
    s_mov_b64 exec, -1
J_help3:
    s_load_dwordx2 s[76:77], s[0:1], 48
    s_load_dwordx2 s[80:81], s[0:1], 56
    s_mov_b32 s3, s2
    s_lshl_b32 s36, s16, 26
    s_and_b32 s20, s3, 7
    s_lshr_b32 s35, s3, 3
    s_lshl_b32 s37, s20, 5
    s_add_u32 s37, s37, s35
    s_lshl_b32 s37, s37, 6
    s_add_u32 s37, s37, s36
    s_add_u32 s37, s37, 1836800
    s_nop 15
    s_waitcnt vmcnt(0)
    s_mov_b64 exec, 1
    buffer_store_dword v1, v1, s[4:7], s32 offen sc1
    s_mov_b64 exec, -1
    s_mov_b32 s79, 0x00020000
    s_and_b32 s25, s16, 1
    s_lshl2_add_u32 s38, s3, s16
    s_mov_b32 s82, 896
    s_mov_b32 s78, 1605632
    s_mul_i32 s38, s38, 14336
    v_lshrrev_b32 v8, 4, v1
    v_xor_b32 v8, v8, v1
    v_and_b32 v8, 7, v8
    v_lshrrev_b32 v9, 3, v1
    v_mul_u32_u24 v9, 56, v9
    v_add_lshl_u32 v12, v8, v9, 4
    v_xor_b32 v13, 64, v12
    v_add_u32 v13, 6144, v13
    s_lshl_b32 s34, s16, 11
    s_add_u32 m0, s34, 0
    s_waitcnt lgkmcnt(0)
    buffer_load_dwordx4 v12, s[76:79], s38 offen offset:0 lds
    buffer_load_dwordx4 v13, s[76:79], s38 offen offset:1024 lds
    s_add_u32 m0, s34, 8192
    s_add_u32 s23, s38, 128
    buffer_load_dwordx4 v12, s[76:79], s23 offen offset:0 lds
    buffer_load_dwordx4 v13, s[76:79], s23 offen offset:1024 lds
    s_add_u32 m0, s34, 16384
    s_add_u32 s23, s38, 256
    buffer_load_dwordx4 v12, s[76:79], s23 offen offset:0 lds
    buffer_load_dwordx4 v13, s[76:79], s23 offen offset:1024 lds
    s_add_u32 m0, s34, 24576
    s_add_u32 s23, s38, 384
    buffer_load_dwordx4 v12, s[76:79], s23 offen offset:0 lds
    buffer_load_dwordx4 v13, s[76:79], s23 offen offset:1024 lds
    s_add_u32 m0, s34, 32768
    s_add_u32 s23, s38, 512
    buffer_load_dwordx4 v12, s[76:79], s23 offen offset:0 lds
    buffer_load_dwordx4 v13, s[76:79], s23 offen offset:1024 lds
    s_add_u32 m0, s34, 40960
    s_add_u32 s23, s38, 640
    buffer_load_dwordx4 v12, s[76:79], s23 offen offset:0 lds
    buffer_load_dwordx4 v13, s[76:79], s23 offen offset:1024 lds
    s_add_u32 m0, s34, 49152
    s_add_u32 s23, s38, 768
    buffer_load_dwordx4 v12, s[76:79], s23 offen offset:0 lds
    buffer_load_dwordx4 v13, s[76:79], s23 offen offset:1024 lds
    s_mov_b32 s83, 0x00020000
    v_accvgpr_write_b32 a252, -1
    v_accvgpr_write_b32 a253, -1
    v_accvgpr_write_b32 a254, -1
    v_accvgpr_write_b32 a255, -1
    s_mov_b32 s21, 0
    s_lshl2_add_u32 s20, s20, s35
    s_lshr_b32 s24, s16, 1
    s_mul_i32 s27, s24, 7
    s_lshl2_add_u32 s26, s25, s27
    s_add_u32 s27, s27, 3
    s_lshl1_add_u32 s17, s20, s25
    s_mul_i32 s18, s17, 28672
    s_mul_i32 s22, s24, 14336
    s_add_u32 s18, s18, s22
    s_lshl_b32 s19, s3, 7
    s_and_b32 s30, s3, 1
    s_mul_i32 s30, s30, 391
    s_add_u32 s30, s30, s3
    s_lshl_b32 s30, s30, 11
    s_add_u32 s30, s30, 20971520
    s_cmp_gt_u32 s3, 27
    s_cselect_b32 s30, 0x4000000, s30
    s_mul_i32 s31, s25, 401408
    s_add_u32 s38, s30, s31
    v_bfe_u32 v141, v1, 2, 2
    v_lshrrev_b32 v142, 5, v1
    v_lshl_add_u32 v142, v142, 2, v141
    v_lshrrev_b32 v141, 1, v142
    v_bfe_u32 v140, v1, 1, 1
    v_xor_b32 v141, v141, v140
    v_bfe_u32 v140, v1, 4, 1
    v_lshlrev_b32 v140, 1, v140
    v_xor_b32 v141, v141, v140
    v_lshlrev_b32 v141, 4, v141
    v_lshl_add_u32 v141, v142, 7, v141
    v_and_b32 v140, 1, v1
    v_lshl_add_u32 v141, v140, 3, v141
    s_lshl_b32 s30, s25, 12
    s_lshl_b32 s31, s24, 6
    s_add_u32 s30, s30, s31
    v_add_u32 v140, s30, v141
    v_xor_b32 v141, 64, v140
    s_lshl_b32 s31, s24, 10
    s_add_u32 s38, s38, s31
    v_and_b32 v4, 31, v1
    v_lshrrev_b32 v3, 5, v1
    v_lshlrev_b32 v3, 1, v3
    s_mov_b32 s34, 0x3d88d677
    v_lshlrev_b32 v5, 31, v1
    v_mov_b32 v6, 0x3d41848f
    v_xor_b32 v5, v5, v6
    v_cvt_pk_bf16_f32 v5, v5, v6
    s_mul_i32 s28, s16, 14336
    v_add_u32 v12, s28, v15
    v_add_u32 v12, 57344, v12
    s_add_u32 s30, s26, 0
    s_lshl_b32 s30, s30, 5
    v_add_u32 v7, s30, v4
    v_cvt_f32_u32 v7, v7
    v_mul_f32 v7, 0x3b124925, v7
    v_mov_b32 v8, v3
    v_cmp_eq_u32 s[32:33], 0, v8
    v_cvt_f32_u32 v8, v8
    v_mul_f32 v8, v8, v7
    v_fract_f32 v8, v8
    v_mul_f32 v9, 8.0, v7
    v_cos_f32 v9, v9
    s_nop 0
    v_add_f32 v9, v9, v9
    v_sub_f32 v11, 0, v9
    v_fmamk_f32 v10, v7, 0x00000000, v8
    v_cos_f32 v16, v10
    v_sin_f32 v17, v10
    v_fmamk_f32 v10, v7, 0x3f800000, v8
    v_cos_f32 v18, v10
    v_sin_f32 v19, v10
    v_fmamk_f32 v10, v7, 0x40800000, v8
    v_cos_f32 v20, v10
    v_sin_f32 v21, v10
    v_fmamk_f32 v10, v7, 0x40a00000, v8
    v_cos_f32 v22, v10
    v_sin_f32 v23, v10
    v_mul_f32 v16, s34, v16
    v_mul_f32 v17, s34, v17
    v_mul_f32 v18, s34, v18
    v_mul_f32 v19, s34, v19
    v_mul_f32 v20, s34, v20
    v_mul_f32 v21, s34, v21
    v_mul_f32 v22, s34, v22
    v_mul_f32 v23, s34, v23
    v_cvt_pk_bf16_f32 v160, v16, -v17
    v_cvt_pk_bf16_f32 v161, v18, -v19
    v_cvt_pk_bf16_f32 v162, v20, -v21
    v_cvt_pk_bf16_f32 v163, v22, -v23
    v_cndmask_b32 v160, v160, v5, s[32:33]
    v_fmamk_f32 v10, v7, 0x41000000, v8
    v_cos_f32 v24, v10
    v_sin_f32 v25, v10
    v_fmamk_f32 v10, v7, 0x41100000, v8
    v_cos_f32 v26, v10
    v_sin_f32 v27, v10
    v_fmamk_f32 v10, v7, 0x41400000, v8
    v_cos_f32 v28, v10
    v_sin_f32 v29, v10
    v_fmamk_f32 v10, v7, 0x41500000, v8
    v_cos_f32 v30, v10
    v_sin_f32 v31, v10
    v_mul_f32 v24, s34, v24
    v_mul_f32 v25, s34, v25
    v_mul_f32 v26, s34, v26
    v_mul_f32 v27, s34, v27
    v_mul_f32 v28, s34, v28
    v_mul_f32 v29, s34, v29
    v_mul_f32 v30, s34, v30
    v_mul_f32 v31, s34, v31
    v_cvt_pk_bf16_f32 v164, v24, -v25
    v_cvt_pk_bf16_f32 v165, v26, -v27
    v_cvt_pk_bf16_f32 v166, v28, -v29
    v_cvt_pk_bf16_f32 v167, v30, -v31
    v_fmac_f32 v16, v11, v24
    v_fmac_f32 v17, v11, v25
    v_fmac_f32 v18, v11, v26
    v_fmac_f32 v19, v11, v27
    v_fmac_f32 v20, v11, v28
    v_fmac_f32 v21, v11, v29
    v_fmac_f32 v22, v11, v30
    v_fmac_f32 v23, v11, v31
    v_cvt_pk_bf16_f32 v168, -v16, v17
    v_cvt_pk_bf16_f32 v169, -v18, v19
    v_cvt_pk_bf16_f32 v170, -v20, v21
    v_cvt_pk_bf16_f32 v171, -v22, v23
    v_fmac_f32 v24, v9, v16
    v_fmac_f32 v25, v9, v17
    v_fmac_f32 v26, v9, v18
    v_fmac_f32 v27, v9, v19
    v_fmac_f32 v28, v9, v20
    v_fmac_f32 v29, v9, v21
    v_fmac_f32 v30, v9, v22
    v_fmac_f32 v31, v9, v23
    v_cvt_pk_bf16_f32 v172, -v24, v25
    v_cvt_pk_bf16_f32 v173, -v26, v27
    v_cvt_pk_bf16_f32 v174, -v28, v29
    v_cvt_pk_bf16_f32 v175, -v30, v31
    v_fmac_f32 v16, v11, v24
    v_fmac_f32 v17, v11, v25
    v_fmac_f32 v18, v11, v26
    v_fmac_f32 v19, v11, v27
    v_fmac_f32 v20, v11, v28
    v_fmac_f32 v21, v11, v29
    v_fmac_f32 v22, v11, v30
    v_fmac_f32 v23, v11, v31
    v_cvt_pk_bf16_f32 v176, v16, -v17
    v_cvt_pk_bf16_f32 v177, v18, -v19
    v_cvt_pk_bf16_f32 v178, v20, -v21
    v_cvt_pk_bf16_f32 v179, v22, -v23
    v_fmac_f32 v24, v9, v16
    v_fmac_f32 v25, v9, v17
    v_fmac_f32 v26, v9, v18
    v_fmac_f32 v27, v9, v19
    v_fmac_f32 v28, v9, v20
    v_fmac_f32 v29, v9, v21
    v_fmac_f32 v30, v9, v22
    v_fmac_f32 v31, v9, v23
    v_cvt_pk_bf16_f32 v180, v24, -v25
    v_cvt_pk_bf16_f32 v181, v26, -v27
    v_cvt_pk_bf16_f32 v182, v28, -v29
    v_cvt_pk_bf16_f32 v183, v30, -v31
    v_fmac_f32 v16, v11, v24
    v_fmac_f32 v17, v11, v25
    v_fmac_f32 v18, v11, v26
    v_fmac_f32 v19, v11, v27
    v_fmac_f32 v20, v11, v28
    v_fmac_f32 v21, v11, v29
    v_fmac_f32 v22, v11, v30
    v_fmac_f32 v23, v11, v31
    v_cvt_pk_bf16_f32 v184, -v16, v17
    v_cvt_pk_bf16_f32 v185, -v18, v19
    v_cvt_pk_bf16_f32 v186, -v20, v21
    v_cvt_pk_bf16_f32 v187, -v22, v23
    v_fmac_f32 v24, v9, v16
    v_fmac_f32 v25, v9, v17
    v_fmac_f32 v26, v9, v18
    v_fmac_f32 v27, v9, v19
    v_fmac_f32 v28, v9, v20
    v_fmac_f32 v29, v9, v21
    v_fmac_f32 v30, v9, v22
    v_fmac_f32 v31, v9, v23
    v_cvt_pk_bf16_f32 v188, -v24, v25
    v_cvt_pk_bf16_f32 v189, -v26, v27
    v_cvt_pk_bf16_f32 v190, -v28, v29
    v_cvt_pk_bf16_f32 v191, -v30, v31
    v_fmac_f32 v16, v11, v24
    v_fmac_f32 v17, v11, v25
    v_fmac_f32 v18, v11, v26
    v_fmac_f32 v19, v11, v27
    v_fmac_f32 v20, v11, v28
    v_fmac_f32 v21, v11, v29
    v_fmac_f32 v22, v11, v30
    v_fmac_f32 v23, v11, v31
    v_cvt_pk_bf16_f32 v192, v16, -v17
    v_cvt_pk_bf16_f32 v193, v18, -v19
    v_cvt_pk_bf16_f32 v194, v20, -v21
    v_cvt_pk_bf16_f32 v195, v22, -v23
    v_fmac_f32 v24, v9, v16
    v_fmac_f32 v25, v9, v17
    v_fmac_f32 v26, v9, v18
    v_fmac_f32 v27, v9, v19
    v_fmac_f32 v28, v9, v20
    v_fmac_f32 v29, v9, v21
    v_fmac_f32 v30, v9, v22
    v_fmac_f32 v31, v9, v23
    v_cvt_pk_bf16_f32 v196, v24, -v25
    v_cvt_pk_bf16_f32 v197, v26, -v27
    v_cvt_pk_bf16_f32 v198, v28, -v29
    v_cvt_pk_bf16_f32 v199, v30, -v31
    v_fmac_f32 v16, v11, v24
    v_fmac_f32 v17, v11, v25
    v_fmac_f32 v18, v11, v26
    v_fmac_f32 v19, v11, v27
    v_fmac_f32 v20, v11, v28
    v_fmac_f32 v21, v11, v29
    v_fmac_f32 v22, v11, v30
    v_fmac_f32 v23, v11, v31
    v_cvt_pk_bf16_f32 v200, -v16, v17
    v_cvt_pk_bf16_f32 v201, -v18, v19
    v_cvt_pk_bf16_f32 v202, -v20, v21
    v_cvt_pk_bf16_f32 v203, -v22, v23
    v_fmac_f32 v24, v9, v16
    v_fmac_f32 v25, v9, v17
    v_fmac_f32 v26, v9, v18
    v_fmac_f32 v27, v9, v19
    v_fmac_f32 v28, v9, v20
    v_fmac_f32 v29, v9, v21
    v_fmac_f32 v30, v9, v22
    v_fmac_f32 v31, v9, v23
    v_cvt_pk_bf16_f32 v204, -v24, v25
    v_cvt_pk_bf16_f32 v205, -v26, v27
    v_cvt_pk_bf16_f32 v206, -v28, v29
    v_cvt_pk_bf16_f32 v207, -v30, v31
    v_fmac_f32 v16, v11, v24
    v_fmac_f32 v17, v11, v25
    v_fmac_f32 v18, v11, v26
    v_fmac_f32 v19, v11, v27
    v_fmac_f32 v20, v11, v28
    v_fmac_f32 v21, v11, v29
    v_fmac_f32 v22, v11, v30
    v_fmac_f32 v23, v11, v31
    v_cvt_pk_bf16_f32 v208, v16, -v17
    v_cvt_pk_bf16_f32 v209, v18, -v19
    v_cvt_pk_bf16_f32 v210, v20, -v21
    v_cvt_pk_bf16_f32 v211, v22, -v23
    v_fmac_f32 v24, v9, v16
    v_fmac_f32 v25, v9, v17
    v_fmac_f32 v26, v9, v18
    v_fmac_f32 v27, v9, v19
    v_fmac_f32 v28, v9, v20
    v_fmac_f32 v29, v9, v21
    v_fmac_f32 v30, v9, v22
    v_fmac_f32 v31, v9, v23
    v_cvt_pk_bf16_f32 v212, v24, -v25
    v_cvt_pk_bf16_f32 v213, v26, -v27
    v_cvt_pk_bf16_f32 v214, v28, -v29
    v_cvt_pk_bf16_f32 v215, v30, -v31
    v_fmac_f32 v16, v11, v24
    v_fmac_f32 v17, v11, v25
    v_fmac_f32 v18, v11, v26
    v_fmac_f32 v19, v11, v27
    v_fmac_f32 v20, v11, v28
    v_fmac_f32 v21, v11, v29
    v_fmac_f32 v22, v11, v30
    v_fmac_f32 v23, v11, v31
    v_cvt_pk_bf16_f32 v216, -v16, v17
    v_cvt_pk_bf16_f32 v217, -v18, v19
    v_cvt_pk_bf16_f32 v218, -v20, v21
    v_cvt_pk_bf16_f32 v219, -v22, v23
    v_fmac_f32 v24, v9, v16
    v_fmac_f32 v25, v9, v17
    v_fmac_f32 v26, v9, v18
    v_fmac_f32 v27, v9, v19
    v_fmac_f32 v28, v9, v20
    v_fmac_f32 v29, v9, v21
    v_fmac_f32 v30, v9, v22
    v_fmac_f32 v31, v9, v23
    v_cvt_pk_bf16_f32 v220, -v24, v25
    v_cvt_pk_bf16_f32 v221, -v26, v27
    v_cvt_pk_bf16_f32 v222, -v28, v29
    v_cvt_pk_bf16_f32 v223, -v30, v31
    v_fmac_f32 v16, v11, v24
    v_fmac_f32 v17, v11, v25
    v_fmac_f32 v18, v11, v26
    v_fmac_f32 v19, v11, v27
    v_fmac_f32 v20, v11, v28
    v_fmac_f32 v21, v11, v29
    v_fmac_f32 v22, v11, v30
    v_fmac_f32 v23, v11, v31
    v_cvt_pk_bf16_f32 v224, v16, -v17
    v_cvt_pk_bf16_f32 v225, v18, -v19
    v_cvt_pk_bf16_f32 v226, v20, -v21
    v_cvt_pk_bf16_f32 v227, v22, -v23
    v_fmac_f32 v24, v9, v16
    v_fmac_f32 v25, v9, v17
    v_fmac_f32 v26, v9, v18
    v_fmac_f32 v27, v9, v19
    v_fmac_f32 v28, v9, v20
    v_fmac_f32 v29, v9, v21
    v_fmac_f32 v30, v9, v22
    v_fmac_f32 v31, v9, v23
    v_cvt_pk_bf16_f32 v228, v24, -v25
    v_cvt_pk_bf16_f32 v229, v26, -v27
    v_cvt_pk_bf16_f32 v230, v28, -v29
    v_cvt_pk_bf16_f32 v231, v30, -v31
    v_fmac_f32 v16, v11, v24
    v_fmac_f32 v17, v11, v25
    v_fmac_f32 v18, v11, v26
    v_fmac_f32 v19, v11, v27
    v_fmac_f32 v20, v11, v28
    v_fmac_f32 v21, v11, v29
    v_fmac_f32 v22, v11, v30
    v_fmac_f32 v23, v11, v31
    v_cvt_pk_bf16_f32 v232, -v16, v17
    v_cvt_pk_bf16_f32 v233, -v18, v19
    v_cvt_pk_bf16_f32 v234, -v20, v21
    v_cvt_pk_bf16_f32 v235, -v22, v23
    v_fmac_f32 v24, v9, v16
    v_fmac_f32 v25, v9, v17
    v_fmac_f32 v26, v9, v18
    v_fmac_f32 v27, v9, v19
    v_fmac_f32 v28, v9, v20
    v_fmac_f32 v29, v9, v21
    v_fmac_f32 v30, v9, v22
    v_fmac_f32 v31, v9, v23
    v_cvt_pk_bf16_f32 v236, -v24, v25
    v_cvt_pk_bf16_f32 v237, -v26, v27
    v_cvt_pk_bf16_f32 v238, -v28, v29
    v_cvt_pk_bf16_f32 v239, -v30, v31
    v_fmac_f32 v16, v11, v24
    v_fmac_f32 v17, v11, v25
    v_fmac_f32 v18, v11, v26
    v_fmac_f32 v19, v11, v27
    v_fmac_f32 v20, v11, v28
    v_fmac_f32 v21, v11, v29
    v_fmac_f32 v22, v11, v30
    v_fmac_f32 v23, v11, v31
    v_cvt_pk_bf16_f32 v240, v16, -v17
    v_cvt_pk_bf16_f32 v241, v18, -v19
    v_cvt_pk_bf16_f32 v242, v20, -v21
    v_cvt_pk_bf16_f32 v243, v22, -v23
    v_fmac_f32 v24, v9, v16
    v_fmac_f32 v25, v9, v17
    v_fmac_f32 v26, v9, v18
    v_fmac_f32 v27, v9, v19
    v_fmac_f32 v28, v9, v20
    v_fmac_f32 v29, v9, v21
    v_fmac_f32 v30, v9, v22
    v_fmac_f32 v31, v9, v23
    v_cvt_pk_bf16_f32 v244, v24, -v25
    v_cvt_pk_bf16_f32 v245, v26, -v27
    v_cvt_pk_bf16_f32 v246, v28, -v29
    v_cvt_pk_bf16_f32 v247, v30, -v31
    v_fmac_f32 v16, v11, v24
    v_fmac_f32 v17, v11, v25
    v_fmac_f32 v18, v11, v26
    v_fmac_f32 v19, v11, v27
    v_fmac_f32 v20, v11, v28
    v_fmac_f32 v21, v11, v29
    v_fmac_f32 v22, v11, v30
    v_fmac_f32 v23, v11, v31
    v_cvt_pk_bf16_f32 v248, -v16, v17
    v_cvt_pk_bf16_f32 v249, -v18, v19
    v_cvt_pk_bf16_f32 v250, -v20, v21
    v_cvt_pk_bf16_f32 v251, -v22, v23
    v_fmac_f32 v24, v9, v16
    v_fmac_f32 v25, v9, v17
    v_fmac_f32 v26, v9, v18
    v_fmac_f32 v27, v9, v19
    v_fmac_f32 v28, v9, v20
    v_fmac_f32 v29, v9, v21
    v_fmac_f32 v30, v9, v22
    v_fmac_f32 v31, v9, v23
    v_cvt_pk_bf16_f32 v252, -v24, v25
    v_cvt_pk_bf16_f32 v253, -v26, v27
    v_cvt_pk_bf16_f32 v254, -v28, v29
    v_cvt_pk_bf16_f32 v255, -v30, v31
    v_fmac_f32 v16, v11, v24
    v_fmac_f32 v17, v11, v25
    v_fmac_f32 v18, v11, v26
    v_fmac_f32 v19, v11, v27
    v_fmac_f32 v20, v11, v28
    v_fmac_f32 v21, v11, v29
    v_fmac_f32 v22, v11, v30
    v_fmac_f32 v23, v11, v31
    v_cvt_pk_bf16_f32 v32, v16, -v17
    v_cvt_pk_bf16_f32 v33, v18, -v19
    v_cvt_pk_bf16_f32 v34, v20, -v21
    v_cvt_pk_bf16_f32 v35, v22, -v23
    v_accvgpr_write_b32 a0, v32
    v_accvgpr_write_b32 a1, v33
    v_accvgpr_write_b32 a2, v34
    v_accvgpr_write_b32 a3, v35
    v_fmac_f32 v24, v9, v16
    v_fmac_f32 v25, v9, v17
    v_fmac_f32 v26, v9, v18
    v_fmac_f32 v27, v9, v19
    v_fmac_f32 v28, v9, v20
    v_fmac_f32 v29, v9, v21
    v_fmac_f32 v30, v9, v22
    v_fmac_f32 v31, v9, v23
    v_cvt_pk_bf16_f32 v36, v24, -v25
    v_cvt_pk_bf16_f32 v37, v26, -v27
    v_cvt_pk_bf16_f32 v38, v28, -v29
    v_cvt_pk_bf16_f32 v39, v30, -v31
    v_accvgpr_write_b32 a4, v36
    v_accvgpr_write_b32 a5, v37
    v_accvgpr_write_b32 a6, v38
    v_accvgpr_write_b32 a7, v39
    v_fmac_f32 v16, v11, v24
    v_fmac_f32 v17, v11, v25
    v_fmac_f32 v18, v11, v26
    v_fmac_f32 v19, v11, v27
    v_fmac_f32 v20, v11, v28
    v_fmac_f32 v21, v11, v29
    v_fmac_f32 v22, v11, v30
    v_fmac_f32 v23, v11, v31
    v_cvt_pk_bf16_f32 v32, -v16, v17
    v_cvt_pk_bf16_f32 v33, -v18, v19
    v_cvt_pk_bf16_f32 v34, -v20, v21
    v_cvt_pk_bf16_f32 v35, -v22, v23
    v_accvgpr_write_b32 a8, v32
    v_accvgpr_write_b32 a9, v33
    v_accvgpr_write_b32 a10, v34
    v_accvgpr_write_b32 a11, v35
    v_fmac_f32 v24, v9, v16
    v_fmac_f32 v25, v9, v17
    v_fmac_f32 v26, v9, v18
    v_fmac_f32 v27, v9, v19
    v_fmac_f32 v28, v9, v20
    v_fmac_f32 v29, v9, v21
    v_fmac_f32 v30, v9, v22
    v_fmac_f32 v31, v9, v23
    v_cvt_pk_bf16_f32 v36, -v24, v25
    v_cvt_pk_bf16_f32 v37, -v26, v27
    v_cvt_pk_bf16_f32 v38, -v28, v29
    v_cvt_pk_bf16_f32 v39, -v30, v31
    v_accvgpr_write_b32 a12, v36
    v_accvgpr_write_b32 a13, v37
    v_accvgpr_write_b32 a14, v38
    v_accvgpr_write_b32 a15, v39
    s_add_u32 s22, s19, 1916928
    v_mov_b32 v3, 0
    s_mov_b32 s28, 0x05040100
    s_mov_b32 s29, 0x07060302
    s_sleep 3
    buffer_load_dword v4, v3, s[4:7], s22 offen sc1
    s_waitcnt vmcnt(0)
    v_cmp_eq_u32 vcc, -1, v4
    s_cbranch_vccnz R_hg0
B_hg0:
    s_mov_b32 s21, 0
    s_cmp_lt_u32 s16, 2
    s_cselect_b32 s32, 0xff, 0
    s_mov_b32 s33, 0
    v_mov_b32 v4, 0
    v_mov_b32 v5, 0
    v_mov_b32 v6, 0
    v_mov_b32 v7, 0
    s_sleep 16
    s_add_u32 s23, s18, 2097152
    buffer_load_dwordx4 v[16:19], v15, s[4:7], s23 offen offset:0 sc1
    buffer_load_dwordx4 v[20:23], v15, s[4:7], s23 offen offset:1024 sc1
    buffer_load_dwordx4 v[24:27], v15, s[4:7], s23 offen offset:2048 sc1
    buffer_load_dwordx4 v[28:31], v15, s[4:7], s23 offen offset:3072 sc1
    s_add_u32 s23, s18, 2101248
    buffer_load_dwordx4 v[32:35], v15, s[4:7], s23 offen offset:0 sc1
    buffer_load_dwordx4 v[36:39], v15, s[4:7], s23 offen offset:1024 sc1
    buffer_load_dwordx4 v[40:43], v15, s[4:7], s23 offen offset:2048 sc1
    buffer_load_dwordx4 v[44:47], v15, s[4:7], s23 offen offset:3072 sc1
    s_add_u32 s23, s18, 2105344
    buffer_load_dwordx4 v[48:51], v15, s[4:7], s23 offen offset:0 sc1
    buffer_load_dwordx4 v[52:55], v15, s[4:7], s23 offen offset:1024 sc1
    buffer_load_dwordx4 v[56:59], v15, s[4:7], s23 offen offset:2048 sc1
    buffer_load_dwordx4 v[60:63], v15, s[4:7], s23 offen offset:3072 sc1
    s_add_u32 s23, s18, 2109440
    buffer_load_dwordx4 v[64:67], v15, s[4:7], s23 offen offset:0 sc1
    buffer_load_dwordx4 v[68:71], v15, s[4:7], s23 offen offset:1024 sc1
    s_waitcnt vmcnt(11)
    v_max3_u32 v14, v16, v20, v24
    s_waitcnt vmcnt(10)
    v_max_u32 v14, v14, v28
    v_cmp_eq_u32 vcc, -1, v14
    s_cbranch_vccnz R_hx0_0
B_hx0_0:
    v_cndmask_b32 v12, v18, 0, s[32:33]
    v_cndmask_b32 v13, v19, 0, s[32:33]
    v_perm_b32 v128, v12, v16, s28
    v_perm_b32 v129, v12, v16, s29
    v_perm_b32 v130, v13, v17, s28
    v_perm_b32 v131, v13, v17, s29
    v_dot2c_f32_bf16 v4, v128, v128
    v_dot2c_f32_bf16 v5, v129, v129
    v_dot2c_f32_bf16 v6, v130, v130
    v_dot2c_f32_bf16 v7, v131, v131
    v_perm_b32 v132, v22, v20, s28
    v_perm_b32 v133, v22, v20, s29
    v_perm_b32 v134, v23, v21, s28
    v_perm_b32 v135, v23, v21, s29
    v_dot2c_f32_bf16 v4, v132, v132
    v_dot2c_f32_bf16 v5, v133, v133
    v_dot2c_f32_bf16 v6, v134, v134
    v_dot2c_f32_bf16 v7, v135, v135
    v_perm_b32 v128, v26, v24, s28
    v_perm_b32 v129, v26, v24, s29
    v_perm_b32 v130, v27, v25, s28
    v_perm_b32 v131, v27, v25, s29
    v_dot2c_f32_bf16 v4, v128, v128
    v_dot2c_f32_bf16 v5, v129, v129
    v_dot2c_f32_bf16 v6, v130, v130
    v_dot2c_f32_bf16 v7, v131, v131
    v_perm_b32 v132, v30, v28, s28
    v_perm_b32 v133, v30, v28, s29
    v_perm_b32 v134, v31, v29, s28
    v_perm_b32 v135, v31, v29, s29
    v_dot2c_f32_bf16 v4, v132, v132
    v_dot2c_f32_bf16 v5, v133, v133
    v_dot2c_f32_bf16 v6, v134, v134
    v_dot2c_f32_bf16 v7, v135, v135
    s_waitcnt vmcnt(7)
    v_max3_u32 v14, v32, v36, v40
    s_waitcnt vmcnt(6)
    v_max_u32 v14, v14, v44
    v_cmp_eq_u32 vcc, -1, v14
    s_cbranch_vccnz R_hx0_1
B_hx0_1:
    v_perm_b32 v128, v34, v32, s28
    v_perm_b32 v129, v34, v32, s29
    v_perm_b32 v130, v35, v33, s28
    v_perm_b32 v131, v35, v33, s29
    v_dot2c_f32_bf16 v4, v128, v128
    v_dot2c_f32_bf16 v5, v129, v129
    v_dot2c_f32_bf16 v6, v130, v130
    v_dot2c_f32_bf16 v7, v131, v131
    v_perm_b32 v132, v38, v36, s28
    v_perm_b32 v133, v38, v36, s29
    v_perm_b32 v134, v39, v37, s28
    v_perm_b32 v135, v39, v37, s29
    v_dot2c_f32_bf16 v4, v132, v132
    v_dot2c_f32_bf16 v5, v133, v133
    v_dot2c_f32_bf16 v6, v134, v134
    v_dot2c_f32_bf16 v7, v135, v135
    v_perm_b32 v128, v42, v40, s28
    v_perm_b32 v129, v42, v40, s29
    v_perm_b32 v130, v43, v41, s28
    v_perm_b32 v131, v43, v41, s29
    v_dot2c_f32_bf16 v4, v128, v128
    v_dot2c_f32_bf16 v5, v129, v129
    v_dot2c_f32_bf16 v6, v130, v130
    v_dot2c_f32_bf16 v7, v131, v131
    v_perm_b32 v132, v46, v44, s28
    v_perm_b32 v133, v46, v44, s29
    v_perm_b32 v134, v47, v45, s28
    v_perm_b32 v135, v47, v45, s29
    v_dot2c_f32_bf16 v4, v132, v132
    v_dot2c_f32_bf16 v5, v133, v133
    v_dot2c_f32_bf16 v6, v134, v134
    v_dot2c_f32_bf16 v7, v135, v135
    s_waitcnt vmcnt(3)
    v_max3_u32 v14, v48, v52, v56
    s_waitcnt vmcnt(2)
    v_max_u32 v14, v14, v60
    v_cmp_eq_u32 vcc, -1, v14
    s_cbranch_vccnz R_hx0_2
B_hx0_2:
    v_perm_b32 v128, v50, v48, s28
    v_perm_b32 v129, v50, v48, s29
    v_perm_b32 v130, v51, v49, s28
    v_perm_b32 v131, v51, v49, s29
    v_dot2c_f32_bf16 v4, v128, v128
    v_dot2c_f32_bf16 v5, v129, v129
    v_dot2c_f32_bf16 v6, v130, v130
    v_dot2c_f32_bf16 v7, v131, v131
    v_perm_b32 v132, v54, v52, s28
    v_perm_b32 v133, v54, v52, s29
    v_perm_b32 v134, v55, v53, s28
    v_perm_b32 v135, v55, v53, s29
    v_dot2c_f32_bf16 v4, v132, v132
    v_dot2c_f32_bf16 v5, v133, v133
    v_dot2c_f32_bf16 v6, v134, v134
    v_dot2c_f32_bf16 v7, v135, v135
    v_perm_b32 v128, v58, v56, s28
    v_perm_b32 v129, v58, v56, s29
    v_perm_b32 v130, v59, v57, s28
    v_perm_b32 v131, v59, v57, s29
    v_dot2c_f32_bf16 v4, v128, v128
    v_dot2c_f32_bf16 v5, v129, v129
    v_dot2c_f32_bf16 v6, v130, v130
    v_dot2c_f32_bf16 v7, v131, v131
    v_perm_b32 v132, v62, v60, s28
    v_perm_b32 v133, v62, v60, s29
    v_perm_b32 v134, v63, v61, s28
    v_perm_b32 v135, v63, v61, s29
    v_dot2c_f32_bf16 v4, v132, v132
    v_dot2c_f32_bf16 v5, v133, v133
    v_dot2c_f32_bf16 v6, v134, v134
    v_dot2c_f32_bf16 v7, v135, v135
    s_waitcnt vmcnt(0)
    v_max_u32 v14, v64, v68
    v_cmp_eq_u32 vcc, -1, v14
    s_cbranch_vccnz R_hx0_3
B_hx0_3:
    v_perm_b32 v128, v66, v64, s28
    v_perm_b32 v129, v66, v64, s29
    v_perm_b32 v130, v67, v65, s28
    v_perm_b32 v131, v67, v65, s29
    v_dot2c_f32_bf16 v4, v128, v128
    v_dot2c_f32_bf16 v5, v129, v129
    v_dot2c_f32_bf16 v6, v130, v130
    v_dot2c_f32_bf16 v7, v131, v131
    v_perm_b32 v132, v70, v68, s28
    v_perm_b32 v133, v70, v68, s29
    v_perm_b32 v134, v71, v69, s28
    v_perm_b32 v135, v71, v69, s29
    v_dot2c_f32_bf16 v4, v132, v132
    v_dot2c_f32_bf16 v5, v133, v133
    v_dot2c_f32_bf16 v6, v134, v134
    v_dot2c_f32_bf16 v7, v135, v135
    v_add_f32_dpp v4, v4, v4 row_ror:8 row_mask:0xf bank_mask:0xf
    v_add_f32_dpp v5, v5, v5 row_ror:8 row_mask:0xf bank_mask:0xf
    v_add_f32_dpp v6, v6, v6 row_ror:8 row_mask:0xf bank_mask:0xf
    v_add_f32_dpp v7, v7, v7 row_ror:8 row_mask:0xf bank_mask:0xf
    v_mov_b32 v8, v4
    v_mov_b32 v9, v5
    v_mov_b32 v10, v6
    v_mov_b32 v11, v7
    v_permlane16_swap_b32 v4, v8
    v_permlane16_swap_b32 v5, v9
    v_permlane16_swap_b32 v6, v10
    v_permlane16_swap_b32 v7, v11
    v_add_f32 v4, v4, v8
    v_add_f32 v5, v5, v9
    v_add_f32 v6, v6, v10
    v_add_f32 v7, v7, v11
    v_mov_b32 v8, v4
    v_mov_b32 v9, v5
    v_mov_b32 v10, v6
    v_mov_b32 v11, v7
    v_permlane32_swap_b32 v4, v8
    v_permlane32_swap_b32 v5, v9
    v_permlane32_swap_b32 v6, v10
    v_permlane32_swap_b32 v7, v11
    v_add_f32 v4, v4, v8
    v_add_f32 v5, v5, v9
    v_add_f32 v6, v6, v10
    v_add_f32 v7, v7, v11
    s_lshl_b32 s23, s17, 7
    s_lshl_b32 s30, s24, 13
    s_add_u32 s23, s23, s30
    s_add_u32 s23, s23, 1851392
    s_mov_b64 exec, 0xff
    buffer_store_dwordx4 v[4:7], v15, s[4:7], s23 offen sc1
    s_mov_b64 exec, -1
    s_nop 0
    v_and_b32 v4, 31, v1
    v_lshrrev_b32 v3, 5, v1
    v_lshlrev_b32 v3, 1, v3
    s_mov_b32 s34, 0x3d88d677
    v_lshlrev_b32 v5, 31, v1
    v_mov_b32 v6, 0x3d41848f
    v_xor_b32 v5, v5, v6
    v_cvt_pk_bf16_f32 v5, v5, v6
    s_mul_i32 s28, s16, 14336
    v_add_u32 v12, s28, v15
    v_add_u32 v12, 57344, v12
    s_add_u32 s30, s26, 1
    s_lshl_b32 s30, s30, 5
    v_add_u32 v7, s30, v4
    v_cvt_f32_u32 v7, v7
    v_mul_f32 v7, 0x3b124925, v7
    v_mov_b32 v8, v3
    v_cmp_eq_u32 s[32:33], 0, v8
    v_cvt_f32_u32 v8, v8
    v_mul_f32 v8, v8, v7
    v_fract_f32 v8, v8
    v_mul_f32 v9, 8.0, v7
    v_cos_f32 v9, v9
    s_nop 0
    v_add_f32 v9, v9, v9
    v_sub_f32 v11, 0, v9
    v_fmamk_f32 v10, v7, 0x00000000, v8
    v_cos_f32 v16, v10
    v_sin_f32 v17, v10
    v_fmamk_f32 v10, v7, 0x3f800000, v8
    v_cos_f32 v18, v10
    v_sin_f32 v19, v10
    v_fmamk_f32 v10, v7, 0x40800000, v8
    v_cos_f32 v20, v10
    v_sin_f32 v21, v10
    v_fmamk_f32 v10, v7, 0x40a00000, v8
    v_cos_f32 v22, v10
    v_sin_f32 v23, v10
    v_mul_f32 v16, s34, v16
    v_mul_f32 v17, s34, v17
    v_mul_f32 v18, s34, v18
    v_mul_f32 v19, s34, v19
    v_mul_f32 v20, s34, v20
    v_mul_f32 v21, s34, v21
    v_mul_f32 v22, s34, v22
    v_mul_f32 v23, s34, v23
    v_cvt_pk_bf16_f32 v32, v16, -v17
    v_cvt_pk_bf16_f32 v33, v18, -v19
    v_cvt_pk_bf16_f32 v34, v20, -v21
    v_cvt_pk_bf16_f32 v35, v22, -v23
    v_cndmask_b32 v32, v32, v5, s[32:33]
    v_accvgpr_write_b32 a16, v32
    v_accvgpr_write_b32 a17, v33
    v_accvgpr_write_b32 a18, v34
    v_accvgpr_write_b32 a19, v35
    s_add_u32 s23, s18, 3932160
    buffer_store_dwordx4 a[252:255], v15, s[4:7], s23 offen sc1
    v_fmamk_f32 v10, v7, 0x41000000, v8
    v_cos_f32 v24, v10
    v_sin_f32 v25, v10
    v_fmamk_f32 v10, v7, 0x41100000, v8
    v_cos_f32 v26, v10
    v_sin_f32 v27, v10
    v_fmamk_f32 v10, v7, 0x41400000, v8
    v_cos_f32 v28, v10
    v_sin_f32 v29, v10
    v_fmamk_f32 v10, v7, 0x41500000, v8
    v_cos_f32 v30, v10
    v_sin_f32 v31, v10
    v_mul_f32 v24, s34, v24
    v_mul_f32 v25, s34, v25
    v_mul_f32 v26, s34, v26
    v_mul_f32 v27, s34, v27
    v_mul_f32 v28, s34, v28
    v_mul_f32 v29, s34, v29
    v_mul_f32 v30, s34, v30
    v_mul_f32 v31, s34, v31
    v_cvt_pk_bf16_f32 v36, v24, -v25
    v_cvt_pk_bf16_f32 v37, v26, -v27
    v_cvt_pk_bf16_f32 v38, v28, -v29
    v_cvt_pk_bf16_f32 v39, v30, -v31
    v_accvgpr_write_b32 a20, v36
    v_accvgpr_write_b32 a21, v37
    v_accvgpr_write_b32 a22, v38
    v_accvgpr_write_b32 a23, v39
    s_add_u32 s23, s18, 3933184
    buffer_store_dwordx4 a[252:255], v15, s[4:7], s23 offen sc1
    v_fmac_f32 v16, v11, v24
    v_fmac_f32 v17, v11, v25
    v_fmac_f32 v18, v11, v26
    v_fmac_f32 v19, v11, v27
    v_fmac_f32 v20, v11, v28
    v_fmac_f32 v21, v11, v29
    v_fmac_f32 v22, v11, v30
    v_fmac_f32 v23, v11, v31
    v_cvt_pk_bf16_f32 v32, -v16, v17
    v_cvt_pk_bf16_f32 v33, -v18, v19
    v_cvt_pk_bf16_f32 v34, -v20, v21
    v_cvt_pk_bf16_f32 v35, -v22, v23
    v_accvgpr_write_b32 a24, v32
    v_accvgpr_write_b32 a25, v33
    v_accvgpr_write_b32 a26, v34
    v_accvgpr_write_b32 a27, v35
    s_add_u32 s23, s18, 3934208
    buffer_store_dwordx4 a[252:255], v15, s[4:7], s23 offen sc1
    v_fmac_f32 v24, v9, v16
    v_fmac_f32 v25, v9, v17
    v_fmac_f32 v26, v9, v18
    v_fmac_f32 v27, v9, v19
    v_fmac_f32 v28, v9, v20
    v_fmac_f32 v29, v9, v21
    v_fmac_f32 v30, v9, v22
    v_fmac_f32 v31, v9, v23
    v_cvt_pk_bf16_f32 v36, -v24, v25
    v_cvt_pk_bf16_f32 v37, -v26, v27
    v_cvt_pk_bf16_f32 v38, -v28, v29
    v_cvt_pk_bf16_f32 v39, -v30, v31
    v_accvgpr_write_b32 a28, v36
    v_accvgpr_write_b32 a29, v37
    v_accvgpr_write_b32 a30, v38
    v_accvgpr_write_b32 a31, v39
    s_add_u32 s23, s18, 3935232
    buffer_store_dwordx4 a[252:255], v15, s[4:7], s23 offen sc1
    v_fmac_f32 v16, v11, v24
    v_fmac_f32 v17, v11, v25
    v_fmac_f32 v18, v11, v26
    v_fmac_f32 v19, v11, v27
    v_fmac_f32 v20, v11, v28
    v_fmac_f32 v21, v11, v29
    v_fmac_f32 v22, v11, v30
    v_fmac_f32 v23, v11, v31
    v_cvt_pk_bf16_f32 v32, v16, -v17
    v_cvt_pk_bf16_f32 v33, v18, -v19
    v_cvt_pk_bf16_f32 v34, v20, -v21
    v_cvt_pk_bf16_f32 v35, v22, -v23
    v_accvgpr_write_b32 a32, v32
    v_accvgpr_write_b32 a33, v33
    v_accvgpr_write_b32 a34, v34
    v_accvgpr_write_b32 a35, v35
    s_add_u32 s23, s18, 3936256
    buffer_store_dwordx4 a[252:255], v15, s[4:7], s23 offen sc1
    v_fmac_f32 v24, v9, v16
    v_fmac_f32 v25, v9, v17
    v_fmac_f32 v26, v9, v18
    v_fmac_f32 v27, v9, v19
    v_fmac_f32 v28, v9, v20
    v_fmac_f32 v29, v9, v21
    v_fmac_f32 v30, v9, v22
    v_fmac_f32 v31, v9, v23
    v_cvt_pk_bf16_f32 v36, v24, -v25
    v_cvt_pk_bf16_f32 v37, v26, -v27
    v_cvt_pk_bf16_f32 v38, v28, -v29
    v_cvt_pk_bf16_f32 v39, v30, -v31
    v_accvgpr_write_b32 a36, v36
    v_accvgpr_write_b32 a37, v37
    v_accvgpr_write_b32 a38, v38
    v_accvgpr_write_b32 a39, v39
    s_add_u32 s23, s18, 3937280
    buffer_store_dwordx4 a[252:255], v15, s[4:7], s23 offen sc1
    v_fmac_f32 v16, v11, v24
    v_fmac_f32 v17, v11, v25
    v_fmac_f32 v18, v11, v26
    v_fmac_f32 v19, v11, v27
    v_fmac_f32 v20, v11, v28
    v_fmac_f32 v21, v11, v29
    v_fmac_f32 v22, v11, v30
    v_fmac_f32 v23, v11, v31
    v_cvt_pk_bf16_f32 v32, -v16, v17
    v_cvt_pk_bf16_f32 v33, -v18, v19
    v_cvt_pk_bf16_f32 v34, -v20, v21
    v_cvt_pk_bf16_f32 v35, -v22, v23
    v_accvgpr_write_b32 a40, v32
    v_accvgpr_write_b32 a41, v33
    v_accvgpr_write_b32 a42, v34
    v_accvgpr_write_b32 a43, v35
    s_add_u32 s23, s18, 3938304
    buffer_store_dwordx4 a[252:255], v15, s[4:7], s23 offen sc1
    v_fmac_f32 v24, v9, v16
    v_fmac_f32 v25, v9, v17
    v_fmac_f32 v26, v9, v18
    v_fmac_f32 v27, v9, v19
    v_fmac_f32 v28, v9, v20
    v_fmac_f32 v29, v9, v21
    v_fmac_f32 v30, v9, v22
    v_fmac_f32 v31, v9, v23
    v_cvt_pk_bf16_f32 v36, -v24, v25
    v_cvt_pk_bf16_f32 v37, -v26, v27
    v_cvt_pk_bf16_f32 v38, -v28, v29
    v_cvt_pk_bf16_f32 v39, -v30, v31
    v_accvgpr_write_b32 a44, v36
    v_accvgpr_write_b32 a45, v37
    v_accvgpr_write_b32 a46, v38
    v_accvgpr_write_b32 a47, v39
    s_add_u32 s23, s18, 3939328
    buffer_store_dwordx4 a[252:255], v15, s[4:7], s23 offen sc1
    v_fmac_f32 v16, v11, v24
    v_fmac_f32 v17, v11, v25
    v_fmac_f32 v18, v11, v26
    v_fmac_f32 v19, v11, v27
    v_fmac_f32 v20, v11, v28
    v_fmac_f32 v21, v11, v29
    v_fmac_f32 v22, v11, v30
    v_fmac_f32 v23, v11, v31
    v_cvt_pk_bf16_f32 v32, v16, -v17
    v_cvt_pk_bf16_f32 v33, v18, -v19
    v_cvt_pk_bf16_f32 v34, v20, -v21
    v_cvt_pk_bf16_f32 v35, v22, -v23
    v_accvgpr_write_b32 a48, v32
    v_accvgpr_write_b32 a49, v33
    v_accvgpr_write_b32 a50, v34
    v_accvgpr_write_b32 a51, v35
    s_add_u32 s23, s18, 3940352
    buffer_store_dwordx4 a[252:255], v15, s[4:7], s23 offen sc1
    v_fmac_f32 v24, v9, v16
    v_fmac_f32 v25, v9, v17
    v_fmac_f32 v26, v9, v18
    v_fmac_f32 v27, v9, v19
    v_fmac_f32 v28, v9, v20
    v_fmac_f32 v29, v9, v21
    v_fmac_f32 v30, v9, v22
    v_fmac_f32 v31, v9, v23
    v_cvt_pk_bf16_f32 v36, v24, -v25
    v_cvt_pk_bf16_f32 v37, v26, -v27
    v_cvt_pk_bf16_f32 v38, v28, -v29
    v_cvt_pk_bf16_f32 v39, v30, -v31
    v_accvgpr_write_b32 a52, v36
    v_accvgpr_write_b32 a53, v37
    v_accvgpr_write_b32 a54, v38
    v_accvgpr_write_b32 a55, v39
    s_add_u32 s23, s18, 3941376
    buffer_store_dwordx4 a[252:255], v15, s[4:7], s23 offen sc1
    v_fmac_f32 v16, v11, v24
    v_fmac_f32 v17, v11, v25
    v_fmac_f32 v18, v11, v26
    v_fmac_f32 v19, v11, v27
    v_fmac_f32 v20, v11, v28
    v_fmac_f32 v21, v11, v29
    v_fmac_f32 v22, v11, v30
    v_fmac_f32 v23, v11, v31
    v_cvt_pk_bf16_f32 v32, -v16, v17
    v_cvt_pk_bf16_f32 v33, -v18, v19
    v_cvt_pk_bf16_f32 v34, -v20, v21
    v_cvt_pk_bf16_f32 v35, -v22, v23
    v_accvgpr_write_b32 a56, v32
    v_accvgpr_write_b32 a57, v33
    v_accvgpr_write_b32 a58, v34
    v_accvgpr_write_b32 a59, v35
    s_add_u32 s23, s18, 3942400
    buffer_store_dwordx4 a[252:255], v15, s[4:7], s23 offen sc1
    v_fmac_f32 v24, v9, v16
    v_fmac_f32 v25, v9, v17
    v_fmac_f32 v26, v9, v18
    v_fmac_f32 v27, v9, v19
    v_fmac_f32 v28, v9, v20
    v_fmac_f32 v29, v9, v21
    v_fmac_f32 v30, v9, v22
    v_fmac_f32 v31, v9, v23
    v_cvt_pk_bf16_f32 v36, -v24, v25
    v_cvt_pk_bf16_f32 v37, -v26, v27
    v_cvt_pk_bf16_f32 v38, -v28, v29
    v_cvt_pk_bf16_f32 v39, -v30, v31
    v_accvgpr_write_b32 a60, v36
    v_accvgpr_write_b32 a61, v37
    v_accvgpr_write_b32 a62, v38
    v_accvgpr_write_b32 a63, v39
    s_add_u32 s23, s18, 3943424
    buffer_store_dwordx4 a[252:255], v15, s[4:7], s23 offen sc1
    v_fmac_f32 v16, v11, v24
    v_fmac_f32 v17, v11, v25
    v_fmac_f32 v18, v11, v26
    v_fmac_f32 v19, v11, v27
    v_fmac_f32 v20, v11, v28
    v_fmac_f32 v21, v11, v29
    v_fmac_f32 v22, v11, v30
    v_fmac_f32 v23, v11, v31
    v_cvt_pk_bf16_f32 v32, v16, -v17
    v_cvt_pk_bf16_f32 v33, v18, -v19
    v_cvt_pk_bf16_f32 v34, v20, -v21
    v_cvt_pk_bf16_f32 v35, v22, -v23
    v_accvgpr_write_b32 a64, v32
    v_accvgpr_write_b32 a65, v33
    v_accvgpr_write_b32 a66, v34
    v_accvgpr_write_b32 a67, v35
    s_add_u32 s23, s18, 3944448
    buffer_store_dwordx4 a[252:255], v15, s[4:7], s23 offen sc1
    v_fmac_f32 v24, v9, v16
    v_fmac_f32 v25, v9, v17
    v_fmac_f32 v26, v9, v18
    v_fmac_f32 v27, v9, v19
    v_fmac_f32 v28, v9, v20
    v_fmac_f32 v29, v9, v21
    v_fmac_f32 v30, v9, v22
    v_fmac_f32 v31, v9, v23
    v_cvt_pk_bf16_f32 v36, v24, -v25
    v_cvt_pk_bf16_f32 v37, v26, -v27
    v_cvt_pk_bf16_f32 v38, v28, -v29
    v_cvt_pk_bf16_f32 v39, v30, -v31
    v_accvgpr_write_b32 a68, v36
    v_accvgpr_write_b32 a69, v37
    v_accvgpr_write_b32 a70, v38
    v_accvgpr_write_b32 a71, v39
    s_add_u32 s23, s18, 3945472
    buffer_store_dwordx4 a[252:255], v15, s[4:7], s23 offen sc1
    v_fmac_f32 v16, v11, v24
    v_fmac_f32 v17, v11, v25
    v_fmac_f32 v18, v11, v26
    v_fmac_f32 v19, v11, v27
    v_fmac_f32 v20, v11, v28
    v_fmac_f32 v21, v11, v29
    v_fmac_f32 v22, v11, v30
    v_fmac_f32 v23, v11, v31
    v_cvt_pk_bf16_f32 v32, -v16, v17
    v_cvt_pk_bf16_f32 v33, -v18, v19
    v_cvt_pk_bf16_f32 v34, -v20, v21
    v_cvt_pk_bf16_f32 v35, -v22, v23
    v_accvgpr_write_b32 a72, v32
    v_accvgpr_write_b32 a73, v33
    v_accvgpr_write_b32 a74, v34
    v_accvgpr_write_b32 a75, v35
    s_barrier
    v_fmac_f32 v24, v9, v16
    v_fmac_f32 v25, v9, v17
    v_fmac_f32 v26, v9, v18
    v_fmac_f32 v27, v9, v19
    v_fmac_f32 v28, v9, v20
    v_fmac_f32 v29, v9, v21
    v_fmac_f32 v30, v9, v22
    v_fmac_f32 v31, v9, v23
    v_cvt_pk_bf16_f32 v36, -v24, v25
    v_cvt_pk_bf16_f32 v37, -v26, v27
    v_cvt_pk_bf16_f32 v38, -v28, v29
    v_cvt_pk_bf16_f32 v39, -v30, v31
    v_accvgpr_write_b32 a76, v36
    v_accvgpr_write_b32 a77, v37
    v_accvgpr_write_b32 a78, v38
    v_accvgpr_write_b32 a79, v39
    ds_read_b64_tr_b16 v[48:49], v140 offset:0
    ds_read_b64_tr_b16 v[50:51], v141 offset:1024
    ds_read_b64_tr_b16 v[52:53], v140 offset:2048
    ds_read_b64_tr_b16 v[54:55], v141 offset:3072
    v_fmac_f32 v16, v11, v24
    v_fmac_f32 v17, v11, v25
    v_fmac_f32 v18, v11, v26
    v_fmac_f32 v19, v11, v27
    v_fmac_f32 v20, v11, v28
    v_fmac_f32 v21, v11, v29
    v_fmac_f32 v22, v11, v30
    v_fmac_f32 v23, v11, v31
    v_cvt_pk_bf16_f32 v32, v16, -v17
    v_cvt_pk_bf16_f32 v33, v18, -v19
    v_cvt_pk_bf16_f32 v34, v20, -v21
    v_cvt_pk_bf16_f32 v35, v22, -v23
    v_accvgpr_write_b32 a80, v32
    v_accvgpr_write_b32 a81, v33
    v_accvgpr_write_b32 a82, v34
    v_accvgpr_write_b32 a83, v35
    ds_read_b64_tr_b16 v[56:57], v140 offset:8192
    ds_read_b64_tr_b16 v[58:59], v141 offset:9216
    ds_read_b64_tr_b16 v[60:61], v140 offset:10240
    ds_read_b64_tr_b16 v[62:63], v141 offset:11264
    v_fmac_f32 v24, v9, v16
    v_fmac_f32 v25, v9, v17
    v_fmac_f32 v26, v9, v18
    v_fmac_f32 v27, v9, v19
    v_fmac_f32 v28, v9, v20
    v_fmac_f32 v29, v9, v21
    v_fmac_f32 v30, v9, v22
    v_fmac_f32 v31, v9, v23
    v_cvt_pk_bf16_f32 v36, v24, -v25
    v_cvt_pk_bf16_f32 v37, v26, -v27
    v_cvt_pk_bf16_f32 v38, v28, -v29
    v_cvt_pk_bf16_f32 v39, v30, -v31
    v_accvgpr_write_b32 a84, v36
    v_accvgpr_write_b32 a85, v37
    v_accvgpr_write_b32 a86, v38
    v_accvgpr_write_b32 a87, v39
    ds_read_b64_tr_b16 v[64:65], v140 offset:16384
    ds_read_b64_tr_b16 v[66:67], v141 offset:17408
    ds_read_b64_tr_b16 v[68:69], v140 offset:18432
    ds_read_b64_tr_b16 v[70:71], v141 offset:19456
    v_fmac_f32 v16, v11, v24
    v_fmac_f32 v17, v11, v25
    v_fmac_f32 v18, v11, v26
    v_fmac_f32 v19, v11, v27
    v_fmac_f32 v20, v11, v28
    v_fmac_f32 v21, v11, v29
    v_fmac_f32 v22, v11, v30
    v_fmac_f32 v23, v11, v31
    v_cvt_pk_bf16_f32 v32, -v16, v17
    v_cvt_pk_bf16_f32 v33, -v18, v19
    v_cvt_pk_bf16_f32 v34, -v20, v21
    v_cvt_pk_bf16_f32 v35, -v22, v23
    v_accvgpr_write_b32 a88, v32
    v_accvgpr_write_b32 a89, v33
    v_accvgpr_write_b32 a90, v34
    v_accvgpr_write_b32 a91, v35
    ds_read_b64_tr_b16 v[72:73], v140 offset:24576
    ds_read_b64_tr_b16 v[74:75], v141 offset:25600
    ds_read_b64_tr_b16 v[76:77], v140 offset:26624
    ds_read_b64_tr_b16 v[78:79], v141 offset:27648
    v_fmac_f32 v24, v9, v16
    v_fmac_f32 v25, v9, v17
    v_fmac_f32 v26, v9, v18
    v_fmac_f32 v27, v9, v19
    v_fmac_f32 v28, v9, v20
    v_fmac_f32 v29, v9, v21
    v_fmac_f32 v30, v9, v22
    v_fmac_f32 v31, v9, v23
    v_cvt_pk_bf16_f32 v36, -v24, v25
    v_cvt_pk_bf16_f32 v37, -v26, v27
    v_cvt_pk_bf16_f32 v38, -v28, v29
    v_cvt_pk_bf16_f32 v39, -v30, v31
    v_accvgpr_write_b32 a92, v36
    v_accvgpr_write_b32 a93, v37
    v_accvgpr_write_b32 a94, v38
    v_accvgpr_write_b32 a95, v39
    ds_read_b64_tr_b16 v[80:81], v140 offset:32768
    ds_read_b64_tr_b16 v[82:83], v141 offset:33792
    ds_read_b64_tr_b16 v[84:85], v140 offset:34816
    ds_read_b64_tr_b16 v[86:87], v141 offset:35840
    v_fmac_f32 v16, v11, v24
    v_fmac_f32 v17, v11, v25
    v_fmac_f32 v18, v11, v26
    v_fmac_f32 v19, v11, v27
    v_fmac_f32 v20, v11, v28
    v_fmac_f32 v21, v11, v29
    v_fmac_f32 v22, v11, v30
    v_fmac_f32 v23, v11, v31
    v_cvt_pk_bf16_f32 v32, v16, -v17
    v_cvt_pk_bf16_f32 v33, v18, -v19
    v_cvt_pk_bf16_f32 v34, v20, -v21
    v_cvt_pk_bf16_f32 v35, v22, -v23
    v_accvgpr_write_b32 a96, v32
    v_accvgpr_write_b32 a97, v33
    v_accvgpr_write_b32 a98, v34
    v_accvgpr_write_b32 a99, v35
    ds_read_b64_tr_b16 v[88:89], v140 offset:40960
    ds_read_b64_tr_b16 v[90:91], v141 offset:41984
    ds_read_b64_tr_b16 v[92:93], v140 offset:43008
    ds_read_b64_tr_b16 v[94:95], v141 offset:44032
    v_fmac_f32 v24, v9, v16
    v_fmac_f32 v25, v9, v17
    v_fmac_f32 v26, v9, v18
    v_fmac_f32 v27, v9, v19
    v_fmac_f32 v28, v9, v20
    v_fmac_f32 v29, v9, v21
    v_fmac_f32 v30, v9, v22
    v_fmac_f32 v31, v9, v23
    v_cvt_pk_bf16_f32 v36, v24, -v25
    v_cvt_pk_bf16_f32 v37, v26, -v27
    v_cvt_pk_bf16_f32 v38, v28, -v29
    v_cvt_pk_bf16_f32 v39, v30, -v31
    v_accvgpr_write_b32 a100, v36
    v_accvgpr_write_b32 a101, v37
    v_accvgpr_write_b32 a102, v38
    v_accvgpr_write_b32 a103, v39
    ds_read_b64_tr_b16 v[96:97], v140 offset:49152
    ds_read_b64_tr_b16 v[98:99], v141 offset:50176
    ds_read_b64_tr_b16 v[100:101], v140 offset:51200
    ds_read_b64_tr_b16 v[102:103], v141 offset:52224
    v_fmac_f32 v16, v11, v24
    v_fmac_f32 v17, v11, v25
    v_fmac_f32 v18, v11, v26
    v_fmac_f32 v19, v11, v27
    v_fmac_f32 v20, v11, v28
    v_fmac_f32 v21, v11, v29
    v_fmac_f32 v22, v11, v30
    v_fmac_f32 v23, v11, v31
    v_cvt_pk_bf16_f32 v32, -v16, v17
    v_cvt_pk_bf16_f32 v33, -v18, v19
    v_cvt_pk_bf16_f32 v34, -v20, v21
    v_cvt_pk_bf16_f32 v35, -v22, v23
    v_accvgpr_write_b32 a104, v32
    v_accvgpr_write_b32 a105, v33
    v_accvgpr_write_b32 a106, v34
    v_accvgpr_write_b32 a107, v35
    s_add_u32 s23, s38, 2097152
    s_waitcnt lgkmcnt(15)
    buffer_store_dwordx4 v[48:51], v15, s[4:7], s23 offen offset:0 sc1
    buffer_store_dwordx4 v[52:55], v15, s[4:7], s23 offen offset:2048 sc1
    v_fmac_f32 v24, v9, v16
    v_fmac_f32 v25, v9, v17
    v_fmac_f32 v26, v9, v18
    v_fmac_f32 v27, v9, v19
    v_fmac_f32 v28, v9, v20
    v_fmac_f32 v29, v9, v21
    v_fmac_f32 v30, v9, v22
    v_fmac_f32 v31, v9, v23
    v_cvt_pk_bf16_f32 v36, -v24, v25
    v_cvt_pk_bf16_f32 v37, -v26, v27
    v_cvt_pk_bf16_f32 v38, -v28, v29
    v_cvt_pk_bf16_f32 v39, -v30, v31
    v_accvgpr_write_b32 a108, v36
    v_accvgpr_write_b32 a109, v37
    v_accvgpr_write_b32 a110, v38
    v_accvgpr_write_b32 a111, v39
    s_add_u32 s23, s38, 2154496
    buffer_store_dwordx4 v[56:59], v15, s[4:7], s23 offen offset:0 sc1
    buffer_store_dwordx4 v[60:63], v15, s[4:7], s23 offen offset:2048 sc1
    v_fmac_f32 v16, v11, v24
    v_fmac_f32 v17, v11, v25
    v_fmac_f32 v18, v11, v26
    v_fmac_f32 v19, v11, v27
    v_fmac_f32 v20, v11, v28
    v_fmac_f32 v21, v11, v29
    v_fmac_f32 v22, v11, v30
    v_fmac_f32 v23, v11, v31
    v_cvt_pk_bf16_f32 v32, v16, -v17
    v_cvt_pk_bf16_f32 v33, v18, -v19
    v_cvt_pk_bf16_f32 v34, v20, -v21
    v_cvt_pk_bf16_f32 v35, v22, -v23
    v_accvgpr_write_b32 a112, v32
    v_accvgpr_write_b32 a113, v33
    v_accvgpr_write_b32 a114, v34
    v_accvgpr_write_b32 a115, v35
    s_add_u32 s23, s38, 2211840
    buffer_store_dwordx4 v[64:67], v15, s[4:7], s23 offen offset:0 sc1
    buffer_store_dwordx4 v[68:71], v15, s[4:7], s23 offen offset:2048 sc1
    v_fmac_f32 v24, v9, v16
    v_fmac_f32 v25, v9, v17
    v_fmac_f32 v26, v9, v18
    v_fmac_f32 v27, v9, v19
    v_fmac_f32 v28, v9, v20
    v_fmac_f32 v29, v9, v21
    v_fmac_f32 v30, v9, v22
    v_fmac_f32 v31, v9, v23
    v_cvt_pk_bf16_f32 v36, v24, -v25
    v_cvt_pk_bf16_f32 v37, v26, -v27
    v_cvt_pk_bf16_f32 v38, v28, -v29
    v_cvt_pk_bf16_f32 v39, v30, -v31
    v_accvgpr_write_b32 a116, v36
    v_accvgpr_write_b32 a117, v37
    v_accvgpr_write_b32 a118, v38
    v_accvgpr_write_b32 a119, v39
    s_add_u32 s23, s38, 2269184
    s_waitcnt lgkmcnt(14)
    buffer_store_dwordx4 v[72:75], v15, s[4:7], s23 offen offset:0 sc1
    s_waitcnt lgkmcnt(12)
    buffer_store_dwordx4 v[76:79], v15, s[4:7], s23 offen offset:2048 sc1
    v_fmac_f32 v16, v11, v24
    v_fmac_f32 v17, v11, v25
    v_fmac_f32 v18, v11, v26
    v_fmac_f32 v19, v11, v27
    v_fmac_f32 v20, v11, v28
    v_fmac_f32 v21, v11, v29
    v_fmac_f32 v22, v11, v30
    v_fmac_f32 v23, v11, v31
    v_cvt_pk_bf16_f32 v32, -v16, v17
    v_cvt_pk_bf16_f32 v33, -v18, v19
    v_cvt_pk_bf16_f32 v34, -v20, v21
    v_cvt_pk_bf16_f32 v35, -v22, v23
    v_accvgpr_write_b32 a120, v32
    v_accvgpr_write_b32 a121, v33
    v_accvgpr_write_b32 a122, v34
    v_accvgpr_write_b32 a123, v35
    s_add_u32 s23, s38, 2326528
    s_waitcnt lgkmcnt(10)
    buffer_store_dwordx4 v[80:83], v15, s[4:7], s23 offen offset:0 sc1
    s_waitcnt lgkmcnt(8)
    buffer_store_dwordx4 v[84:87], v15, s[4:7], s23 offen offset:2048 sc1
    v_fmac_f32 v24, v9, v16
    v_fmac_f32 v25, v9, v17
    v_fmac_f32 v26, v9, v18
    v_fmac_f32 v27, v9, v19
    v_fmac_f32 v28, v9, v20
    v_fmac_f32 v29, v9, v21
    v_fmac_f32 v30, v9, v22
    v_fmac_f32 v31, v9, v23
    v_cvt_pk_bf16_f32 v36, -v24, v25
    v_cvt_pk_bf16_f32 v37, -v26, v27
    v_cvt_pk_bf16_f32 v38, -v28, v29
    v_cvt_pk_bf16_f32 v39, -v30, v31
    v_accvgpr_write_b32 a124, v36
    v_accvgpr_write_b32 a125, v37
    v_accvgpr_write_b32 a126, v38
    v_accvgpr_write_b32 a127, v39
    s_add_u32 s23, s38, 2383872
    s_waitcnt lgkmcnt(6)
    buffer_store_dwordx4 v[88:91], v15, s[4:7], s23 offen offset:0 sc1
    s_waitcnt lgkmcnt(4)
    buffer_store_dwordx4 v[92:95], v15, s[4:7], s23 offen offset:2048 sc1
    s_add_u32 s30, s26, 2
    s_lshl_b32 s30, s30, 5
    v_add_u32 v7, s30, v4
    v_cvt_f32_u32 v7, v7
    v_mul_f32 v7, 0x3b124925, v7
    v_mov_b32 v8, v3
    v_cmp_eq_u32 s[32:33], 0, v8
    v_cvt_f32_u32 v8, v8
    v_mul_f32 v8, v8, v7
    v_fract_f32 v8, v8
    v_mul_f32 v9, 8.0, v7
    v_cos_f32 v9, v9
    s_nop 0
    v_add_f32 v9, v9, v9
    v_sub_f32 v11, 0, v9
    v_fmamk_f32 v10, v7, 0x00000000, v8
    v_cos_f32 v16, v10
    v_sin_f32 v17, v10
    v_fmamk_f32 v10, v7, 0x3f800000, v8
    v_cos_f32 v18, v10
    v_sin_f32 v19, v10
    v_fmamk_f32 v10, v7, 0x40800000, v8
    v_cos_f32 v20, v10
    v_sin_f32 v21, v10
    v_fmamk_f32 v10, v7, 0x40a00000, v8
    v_cos_f32 v22, v10
    v_sin_f32 v23, v10
    v_mul_f32 v16, s34, v16
    v_mul_f32 v17, s34, v17
    v_mul_f32 v18, s34, v18
    v_mul_f32 v19, s34, v19
    v_mul_f32 v20, s34, v20
    v_mul_f32 v21, s34, v21
    v_mul_f32 v22, s34, v22
    v_mul_f32 v23, s34, v23
    v_cvt_pk_bf16_f32 v32, v16, -v17
    v_cvt_pk_bf16_f32 v33, v18, -v19
    v_cvt_pk_bf16_f32 v34, v20, -v21
    v_cvt_pk_bf16_f32 v35, v22, -v23
    v_cndmask_b32 v32, v32, v5, s[32:33]
    v_accvgpr_write_b32 a128, v32
    v_accvgpr_write_b32 a129, v33
    v_accvgpr_write_b32 a130, v34
    v_accvgpr_write_b32 a131, v35
    s_add_u32 s23, s38, 2441216
    s_waitcnt lgkmcnt(2)
    buffer_store_dwordx4 v[96:99], v15, s[4:7], s23 offen offset:0 sc1
    s_waitcnt lgkmcnt(0)
    buffer_store_dwordx4 v[100:103], v15, s[4:7], s23 offen offset:2048 sc1
    v_fmamk_f32 v10, v7, 0x41000000, v8
    v_cos_f32 v24, v10
    v_sin_f32 v25, v10
    v_fmamk_f32 v10, v7, 0x41100000, v8
    v_cos_f32 v26, v10
    v_sin_f32 v27, v10
    v_fmamk_f32 v10, v7, 0x41400000, v8
    v_cos_f32 v28, v10
    v_sin_f32 v29, v10
    v_fmamk_f32 v10, v7, 0x41500000, v8
    v_cos_f32 v30, v10
    v_sin_f32 v31, v10
    v_mul_f32 v24, s34, v24
    v_mul_f32 v25, s34, v25
    v_mul_f32 v26, s34, v26
    v_mul_f32 v27, s34, v27
    v_mul_f32 v28, s34, v28
    v_mul_f32 v29, s34, v29
    v_mul_f32 v30, s34, v30
    v_mul_f32 v31, s34, v31
    v_cvt_pk_bf16_f32 v36, v24, -v25
    v_cvt_pk_bf16_f32 v37, v26, -v27
    v_cvt_pk_bf16_f32 v38, v28, -v29
    v_cvt_pk_bf16_f32 v39, v30, -v31
    v_accvgpr_write_b32 a132, v36
    v_accvgpr_write_b32 a133, v37
    v_accvgpr_write_b32 a134, v38
    v_accvgpr_write_b32 a135, v39
    v_fmac_f32 v16, v11, v24
    v_fmac_f32 v17, v11, v25
    v_fmac_f32 v18, v11, v26
    v_fmac_f32 v19, v11, v27
    v_fmac_f32 v20, v11, v28
    v_fmac_f32 v21, v11, v29
    v_fmac_f32 v22, v11, v30
    v_fmac_f32 v23, v11, v31
    v_cvt_pk_bf16_f32 v32, -v16, v17
    v_cvt_pk_bf16_f32 v33, -v18, v19
    v_cvt_pk_bf16_f32 v34, -v20, v21
    v_cvt_pk_bf16_f32 v35, -v22, v23
    v_accvgpr_write_b32 a136, v32
    v_accvgpr_write_b32 a137, v33
    v_accvgpr_write_b32 a138, v34
    v_accvgpr_write_b32 a139, v35
    v_fmac_f32 v24, v9, v16
    v_fmac_f32 v25, v9, v17
    v_fmac_f32 v26, v9, v18
    v_fmac_f32 v27, v9, v19
    v_fmac_f32 v28, v9, v20
    v_fmac_f32 v29, v9, v21
    v_fmac_f32 v30, v9, v22
    v_fmac_f32 v31, v9, v23
    v_cvt_pk_bf16_f32 v36, -v24, v25
    v_cvt_pk_bf16_f32 v37, -v26, v27
    v_cvt_pk_bf16_f32 v38, -v28, v29
    v_cvt_pk_bf16_f32 v39, -v30, v31
    v_accvgpr_write_b32 a140, v36
    v_accvgpr_write_b32 a141, v37
    v_accvgpr_write_b32 a142, v38
    v_accvgpr_write_b32 a143, v39
    v_fmac_f32 v16, v11, v24
    v_fmac_f32 v17, v11, v25
    v_fmac_f32 v18, v11, v26
    v_fmac_f32 v19, v11, v27
    v_fmac_f32 v20, v11, v28
    v_fmac_f32 v21, v11, v29
    v_fmac_f32 v22, v11, v30
    v_fmac_f32 v23, v11, v31
    v_cvt_pk_bf16_f32 v32, v16, -v17
    v_cvt_pk_bf16_f32 v33, v18, -v19
    v_cvt_pk_bf16_f32 v34, v20, -v21
    v_cvt_pk_bf16_f32 v35, v22, -v23
    v_accvgpr_write_b32 a144, v32
    v_accvgpr_write_b32 a145, v33
    v_accvgpr_write_b32 a146, v34
    v_accvgpr_write_b32 a147, v35
    v_fmac_f32 v24, v9, v16
    v_fmac_f32 v25, v9, v17
    v_fmac_f32 v26, v9, v18
    v_fmac_f32 v27, v9, v19
    v_fmac_f32 v28, v9, v20
    v_fmac_f32 v29, v9, v21
    v_fmac_f32 v30, v9, v22
    v_fmac_f32 v31, v9, v23
    v_cvt_pk_bf16_f32 v36, v24, -v25
    v_cvt_pk_bf16_f32 v37, v26, -v27
    v_cvt_pk_bf16_f32 v38, v28, -v29
    v_cvt_pk_bf16_f32 v39, v30, -v31
    v_accvgpr_write_b32 a148, v36
    v_accvgpr_write_b32 a149, v37
    v_accvgpr_write_b32 a150, v38
    v_accvgpr_write_b32 a151, v39
    v_fmac_f32 v16, v11, v24
    v_fmac_f32 v17, v11, v25
    v_fmac_f32 v18, v11, v26
    v_fmac_f32 v19, v11, v27
    v_fmac_f32 v20, v11, v28
    v_fmac_f32 v21, v11, v29
    v_fmac_f32 v22, v11, v30
    v_fmac_f32 v23, v11, v31
    v_cvt_pk_bf16_f32 v32, -v16, v17
    v_cvt_pk_bf16_f32 v33, -v18, v19
    v_cvt_pk_bf16_f32 v34, -v20, v21
    v_cvt_pk_bf16_f32 v35, -v22, v23
    v_accvgpr_write_b32 a152, v32
    v_accvgpr_write_b32 a153, v33
    v_accvgpr_write_b32 a154, v34
    v_accvgpr_write_b32 a155, v35
    v_fmac_f32 v24, v9, v16
    v_fmac_f32 v25, v9, v17
    v_fmac_f32 v26, v9, v18
    v_fmac_f32 v27, v9, v19
    v_fmac_f32 v28, v9, v20
    v_fmac_f32 v29, v9, v21
    v_fmac_f32 v30, v9, v22
    v_fmac_f32 v31, v9, v23
    v_cvt_pk_bf16_f32 v36, -v24, v25
    v_cvt_pk_bf16_f32 v37, -v26, v27
    v_cvt_pk_bf16_f32 v38, -v28, v29
    v_cvt_pk_bf16_f32 v39, -v30, v31
    v_accvgpr_write_b32 a156, v36
    v_accvgpr_write_b32 a157, v37
    v_accvgpr_write_b32 a158, v38
    v_accvgpr_write_b32 a159, v39
    v_fmac_f32 v16, v11, v24
    v_fmac_f32 v17, v11, v25
    v_fmac_f32 v18, v11, v26
    v_fmac_f32 v19, v11, v27
    v_fmac_f32 v20, v11, v28
    v_fmac_f32 v21, v11, v29
    v_fmac_f32 v22, v11, v30
    v_fmac_f32 v23, v11, v31
    v_cvt_pk_bf16_f32 v32, v16, -v17
    v_cvt_pk_bf16_f32 v33, v18, -v19
    v_cvt_pk_bf16_f32 v34, v20, -v21
    v_cvt_pk_bf16_f32 v35, v22, -v23
    v_accvgpr_write_b32 a160, v32
    v_accvgpr_write_b32 a161, v33
    v_accvgpr_write_b32 a162, v34
    v_accvgpr_write_b32 a163, v35
    v_fmac_f32 v24, v9, v16
    v_fmac_f32 v25, v9, v17
    v_fmac_f32 v26, v9, v18
    v_fmac_f32 v27, v9, v19
    v_fmac_f32 v28, v9, v20
    v_fmac_f32 v29, v9, v21
    v_fmac_f32 v30, v9, v22
    v_fmac_f32 v31, v9, v23
    v_cvt_pk_bf16_f32 v36, v24, -v25
    v_cvt_pk_bf16_f32 v37, v26, -v27
    v_cvt_pk_bf16_f32 v38, v28, -v29
    v_cvt_pk_bf16_f32 v39, v30, -v31
    v_accvgpr_write_b32 a164, v36
    v_accvgpr_write_b32 a165, v37
    v_accvgpr_write_b32 a166, v38
    v_accvgpr_write_b32 a167, v39
    v_fmac_f32 v16, v11, v24
    v_fmac_f32 v17, v11, v25
    v_fmac_f32 v18, v11, v26
    v_fmac_f32 v19, v11, v27
    v_fmac_f32 v20, v11, v28
    v_fmac_f32 v21, v11, v29
    v_fmac_f32 v22, v11, v30
    v_fmac_f32 v23, v11, v31
    v_cvt_pk_bf16_f32 v32, -v16, v17
    v_cvt_pk_bf16_f32 v33, -v18, v19
    v_cvt_pk_bf16_f32 v34, -v20, v21
    v_cvt_pk_bf16_f32 v35, -v22, v23
    v_accvgpr_write_b32 a168, v32
    v_accvgpr_write_b32 a169, v33
    v_accvgpr_write_b32 a170, v34
    v_accvgpr_write_b32 a171, v35
    v_fmac_f32 v24, v9, v16
    v_fmac_f32 v25, v9, v17
    v_fmac_f32 v26, v9, v18
    v_fmac_f32 v27, v9, v19
    v_fmac_f32 v28, v9, v20
    v_fmac_f32 v29, v9, v21
    v_fmac_f32 v30, v9, v22
    v_fmac_f32 v31, v9, v23
    v_cvt_pk_bf16_f32 v36, -v24, v25
    v_cvt_pk_bf16_f32 v37, -v26, v27
    v_cvt_pk_bf16_f32 v38, -v28, v29
    v_cvt_pk_bf16_f32 v39, -v30, v31
    v_accvgpr_write_b32 a172, v36
    v_accvgpr_write_b32 a173, v37
    v_accvgpr_write_b32 a174, v38
    v_accvgpr_write_b32 a175, v39
    v_fmac_f32 v16, v11, v24
    v_fmac_f32 v17, v11, v25
    v_fmac_f32 v18, v11, v26
    v_fmac_f32 v19, v11, v27
    v_fmac_f32 v20, v11, v28
    v_fmac_f32 v21, v11, v29
    v_fmac_f32 v22, v11, v30
    v_fmac_f32 v23, v11, v31
    v_cvt_pk_bf16_f32 v32, v16, -v17
    v_cvt_pk_bf16_f32 v33, v18, -v19
    v_cvt_pk_bf16_f32 v34, v20, -v21
    v_cvt_pk_bf16_f32 v35, v22, -v23
    v_accvgpr_write_b32 a176, v32
    v_accvgpr_write_b32 a177, v33
    v_accvgpr_write_b32 a178, v34
    v_accvgpr_write_b32 a179, v35
    v_fmac_f32 v24, v9, v16
    v_fmac_f32 v25, v9, v17
    v_fmac_f32 v26, v9, v18
    v_fmac_f32 v27, v9, v19
    v_fmac_f32 v28, v9, v20
    v_fmac_f32 v29, v9, v21
    v_fmac_f32 v30, v9, v22
    v_fmac_f32 v31, v9, v23
    v_cvt_pk_bf16_f32 v36, v24, -v25
    v_cvt_pk_bf16_f32 v37, v26, -v27
    v_cvt_pk_bf16_f32 v38, v28, -v29
    v_cvt_pk_bf16_f32 v39, v30, -v31
    v_accvgpr_write_b32 a180, v36
    v_accvgpr_write_b32 a181, v37
    v_accvgpr_write_b32 a182, v38
    v_accvgpr_write_b32 a183, v39
    s_waitcnt vmcnt(0)
    s_barrier
    s_mov_b64 exec, 1
    buffer_store_dword v1, v1, s[4:7], s37 offen offset:8 sc1
    s_mov_b64 exec, -1
    v_fmac_f32 v16, v11, v24
    v_fmac_f32 v17, v11, v25
    v_fmac_f32 v18, v11, v26
    v_fmac_f32 v19, v11, v27
    v_fmac_f32 v20, v11, v28
    v_fmac_f32 v21, v11, v29
    v_fmac_f32 v22, v11, v30
    v_fmac_f32 v23, v11, v31
    v_cvt_pk_bf16_f32 v32, -v16, v17
    v_cvt_pk_bf16_f32 v33, -v18, v19
    v_cvt_pk_bf16_f32 v34, -v20, v21
    v_cvt_pk_bf16_f32 v35, -v22, v23
    v_accvgpr_write_b32 a184, v32
    v_accvgpr_write_b32 a185, v33
    v_accvgpr_write_b32 a186, v34
    v_accvgpr_write_b32 a187, v35
    s_add_u32 s23, s18, 5767168
    buffer_store_dwordx4 a[252:255], v15, s[4:7], s23 offen sc1
    v_fmac_f32 v24, v9, v16
    v_fmac_f32 v25, v9, v17
    v_fmac_f32 v26, v9, v18
    v_fmac_f32 v27, v9, v19
    v_fmac_f32 v28, v9, v20
    v_fmac_f32 v29, v9, v21
    v_fmac_f32 v30, v9, v22
    v_fmac_f32 v31, v9, v23
    v_cvt_pk_bf16_f32 v36, -v24, v25
    v_cvt_pk_bf16_f32 v37, -v26, v27
    v_cvt_pk_bf16_f32 v38, -v28, v29
    v_cvt_pk_bf16_f32 v39, -v30, v31
    v_accvgpr_write_b32 a188, v36
    v_accvgpr_write_b32 a189, v37
    v_accvgpr_write_b32 a190, v38
    v_accvgpr_write_b32 a191, v39
    s_add_u32 s23, s18, 5768192
    buffer_store_dwordx4 a[252:255], v15, s[4:7], s23 offen sc1
    v_fmac_f32 v16, v11, v24
    v_fmac_f32 v17, v11, v25
    v_fmac_f32 v18, v11, v26
    v_fmac_f32 v19, v11, v27
    v_fmac_f32 v20, v11, v28
    v_fmac_f32 v21, v11, v29
    v_fmac_f32 v22, v11, v30
    v_fmac_f32 v23, v11, v31
    v_cvt_pk_bf16_f32 v32, v16, -v17
    v_cvt_pk_bf16_f32 v33, v18, -v19
    v_cvt_pk_bf16_f32 v34, v20, -v21
    v_cvt_pk_bf16_f32 v35, v22, -v23
    v_accvgpr_write_b32 a192, v32
    v_accvgpr_write_b32 a193, v33
    v_accvgpr_write_b32 a194, v34
    v_accvgpr_write_b32 a195, v35
    s_add_u32 s23, s18, 5769216
    buffer_store_dwordx4 a[252:255], v15, s[4:7], s23 offen sc1
    v_fmac_f32 v24, v9, v16
    v_fmac_f32 v25, v9, v17
    v_fmac_f32 v26, v9, v18
    v_fmac_f32 v27, v9, v19
    v_fmac_f32 v28, v9, v20
    v_fmac_f32 v29, v9, v21
    v_fmac_f32 v30, v9, v22
    v_fmac_f32 v31, v9, v23
    v_cvt_pk_bf16_f32 v36, v24, -v25
    v_cvt_pk_bf16_f32 v37, v26, -v27
    v_cvt_pk_bf16_f32 v38, v28, -v29
    v_cvt_pk_bf16_f32 v39, v30, -v31
    v_accvgpr_write_b32 a196, v36
    v_accvgpr_write_b32 a197, v37
    v_accvgpr_write_b32 a198, v38
    v_accvgpr_write_b32 a199, v39
    s_add_u32 s23, s18, 5770240
    buffer_store_dwordx4 a[252:255], v15, s[4:7], s23 offen sc1
    v_fmac_f32 v16, v11, v24
    v_fmac_f32 v17, v11, v25
    v_fmac_f32 v18, v11, v26
    v_fmac_f32 v19, v11, v27
    v_fmac_f32 v20, v11, v28
    v_fmac_f32 v21, v11, v29
    v_fmac_f32 v22, v11, v30
    v_fmac_f32 v23, v11, v31
    v_cvt_pk_bf16_f32 v32, -v16, v17
    v_cvt_pk_bf16_f32 v33, -v18, v19
    v_cvt_pk_bf16_f32 v34, -v20, v21
    v_cvt_pk_bf16_f32 v35, -v22, v23
    v_accvgpr_write_b32 a200, v32
    v_accvgpr_write_b32 a201, v33
    v_accvgpr_write_b32 a202, v34
    v_accvgpr_write_b32 a203, v35
    s_add_u32 s23, s18, 5771264
    buffer_store_dwordx4 a[252:255], v15, s[4:7], s23 offen sc1
    v_fmac_f32 v24, v9, v16
    v_fmac_f32 v25, v9, v17
    v_fmac_f32 v26, v9, v18
    v_fmac_f32 v27, v9, v19
    v_fmac_f32 v28, v9, v20
    v_fmac_f32 v29, v9, v21
    v_fmac_f32 v30, v9, v22
    v_fmac_f32 v31, v9, v23
    v_cvt_pk_bf16_f32 v36, -v24, v25
    v_cvt_pk_bf16_f32 v37, -v26, v27
    v_cvt_pk_bf16_f32 v38, -v28, v29
    v_cvt_pk_bf16_f32 v39, -v30, v31
    v_accvgpr_write_b32 a204, v36
    v_accvgpr_write_b32 a205, v37
    v_accvgpr_write_b32 a206, v38
    v_accvgpr_write_b32 a207, v39
    s_add_u32 s23, s18, 5772288
    buffer_store_dwordx4 a[252:255], v15, s[4:7], s23 offen sc1
    v_fmac_f32 v16, v11, v24
    v_fmac_f32 v17, v11, v25
    v_fmac_f32 v18, v11, v26
    v_fmac_f32 v19, v11, v27
    v_fmac_f32 v20, v11, v28
    v_fmac_f32 v21, v11, v29
    v_fmac_f32 v22, v11, v30
    v_fmac_f32 v23, v11, v31
    v_cvt_pk_bf16_f32 v32, v16, -v17
    v_cvt_pk_bf16_f32 v33, v18, -v19
    v_cvt_pk_bf16_f32 v34, v20, -v21
    v_cvt_pk_bf16_f32 v35, v22, -v23
    v_accvgpr_write_b32 a208, v32
    v_accvgpr_write_b32 a209, v33
    v_accvgpr_write_b32 a210, v34
    v_accvgpr_write_b32 a211, v35
    s_add_u32 s23, s18, 5773312
    buffer_store_dwordx4 a[252:255], v15, s[4:7], s23 offen sc1
    v_fmac_f32 v24, v9, v16
    v_fmac_f32 v25, v9, v17
    v_fmac_f32 v26, v9, v18
    v_fmac_f32 v27, v9, v19
    v_fmac_f32 v28, v9, v20
    v_fmac_f32 v29, v9, v21
    v_fmac_f32 v30, v9, v22
    v_fmac_f32 v31, v9, v23
    v_cvt_pk_bf16_f32 v36, v24, -v25
    v_cvt_pk_bf16_f32 v37, v26, -v27
    v_cvt_pk_bf16_f32 v38, v28, -v29
    v_cvt_pk_bf16_f32 v39, v30, -v31
    v_accvgpr_write_b32 a212, v36
    v_accvgpr_write_b32 a213, v37
    v_accvgpr_write_b32 a214, v38
    v_accvgpr_write_b32 a215, v39
    s_add_u32 s23, s18, 5774336
    buffer_store_dwordx4 a[252:255], v15, s[4:7], s23 offen sc1
    v_fmac_f32 v16, v11, v24
    v_fmac_f32 v17, v11, v25
    v_fmac_f32 v18, v11, v26
    v_fmac_f32 v19, v11, v27
    v_fmac_f32 v20, v11, v28
    v_fmac_f32 v21, v11, v29
    v_fmac_f32 v22, v11, v30
    v_fmac_f32 v23, v11, v31
    v_cvt_pk_bf16_f32 v32, -v16, v17
    v_cvt_pk_bf16_f32 v33, -v18, v19
    v_cvt_pk_bf16_f32 v34, -v20, v21
    v_cvt_pk_bf16_f32 v35, -v22, v23
    v_accvgpr_write_b32 a216, v32
    v_accvgpr_write_b32 a217, v33
    v_accvgpr_write_b32 a218, v34
    v_accvgpr_write_b32 a219, v35
    s_add_u32 s23, s18, 5775360
    buffer_store_dwordx4 a[252:255], v15, s[4:7], s23 offen sc1
    v_fmac_f32 v24, v9, v16
    v_fmac_f32 v25, v9, v17
    v_fmac_f32 v26, v9, v18
    v_fmac_f32 v27, v9, v19
    v_fmac_f32 v28, v9, v20
    v_fmac_f32 v29, v9, v21
    v_fmac_f32 v30, v9, v22
    v_fmac_f32 v31, v9, v23
    v_cvt_pk_bf16_f32 v36, -v24, v25
    v_cvt_pk_bf16_f32 v37, -v26, v27
    v_cvt_pk_bf16_f32 v38, -v28, v29
    v_cvt_pk_bf16_f32 v39, -v30, v31
    v_accvgpr_write_b32 a220, v36
    v_accvgpr_write_b32 a221, v37
    v_accvgpr_write_b32 a222, v38
    v_accvgpr_write_b32 a223, v39
    s_add_u32 s23, s18, 5776384
    buffer_store_dwordx4 a[252:255], v15, s[4:7], s23 offen sc1
    v_fmac_f32 v16, v11, v24
    v_fmac_f32 v17, v11, v25
    v_fmac_f32 v18, v11, v26
    v_fmac_f32 v19, v11, v27
    v_fmac_f32 v20, v11, v28
    v_fmac_f32 v21, v11, v29
    v_fmac_f32 v22, v11, v30
    v_fmac_f32 v23, v11, v31
    v_cvt_pk_bf16_f32 v32, v16, -v17
    v_cvt_pk_bf16_f32 v33, v18, -v19
    v_cvt_pk_bf16_f32 v34, v20, -v21
    v_cvt_pk_bf16_f32 v35, v22, -v23
    v_accvgpr_write_b32 a224, v32
    v_accvgpr_write_b32 a225, v33
    v_accvgpr_write_b32 a226, v34
    v_accvgpr_write_b32 a227, v35
    s_add_u32 s23, s18, 5777408
    buffer_store_dwordx4 a[252:255], v15, s[4:7], s23 offen sc1
    v_fmac_f32 v24, v9, v16
    v_fmac_f32 v25, v9, v17
    v_fmac_f32 v26, v9, v18
    v_fmac_f32 v27, v9, v19
    v_fmac_f32 v28, v9, v20
    v_fmac_f32 v29, v9, v21
    v_fmac_f32 v30, v9, v22
    v_fmac_f32 v31, v9, v23
    v_cvt_pk_bf16_f32 v36, v24, -v25
    v_cvt_pk_bf16_f32 v37, v26, -v27
    v_cvt_pk_bf16_f32 v38, v28, -v29
    v_cvt_pk_bf16_f32 v39, v30, -v31
    v_accvgpr_write_b32 a228, v36
    v_accvgpr_write_b32 a229, v37
    v_accvgpr_write_b32 a230, v38
    v_accvgpr_write_b32 a231, v39
    s_add_u32 s23, s18, 5778432
    buffer_store_dwordx4 a[252:255], v15, s[4:7], s23 offen sc1
    v_fmac_f32 v16, v11, v24
    v_fmac_f32 v17, v11, v25
    v_fmac_f32 v18, v11, v26
    v_fmac_f32 v19, v11, v27
    v_fmac_f32 v20, v11, v28
    v_fmac_f32 v21, v11, v29
    v_fmac_f32 v22, v11, v30
    v_fmac_f32 v23, v11, v31
    v_cvt_pk_bf16_f32 v32, -v16, v17
    v_cvt_pk_bf16_f32 v33, -v18, v19
    v_cvt_pk_bf16_f32 v34, -v20, v21
    v_cvt_pk_bf16_f32 v35, -v22, v23
    v_accvgpr_write_b32 a232, v32
    v_accvgpr_write_b32 a233, v33
    v_accvgpr_write_b32 a234, v34
    v_accvgpr_write_b32 a235, v35
    s_add_u32 s23, s18, 5779456
    buffer_store_dwordx4 a[252:255], v15, s[4:7], s23 offen sc1
    v_fmac_f32 v24, v9, v16
    v_fmac_f32 v25, v9, v17
    v_fmac_f32 v26, v9, v18
    v_fmac_f32 v27, v9, v19
    v_fmac_f32 v28, v9, v20
    v_fmac_f32 v29, v9, v21
    v_fmac_f32 v30, v9, v22
    v_fmac_f32 v31, v9, v23
    v_cvt_pk_bf16_f32 v36, -v24, v25
    v_cvt_pk_bf16_f32 v37, -v26, v27
    v_cvt_pk_bf16_f32 v38, -v28, v29
    v_cvt_pk_bf16_f32 v39, -v30, v31
    v_accvgpr_write_b32 a236, v36
    v_accvgpr_write_b32 a237, v37
    v_accvgpr_write_b32 a238, v38
    v_accvgpr_write_b32 a239, v39
    s_add_u32 s23, s18, 5780480
    buffer_store_dwordx4 a[252:255], v15, s[4:7], s23 offen sc1
    s_mul_i32 s29, s25, 112
    s_add_u32 s30, s27, 0
    s_lshl_b32 s30, s30, 5
    v_add_u32 v7, s30, v4
    v_cvt_f32_u32 v7, v7
    v_mul_f32 v7, 0x3b124925, v7
    v_add_u32 v8, s29, v3
    v_cmp_eq_u32 s[32:33], 0, v8
    v_cvt_f32_u32 v8, v8
    v_mul_f32 v8, v8, v7
    v_fract_f32 v8, v8
    v_mul_f32 v9, 8.0, v7
    v_cos_f32 v9, v9
    s_nop 0
    v_add_f32 v9, v9, v9
    v_sub_f32 v11, 0, v9
    v_fmamk_f32 v10, v7, 0x00000000, v8
    v_cos_f32 v16, v10
    v_sin_f32 v17, v10
    v_fmamk_f32 v10, v7, 0x3f800000, v8
    v_cos_f32 v18, v10
    v_sin_f32 v19, v10
    v_fmamk_f32 v10, v7, 0x40800000, v8
    v_cos_f32 v20, v10
    v_sin_f32 v21, v10
    v_fmamk_f32 v10, v7, 0x40a00000, v8
    v_cos_f32 v22, v10
    v_sin_f32 v23, v10
    v_mul_f32 v16, s34, v16
    v_mul_f32 v17, s34, v17
    v_mul_f32 v18, s34, v18
    v_mul_f32 v19, s34, v19
    v_mul_f32 v20, s34, v20
    v_mul_f32 v21, s34, v21
    v_mul_f32 v22, s34, v22
    v_mul_f32 v23, s34, v23
    v_cvt_pk_bf16_f32 v32, v16, -v17
    v_cvt_pk_bf16_f32 v33, v18, -v19
    v_cvt_pk_bf16_f32 v34, v20, -v21
    v_cvt_pk_bf16_f32 v35, v22, -v23
    v_cndmask_b32 v32, v32, v5, s[32:33]
    ds_write_b128 v12, v[32:35] offset:0
    s_add_u32 s23, s18, 7602176
    buffer_store_dwordx4 a[252:255], v15, s[4:7], s23 offen sc1
    v_fmamk_f32 v10, v7, 0x41000000, v8
    v_cos_f32 v24, v10
    v_sin_f32 v25, v10
    v_fmamk_f32 v10, v7, 0x41100000, v8
    v_cos_f32 v26, v10
    v_sin_f32 v27, v10
    v_fmamk_f32 v10, v7, 0x41400000, v8
    v_cos_f32 v28, v10
    v_sin_f32 v29, v10
    v_fmamk_f32 v10, v7, 0x41500000, v8
    v_cos_f32 v30, v10
    v_sin_f32 v31, v10
    v_mul_f32 v24, s34, v24
    v_mul_f32 v25, s34, v25
    v_mul_f32 v26, s34, v26
    v_mul_f32 v27, s34, v27
    v_mul_f32 v28, s34, v28
    v_mul_f32 v29, s34, v29
    v_mul_f32 v30, s34, v30
    v_mul_f32 v31, s34, v31
    v_cvt_pk_bf16_f32 v36, v24, -v25
    v_cvt_pk_bf16_f32 v37, v26, -v27
    v_cvt_pk_bf16_f32 v38, v28, -v29
    v_cvt_pk_bf16_f32 v39, v30, -v31
    ds_write_b128 v12, v[36:39] offset:1024
    s_add_u32 s23, s18, 7603200
    buffer_store_dwordx4 a[252:255], v15, s[4:7], s23 offen sc1
    v_fmac_f32 v16, v11, v24
    v_fmac_f32 v17, v11, v25
    v_fmac_f32 v18, v11, v26
    v_fmac_f32 v19, v11, v27
    v_fmac_f32 v20, v11, v28
    v_fmac_f32 v21, v11, v29
    v_fmac_f32 v22, v11, v30
    v_fmac_f32 v23, v11, v31
    v_cvt_pk_bf16_f32 v32, -v16, v17
    v_cvt_pk_bf16_f32 v33, -v18, v19
    v_cvt_pk_bf16_f32 v34, -v20, v21
    v_cvt_pk_bf16_f32 v35, -v22, v23
    ds_write_b128 v12, v[32:35] offset:2048
    s_add_u32 s23, s18, 7604224
    buffer_store_dwordx4 a[252:255], v15, s[4:7], s23 offen sc1
    v_fmac_f32 v24, v9, v16
    v_fmac_f32 v25, v9, v17
    v_fmac_f32 v26, v9, v18
    v_fmac_f32 v27, v9, v19
    v_fmac_f32 v28, v9, v20
    v_fmac_f32 v29, v9, v21
    v_fmac_f32 v30, v9, v22
    v_fmac_f32 v31, v9, v23
    v_cvt_pk_bf16_f32 v36, -v24, v25
    v_cvt_pk_bf16_f32 v37, -v26, v27
    v_cvt_pk_bf16_f32 v38, -v28, v29
    v_cvt_pk_bf16_f32 v39, -v30, v31
    ds_write_b128 v12, v[36:39] offset:3072
    s_add_u32 s23, s18, 7605248
    buffer_store_dwordx4 a[252:255], v15, s[4:7], s23 offen sc1
    v_fmac_f32 v16, v11, v24
    v_fmac_f32 v17, v11, v25
    v_fmac_f32 v18, v11, v26
    v_fmac_f32 v19, v11, v27
    v_fmac_f32 v20, v11, v28
    v_fmac_f32 v21, v11, v29
    v_fmac_f32 v22, v11, v30
    v_fmac_f32 v23, v11, v31
    v_cvt_pk_bf16_f32 v32, v16, -v17
    v_cvt_pk_bf16_f32 v33, v18, -v19
    v_cvt_pk_bf16_f32 v34, v20, -v21
    v_cvt_pk_bf16_f32 v35, v22, -v23
    ds_write_b128 v12, v[32:35] offset:4096
    s_add_u32 s23, s18, 7606272
    buffer_store_dwordx4 a[252:255], v15, s[4:7], s23 offen sc1
    v_fmac_f32 v24, v9, v16
    v_fmac_f32 v25, v9, v17
    v_fmac_f32 v26, v9, v18
    v_fmac_f32 v27, v9, v19
    v_fmac_f32 v28, v9, v20
    v_fmac_f32 v29, v9, v21
    v_fmac_f32 v30, v9, v22
    v_fmac_f32 v31, v9, v23
    v_cvt_pk_bf16_f32 v36, v24, -v25
    v_cvt_pk_bf16_f32 v37, v26, -v27
    v_cvt_pk_bf16_f32 v38, v28, -v29
    v_cvt_pk_bf16_f32 v39, v30, -v31
    ds_write_b128 v12, v[36:39] offset:5120
    s_add_u32 s23, s18, 7607296
    buffer_store_dwordx4 a[252:255], v15, s[4:7], s23 offen sc1
    v_fmac_f32 v16, v11, v24
    v_fmac_f32 v17, v11, v25
    v_fmac_f32 v18, v11, v26
    v_fmac_f32 v19, v11, v27
    v_fmac_f32 v20, v11, v28
    v_fmac_f32 v21, v11, v29
    v_fmac_f32 v22, v11, v30
    v_fmac_f32 v23, v11, v31
    v_cvt_pk_bf16_f32 v32, -v16, v17
    v_cvt_pk_bf16_f32 v33, -v18, v19
    v_cvt_pk_bf16_f32 v34, -v20, v21
    v_cvt_pk_bf16_f32 v35, -v22, v23
    ds_write_b128 v12, v[32:35] offset:6144
    s_add_u32 s23, s18, 7608320
    buffer_store_dwordx4 a[252:255], v15, s[4:7], s23 offen sc1
    v_fmac_f32 v24, v9, v16
    v_fmac_f32 v25, v9, v17
    v_fmac_f32 v26, v9, v18
    v_fmac_f32 v27, v9, v19
    v_fmac_f32 v28, v9, v20
    v_fmac_f32 v29, v9, v21
    v_fmac_f32 v30, v9, v22
    v_fmac_f32 v31, v9, v23
    v_cvt_pk_bf16_f32 v36, -v24, v25
    v_cvt_pk_bf16_f32 v37, -v26, v27
    v_cvt_pk_bf16_f32 v38, -v28, v29
    v_cvt_pk_bf16_f32 v39, -v30, v31
    ds_write_b128 v12, v[36:39] offset:7168
    s_add_u32 s23, s18, 7609344
    buffer_store_dwordx4 a[252:255], v15, s[4:7], s23 offen sc1
    v_fmac_f32 v16, v11, v24
    v_fmac_f32 v17, v11, v25
    v_fmac_f32 v18, v11, v26
    v_fmac_f32 v19, v11, v27
    v_fmac_f32 v20, v11, v28
    v_fmac_f32 v21, v11, v29
    v_fmac_f32 v22, v11, v30
    v_fmac_f32 v23, v11, v31
    v_cvt_pk_bf16_f32 v32, v16, -v17
    v_cvt_pk_bf16_f32 v33, v18, -v19
    v_cvt_pk_bf16_f32 v34, v20, -v21
    v_cvt_pk_bf16_f32 v35, v22, -v23
    ds_write_b128 v12, v[32:35] offset:8192
    s_add_u32 s23, s18, 7610368
    buffer_store_dwordx4 a[252:255], v15, s[4:7], s23 offen sc1
    v_fmac_f32 v24, v9, v16
    v_fmac_f32 v25, v9, v17
    v_fmac_f32 v26, v9, v18
    v_fmac_f32 v27, v9, v19
    v_fmac_f32 v28, v9, v20
    v_fmac_f32 v29, v9, v21
    v_fmac_f32 v30, v9, v22
    v_fmac_f32 v31, v9, v23
    v_cvt_pk_bf16_f32 v36, v24, -v25
    v_cvt_pk_bf16_f32 v37, v26, -v27
    v_cvt_pk_bf16_f32 v38, v28, -v29
    v_cvt_pk_bf16_f32 v39, v30, -v31
    ds_write_b128 v12, v[36:39] offset:9216
    s_add_u32 s23, s18, 7611392
    buffer_store_dwordx4 a[252:255], v15, s[4:7], s23 offen sc1
    v_fmac_f32 v16, v11, v24
    v_fmac_f32 v17, v11, v25
    v_fmac_f32 v18, v11, v26
    v_fmac_f32 v19, v11, v27
    v_fmac_f32 v20, v11, v28
    v_fmac_f32 v21, v11, v29
    v_fmac_f32 v22, v11, v30
    v_fmac_f32 v23, v11, v31
    v_cvt_pk_bf16_f32 v32, -v16, v17
    v_cvt_pk_bf16_f32 v33, -v18, v19
    v_cvt_pk_bf16_f32 v34, -v20, v21
    v_cvt_pk_bf16_f32 v35, -v22, v23
    ds_write_b128 v12, v[32:35] offset:10240
    s_add_u32 s23, s18, 7612416
    buffer_store_dwordx4 a[252:255], v15, s[4:7], s23 offen sc1
    v_fmac_f32 v24, v9, v16
    v_fmac_f32 v25, v9, v17
    v_fmac_f32 v26, v9, v18
    v_fmac_f32 v27, v9, v19
    v_fmac_f32 v28, v9, v20
    v_fmac_f32 v29, v9, v21
    v_fmac_f32 v30, v9, v22
    v_fmac_f32 v31, v9, v23
    v_cvt_pk_bf16_f32 v36, -v24, v25
    v_cvt_pk_bf16_f32 v37, -v26, v27
    v_cvt_pk_bf16_f32 v38, -v28, v29
    v_cvt_pk_bf16_f32 v39, -v30, v31
    ds_write_b128 v12, v[36:39] offset:11264
    s_add_u32 s23, s18, 7613440
    buffer_store_dwordx4 a[252:255], v15, s[4:7], s23 offen sc1
    v_fmac_f32 v16, v11, v24
    v_fmac_f32 v17, v11, v25
    v_fmac_f32 v18, v11, v26
    v_fmac_f32 v19, v11, v27
    v_fmac_f32 v20, v11, v28
    v_fmac_f32 v21, v11, v29
    v_fmac_f32 v22, v11, v30
    v_fmac_f32 v23, v11, v31
    v_cvt_pk_bf16_f32 v32, v16, -v17
    v_cvt_pk_bf16_f32 v33, v18, -v19
    v_cvt_pk_bf16_f32 v34, v20, -v21
    v_cvt_pk_bf16_f32 v35, v22, -v23
    ds_write_b128 v12, v[32:35] offset:12288
    s_add_u32 s23, s18, 7614464
    buffer_store_dwordx4 a[252:255], v15, s[4:7], s23 offen sc1
    v_fmac_f32 v24, v9, v16
    v_fmac_f32 v25, v9, v17
    v_fmac_f32 v26, v9, v18
    v_fmac_f32 v27, v9, v19
    v_fmac_f32 v28, v9, v20
    v_fmac_f32 v29, v9, v21
    v_fmac_f32 v30, v9, v22
    v_fmac_f32 v31, v9, v23
    v_cvt_pk_bf16_f32 v36, v24, -v25
    v_cvt_pk_bf16_f32 v37, v26, -v27
    v_cvt_pk_bf16_f32 v38, v28, -v29
    v_cvt_pk_bf16_f32 v39, v30, -v31
    ds_write_b128 v12, v[36:39] offset:13312
    s_add_u32 s23, s18, 7615488
    buffer_store_dwordx4 a[252:255], v15, s[4:7], s23 offen sc1
    s_waitcnt vmcnt(0)
    s_barrier
    s_add_u32 s23, s19, s36
    s_add_u32 s23, s23, 1925120
    s_mov_b64 exec, 1
    buffer_store_dword v1, v1, s[4:7], s23 offen sc1
    s_mov_b64 exec, -1
    s_add_u32 s22, s19, 1921024
    v_mov_b32 v3, 0
    s_mov_b32 s28, 0x05040100
    s_mov_b32 s29, 0x07060302
    s_sleep 3
    buffer_load_dword v4, v3, s[4:7], s22 offen sc1
    s_waitcnt vmcnt(0) lgkmcnt(0)
    v_cmp_eq_u32 vcc, -1, v4
    s_cbranch_vccnz R_hg1
B_hg1:
    s_mov_b32 s21, 0
    s_cmp_lt_u32 s16, 2
    s_cselect_b32 s32, 0xff, 0
    s_mov_b32 s33, 0
    v_mov_b32 v4, 0
    v_mov_b32 v5, 0
    v_mov_b32 v6, 0
    v_mov_b32 v7, 0
    s_sleep 16
    s_add_u32 s23, s18, 5767168
    buffer_load_dwordx4 v[16:19], v15, s[4:7], s23 offen offset:0 sc1
    buffer_load_dwordx4 v[20:23], v15, s[4:7], s23 offen offset:1024 sc1
    buffer_load_dwordx4 v[24:27], v15, s[4:7], s23 offen offset:2048 sc1
    buffer_load_dwordx4 v[28:31], v15, s[4:7], s23 offen offset:3072 sc1
    s_add_u32 s23, s18, 5771264
    buffer_load_dwordx4 v[32:35], v15, s[4:7], s23 offen offset:0 sc1
    buffer_load_dwordx4 v[36:39], v15, s[4:7], s23 offen offset:1024 sc1
    buffer_load_dwordx4 v[40:43], v15, s[4:7], s23 offen offset:2048 sc1
    buffer_load_dwordx4 v[44:47], v15, s[4:7], s23 offen offset:3072 sc1
    s_add_u32 s23, s18, 5775360
    buffer_load_dwordx4 v[48:51], v15, s[4:7], s23 offen offset:0 sc1
    buffer_load_dwordx4 v[52:55], v15, s[4:7], s23 offen offset:1024 sc1
    buffer_load_dwordx4 v[56:59], v15, s[4:7], s23 offen offset:2048 sc1
    buffer_load_dwordx4 v[60:63], v15, s[4:7], s23 offen offset:3072 sc1
    s_add_u32 s23, s18, 5779456
    buffer_load_dwordx4 v[64:67], v15, s[4:7], s23 offen offset:0 sc1
    buffer_load_dwordx4 v[68:71], v15, s[4:7], s23 offen offset:1024 sc1
    s_mul_i32 s23, s25, 28672
    s_mul_i32 s30, s24, 14336
    s_add_u32 s23, s23, s30
    v_add_u32 v3, s23, v15
    s_waitcnt vmcnt(11)
    v_max3_u32 v14, v16, v20, v24
    s_waitcnt vmcnt(10)
    v_max_u32 v14, v14, v28
    v_cmp_eq_u32 vcc, -1, v14
    s_cbranch_vccnz R_hx1_0
B_hx1_0:
    ds_write_b128 v3, v[16:19] offset:0
    v_cndmask_b32 v12, v18, 0, s[32:33]
    v_cndmask_b32 v13, v19, 0, s[32:33]
    v_perm_b32 v128, v12, v16, s28
    v_perm_b32 v129, v12, v16, s29
    v_perm_b32 v130, v13, v17, s28
    v_perm_b32 v131, v13, v17, s29
    v_dot2c_f32_bf16 v4, v128, v128
    v_dot2c_f32_bf16 v5, v129, v129
    v_dot2c_f32_bf16 v6, v130, v130
    v_dot2c_f32_bf16 v7, v131, v131
    ds_write_b128 v3, v[20:23] offset:1024
    v_perm_b32 v132, v22, v20, s28
    v_perm_b32 v133, v22, v20, s29
    v_perm_b32 v134, v23, v21, s28
    v_perm_b32 v135, v23, v21, s29
    v_dot2c_f32_bf16 v4, v132, v132
    v_dot2c_f32_bf16 v5, v133, v133
    v_dot2c_f32_bf16 v6, v134, v134
    v_dot2c_f32_bf16 v7, v135, v135
    ds_write_b128 v3, v[24:27] offset:2048
    v_perm_b32 v128, v26, v24, s28
    v_perm_b32 v129, v26, v24, s29
    v_perm_b32 v130, v27, v25, s28
    v_perm_b32 v131, v27, v25, s29
    v_dot2c_f32_bf16 v4, v128, v128
    v_dot2c_f32_bf16 v5, v129, v129
    v_dot2c_f32_bf16 v6, v130, v130
    v_dot2c_f32_bf16 v7, v131, v131
    ds_write_b128 v3, v[28:31] offset:3072
    v_perm_b32 v132, v30, v28, s28
    v_perm_b32 v133, v30, v28, s29
    v_perm_b32 v134, v31, v29, s28
    v_perm_b32 v135, v31, v29, s29
    v_dot2c_f32_bf16 v4, v132, v132
    v_dot2c_f32_bf16 v5, v133, v133
    v_dot2c_f32_bf16 v6, v134, v134
    v_dot2c_f32_bf16 v7, v135, v135
    s_waitcnt vmcnt(7)
    v_max3_u32 v14, v32, v36, v40
    s_waitcnt vmcnt(6)
    v_max_u32 v14, v14, v44
    v_cmp_eq_u32 vcc, -1, v14
    s_cbranch_vccnz R_hx1_1
B_hx1_1:
    ds_write_b128 v3, v[32:35] offset:4096
    v_perm_b32 v128, v34, v32, s28
    v_perm_b32 v129, v34, v32, s29
    v_perm_b32 v130, v35, v33, s28
    v_perm_b32 v131, v35, v33, s29
    v_dot2c_f32_bf16 v4, v128, v128
    v_dot2c_f32_bf16 v5, v129, v129
    v_dot2c_f32_bf16 v6, v130, v130
    v_dot2c_f32_bf16 v7, v131, v131
    ds_write_b128 v3, v[36:39] offset:5120
    v_perm_b32 v132, v38, v36, s28
    v_perm_b32 v133, v38, v36, s29
    v_perm_b32 v134, v39, v37, s28
    v_perm_b32 v135, v39, v37, s29
    v_dot2c_f32_bf16 v4, v132, v132
    v_dot2c_f32_bf16 v5, v133, v133
    v_dot2c_f32_bf16 v6, v134, v134
    v_dot2c_f32_bf16 v7, v135, v135
    ds_write_b128 v3, v[40:43] offset:6144
    v_perm_b32 v128, v42, v40, s28
    v_perm_b32 v129, v42, v40, s29
    v_perm_b32 v130, v43, v41, s28
    v_perm_b32 v131, v43, v41, s29
    v_dot2c_f32_bf16 v4, v128, v128
    v_dot2c_f32_bf16 v5, v129, v129
    v_dot2c_f32_bf16 v6, v130, v130
    v_dot2c_f32_bf16 v7, v131, v131
    ds_write_b128 v3, v[44:47] offset:7168
    v_perm_b32 v132, v46, v44, s28
    v_perm_b32 v133, v46, v44, s29
    v_perm_b32 v134, v47, v45, s28
    v_perm_b32 v135, v47, v45, s29
    v_dot2c_f32_bf16 v4, v132, v132
    v_dot2c_f32_bf16 v5, v133, v133
    v_dot2c_f32_bf16 v6, v134, v134
    v_dot2c_f32_bf16 v7, v135, v135
    s_waitcnt vmcnt(3)
    v_max3_u32 v14, v48, v52, v56
    s_waitcnt vmcnt(2)
    v_max_u32 v14, v14, v60
    v_cmp_eq_u32 vcc, -1, v14
    s_cbranch_vccnz R_hx1_2
B_hx1_2:
    ds_write_b128 v3, v[48:51] offset:8192
    v_perm_b32 v128, v50, v48, s28
    v_perm_b32 v129, v50, v48, s29
    v_perm_b32 v130, v51, v49, s28
    v_perm_b32 v131, v51, v49, s29
    v_dot2c_f32_bf16 v4, v128, v128
    v_dot2c_f32_bf16 v5, v129, v129
    v_dot2c_f32_bf16 v6, v130, v130
    v_dot2c_f32_bf16 v7, v131, v131
    ds_write_b128 v3, v[52:55] offset:9216
    v_perm_b32 v132, v54, v52, s28
    v_perm_b32 v133, v54, v52, s29
    v_perm_b32 v134, v55, v53, s28
    v_perm_b32 v135, v55, v53, s29
    v_dot2c_f32_bf16 v4, v132, v132
    v_dot2c_f32_bf16 v5, v133, v133
    v_dot2c_f32_bf16 v6, v134, v134
    v_dot2c_f32_bf16 v7, v135, v135
    ds_write_b128 v3, v[56:59] offset:10240
    v_perm_b32 v128, v58, v56, s28
    v_perm_b32 v129, v58, v56, s29
    v_perm_b32 v130, v59, v57, s28
    v_perm_b32 v131, v59, v57, s29
    v_dot2c_f32_bf16 v4, v128, v128
    v_dot2c_f32_bf16 v5, v129, v129
    v_dot2c_f32_bf16 v6, v130, v130
    v_dot2c_f32_bf16 v7, v131, v131
    ds_write_b128 v3, v[60:63] offset:11264
    v_perm_b32 v132, v62, v60, s28
    v_perm_b32 v133, v62, v60, s29
    v_perm_b32 v134, v63, v61, s28
    v_perm_b32 v135, v63, v61, s29
    v_dot2c_f32_bf16 v4, v132, v132
    v_dot2c_f32_bf16 v5, v133, v133
    v_dot2c_f32_bf16 v6, v134, v134
    v_dot2c_f32_bf16 v7, v135, v135
    s_waitcnt vmcnt(0)
    v_max_u32 v14, v64, v68
    v_cmp_eq_u32 vcc, -1, v14
    s_cbranch_vccnz R_hx1_3
B_hx1_3:
    ds_write_b128 v3, v[64:67] offset:12288
    v_perm_b32 v128, v66, v64, s28
    v_perm_b32 v129, v66, v64, s29
    v_perm_b32 v130, v67, v65, s28
    v_perm_b32 v131, v67, v65, s29
    v_dot2c_f32_bf16 v4, v128, v128
    v_dot2c_f32_bf16 v5, v129, v129
    v_dot2c_f32_bf16 v6, v130, v130
    v_dot2c_f32_bf16 v7, v131, v131
    ds_write_b128 v3, v[68:71] offset:13312
    v_perm_b32 v132, v70, v68, s28
    v_perm_b32 v133, v70, v68, s29
    v_perm_b32 v134, v71, v69, s28
    v_perm_b32 v135, v71, v69, s29
    v_dot2c_f32_bf16 v4, v132, v132
    v_dot2c_f32_bf16 v5, v133, v133
    v_dot2c_f32_bf16 v6, v134, v134
    v_dot2c_f32_bf16 v7, v135, v135
    v_add_f32_dpp v4, v4, v4 row_ror:8 row_mask:0xf bank_mask:0xf
    v_add_f32_dpp v5, v5, v5 row_ror:8 row_mask:0xf bank_mask:0xf
    v_add_f32_dpp v6, v6, v6 row_ror:8 row_mask:0xf bank_mask:0xf
    v_add_f32_dpp v7, v7, v7 row_ror:8 row_mask:0xf bank_mask:0xf
    v_mov_b32 v8, v4
    v_mov_b32 v9, v5
    v_mov_b32 v10, v6
    v_mov_b32 v11, v7
    v_permlane16_swap_b32 v4, v8
    v_permlane16_swap_b32 v5, v9
    v_permlane16_swap_b32 v6, v10
    v_permlane16_swap_b32 v7, v11
    v_add_f32 v4, v4, v8
    v_add_f32 v5, v5, v9
    v_add_f32 v6, v6, v10
    v_add_f32 v7, v7, v11
    v_mov_b32 v8, v4
    v_mov_b32 v9, v5
    v_mov_b32 v10, v6
    v_mov_b32 v11, v7
    v_permlane32_swap_b32 v4, v8
    v_permlane32_swap_b32 v5, v9
    v_permlane32_swap_b32 v6, v10
    v_permlane32_swap_b32 v7, v11
    v_add_f32 v4, v4, v8
    v_add_f32 v5, v5, v9
    v_add_f32 v6, v6, v10
    v_add_f32 v7, v7, v11
    s_lshl_b32 s23, s17, 7
    s_lshl_b32 s30, s24, 13
    s_add_u32 s23, s23, s30
    s_add_u32 s23, s23, 1867776
    s_mov_b64 exec, 0xff
    buffer_store_dwordx4 v[4:7], v15, s[4:7], s23 offen sc1
    s_mov_b64 exec, -1
    v_lshrrev_b32 v3, 5, v1
    v_lshlrev_b32 v3, 3, v3
    v_and_b32 v6, 3, v1
    v_lshlrev_b32 v6, 4, v6
    v_and_b32 v5, 4, v1
    v_lshl_or_b32 v6, v5, 1, v6
    v_and_b32 v5, 8, v1
    v_lshl_or_b32 v6, v5, 4, v6
    v_and_b32 v5, 16, v1
    v_lshl_or_b32 v6, v5, 2, v6
    v_and_b32 v5, 32, v1
    v_lshl_or_b32 v6, v5, 3, v6
    s_mul_i32 s23, s25, 28672
    s_sub_u32 s24, 28672, s23
    v_add_u32 v4, s23, v6
    v_add_u32 v5, s24, v6
    s_lshr_b32 s28, s16, 1
    s_mul_i32 s28, s28, 28672
    v_add_u32 v12, s28, v15
    v_add_u32 v12, 57344, v12
    s_mul_i32 s22, s20, 57344
    s_add_u32 s22, s22, 7602176
    s_add_u32 s24, s24, s22
    s_add_u32 s22, s22, s23
    s_mov_b32 s23, s24
    s_waitcnt lgkmcnt(0)
    s_barrier
    ds_read_b64_tr_b16 v[128:129], v4 offset:0
    ds_read_b64_tr_b16 v[130:131], v4 offset:512
    ds_read_b64_tr_b16 v[132:133], v5 offset:0
    ds_read_b64_tr_b16 v[134:135], v5 offset:512
    ds_read_b128 v[152:155], v12 offset:0
    ds_read_b64_tr_b16 v[136:137], v4 offset:1024
    ds_read_b64_tr_b16 v[138:139], v4 offset:1536
    ds_read_b64_tr_b16 v[140:141], v5 offset:1024
    ds_read_b64_tr_b16 v[142:143], v5 offset:1536
    s_waitcnt lgkmcnt(7)
    v_mfma_f32_32x32x16_bf16 v[16:31], v[160:163], v[128:131], 0
    ds_read_b64_tr_b16 v[144:145], v4 offset:2048
    ds_read_b64_tr_b16 v[146:147], v4 offset:2560
    ds_read_b64_tr_b16 v[148:149], v5 offset:2048
    ds_read_b64_tr_b16 v[150:151], v5 offset:2560
    s_waitcnt lgkmcnt(9)
    v_mfma_f32_32x32x16_bf16 v[32:47], v[160:163], v[132:135], 0
    ds_read_b128 v[156:159], v12 offset:1024
    v_mfma_f32_32x32x16_bf16 v[48:63], a[16:19], v[128:131], 0
    v_mfma_f32_32x32x16_bf16 v[64:79], a[16:19], v[132:135], 0
    v_mfma_f32_32x32x16_bf16 v[80:95], a[128:131], v[128:131], 0
    v_mfma_f32_32x32x16_bf16 v[96:111], a[128:131], v[132:135], 0
    s_waitcnt lgkmcnt(9)
    v_mfma_f32_32x32x16_bf16 v[112:127], v[152:155], v[128:131], 0
    s_waitcnt lgkmcnt(7)
    v_mfma_f32_32x32x16_bf16 v[16:31], v[164:167], v[136:139], v[16:31]
    ds_read_b64_tr_b16 v[128:129], v4 offset:3072
    ds_read_b64_tr_b16 v[130:131], v4 offset:3584
    ds_read_b64_tr_b16 v[132:133], v5 offset:3072
    ds_read_b64_tr_b16 v[134:135], v5 offset:3584
    s_waitcnt lgkmcnt(9)
    v_mfma_f32_32x32x16_bf16 v[32:47], v[164:167], v[140:143], v[32:47]
    ds_read_b128 v[152:155], v12 offset:2048
    v_mfma_f32_32x32x16_bf16 v[48:63], a[20:23], v[136:139], v[48:63]
    v_mfma_f32_32x32x16_bf16 v[64:79], a[20:23], v[140:143], v[64:79]
    v_mfma_f32_32x32x16_bf16 v[80:95], a[132:135], v[136:139], v[80:95]
    v_mfma_f32_32x32x16_bf16 v[96:111], a[132:135], v[140:143], v[96:111]
    s_waitcnt lgkmcnt(5)
    v_mfma_f32_32x32x16_bf16 v[112:127], v[156:159], v[136:139], v[112:127]
    v_mfma_f32_32x32x16_bf16 v[16:31], v[168:171], v[144:147], v[16:31]
    ds_read_b64_tr_b16 v[136:137], v4 offset:4096
    ds_read_b64_tr_b16 v[138:139], v4 offset:4608
    ds_read_b64_tr_b16 v[140:141], v5 offset:4096
    ds_read_b64_tr_b16 v[142:143], v5 offset:4608
    v_mfma_f32_32x32x16_bf16 v[32:47], v[168:171], v[148:151], v[32:47]
    ds_read_b128 v[156:159], v12 offset:3072
    v_mfma_f32_32x32x16_bf16 v[48:63], a[24:27], v[144:147], v[48:63]
    v_mfma_f32_32x32x16_bf16 v[64:79], a[24:27], v[148:151], v[64:79]
    v_mfma_f32_32x32x16_bf16 v[80:95], a[136:139], v[144:147], v[80:95]
    v_mfma_f32_32x32x16_bf16 v[96:111], a[136:139], v[148:151], v[96:111]
    s_waitcnt lgkmcnt(5)
    v_mfma_f32_32x32x16_bf16 v[112:127], v[152:155], v[144:147], v[112:127]
    v_mfma_f32_32x32x16_bf16 v[16:31], v[172:175], v[128:131], v[16:31]
    ds_read_b64_tr_b16 v[144:145], v4 offset:5120
    ds_read_b64_tr_b16 v[146:147], v4 offset:5632
    ds_read_b64_tr_b16 v[148:149], v5 offset:5120
    ds_read_b64_tr_b16 v[150:151], v5 offset:5632
    v_mfma_f32_32x32x16_bf16 v[32:47], v[172:175], v[132:135], v[32:47]
    ds_read_b128 v[152:155], v12 offset:4096
    v_mfma_f32_32x32x16_bf16 v[48:63], a[28:31], v[128:131], v[48:63]
    v_mfma_f32_32x32x16_bf16 v[64:79], a[28:31], v[132:135], v[64:79]
    v_mfma_f32_32x32x16_bf16 v[80:95], a[140:143], v[128:131], v[80:95]
    v_mfma_f32_32x32x16_bf16 v[96:111], a[140:143], v[132:135], v[96:111]
    s_waitcnt lgkmcnt(5)
    v_mfma_f32_32x32x16_bf16 v[112:127], v[156:159], v[128:131], v[112:127]
    v_mfma_f32_32x32x16_bf16 v[16:31], v[176:179], v[136:139], v[16:31]
    ds_read_b64_tr_b16 v[128:129], v4 offset:6144
    ds_read_b64_tr_b16 v[130:131], v4 offset:6656
    ds_read_b64_tr_b16 v[132:133], v5 offset:6144
    ds_read_b64_tr_b16 v[134:135], v5 offset:6656
    v_mfma_f32_32x32x16_bf16 v[32:47], v[176:179], v[140:143], v[32:47]
    ds_read_b128 v[156:159], v12 offset:5120
    v_mfma_f32_32x32x16_bf16 v[48:63], a[32:35], v[136:139], v[48:63]
    v_mfma_f32_32x32x16_bf16 v[64:79], a[32:35], v[140:143], v[64:79]
    v_mfma_f32_32x32x16_bf16 v[80:95], a[144:147], v[136:139], v[80:95]
    v_mfma_f32_32x32x16_bf16 v[96:111], a[144:147], v[140:143], v[96:111]
    s_waitcnt lgkmcnt(5)
    v_mfma_f32_32x32x16_bf16 v[112:127], v[152:155], v[136:139], v[112:127]
    v_mfma_f32_32x32x16_bf16 v[16:31], v[180:183], v[144:147], v[16:31]
    ds_read_b64_tr_b16 v[136:137], v4 offset:7168
    ds_read_b64_tr_b16 v[138:139], v4 offset:7680
    ds_read_b64_tr_b16 v[140:141], v5 offset:7168
    ds_read_b64_tr_b16 v[142:143], v5 offset:7680
    v_mfma_f32_32x32x16_bf16 v[32:47], v[180:183], v[148:151], v[32:47]
    ds_read_b128 v[152:155], v12 offset:6144
    v_mfma_f32_32x32x16_bf16 v[48:63], a[36:39], v[144:147], v[48:63]
    v_mfma_f32_32x32x16_bf16 v[64:79], a[36:39], v[148:151], v[64:79]
    v_mfma_f32_32x32x16_bf16 v[80:95], a[148:151], v[144:147], v[80:95]
    v_mfma_f32_32x32x16_bf16 v[96:111], a[148:151], v[148:151], v[96:111]
    s_waitcnt lgkmcnt(5)
    v_mfma_f32_32x32x16_bf16 v[112:127], v[156:159], v[144:147], v[112:127]
    v_mfma_f32_32x32x16_bf16 v[16:31], v[184:187], v[128:131], v[16:31]
    ds_read_b64_tr_b16 v[144:145], v4 offset:8192
    ds_read_b64_tr_b16 v[146:147], v4 offset:8704
    ds_read_b64_tr_b16 v[148:149], v5 offset:8192
    ds_read_b64_tr_b16 v[150:151], v5 offset:8704
    v_mfma_f32_32x32x16_bf16 v[32:47], v[184:187], v[132:135], v[32:47]
    ds_read_b128 v[156:159], v12 offset:7168
    v_mfma_f32_32x32x16_bf16 v[48:63], a[40:43], v[128:131], v[48:63]
    v_mfma_f32_32x32x16_bf16 v[64:79], a[40:43], v[132:135], v[64:79]
    v_mfma_f32_32x32x16_bf16 v[80:95], a[152:155], v[128:131], v[80:95]
    v_mfma_f32_32x32x16_bf16 v[96:111], a[152:155], v[132:135], v[96:111]
    s_waitcnt lgkmcnt(5)
    v_mfma_f32_32x32x16_bf16 v[112:127], v[152:155], v[128:131], v[112:127]
    v_mfma_f32_32x32x16_bf16 v[16:31], v[188:191], v[136:139], v[16:31]
    ds_read_b64_tr_b16 v[128:129], v4 offset:9216
    ds_read_b64_tr_b16 v[130:131], v4 offset:9728
    ds_read_b64_tr_b16 v[132:133], v5 offset:9216
    ds_read_b64_tr_b16 v[134:135], v5 offset:9728
    v_mfma_f32_32x32x16_bf16 v[32:47], v[188:191], v[140:143], v[32:47]
    ds_read_b128 v[152:155], v12 offset:8192
    v_mfma_f32_32x32x16_bf16 v[48:63], a[44:47], v[136:139], v[48:63]
    v_mfma_f32_32x32x16_bf16 v[64:79], a[44:47], v[140:143], v[64:79]
    v_mfma_f32_32x32x16_bf16 v[80:95], a[156:159], v[136:139], v[80:95]
    v_mfma_f32_32x32x16_bf16 v[96:111], a[156:159], v[140:143], v[96:111]
    s_waitcnt lgkmcnt(5)
    v_mfma_f32_32x32x16_bf16 v[112:127], v[156:159], v[136:139], v[112:127]
    v_mfma_f32_32x32x16_bf16 v[16:31], v[192:195], v[144:147], v[16:31]
    ds_read_b64_tr_b16 v[136:137], v4 offset:10240
    ds_read_b64_tr_b16 v[138:139], v4 offset:10752
    ds_read_b64_tr_b16 v[140:141], v5 offset:10240
    ds_read_b64_tr_b16 v[142:143], v5 offset:10752
    v_mfma_f32_32x32x16_bf16 v[32:47], v[192:195], v[148:151], v[32:47]
    ds_read_b128 v[156:159], v12 offset:9216
    v_mfma_f32_32x32x16_bf16 v[48:63], a[48:51], v[144:147], v[48:63]
    v_mfma_f32_32x32x16_bf16 v[64:79], a[48:51], v[148:151], v[64:79]
    v_mfma_f32_32x32x16_bf16 v[80:95], a[160:163], v[144:147], v[80:95]
    v_mfma_f32_32x32x16_bf16 v[96:111], a[160:163], v[148:151], v[96:111]
    s_waitcnt lgkmcnt(5)
    v_mfma_f32_32x32x16_bf16 v[112:127], v[152:155], v[144:147], v[112:127]
    v_mfma_f32_32x32x16_bf16 v[16:31], v[196:199], v[128:131], v[16:31]
    ds_read_b64_tr_b16 v[144:145], v4 offset:11264
    ds_read_b64_tr_b16 v[146:147], v4 offset:11776
    ds_read_b64_tr_b16 v[148:149], v5 offset:11264
    ds_read_b64_tr_b16 v[150:151], v5 offset:11776
    v_mfma_f32_32x32x16_bf16 v[32:47], v[196:199], v[132:135], v[32:47]
    ds_read_b128 v[152:155], v12 offset:10240
    v_mfma_f32_32x32x16_bf16 v[48:63], a[52:55], v[128:131], v[48:63]
    v_mfma_f32_32x32x16_bf16 v[64:79], a[52:55], v[132:135], v[64:79]
    v_mfma_f32_32x32x16_bf16 v[80:95], a[164:167], v[128:131], v[80:95]
    v_mfma_f32_32x32x16_bf16 v[96:111], a[164:167], v[132:135], v[96:111]
    s_waitcnt lgkmcnt(5)
    v_mfma_f32_32x32x16_bf16 v[112:127], v[156:159], v[128:131], v[112:127]
    v_mfma_f32_32x32x16_bf16 v[16:31], v[200:203], v[136:139], v[16:31]
    ds_read_b64_tr_b16 v[128:129], v4 offset:12288
    ds_read_b64_tr_b16 v[130:131], v4 offset:12800
    ds_read_b64_tr_b16 v[132:133], v5 offset:12288
    ds_read_b64_tr_b16 v[134:135], v5 offset:12800
    v_mfma_f32_32x32x16_bf16 v[32:47], v[200:203], v[140:143], v[32:47]
    ds_read_b128 v[156:159], v12 offset:11264
    v_mfma_f32_32x32x16_bf16 v[48:63], a[56:59], v[136:139], v[48:63]
    s_add_u32 s30, s26, 0
    s_lshl_b32 s30, s30, 6
    buffer_load_dwordx2 v[160:161], v3, s[80:83], s30 offen offset:0
    buffer_load_dwordx2 v[162:163], v3, s[80:83], s30 offen offset:16
    buffer_load_dwordx2 v[164:165], v3, s[80:83], s30 offen offset:32
    buffer_load_dwordx2 v[166:167], v3, s[80:83], s30 offen offset:48
    v_mfma_f32_32x32x16_bf16 v[64:79], a[56:59], v[140:143], v[64:79]
    v_mfma_f32_32x32x16_bf16 v[80:95], a[168:171], v[136:139], v[80:95]
    v_mfma_f32_32x32x16_bf16 v[96:111], a[168:171], v[140:143], v[96:111]
    s_waitcnt lgkmcnt(5)
    v_mfma_f32_32x32x16_bf16 v[112:127], v[152:155], v[136:139], v[112:127]
    v_mfma_f32_32x32x16_bf16 v[16:31], v[204:207], v[144:147], v[16:31]
    ds_read_b64_tr_b16 v[136:137], v4 offset:13312
    ds_read_b64_tr_b16 v[138:139], v4 offset:13824
    ds_read_b64_tr_b16 v[140:141], v5 offset:13312
    ds_read_b64_tr_b16 v[142:143], v5 offset:13824
    v_mfma_f32_32x32x16_bf16 v[32:47], v[204:207], v[148:151], v[32:47]
    ds_read_b128 v[152:155], v12 offset:12288
    v_mfma_f32_32x32x16_bf16 v[48:63], a[60:63], v[144:147], v[48:63]
    s_add_u32 s30, s26, 1
    s_lshl_b32 s30, s30, 6
    buffer_load_dwordx2 v[168:169], v3, s[80:83], s30 offen offset:0
    buffer_load_dwordx2 v[170:171], v3, s[80:83], s30 offen offset:16
    buffer_load_dwordx2 v[172:173], v3, s[80:83], s30 offen offset:32
    buffer_load_dwordx2 v[174:175], v3, s[80:83], s30 offen offset:48
    v_mfma_f32_32x32x16_bf16 v[64:79], a[60:63], v[148:151], v[64:79]
    v_mfma_f32_32x32x16_bf16 v[80:95], a[172:175], v[144:147], v[80:95]
    v_mfma_f32_32x32x16_bf16 v[96:111], a[172:175], v[148:151], v[96:111]
    s_waitcnt lgkmcnt(5)
    v_mfma_f32_32x32x16_bf16 v[112:127], v[156:159], v[144:147], v[112:127]
    v_mfma_f32_32x32x16_bf16 v[16:31], v[208:211], v[128:131], v[16:31]
    ds_read_b64_tr_b16 v[144:145], v4 offset:14336
    ds_read_b64_tr_b16 v[146:147], v4 offset:14848
    ds_read_b64_tr_b16 v[148:149], v5 offset:14336
    ds_read_b64_tr_b16 v[150:151], v5 offset:14848
    v_mfma_f32_32x32x16_bf16 v[32:47], v[208:211], v[132:135], v[32:47]
    ds_read_b128 v[156:159], v12 offset:13312
    v_mfma_f32_32x32x16_bf16 v[48:63], a[64:67], v[128:131], v[48:63]
    s_add_u32 s30, s26, 2
    s_lshl_b32 s30, s30, 6
    buffer_load_dwordx2 v[176:177], v3, s[80:83], s30 offen offset:0
    buffer_load_dwordx2 v[178:179], v3, s[80:83], s30 offen offset:16
    buffer_load_dwordx2 v[180:181], v3, s[80:83], s30 offen offset:32
    buffer_load_dwordx2 v[182:183], v3, s[80:83], s30 offen offset:48
    v_mfma_f32_32x32x16_bf16 v[64:79], a[64:67], v[132:135], v[64:79]
    v_mfma_f32_32x32x16_bf16 v[80:95], a[176:179], v[128:131], v[80:95]
    v_mfma_f32_32x32x16_bf16 v[96:111], a[176:179], v[132:135], v[96:111]
    s_waitcnt lgkmcnt(5)
    v_mfma_f32_32x32x16_bf16 v[112:127], v[152:155], v[128:131], v[112:127]
    v_mfma_f32_32x32x16_bf16 v[16:31], v[212:215], v[136:139], v[16:31]
    ds_read_b64_tr_b16 v[128:129], v4 offset:15360
    ds_read_b64_tr_b16 v[130:131], v4 offset:15872
    ds_read_b64_tr_b16 v[132:133], v5 offset:15360
    ds_read_b64_tr_b16 v[134:135], v5 offset:15872
    v_mfma_f32_32x32x16_bf16 v[32:47], v[212:215], v[140:143], v[32:47]
    ds_read_b128 v[152:155], v12 offset:14336
    v_mfma_f32_32x32x16_bf16 v[48:63], a[68:71], v[136:139], v[48:63]
    s_lshl_b32 s30, s27, 6
    buffer_load_dwordx2 v[184:185], v3, s[80:83], s30 offen offset:0
    buffer_load_dwordx2 v[186:187], v3, s[80:83], s30 offen offset:16
    buffer_load_dwordx2 v[188:189], v3, s[80:83], s30 offen offset:32
    buffer_load_dwordx2 v[190:191], v3, s[80:83], s30 offen offset:48
    v_mfma_f32_32x32x16_bf16 v[64:79], a[68:71], v[140:143], v[64:79]
    v_mfma_f32_32x32x16_bf16 v[80:95], a[180:183], v[136:139], v[80:95]
    v_mfma_f32_32x32x16_bf16 v[96:111], a[180:183], v[140:143], v[96:111]
    s_waitcnt lgkmcnt(5)
    v_mfma_f32_32x32x16_bf16 v[112:127], v[156:159], v[136:139], v[112:127]
    v_mfma_f32_32x32x16_bf16 v[16:31], v[216:219], v[144:147], v[16:31]
    ds_read_b64_tr_b16 v[136:137], v4 offset:16384
    ds_read_b64_tr_b16 v[138:139], v4 offset:16896
    ds_read_b64_tr_b16 v[140:141], v5 offset:16384
    ds_read_b64_tr_b16 v[142:143], v5 offset:16896
    v_mfma_f32_32x32x16_bf16 v[32:47], v[216:219], v[148:151], v[32:47]
    ds_read_b128 v[156:159], v12 offset:15360
    v_mfma_f32_32x32x16_bf16 v[48:63], a[72:75], v[144:147], v[48:63]
    v_mfma_f32_32x32x16_bf16 v[64:79], a[72:75], v[148:151], v[64:79]
    v_mfma_f32_32x32x16_bf16 v[80:95], a[184:187], v[144:147], v[80:95]
    v_mfma_f32_32x32x16_bf16 v[96:111], a[184:187], v[148:151], v[96:111]
    s_waitcnt lgkmcnt(5)
    v_mfma_f32_32x32x16_bf16 v[112:127], v[152:155], v[144:147], v[112:127]
    v_mfma_f32_32x32x16_bf16 v[16:31], v[220:223], v[128:131], v[16:31]
    ds_read_b64_tr_b16 v[144:145], v4 offset:17408
    ds_read_b64_tr_b16 v[146:147], v4 offset:17920
    ds_read_b64_tr_b16 v[148:149], v5 offset:17408
    ds_read_b64_tr_b16 v[150:151], v5 offset:17920
    v_mfma_f32_32x32x16_bf16 v[32:47], v[220:223], v[132:135], v[32:47]
    ds_read_b128 v[152:155], v12 offset:16384
    v_mfma_f32_32x32x16_bf16 v[48:63], a[76:79], v[128:131], v[48:63]
    v_mfma_f32_32x32x16_bf16 v[64:79], a[76:79], v[132:135], v[64:79]
    v_mfma_f32_32x32x16_bf16 v[80:95], a[188:191], v[128:131], v[80:95]
    v_mfma_f32_32x32x16_bf16 v[96:111], a[188:191], v[132:135], v[96:111]
    s_waitcnt lgkmcnt(5)
    v_mfma_f32_32x32x16_bf16 v[112:127], v[156:159], v[128:131], v[112:127]
    v_mfma_f32_32x32x16_bf16 v[16:31], v[224:227], v[136:139], v[16:31]
    ds_read_b64_tr_b16 v[128:129], v4 offset:18432
    ds_read_b64_tr_b16 v[130:131], v4 offset:18944
    ds_read_b64_tr_b16 v[132:133], v5 offset:18432
    ds_read_b64_tr_b16 v[134:135], v5 offset:18944
    v_mfma_f32_32x32x16_bf16 v[32:47], v[224:227], v[140:143], v[32:47]
    ds_read_b128 v[156:159], v12 offset:17408
    v_mfma_f32_32x32x16_bf16 v[48:63], a[80:83], v[136:139], v[48:63]
    s_waitcnt vmcnt(15)
    v_lshlrev_b32 v192, 16, v160
    v_and_b32 v193, 0xffff0000, v160
    v_lshlrev_b32 v194, 16, v161
    v_and_b32 v195, 0xffff0000, v161
    v_mfma_f32_32x32x16_bf16 v[64:79], a[80:83], v[140:143], v[64:79]
    s_waitcnt vmcnt(14)
    v_lshlrev_b32 v196, 16, v162
    v_and_b32 v197, 0xffff0000, v162
    v_lshlrev_b32 v198, 16, v163
    v_and_b32 v199, 0xffff0000, v163
    v_mfma_f32_32x32x16_bf16 v[80:95], a[192:195], v[136:139], v[80:95]
    s_waitcnt vmcnt(13)
    v_lshlrev_b32 v200, 16, v164
    v_and_b32 v201, 0xffff0000, v164
    v_lshlrev_b32 v202, 16, v165
    v_and_b32 v203, 0xffff0000, v165
    v_mfma_f32_32x32x16_bf16 v[96:111], a[192:195], v[140:143], v[96:111]
    s_waitcnt vmcnt(12)
    v_lshlrev_b32 v204, 16, v166
    v_and_b32 v205, 0xffff0000, v166
    v_lshlrev_b32 v206, 16, v167
    v_and_b32 v207, 0xffff0000, v167
    s_waitcnt lgkmcnt(5)
    v_mfma_f32_32x32x16_bf16 v[112:127], v[152:155], v[136:139], v[112:127]
    v_mfma_f32_32x32x16_bf16 v[16:31], v[228:231], v[144:147], v[16:31]
    ds_read_b64_tr_b16 v[136:137], v4 offset:19456
    ds_read_b64_tr_b16 v[138:139], v4 offset:19968
    ds_read_b64_tr_b16 v[140:141], v5 offset:19456
    ds_read_b64_tr_b16 v[142:143], v5 offset:19968
    v_mfma_f32_32x32x16_bf16 v[32:47], v[228:231], v[148:151], v[32:47]
    ds_read_b128 v[152:155], v12 offset:18432
    v_mfma_f32_32x32x16_bf16 v[48:63], a[84:87], v[144:147], v[48:63]
    v_mfma_f32_32x32x16_bf16 v[64:79], a[84:87], v[148:151], v[64:79]
    v_mfma_f32_32x32x16_bf16 v[80:95], a[196:199], v[144:147], v[80:95]
    v_mfma_f32_32x32x16_bf16 v[96:111], a[196:199], v[148:151], v[96:111]
    s_waitcnt lgkmcnt(5)
    v_mfma_f32_32x32x16_bf16 v[112:127], v[156:159], v[144:147], v[112:127]
    v_mfma_f32_32x32x16_bf16 v[16:31], v[232:235], v[128:131], v[16:31]
    ds_read_b64_tr_b16 v[144:145], v4 offset:20480
    ds_read_b64_tr_b16 v[146:147], v4 offset:20992
    ds_read_b64_tr_b16 v[148:149], v5 offset:20480
    ds_read_b64_tr_b16 v[150:151], v5 offset:20992
    v_mfma_f32_32x32x16_bf16 v[32:47], v[232:235], v[132:135], v[32:47]
    ds_read_b128 v[156:159], v12 offset:19456
    v_mfma_f32_32x32x16_bf16 v[48:63], a[88:91], v[128:131], v[48:63]
    s_waitcnt vmcnt(11)
    v_lshlrev_b32 v208, 16, v168
    v_and_b32 v209, 0xffff0000, v168
    v_lshlrev_b32 v210, 16, v169
    v_and_b32 v211, 0xffff0000, v169
    v_mfma_f32_32x32x16_bf16 v[64:79], a[88:91], v[132:135], v[64:79]
    s_waitcnt vmcnt(10)
    v_lshlrev_b32 v212, 16, v170
    v_and_b32 v213, 0xffff0000, v170
    v_lshlrev_b32 v214, 16, v171
    v_and_b32 v215, 0xffff0000, v171
    v_mfma_f32_32x32x16_bf16 v[80:95], a[200:203], v[128:131], v[80:95]
    s_waitcnt vmcnt(9)
    v_lshlrev_b32 v216, 16, v172
    v_and_b32 v217, 0xffff0000, v172
    v_lshlrev_b32 v218, 16, v173
    v_and_b32 v219, 0xffff0000, v173
    v_mfma_f32_32x32x16_bf16 v[96:111], a[200:203], v[132:135], v[96:111]
    s_waitcnt vmcnt(8)
    v_lshlrev_b32 v220, 16, v174
    v_and_b32 v221, 0xffff0000, v174
    v_lshlrev_b32 v222, 16, v175
    v_and_b32 v223, 0xffff0000, v175
    s_waitcnt lgkmcnt(5)
    v_mfma_f32_32x32x16_bf16 v[112:127], v[152:155], v[128:131], v[112:127]
    v_mfma_f32_32x32x16_bf16 v[16:31], v[236:239], v[136:139], v[16:31]
    ds_read_b64_tr_b16 v[128:129], v4 offset:21504
    ds_read_b64_tr_b16 v[130:131], v4 offset:22016
    ds_read_b64_tr_b16 v[132:133], v5 offset:21504
    ds_read_b64_tr_b16 v[134:135], v5 offset:22016
    v_mfma_f32_32x32x16_bf16 v[32:47], v[236:239], v[140:143], v[32:47]
    ds_read_b128 v[152:155], v12 offset:20480
    v_mfma_f32_32x32x16_bf16 v[48:63], a[92:95], v[136:139], v[48:63]
    v_mfma_f32_32x32x16_bf16 v[64:79], a[92:95], v[140:143], v[64:79]
    v_mfma_f32_32x32x16_bf16 v[80:95], a[204:207], v[136:139], v[80:95]
    v_mfma_f32_32x32x16_bf16 v[96:111], a[204:207], v[140:143], v[96:111]
    s_waitcnt lgkmcnt(5)
    v_mfma_f32_32x32x16_bf16 v[112:127], v[156:159], v[136:139], v[112:127]
    v_mfma_f32_32x32x16_bf16 v[16:31], v[240:243], v[144:147], v[16:31]
    ds_read_b64_tr_b16 v[136:137], v4 offset:22528
    ds_read_b64_tr_b16 v[138:139], v4 offset:23040
    ds_read_b64_tr_b16 v[140:141], v5 offset:22528
    ds_read_b64_tr_b16 v[142:143], v5 offset:23040
    v_mfma_f32_32x32x16_bf16 v[32:47], v[240:243], v[148:151], v[32:47]
    ds_read_b128 v[156:159], v12 offset:21504
    v_mfma_f32_32x32x16_bf16 v[48:63], a[96:99], v[144:147], v[48:63]
    s_waitcnt vmcnt(7)
    v_lshlrev_b32 v224, 16, v176
    v_and_b32 v225, 0xffff0000, v176
    v_lshlrev_b32 v226, 16, v177
    v_and_b32 v227, 0xffff0000, v177
    v_mfma_f32_32x32x16_bf16 v[64:79], a[96:99], v[148:151], v[64:79]
    s_waitcnt vmcnt(6)
    v_lshlrev_b32 v228, 16, v178
    v_and_b32 v229, 0xffff0000, v178
    v_lshlrev_b32 v230, 16, v179
    v_and_b32 v231, 0xffff0000, v179
    v_mfma_f32_32x32x16_bf16 v[80:95], a[208:211], v[144:147], v[80:95]
    s_waitcnt vmcnt(5)
    v_lshlrev_b32 v232, 16, v180
    v_and_b32 v233, 0xffff0000, v180
    v_lshlrev_b32 v234, 16, v181
    v_and_b32 v235, 0xffff0000, v181
    v_mfma_f32_32x32x16_bf16 v[96:111], a[208:211], v[148:151], v[96:111]
    s_waitcnt vmcnt(4)
    v_lshlrev_b32 v236, 16, v182
    v_and_b32 v237, 0xffff0000, v182
    v_lshlrev_b32 v238, 16, v183
    v_and_b32 v239, 0xffff0000, v183
    s_waitcnt lgkmcnt(5)
    v_mfma_f32_32x32x16_bf16 v[112:127], v[152:155], v[144:147], v[112:127]
    v_mfma_f32_32x32x16_bf16 v[16:31], v[244:247], v[128:131], v[16:31]
    ds_read_b64_tr_b16 v[144:145], v4 offset:23552
    ds_read_b64_tr_b16 v[146:147], v4 offset:24064
    ds_read_b64_tr_b16 v[148:149], v5 offset:23552
    ds_read_b64_tr_b16 v[150:151], v5 offset:24064
    v_mfma_f32_32x32x16_bf16 v[32:47], v[244:247], v[132:135], v[32:47]
    ds_read_b128 v[152:155], v12 offset:22528
    v_mfma_f32_32x32x16_bf16 v[48:63], a[100:103], v[128:131], v[48:63]
    v_mfma_f32_32x32x16_bf16 v[64:79], a[100:103], v[132:135], v[64:79]
    v_mfma_f32_32x32x16_bf16 v[80:95], a[212:215], v[128:131], v[80:95]
    v_mfma_f32_32x32x16_bf16 v[96:111], a[212:215], v[132:135], v[96:111]
    s_waitcnt lgkmcnt(5)
    v_mfma_f32_32x32x16_bf16 v[112:127], v[156:159], v[128:131], v[112:127]
    v_mfma_f32_32x32x16_bf16 v[16:31], v[248:251], v[136:139], v[16:31]
    ds_read_b64_tr_b16 v[128:129], v4 offset:24576
    ds_read_b64_tr_b16 v[130:131], v4 offset:25088
    ds_read_b64_tr_b16 v[132:133], v5 offset:24576
    ds_read_b64_tr_b16 v[134:135], v5 offset:25088
    v_mfma_f32_32x32x16_bf16 v[32:47], v[248:251], v[140:143], v[32:47]
    ds_read_b128 v[156:159], v12 offset:23552
    v_mfma_f32_32x32x16_bf16 v[48:63], a[104:107], v[136:139], v[48:63]
    v_mfma_f32_32x32x16_bf16 v[64:79], a[104:107], v[140:143], v[64:79]
    v_mfma_f32_32x32x16_bf16 v[80:95], a[216:219], v[136:139], v[80:95]
    v_mfma_f32_32x32x16_bf16 v[96:111], a[216:219], v[140:143], v[96:111]
    s_waitcnt lgkmcnt(5)
    v_mfma_f32_32x32x16_bf16 v[112:127], v[152:155], v[136:139], v[112:127]
    v_mfma_f32_32x32x16_bf16 v[16:31], v[252:255], v[144:147], v[16:31]
    ds_read_b64_tr_b16 v[136:137], v4 offset:25600
    ds_read_b64_tr_b16 v[138:139], v4 offset:26112
    ds_read_b64_tr_b16 v[140:141], v5 offset:25600
    ds_read_b64_tr_b16 v[142:143], v5 offset:26112
    v_mfma_f32_32x32x16_bf16 v[32:47], v[252:255], v[148:151], v[32:47]
    ds_read_b128 v[152:155], v12 offset:24576
    v_mfma_f32_32x32x16_bf16 v[48:63], a[108:111], v[144:147], v[48:63]
    v_mfma_f32_32x32x16_bf16 v[64:79], a[108:111], v[148:151], v[64:79]
    v_mfma_f32_32x32x16_bf16 v[80:95], a[220:223], v[144:147], v[80:95]
    v_mfma_f32_32x32x16_bf16 v[96:111], a[220:223], v[148:151], v[96:111]
    s_waitcnt lgkmcnt(5)
    v_mfma_f32_32x32x16_bf16 v[112:127], v[156:159], v[144:147], v[112:127]
    v_mfma_f32_32x32x16_bf16 v[16:31], a[0:3], v[128:131], v[16:31]
    ds_read_b64_tr_b16 v[144:145], v4 offset:26624
    ds_read_b64_tr_b16 v[146:147], v4 offset:27136
    ds_read_b64_tr_b16 v[148:149], v5 offset:26624
    ds_read_b64_tr_b16 v[150:151], v5 offset:27136
    v_mfma_f32_32x32x16_bf16 v[32:47], a[0:3], v[132:135], v[32:47]
    ds_read_b128 v[156:159], v12 offset:25600
    v_mfma_f32_32x32x16_bf16 v[48:63], a[112:115], v[128:131], v[48:63]
    s_waitcnt vmcnt(3)
    v_lshlrev_b32 v240, 16, v184
    v_and_b32 v241, 0xffff0000, v184
    v_lshlrev_b32 v242, 16, v185
    v_and_b32 v243, 0xffff0000, v185
    v_mfma_f32_32x32x16_bf16 v[64:79], a[112:115], v[132:135], v[64:79]
    s_waitcnt vmcnt(2)
    v_lshlrev_b32 v244, 16, v186
    v_and_b32 v245, 0xffff0000, v186
    v_lshlrev_b32 v246, 16, v187
    v_and_b32 v247, 0xffff0000, v187
    v_mfma_f32_32x32x16_bf16 v[80:95], a[224:227], v[128:131], v[80:95]
    s_waitcnt vmcnt(1)
    v_lshlrev_b32 v248, 16, v188
    v_and_b32 v249, 0xffff0000, v188
    v_lshlrev_b32 v250, 16, v189
    v_and_b32 v251, 0xffff0000, v189
    v_mfma_f32_32x32x16_bf16 v[96:111], a[224:227], v[132:135], v[96:111]
    s_waitcnt vmcnt(0)
    v_lshlrev_b32 v252, 16, v190
    v_and_b32 v253, 0xffff0000, v190
    v_lshlrev_b32 v254, 16, v191
    v_and_b32 v255, 0xffff0000, v191
    s_waitcnt lgkmcnt(5)
    v_mfma_f32_32x32x16_bf16 v[112:127], v[152:155], v[128:131], v[112:127]
    v_mfma_f32_32x32x16_bf16 v[16:31], a[4:7], v[136:139], v[16:31]
    ds_read_b64_tr_b16 v[128:129], v4 offset:27648
    ds_read_b64_tr_b16 v[130:131], v4 offset:28160
    ds_read_b64_tr_b16 v[132:133], v5 offset:27648
    ds_read_b64_tr_b16 v[134:135], v5 offset:28160
    ds_read_b128 v[152:155], v12 offset:26624
    ds_read_b128 v[160:163], v12 offset:27648
    s_waitcnt lgkmcnt(9)
    v_mfma_f32_32x32x16_bf16 v[16:31], a[8:11], v[144:147], v[16:31]
    s_waitcnt lgkmcnt(4)
    v_mfma_f32_32x32x16_bf16 v[16:31], a[12:15], v[128:131], v[16:31]
    v_mfma_f32_32x32x16_bf16 v[32:47], a[4:7], v[140:143], v[32:47]
    v_mfma_f32_32x32x16_bf16 v[32:47], a[8:11], v[148:151], v[32:47]
    s_nop 9
    v_pk_add_f32 v[16:17], v[16:17], v[192:193]
    v_pk_add_f32 v[18:19], v[18:19], v[194:195]
    v_pk_add_f32 v[20:21], v[20:21], v[196:197]
    v_pk_add_f32 v[22:23], v[22:23], v[198:199]
    v_cvt_pk_bf16_f32 v16, v16, v17
    v_cvt_pk_bf16_f32 v17, v18, v19
    v_cvt_pk_bf16_f32 v18, v20, v21
    v_cvt_pk_bf16_f32 v19, v22, v23
    s_add_u32 s30, s26, 0
    s_lshl_b32 s30, s30, 11
    s_add_u32 s30, s30, s22
    buffer_store_dwordx4 v[16:19], v15, s[4:7], s30 offen offset:0 sc1
    s_waitcnt lgkmcnt(2)
    v_mfma_f32_32x32x16_bf16 v[32:47], a[12:15], v[132:135], v[32:47]
    v_pk_add_f32 v[24:25], v[24:25], v[200:201]
    v_pk_add_f32 v[26:27], v[26:27], v[202:203]
    v_pk_add_f32 v[28:29], v[28:29], v[204:205]
    v_pk_add_f32 v[30:31], v[30:31], v[206:207]
    v_cvt_pk_bf16_f32 v24, v24, v25
    v_cvt_pk_bf16_f32 v25, v26, v27
    v_cvt_pk_bf16_f32 v26, v28, v29
    v_cvt_pk_bf16_f32 v27, v30, v31
    buffer_store_dwordx4 v[24:27], v15, s[4:7], s30 offen offset:1024 sc1
    v_mfma_f32_32x32x16_bf16 v[48:63], a[116:119], v[136:139], v[48:63]
    v_mfma_f32_32x32x16_bf16 v[48:63], a[120:123], v[144:147], v[48:63]
    s_nop 0
    v_pk_add_f32 v[32:33], v[32:33], v[192:193]
    v_pk_add_f32 v[34:35], v[34:35], v[194:195]
    v_pk_add_f32 v[36:37], v[36:37], v[196:197]
    v_pk_add_f32 v[38:39], v[38:39], v[198:199]
    v_cvt_pk_bf16_f32 v32, v32, v33
    v_cvt_pk_bf16_f32 v33, v34, v35
    v_cvt_pk_bf16_f32 v34, v36, v37
    v_cvt_pk_bf16_f32 v35, v38, v39
    s_add_u32 s30, s26, 0
    s_lshl_b32 s30, s30, 11
    s_add_u32 s30, s30, s23
    buffer_store_dwordx4 v[32:35], v15, s[4:7], s30 offen offset:0 sc1
    v_mfma_f32_32x32x16_bf16 v[48:63], a[124:127], v[128:131], v[48:63]
    v_pk_add_f32 v[40:41], v[40:41], v[200:201]
    v_pk_add_f32 v[42:43], v[42:43], v[202:203]
    v_pk_add_f32 v[44:45], v[44:45], v[204:205]
    v_pk_add_f32 v[46:47], v[46:47], v[206:207]
    v_cvt_pk_bf16_f32 v40, v40, v41
    v_cvt_pk_bf16_f32 v41, v42, v43
    v_cvt_pk_bf16_f32 v42, v44, v45
    v_cvt_pk_bf16_f32 v43, v46, v47
    buffer_store_dwordx4 v[40:43], v15, s[4:7], s30 offen offset:1024 sc1
    v_mfma_f32_32x32x16_bf16 v[64:79], a[116:119], v[140:143], v[64:79]
    v_mfma_f32_32x32x16_bf16 v[64:79], a[120:123], v[148:151], v[64:79]
    s_nop 0
    v_pk_add_f32 v[48:49], v[48:49], v[208:209]
    v_pk_add_f32 v[50:51], v[50:51], v[210:211]
    v_pk_add_f32 v[52:53], v[52:53], v[212:213]
    v_pk_add_f32 v[54:55], v[54:55], v[214:215]
    v_cvt_pk_bf16_f32 v48, v48, v49
    v_cvt_pk_bf16_f32 v49, v50, v51
    v_cvt_pk_bf16_f32 v50, v52, v53
    v_cvt_pk_bf16_f32 v51, v54, v55
    s_add_u32 s30, s26, 1
    s_lshl_b32 s30, s30, 11
    s_add_u32 s30, s30, s22
    buffer_store_dwordx4 v[48:51], v15, s[4:7], s30 offen offset:0 sc1
    v_mfma_f32_32x32x16_bf16 v[64:79], a[124:127], v[132:135], v[64:79]
    v_pk_add_f32 v[56:57], v[56:57], v[216:217]
    v_pk_add_f32 v[58:59], v[58:59], v[218:219]
    v_pk_add_f32 v[60:61], v[60:61], v[220:221]
    v_pk_add_f32 v[62:63], v[62:63], v[222:223]
    v_cvt_pk_bf16_f32 v56, v56, v57
    v_cvt_pk_bf16_f32 v57, v58, v59
    v_cvt_pk_bf16_f32 v58, v60, v61
    v_cvt_pk_bf16_f32 v59, v62, v63
    buffer_store_dwordx4 v[56:59], v15, s[4:7], s30 offen offset:1024 sc1
    v_mfma_f32_32x32x16_bf16 v[80:95], a[228:231], v[136:139], v[80:95]
    v_mfma_f32_32x32x16_bf16 v[80:95], a[232:235], v[144:147], v[80:95]
    s_nop 0
    v_pk_add_f32 v[64:65], v[64:65], v[208:209]
    v_pk_add_f32 v[66:67], v[66:67], v[210:211]
    v_pk_add_f32 v[68:69], v[68:69], v[212:213]
    v_pk_add_f32 v[70:71], v[70:71], v[214:215]
    v_cvt_pk_bf16_f32 v64, v64, v65
    v_cvt_pk_bf16_f32 v65, v66, v67
    v_cvt_pk_bf16_f32 v66, v68, v69
    v_cvt_pk_bf16_f32 v67, v70, v71
    s_add_u32 s30, s26, 1
    s_lshl_b32 s30, s30, 11
    s_add_u32 s30, s30, s23
    buffer_store_dwordx4 v[64:67], v15, s[4:7], s30 offen offset:0 sc1
    v_mfma_f32_32x32x16_bf16 v[80:95], a[236:239], v[128:131], v[80:95]
    v_pk_add_f32 v[72:73], v[72:73], v[216:217]
    v_pk_add_f32 v[74:75], v[74:75], v[218:219]
    v_pk_add_f32 v[76:77], v[76:77], v[220:221]
    v_pk_add_f32 v[78:79], v[78:79], v[222:223]
    v_cvt_pk_bf16_f32 v72, v72, v73
    v_cvt_pk_bf16_f32 v73, v74, v75
    v_cvt_pk_bf16_f32 v74, v76, v77
    v_cvt_pk_bf16_f32 v75, v78, v79
    buffer_store_dwordx4 v[72:75], v15, s[4:7], s30 offen offset:1024 sc1
    v_mfma_f32_32x32x16_bf16 v[96:111], a[228:231], v[140:143], v[96:111]
    v_mfma_f32_32x32x16_bf16 v[96:111], a[232:235], v[148:151], v[96:111]
    s_nop 0
    v_pk_add_f32 v[80:81], v[80:81], v[224:225]
    v_pk_add_f32 v[82:83], v[82:83], v[226:227]
    v_pk_add_f32 v[84:85], v[84:85], v[228:229]
    v_pk_add_f32 v[86:87], v[86:87], v[230:231]
    v_cvt_pk_bf16_f32 v80, v80, v81
    v_cvt_pk_bf16_f32 v81, v82, v83
    v_cvt_pk_bf16_f32 v82, v84, v85
    v_cvt_pk_bf16_f32 v83, v86, v87
    s_add_u32 s30, s26, 2
    s_lshl_b32 s30, s30, 11
    s_add_u32 s30, s30, s22
    buffer_store_dwordx4 v[80:83], v15, s[4:7], s30 offen offset:0 sc1
    v_mfma_f32_32x32x16_bf16 v[96:111], a[236:239], v[132:135], v[96:111]
    v_pk_add_f32 v[88:89], v[88:89], v[232:233]
    v_pk_add_f32 v[90:91], v[90:91], v[234:235]
    v_pk_add_f32 v[92:93], v[92:93], v[236:237]
    v_pk_add_f32 v[94:95], v[94:95], v[238:239]
    v_cvt_pk_bf16_f32 v88, v88, v89
    v_cvt_pk_bf16_f32 v89, v90, v91
    v_cvt_pk_bf16_f32 v90, v92, v93
    v_cvt_pk_bf16_f32 v91, v94, v95
    buffer_store_dwordx4 v[88:91], v15, s[4:7], s30 offen offset:1024 sc1
    v_mfma_f32_32x32x16_bf16 v[112:127], v[156:159], v[136:139], v[112:127]
    s_waitcnt lgkmcnt(1)
    v_mfma_f32_32x32x16_bf16 v[112:127], v[152:155], v[144:147], v[112:127]
    v_pk_add_f32 v[96:97], v[96:97], v[224:225]
    v_pk_add_f32 v[98:99], v[98:99], v[226:227]
    v_pk_add_f32 v[100:101], v[100:101], v[228:229]
    v_pk_add_f32 v[102:103], v[102:103], v[230:231]
    v_cvt_pk_bf16_f32 v96, v96, v97
    v_cvt_pk_bf16_f32 v97, v98, v99
    v_cvt_pk_bf16_f32 v98, v100, v101
    v_cvt_pk_bf16_f32 v99, v102, v103
    s_add_u32 s30, s26, 2
    s_lshl_b32 s30, s30, 11
    s_add_u32 s30, s30, s23
    buffer_store_dwordx4 v[96:99], v15, s[4:7], s30 offen offset:0 sc1
    s_waitcnt lgkmcnt(0)
    v_mfma_f32_32x32x16_bf16 v[112:127], v[160:163], v[128:131], v[112:127]
    v_pk_add_f32 v[104:105], v[104:105], v[232:233]
    v_pk_add_f32 v[106:107], v[106:107], v[234:235]
    v_pk_add_f32 v[108:109], v[108:109], v[236:237]
    v_pk_add_f32 v[110:111], v[110:111], v[238:239]
    v_cvt_pk_bf16_f32 v104, v104, v105
    v_cvt_pk_bf16_f32 v105, v106, v107
    v_cvt_pk_bf16_f32 v106, v108, v109
    v_cvt_pk_bf16_f32 v107, v110, v111
    buffer_store_dwordx4 v[104:107], v15, s[4:7], s30 offen offset:1024 sc1
    s_nop 2
    v_pk_add_f32 v[112:113], v[112:113], v[240:241]
    v_pk_add_f32 v[114:115], v[114:115], v[242:243]
    v_pk_add_f32 v[116:117], v[116:117], v[244:245]
    v_pk_add_f32 v[118:119], v[118:119], v[246:247]
    v_cvt_pk_bf16_f32 v112, v112, v113
    v_cvt_pk_bf16_f32 v113, v114, v115
    v_cvt_pk_bf16_f32 v114, v116, v117
    v_cvt_pk_bf16_f32 v115, v118, v119
    s_lshl_b32 s30, s27, 11
    s_add_u32 s30, s30, s22
    buffer_store_dwordx4 v[112:115], v15, s[4:7], s30 offen offset:0 sc1
    v_pk_add_f32 v[120:121], v[120:121], v[248:249]
    v_pk_add_f32 v[122:123], v[122:123], v[250:251]
    v_pk_add_f32 v[124:125], v[124:125], v[252:253]
    v_pk_add_f32 v[126:127], v[126:127], v[254:255]
    v_cvt_pk_bf16_f32 v120, v120, v121
    v_cvt_pk_bf16_f32 v121, v122, v123
    v_cvt_pk_bf16_f32 v122, v124, v125
    v_cvt_pk_bf16_f32 v123, v126, v127
    buffer_store_dwordx4 v[120:123], v15, s[4:7], s30 offen offset:1024 sc1
    s_endpgm
R_hdbg:
    s_add_u32 s21, s21, 1
    s_cmp_gt_u32 s21, 4096
    s_cbranch_scc1 B_hdbg
    v_and_b32 v14, 0xf0, v15
    buffer_load_dword v14, v14, s[84:87], 0 offen sc1
    s_waitcnt vmcnt(0)
    v_cmp_eq_u32 vcc, 0, v14
    s_cbranch_vccnz R_hdbg
    s_branch B_hdbg
R_hg0:
    s_add_u32 s21, s21, 1
    s_cmp_gt_u32 s21, 4096
    s_cbranch_scc1 B_hg0
    s_sleep 3
    buffer_load_dword v4, v3, s[4:7], s22 offen sc1
    s_waitcnt vmcnt(0)
    v_cmp_eq_u32 vcc, -1, v4
    s_cbranch_vccnz R_hg0
    s_branch B_hg0
R_hx0_0:
    s_add_u32 s21, s21, 1
    s_cmp_gt_u32 s21, 4096
    s_cbranch_scc1 B_hx0_0
    s_add_u32 s23, s18, 2097152
    buffer_load_dwordx4 v[16:19], v15, s[4:7], s23 offen offset:0 sc1
    buffer_load_dwordx4 v[20:23], v15, s[4:7], s23 offen offset:1024 sc1
    buffer_load_dwordx4 v[24:27], v15, s[4:7], s23 offen offset:2048 sc1
    buffer_load_dwordx4 v[28:31], v15, s[4:7], s23 offen offset:3072 sc1
    s_waitcnt vmcnt(1)
    v_max3_u32 v14, v16, v20, v24
    s_waitcnt vmcnt(0)
    v_max_u32 v14, v14, v28
    v_cmp_eq_u32 vcc, -1, v14
    s_cbranch_vccnz R_hx0_0
    s_branch B_hx0_0
R_hx0_1:
    s_add_u32 s21, s21, 1
    s_cmp_gt_u32 s21, 4096
    s_cbranch_scc1 B_hx0_1
    s_add_u32 s23, s18, 2101248
    buffer_load_dwordx4 v[32:35], v15, s[4:7], s23 offen offset:0 sc1
    buffer_load_dwordx4 v[36:39], v15, s[4:7], s23 offen offset:1024 sc1
    buffer_load_dwordx4 v[40:43], v15, s[4:7], s23 offen offset:2048 sc1
    buffer_load_dwordx4 v[44:47], v15, s[4:7], s23 offen offset:3072 sc1
    s_waitcnt vmcnt(1)
    v_max3_u32 v14, v32, v36, v40
    s_waitcnt vmcnt(0)
    v_max_u32 v14, v14, v44
    v_cmp_eq_u32 vcc, -1, v14
    s_cbranch_vccnz R_hx0_1
    s_branch B_hx0_1
R_hx0_2:
    s_add_u32 s21, s21, 1
    s_cmp_gt_u32 s21, 4096
    s_cbranch_scc1 B_hx0_2
    s_add_u32 s23, s18, 2105344
    buffer_load_dwordx4 v[48:51], v15, s[4:7], s23 offen offset:0 sc1
    buffer_load_dwordx4 v[52:55], v15, s[4:7], s23 offen offset:1024 sc1
    buffer_load_dwordx4 v[56:59], v15, s[4:7], s23 offen offset:2048 sc1
    buffer_load_dwordx4 v[60:63], v15, s[4:7], s23 offen offset:3072 sc1
    s_waitcnt vmcnt(1)
    v_max3_u32 v14, v48, v52, v56
    s_waitcnt vmcnt(0)
    v_max_u32 v14, v14, v60
    v_cmp_eq_u32 vcc, -1, v14
    s_cbranch_vccnz R_hx0_2
    s_branch B_hx0_2
R_hx0_3:
    s_add_u32 s21, s21, 1
    s_cmp_gt_u32 s21, 4096
    s_cbranch_scc1 B_hx0_3
    s_add_u32 s23, s18, 2109440
    buffer_load_dwordx4 v[64:67], v15, s[4:7], s23 offen offset:0 sc1
    buffer_load_dwordx4 v[68:71], v15, s[4:7], s23 offen offset:1024 sc1
    s_waitcnt vmcnt(0)
    v_max_u32 v14, v64, v68
    v_cmp_eq_u32 vcc, -1, v14
    s_cbranch_vccnz R_hx0_3
    s_branch B_hx0_3
R_hg1:
    s_add_u32 s21, s21, 1
    s_cmp_gt_u32 s21, 4096
    s_cbranch_scc1 B_hg1
    s_sleep 3
    buffer_load_dword v4, v3, s[4:7], s22 offen sc1
    s_waitcnt vmcnt(0)
    v_cmp_eq_u32 vcc, -1, v4
    s_cbranch_vccnz R_hg1
    s_branch B_hg1
R_hx1_0:
    s_add_u32 s21, s21, 1
    s_cmp_gt_u32 s21, 4096
    s_cbranch_scc1 B_hx1_0
    s_add_u32 s23, s18, 5767168
    buffer_load_dwordx4 v[16:19], v15, s[4:7], s23 offen offset:0 sc1
    buffer_load_dwordx4 v[20:23], v15, s[4:7], s23 offen offset:1024 sc1
    buffer_load_dwordx4 v[24:27], v15, s[4:7], s23 offen offset:2048 sc1
    buffer_load_dwordx4 v[28:31], v15, s[4:7], s23 offen offset:3072 sc1
    s_waitcnt vmcnt(1)
    v_max3_u32 v14, v16, v20, v24
    s_waitcnt vmcnt(0)
    v_max_u32 v14, v14, v28
    v_cmp_eq_u32 vcc, -1, v14
    s_cbranch_vccnz R_hx1_0
    s_branch B_hx1_0
R_hx1_1:
    s_add_u32 s21, s21, 1
    s_cmp_gt_u32 s21, 4096
    s_cbranch_scc1 B_hx1_1
    s_add_u32 s23, s18, 5771264
    buffer_load_dwordx4 v[32:35], v15, s[4:7], s23 offen offset:0 sc1
    buffer_load_dwordx4 v[36:39], v15, s[4:7], s23 offen offset:1024 sc1
    buffer_load_dwordx4 v[40:43], v15, s[4:7], s23 offen offset:2048 sc1
    buffer_load_dwordx4 v[44:47], v15, s[4:7], s23 offen offset:3072 sc1
    s_waitcnt vmcnt(1)
    v_max3_u32 v14, v32, v36, v40
    s_waitcnt vmcnt(0)
    v_max_u32 v14, v14, v44
    v_cmp_eq_u32 vcc, -1, v14
    s_cbranch_vccnz R_hx1_1
    s_branch B_hx1_1
R_hx1_2:
    s_add_u32 s21, s21, 1
    s_cmp_gt_u32 s21, 4096
    s_cbranch_scc1 B_hx1_2
    s_add_u32 s23, s18, 5775360
    buffer_load_dwordx4 v[48:51], v15, s[4:7], s23 offen offset:0 sc1
    buffer_load_dwordx4 v[52:55], v15, s[4:7], s23 offen offset:1024 sc1
    buffer_load_dwordx4 v[56:59], v15, s[4:7], s23 offen offset:2048 sc1
    buffer_load_dwordx4 v[60:63], v15, s[4:7], s23 offen offset:3072 sc1
    s_waitcnt vmcnt(1)
    v_max3_u32 v14, v48, v52, v56
    s_waitcnt vmcnt(0)
    v_max_u32 v14, v14, v60
    v_cmp_eq_u32 vcc, -1, v14
    s_cbranch_vccnz R_hx1_2
    s_branch B_hx1_2
R_hx1_3:
    s_add_u32 s21, s21, 1
    s_cmp_gt_u32 s21, 4096
    s_cbranch_scc1 B_hx1_3
    s_add_u32 s23, s18, 5779456
    buffer_load_dwordx4 v[64:67], v15, s[4:7], s23 offen offset:0 sc1
    buffer_load_dwordx4 v[68:71], v15, s[4:7], s23 offen offset:1024 sc1
    s_waitcnt vmcnt(0)
    v_max_u32 v14, v64, v68
    v_cmp_eq_u32 vcc, -1, v14
    s_cbranch_vccnz R_hx1_3
    s_branch B_hx1_3

L_exit:
    s_endpgm
.section .rodata,"a"
.p2align 6
.amdhsa_kernel k_kernel
  .amdhsa_next_free_vgpr 512
  .amdhsa_next_free_sgpr 102
  .amdhsa_accum_offset 256
  .amdhsa_group_segment_fixed_size 0
  .amdhsa_kernarg_size 88
  .amdhsa_user_sgpr_count 2
  .amdhsa_user_sgpr_kernarg_segment_ptr 1
  .amdhsa_system_sgpr_workgroup_id_x 1
.end_amdhsa_kernel
```
